```python
import torch

def _softmax(x, axis=-1):
    return torch.softmax(x, dim=axis)
def _gelu(x):
    return torch.nn.functional.gelu(x, approximate="tanh")
def _silu(x):
    return torch.nn.functional.silu(x)
def _sigmoid(x):
    return torch.sigmoid(x)
def _layernorm(x, axis=-1, eps=1e-5):
    m = x.mean(dim=axis, keepdim=True)
    v = x.var(dim=axis, keepdim=True, unbiased=False)
    return (x - m) / torch.sqrt(v + eps)
def _scatter_add(tgt, idx, src, axis=0):
    return tgt.clone().index_add_(axis, idx, src)
def _segment_sum(src, seg, n):
    out = torch.zeros((n,) + src.shape[1:], dtype=src.dtype)
    return out.index_add_(0, seg, src)
def _pad(x, pw):
    flat = tuple(v for pair in reversed(pw) for v in pair)
    return torch.nn.functional.pad(x, flat)

kernel_name = 'concat_heads__mha_block_cached__gqa_block_cached__near_ridge'

def setup_inputs():

    _w = (lambda a: (lambda t: t.to(torch.bfloat16) if t.is_floating_point() else t)(torch.as_tensor(a)))
    def _A_setup():
        B, Sq, D = 16, 96, 448
        H, Sk, Dh = 16, 512, 256
        return {
            "x": _w((lambda *s: torch.randn(*s, dtype=torch.bfloat16) * 0.8)(B, Sq, D)),
            "k_cache": _w((lambda *s: torch.randn(*s, dtype=torch.bfloat16) * 0.8)(B, H, Sk, Dh)),
            "v_cache": _w((lambda *s: torch.randn(*s, dtype=torch.bfloat16) * 0.05)(B, H, Sk, Dh)),
            "wq": _w((lambda *s: torch.randn(*s, dtype=torch.bfloat16) * 0.8)(D, H * Dh) * (D ** -0.5)),
            "wo": _w((lambda *s: torch.randn(*s, dtype=torch.bfloat16) * 0.05)(H * Dh, D) * ((H * Dh) ** -0.5)),
        }
    _A_in = _A_setup()

    def _B_setup():
        B, Sq, D = 16, 96, 448
        Hq, Hkv, Sk, Dh = 16, 16, 512, 256
        assert Hq % Hkv == 0, (Hq, Hkv)
        return {
            "x": _w((lambda *s: torch.randn(*s, dtype=torch.bfloat16) * 0.8)(B, Sq, D)),
            "k_cache": _w((lambda *s: torch.randn(*s, dtype=torch.bfloat16) * 0.8)(B, Hkv, Sk, Dh)),
            "v_cache": _w((lambda *s: torch.randn(*s, dtype=torch.bfloat16) * 0.05)(B, Hkv, Sk, Dh)),
            "wq": _w((lambda *s: torch.randn(*s, dtype=torch.bfloat16) * 0.8)(D, Hq * Dh) * (D ** -0.5)),
            "wo": _w((lambda *s: torch.randn(*s, dtype=torch.bfloat16) * 0.05)(Hq * Dh, D) * ((Hq * Dh) ** -0.5)),
        }
    _B_in = _B_setup()

    return {
        "A_x": _A_in["x"],
        "A_k_cache": _A_in["k_cache"],
        "A_v_cache": _A_in["v_cache"],
        "A_wq": _A_in["wq"],
        "A_wo": _A_in["wo"],
        "B_x": _B_in["x"],
        "B_k_cache": _B_in["k_cache"],
        "B_v_cache": _B_in["v_cache"],
        "B_wq": _B_in["wq"],
        "B_wo": _B_in["wo"],
    }

def reference(A_x, A_k_cache, A_v_cache, A_wq, A_wo, B_x, B_k_cache, B_v_cache, B_wq, B_wo):
    def _A_ref(x, k_cache, v_cache, wq, wo):
        B, Sq, D = x.shape
        H, Dh = 16, 256
        q = (lambda x, *d: x.permute(*d))((x @ wq).reshape(B, Sq, H, Dh), 0, 2, 1, 3)
        scores = torch.einsum("bhqd,bhkd->bhqk", q, k_cache) * (Dh ** -0.5)
        p = _softmax(scores, axis=-1)
        o = torch.einsum("bhqk,bhkd->bhqd", p, v_cache)
        return (lambda x, *d: x.permute(*d))(o, 0, 2, 1, 3).reshape(B, Sq, H * Dh) @ wo

    def _B_ref(x, k_cache, v_cache, wq, wo):
        B, Sq, D = x.shape
        Hq, Dh = 16, 256
        Hkv = k_cache.shape[1]
        rep = Hq // Hkv
        q = (lambda x, *d: x.permute(*d))((x @ wq).reshape(B, Sq, Hq, Dh), 0, 2, 1, 3)
        k = (lambda x, n, axis: torch.repeat_interleave(x, n, dim=axis))(k_cache, rep, axis=1)
        v = (lambda x, n, axis: torch.repeat_interleave(x, n, dim=axis))(v_cache, rep, axis=1)
        scores = torch.einsum("bhqd,bhkd->bhqk", q, k) * (Dh ** -0.5)
        p = _softmax(scores, axis=-1)
        o = torch.einsum("bhqk,bhkd->bhqd", p, v)
        return (lambda x, *d: x.permute(*d))(o, 0, 2, 1, 3).reshape(B, Sq, Hq * Dh) @ wo

    a = _A_ref(A_x, A_k_cache, A_v_cache, A_wq, A_wo)
    b = _B_ref(B_x, B_k_cache, B_v_cache, B_wq, B_wo)
    return torch.concatenate([a, b], axis=-1)
```

```asm
; @launch grid=(256,1,1) block=(256,1,1) lds=163840
.amdgcn_target "amdgcn-amd-amdhsa--gfx950"
.text
.globl concat_heads__mha_block_cached__gqa_block_cached__near_ridge_kernel
.p2align 8
.type concat_heads__mha_block_cached__gqa_block_cached__near_ridge_kernel,@function
concat_heads__mha_block_cached__gqa_block_cached__near_ridge_kernel:
s_cmp_lt_u32 s2, 256
s_cbranch_scc1 L_start
s_endpgm
L_start:
s_load_dwordx16 s[64:79], s[0:1], 0
s_load_dwordx8 s[80:87], s[0:1], 64
s_load_dwordx2 s[88:89], s[0:1], 96
v_readfirstlane_b32 s3, v0
v_and_b32 v0, 63, v0
s_mov_b32 s93, s2
s_lshr_b32 s4, s2, 1
s_xor_b32 s5, s4, s2
s_and_b32 s4, s4, 3
s_and_b32 s5, s5, 1
s_lshl_b32 s5, s5, 2
s_andn2_b32 s2, s2, 7
s_or_b32 s4, s4, s5
s_or_b32 s2, s2, s4
s_and_b32 s41, s2, 3
s_bfe_u32 s40, s2, 0x10002
s_bfe_u32 s43, s2, 0x10003
s_lshr_b32 s42, s2, 4
s_lshr_b32 s3, s3, 6
s_lshl_b32 s45, s41, 1
s_add_u32 s45, s45, s43
s_lshl_b32 s44, s45, 1
s_cmp_eq_u32 s3, 3
s_cbranch_scc1 L_load
s_cmp_lg_u32 s3, 0
s_cbranch_scc1 L_comp
s_getpc_b64 s[90:91]
L_pc:
s_lshr_b32 s4, s2, 3
v_lshl_add_u32 v34, v0, 5, s4
v_lshlrev_b32 v34, 7, v34
v_min_u32 v34, L_code_end-L_pc-4, v34
global_load_dword v34, v34, s[90:91]
s_branch L_comp
L_load:
s_mul_i32 s4, s43, 3
s_add_u32 s4, s4, s42
s_mul_i32 s5, s41, 2
s_add_u32 s4, s4, s5
s_mul_i32 s5, s4, 37
s_lshr_b32 s5, s5, 8
s_mul_i32 s5, s5, 7
s_sub_u32 s4, s4, s5
s_mul_i32 s5, s42, 86016
s_lshl_b32 s6, s44, 9
v_lshrrev_b32 v1, 3, v0
v_mul_u32_u24 v2, 896, v1
v_and_b32 v3, 7, v0
v_lshrrev_b32 v4, 4, v0
v_xor_b32 v5, v3, v4
v_lshl_add_u32 v16, v5, 4, v2
v_xor_b32 v17, 64, v16
v_add_u32 v17, 6144, v17
v_add_u32 v18, 12288, v16
v_add_u32 v19, 12288, v17
v_lshrrev_b32 v6, 5, v0
v_and_b32 v7, 31, v0
v_lshlrev_b32 v8, 1, v6
v_xor_b32 v8, v8, v7
v_lshlrev_b32 v8, 4, v8
v_lshl_add_u32 v20, v6, 13, v8
v_xor_b32 v21, 64, v20
v_add_u32 v21, 15360, v21
v_xor_b32 v22, 128, v20
v_add_u32 v22, 63488, v22
v_xor_b32 v23, 192, v20
v_add_u32 v23, 78848, v23
s_lshl_b32 s7, s4, 7
s_add_u32 s48, s5, s7
s_lshl_b32 s7, s4, 19
s_add_u32 s56, s6, s7
s_add_u32 s4, s4, 1
s_cmp_eq_u32 s4, 7
s_cselect_b32 s4, 0, s4
s_mul_i32 s43, s42, 37
s_bfe_u32 s43, s43, 0x10008
s_lshl_b32 s43, s43, 18
s_bfe_u32 s7, s2, 65536
s_lshl_b32 s7, s7, 9
s_or_b32 s43, s43, s7
s_mov_b32 s10, 1376256
s_mov_b32 s11, 0x20000
s_mov_b32 s22, 3670016
s_mov_b32 s23, 0x20000
s_waitcnt lgkmcnt(0)
s_cmp_eq_u32 s40, 0
s_cselect_b64 s[8:9], s[64:65], s[74:75]
s_cselect_b64 s[20:21], s[70:71], s[80:81]
s_mov_b32 m0, 0
s_add_u32 s7, s48, 0
buffer_load_dwordx4 v16, s[8:11], s7 offen lds
buffer_load_dwordx4 v17, s[8:11], s7 offen offset:1024 lds
buffer_load_dwordx4 v18, s[8:11], s7 offen offset:2048 lds
buffer_load_dwordx4 v19, s[8:11], s7 offen offset:3072 lds
s_add_u32 m0, m0, 4096
s_add_u32 s7, s7, 28672
buffer_load_dwordx4 v16, s[8:11], s7 offen lds
buffer_load_dwordx4 v17, s[8:11], s7 offen offset:1024 lds
buffer_load_dwordx4 v18, s[8:11], s7 offen offset:2048 lds
buffer_load_dwordx4 v19, s[8:11], s7 offen offset:3072 lds
s_add_u32 m0, m0, 4096
s_add_u32 s7, s7, 28672
buffer_load_dwordx4 v16, s[8:11], s7 offen lds
buffer_load_dwordx4 v17, s[8:11], s7 offen offset:1024 lds
buffer_load_dwordx4 v18, s[8:11], s7 offen offset:2048 lds
buffer_load_dwordx4 v19, s[8:11], s7 offen offset:3072 lds
s_mov_b32 m0, 16384
s_add_u32 s7, s56, 0
s_xor_b32 s7, s7, s43
buffer_load_dwordx4 v20, s[20:23], s7 offen lds
buffer_load_dwordx4 v21, s[20:23], s7 offen offset:1024 lds
buffer_load_dwordx4 v22, s[20:23], s7 offen offset:2048 lds
buffer_load_dwordx4 v23, s[20:23], s7 offen offset:3072 lds
s_add_u32 m0, m0, 4096
s_add_u32 s7, s7, 131072
buffer_load_dwordx4 v20, s[20:23], s7 offen lds
buffer_load_dwordx4 v21, s[20:23], s7 offen offset:1024 lds
buffer_load_dwordx4 v22, s[20:23], s7 offen offset:2048 lds
buffer_load_dwordx4 v23, s[20:23], s7 offen offset:3072 lds
s_add_u32 m0, m0, 4096
s_sub_u32 s7, s7, 98304
buffer_load_dwordx4 v20, s[20:23], s7 offen lds
buffer_load_dwordx4 v21, s[20:23], s7 offen offset:1024 lds
buffer_load_dwordx4 v22, s[20:23], s7 offen offset:2048 lds
buffer_load_dwordx4 v23, s[20:23], s7 offen offset:3072 lds
s_add_u32 m0, m0, 4096
s_add_u32 s7, s7, 131072
buffer_load_dwordx4 v20, s[20:23], s7 offen lds
buffer_load_dwordx4 v21, s[20:23], s7 offen offset:1024 lds
buffer_load_dwordx4 v22, s[20:23], s7 offen offset:2048 lds
buffer_load_dwordx4 v23, s[20:23], s7 offen offset:3072 lds
s_getpc_b64 s[36:37]
L_tpl:
s_add_u32 s36, s36, L_tab-L_tpl
s_addc_u32 s37, s37, 0
s_mov_b32 s38, 1024
s_mov_b32 s39, 0x20000
s_mov_b32 s92, 4
s_barrier
s_mov_b32 m0, 14336
s_add_u32 s92, s92, 4
buffer_load_dword off, s[36:39], s92 lds
v_min_u32 v53, 2, v0
v_mul_u32_u24 v53, 260, v53
v_mov_b32 v54, 0
s_lshl_b32 s7, s4, 7
s_add_u32 s49, s5, s7
s_lshl_b32 s7, s4, 19
s_add_u32 s57, s6, s7
s_add_u32 s4, s4, 1
s_cmp_eq_u32 s4, 7
s_cselect_b32 s4, 0, s4
s_lshl_b32 s7, s4, 7
s_add_u32 s50, s5, s7
s_lshl_b32 s7, s4, 19
s_add_u32 s58, s6, s7
s_add_u32 s4, s4, 1
s_cmp_eq_u32 s4, 7
s_cselect_b32 s4, 0, s4
s_lshl_b32 s7, s4, 7
s_add_u32 s51, s5, s7
s_lshl_b32 s7, s4, 19
s_add_u32 s59, s6, s7
s_add_u32 s4, s4, 1
s_cmp_eq_u32 s4, 7
s_cselect_b32 s4, 0, s4
s_lshl_b32 s7, s4, 7
s_add_u32 s52, s5, s7
s_lshl_b32 s7, s4, 19
s_add_u32 s60, s6, s7
s_add_u32 s4, s4, 1
s_cmp_eq_u32 s4, 7
s_cselect_b32 s4, 0, s4
s_lshl_b32 s7, s4, 7
s_add_u32 s53, s5, s7
s_lshl_b32 s7, s4, 19
s_add_u32 s61, s6, s7
s_add_u32 s4, s4, 1
s_cmp_eq_u32 s4, 7
s_cselect_b32 s4, 0, s4
s_lshl_b32 s7, s4, 7
s_add_u32 s54, s5, s7
s_lshl_b32 s7, s4, 19
s_add_u32 s62, s6, s7
s_add_u32 s4, s4, 1
s_cmp_eq_u32 s4, 7
s_cselect_b32 s4, 0, s4
s_mov_b32 s14, 67108864
s_mov_b32 s15, 0x20000
s_mov_b32 s18, 67108864
s_mov_b32 s19, 0x20000
s_mov_b32 s26, 3670016
s_mov_b32 s27, 0x20000
s_mov_b32 s30, 285868032
s_mov_b32 s31, 0x20000
s_mov_b32 s34, 2752512
s_mov_b32 s35, 0x20000
s_cmp_eq_u32 s40, 0
s_cselect_b64 s[12:13], s[66:67], s[76:77]
s_cselect_b64 s[16:17], s[68:69], s[78:79]
s_cselect_b64 s[24:25], s[72:73], s[82:83]
s_mov_b64 s[28:29], s[88:89]
s_mov_b64 s[32:33], s[84:85]
s_and_b32 s46, s2, 7
s_lshl_b32 s46, s46, 5
s_lshr_b32 s7, s2, 3
s_add_u32 s46, s46, s7
s_lshl_b32 s47, s40, 4
s_add_u32 s47, s47, s42
s_mul_i32 s7, s42, 5248
s_add_u32 s7, s7, 22020096
s_add_u32 s72, s88, s7
s_addc_u32 s73, s89, 0
s_mov_b32 s71, 0
s_bfe_u32 s7, s93, 0x10002
s_mul_i32 s71, s7, 64
s_and_b32 s7, s93, 1
s_mul_i32 s7, s7, 56
s_add_u32 s71, s71, s7
s_add_u32 s71, s71, 96
s_lshl_b32 s63, s42, 4
s_add_u32 s63, s63, s44
s_lshl_b32 s63, s63, 18
s_mul_i32 s55, s44, 229376
s_bitcmp0_b32 s43, 9
s_cselect_b32 s7, 0, 262144
s_xor_b32 s63, s63, s7
s_xor_b32 s76, s63, 262144
s_bitcmp0_b32 s43, 9
s_cselect_b32 s7, 0, 229376
s_add_u32 s55, s55, s7
s_lshl_b32 s7, s7, 1
s_sub_u32 s77, 229376, s7
s_bitcmp0_b32 s43, 18
s_cselect_b32 s7, 0, 114688
s_add_u32 s55, s55, s7
s_lshl_b32 s7, s7, 1
s_sub_u32 s41, 114688, s7
s_mul_i32 s7, s42, 37
s_lshr_b32 s7, s7, 8
s_mul_i32 s7, s7, 7
s_sub_u32 s4, s42, s7
s_lshl_b32 s7, s4, 7
s_add_u32 s64, s55, s7
s_add_u32 s4, s4, 1
s_cmp_eq_u32 s4, 7
s_cselect_b32 s4, 0, s4
s_lshl_b32 s7, s4, 7
s_add_u32 s65, s55, s7
s_add_u32 s4, s4, 1
s_cmp_eq_u32 s4, 7
s_cselect_b32 s4, 0, s4
s_lshl_b32 s7, s4, 7
s_add_u32 s66, s55, s7
s_add_u32 s4, s4, 1
s_cmp_eq_u32 s4, 7
s_cselect_b32 s4, 0, s4
s_lshl_b32 s7, s4, 7
s_add_u32 s67, s55, s7
s_add_u32 s4, s4, 1
s_cmp_eq_u32 s4, 7
s_cselect_b32 s4, 0, s4
s_lshl_b32 s7, s4, 7
s_add_u32 s68, s55, s7
s_add_u32 s4, s4, 1
s_cmp_eq_u32 s4, 7
s_cselect_b32 s4, 0, s4
s_lshl_b32 s7, s4, 7
s_add_u32 s69, s55, s7
s_add_u32 s4, s4, 1
s_cmp_eq_u32 s4, 7
s_cselect_b32 s4, 0, s4
s_lshl_b32 s7, s4, 7
s_add_u32 s70, s55, s7
s_add_u32 s4, s4, 1
s_cmp_eq_u32 s4, 7
s_cselect_b32 s4, 0, s4
v_xor_b32 v9, v6, v7
v_lshlrev_b32 v9, 4, v9
v_lshl_add_u32 v24, v6, 9, v9
v_xor_b32 v25, 32, v24
v_xor_b32 v26, 64, v24
v_xor_b32 v27, 96, v24
v_xor_b32 v28, 128, v24
v_xor_b32 v29, 160, v24
v_xor_b32 v30, 192, v24
v_xor_b32 v31, 224, v24
v_lshl_add_u32 v32, v6, 9, v8
s_lshr_b32 s7, s43, 10
v_xor_b32 v32, s7, v32
v_xor_b32 v33, 64, v32
v_xor_b32 v34, 128, v32
v_xor_b32 v35, 192, v32
v_lshlrev_b32 v11, 1, v4
v_xor_b32 v11, v11, v3
v_lshl_add_u32 v44, v11, 4, v2
v_add_u32 v45, 6144, v44
v_add_u32 v46, 12288, v44
v_add_u32 v47, 18432, v44
s_mov_b32 s93, 0
s_mov_b32 m0, 32768
s_add_u32 s7, s56, 262144
s_xor_b32 s7, s7, s43
s_waitcnt vmcnt(32)
buffer_load_dwordx4 v20, s[20:23], s7 offen lds
buffer_load_dwordx4 v21, s[20:23], s7 offen offset:1024 lds
buffer_load_dwordx4 v22, s[20:23], s7 offen offset:2048 lds
buffer_load_dwordx4 v23, s[20:23], s7 offen offset:3072 lds
s_add_u32 m0, m0, 4096
s_add_u32 s7, s7, 131072
s_waitcnt vmcnt(32)
buffer_load_dwordx4 v20, s[20:23], s7 offen lds
buffer_load_dwordx4 v21, s[20:23], s7 offen offset:1024 lds
buffer_load_dwordx4 v22, s[20:23], s7 offen offset:2048 lds
buffer_load_dwordx4 v23, s[20:23], s7 offen offset:3072 lds
s_add_u32 m0, m0, 4096
s_sub_u32 s7, s7, 98304
s_waitcnt vmcnt(32)
buffer_load_dwordx4 v20, s[20:23], s7 offen lds
buffer_load_dwordx4 v21, s[20:23], s7 offen offset:1024 lds
buffer_load_dwordx4 v22, s[20:23], s7 offen offset:2048 lds
buffer_load_dwordx4 v23, s[20:23], s7 offen offset:3072 lds
s_add_u32 m0, m0, 4096
s_add_u32 s7, s7, 131072
s_waitcnt vmcnt(32)
buffer_load_dwordx4 v20, s[20:23], s7 offen lds
buffer_load_dwordx4 v21, s[20:23], s7 offen offset:1024 lds
buffer_load_dwordx4 v22, s[20:23], s7 offen offset:2048 lds
buffer_load_dwordx4 v23, s[20:23], s7 offen offset:3072 lds
s_mov_b32 m0, 14336
s_add_u32 s92, s92, 4
buffer_load_dword off, s[36:39], s92 lds
s_mov_b32 m0, 49152
s_add_u32 s7, s49, 0
s_waitcnt vmcnt(32)
buffer_load_dwordx4 v16, s[8:11], s7 offen lds
buffer_load_dwordx4 v17, s[8:11], s7 offen offset:1024 lds
buffer_load_dwordx4 v18, s[8:11], s7 offen offset:2048 lds
buffer_load_dwordx4 v19, s[8:11], s7 offen offset:3072 lds
s_add_u32 m0, m0, 4096
s_add_u32 s7, s7, 28672
s_waitcnt vmcnt(32)
buffer_load_dwordx4 v16, s[8:11], s7 offen lds
buffer_load_dwordx4 v17, s[8:11], s7 offen offset:1024 lds
buffer_load_dwordx4 v18, s[8:11], s7 offen offset:2048 lds
buffer_load_dwordx4 v19, s[8:11], s7 offen offset:3072 lds
s_add_u32 m0, m0, 4096
s_add_u32 s7, s7, 28672
s_waitcnt vmcnt(32)
buffer_load_dwordx4 v16, s[8:11], s7 offen lds
buffer_load_dwordx4 v17, s[8:11], s7 offen offset:1024 lds
buffer_load_dwordx4 v18, s[8:11], s7 offen offset:2048 lds
buffer_load_dwordx4 v19, s[8:11], s7 offen offset:3072 lds
s_mov_b32 m0, 14336
s_add_u32 s92, s92, 4
buffer_load_dword off, s[36:39], s92 lds
s_mov_b32 m0, 65536
s_add_u32 s7, s50, 0
s_waitcnt vmcnt(32)
buffer_load_dwordx4 v16, s[8:11], s7 offen lds
buffer_load_dwordx4 v17, s[8:11], s7 offen offset:1024 lds
buffer_load_dwordx4 v18, s[8:11], s7 offen offset:2048 lds
buffer_load_dwordx4 v19, s[8:11], s7 offen offset:3072 lds
s_add_u32 m0, m0, 4096
s_add_u32 s7, s7, 28672
s_waitcnt vmcnt(32)
buffer_load_dwordx4 v16, s[8:11], s7 offen lds
buffer_load_dwordx4 v17, s[8:11], s7 offen offset:1024 lds
buffer_load_dwordx4 v18, s[8:11], s7 offen offset:2048 lds
buffer_load_dwordx4 v19, s[8:11], s7 offen offset:3072 lds
s_add_u32 m0, m0, 4096
s_add_u32 s7, s7, 28672
s_waitcnt vmcnt(32)
buffer_load_dwordx4 v16, s[8:11], s7 offen lds
buffer_load_dwordx4 v17, s[8:11], s7 offen offset:1024 lds
buffer_load_dwordx4 v18, s[8:11], s7 offen offset:2048 lds
buffer_load_dwordx4 v19, s[8:11], s7 offen offset:3072 lds
s_mov_b32 m0, 14336
s_add_u32 s92, s92, 4
buffer_load_dword off, s[36:39], s92 lds
s_mov_b32 m0, 81920
s_add_u32 s7, s57, 0
s_xor_b32 s7, s7, s43
s_waitcnt vmcnt(32)
buffer_load_dwordx4 v20, s[20:23], s7 offen lds
buffer_load_dwordx4 v21, s[20:23], s7 offen offset:1024 lds
buffer_load_dwordx4 v22, s[20:23], s7 offen offset:2048 lds
buffer_load_dwordx4 v23, s[20:23], s7 offen offset:3072 lds
s_add_u32 m0, m0, 4096
s_add_u32 s7, s7, 131072
s_waitcnt vmcnt(32)
buffer_load_dwordx4 v20, s[20:23], s7 offen lds
buffer_load_dwordx4 v21, s[20:23], s7 offen offset:1024 lds
buffer_load_dwordx4 v22, s[20:23], s7 offen offset:2048 lds
buffer_load_dwordx4 v23, s[20:23], s7 offen offset:3072 lds
s_add_u32 m0, m0, 4096
s_sub_u32 s7, s7, 98304
s_waitcnt vmcnt(32)
buffer_load_dwordx4 v20, s[20:23], s7 offen lds
buffer_load_dwordx4 v21, s[20:23], s7 offen offset:1024 lds
buffer_load_dwordx4 v22, s[20:23], s7 offen offset:2048 lds
buffer_load_dwordx4 v23, s[20:23], s7 offen offset:3072 lds
s_add_u32 m0, m0, 4096
s_add_u32 s7, s7, 131072
s_waitcnt vmcnt(32)
buffer_load_dwordx4 v20, s[20:23], s7 offen lds
buffer_load_dwordx4 v21, s[20:23], s7 offen offset:1024 lds
buffer_load_dwordx4 v22, s[20:23], s7 offen offset:2048 lds
buffer_load_dwordx4 v23, s[20:23], s7 offen offset:3072 lds
s_mov_b32 m0, 14336
s_add_u32 s92, s92, 4
buffer_load_dword off, s[36:39], s92 lds
s_mov_b32 m0, 98304
s_add_u32 s7, s57, 262144
s_xor_b32 s7, s7, s43
s_waitcnt vmcnt(32)
buffer_load_dwordx4 v20, s[20:23], s7 offen lds
buffer_load_dwordx4 v21, s[20:23], s7 offen offset:1024 lds
buffer_load_dwordx4 v22, s[20:23], s7 offen offset:2048 lds
buffer_load_dwordx4 v23, s[20:23], s7 offen offset:3072 lds
s_add_u32 m0, m0, 4096
s_add_u32 s7, s7, 131072
s_waitcnt vmcnt(32)
buffer_load_dwordx4 v20, s[20:23], s7 offen lds
buffer_load_dwordx4 v21, s[20:23], s7 offen offset:1024 lds
buffer_load_dwordx4 v22, s[20:23], s7 offen offset:2048 lds
buffer_load_dwordx4 v23, s[20:23], s7 offen offset:3072 lds
s_add_u32 m0, m0, 4096
s_sub_u32 s7, s7, 98304
s_waitcnt vmcnt(32)
buffer_load_dwordx4 v20, s[20:23], s7 offen lds
buffer_load_dwordx4 v21, s[20:23], s7 offen offset:1024 lds
buffer_load_dwordx4 v22, s[20:23], s7 offen offset:2048 lds
buffer_load_dwordx4 v23, s[20:23], s7 offen offset:3072 lds
s_add_u32 m0, m0, 4096
s_add_u32 s7, s7, 131072
s_waitcnt vmcnt(32)
buffer_load_dwordx4 v20, s[20:23], s7 offen lds
buffer_load_dwordx4 v21, s[20:23], s7 offen offset:1024 lds
buffer_load_dwordx4 v22, s[20:23], s7 offen offset:2048 lds
buffer_load_dwordx4 v23, s[20:23], s7 offen offset:3072 lds
s_mov_b32 m0, 14336
s_add_u32 s92, s92, 4
buffer_load_dword off, s[36:39], s92 lds
s_mov_b32 m0, 114688
s_add_u32 s7, s58, 0
s_xor_b32 s7, s7, s43
s_waitcnt vmcnt(32)
buffer_load_dwordx4 v20, s[20:23], s7 offen lds
buffer_load_dwordx4 v21, s[20:23], s7 offen offset:1024 lds
buffer_load_dwordx4 v22, s[20:23], s7 offen offset:2048 lds
buffer_load_dwordx4 v23, s[20:23], s7 offen offset:3072 lds
s_add_u32 m0, m0, 4096
s_add_u32 s7, s7, 131072
s_waitcnt vmcnt(32)
buffer_load_dwordx4 v20, s[20:23], s7 offen lds
buffer_load_dwordx4 v21, s[20:23], s7 offen offset:1024 lds
buffer_load_dwordx4 v22, s[20:23], s7 offen offset:2048 lds
buffer_load_dwordx4 v23, s[20:23], s7 offen offset:3072 lds
s_add_u32 m0, m0, 4096
s_sub_u32 s7, s7, 98304
s_waitcnt vmcnt(32)
buffer_load_dwordx4 v20, s[20:23], s7 offen lds
buffer_load_dwordx4 v21, s[20:23], s7 offen offset:1024 lds
buffer_load_dwordx4 v22, s[20:23], s7 offen offset:2048 lds
buffer_load_dwordx4 v23, s[20:23], s7 offen offset:3072 lds
s_add_u32 m0, m0, 4096
s_add_u32 s7, s7, 131072
s_waitcnt vmcnt(32)
buffer_load_dwordx4 v20, s[20:23], s7 offen lds
buffer_load_dwordx4 v21, s[20:23], s7 offen offset:1024 lds
buffer_load_dwordx4 v22, s[20:23], s7 offen offset:2048 lds
buffer_load_dwordx4 v23, s[20:23], s7 offen offset:3072 lds
s_mov_b32 m0, 14336
s_add_u32 s92, s92, 4
buffer_load_dword off, s[36:39], s92 lds
s_mov_b32 m0, 131072
s_add_u32 s7, s51, 0
s_waitcnt vmcnt(32)
buffer_load_dwordx4 v16, s[8:11], s7 offen lds
buffer_load_dwordx4 v17, s[8:11], s7 offen offset:1024 lds
buffer_load_dwordx4 v18, s[8:11], s7 offen offset:2048 lds
buffer_load_dwordx4 v19, s[8:11], s7 offen offset:3072 lds
s_add_u32 m0, m0, 4096
s_add_u32 s7, s7, 28672
s_waitcnt vmcnt(32)
buffer_load_dwordx4 v16, s[8:11], s7 offen lds
buffer_load_dwordx4 v17, s[8:11], s7 offen offset:1024 lds
buffer_load_dwordx4 v18, s[8:11], s7 offen offset:2048 lds
buffer_load_dwordx4 v19, s[8:11], s7 offen offset:3072 lds
s_add_u32 m0, m0, 4096
s_add_u32 s7, s7, 28672
s_waitcnt vmcnt(32)
buffer_load_dwordx4 v16, s[8:11], s7 offen lds
buffer_load_dwordx4 v17, s[8:11], s7 offen offset:1024 lds
buffer_load_dwordx4 v18, s[8:11], s7 offen offset:2048 lds
buffer_load_dwordx4 v19, s[8:11], s7 offen offset:3072 lds
s_mov_b32 m0, 14336
s_add_u32 s92, s92, 4
buffer_load_dword off, s[36:39], s92 lds
s_mov_b32 m0, 147456
s_add_u32 s7, s58, 262144
s_xor_b32 s7, s7, s43
s_waitcnt vmcnt(32)
buffer_load_dwordx4 v20, s[20:23], s7 offen lds
buffer_load_dwordx4 v21, s[20:23], s7 offen offset:1024 lds
buffer_load_dwordx4 v22, s[20:23], s7 offen offset:2048 lds
buffer_load_dwordx4 v23, s[20:23], s7 offen offset:3072 lds
s_add_u32 m0, m0, 4096
s_add_u32 s7, s7, 131072
s_waitcnt vmcnt(32)
buffer_load_dwordx4 v20, s[20:23], s7 offen lds
buffer_load_dwordx4 v21, s[20:23], s7 offen offset:1024 lds
buffer_load_dwordx4 v22, s[20:23], s7 offen offset:2048 lds
buffer_load_dwordx4 v23, s[20:23], s7 offen offset:3072 lds
s_add_u32 m0, m0, 4096
s_sub_u32 s7, s7, 98304
ds_read_b32 v54, v53 offset:15360
s_waitcnt vmcnt(32)
buffer_load_dwordx4 v20, s[20:23], s7 offen lds
buffer_load_dwordx4 v21, s[20:23], s7 offen offset:1024 lds
buffer_load_dwordx4 v22, s[20:23], s7 offen offset:2048 lds
buffer_load_dwordx4 v23, s[20:23], s7 offen offset:3072 lds
s_add_u32 m0, m0, 4096
s_add_u32 s7, s7, 131072
v_cmp_gt_u32 vcc, 1, v54
s_waitcnt vmcnt(32)
buffer_load_dwordx4 v20, s[20:23], s7 offen lds
buffer_load_dwordx4 v21, s[20:23], s7 offen offset:1024 lds
buffer_load_dwordx4 v22, s[20:23], s7 offen offset:2048 lds
buffer_load_dwordx4 v23, s[20:23], s7 offen offset:3072 lds
s_mov_b32 m0, 14336
s_add_u32 s92, s92, 4
buffer_load_dword off, s[36:39], s92 lds
s_cbranch_vccnz L_iw10
L_ig10:
s_mov_b32 m0, 16384
s_add_u32 s7, s59, 0
s_xor_b32 s7, s7, s43
s_waitcnt vmcnt(32)
buffer_load_dwordx4 v20, s[20:23], s7 offen lds
buffer_load_dwordx4 v21, s[20:23], s7 offen offset:1024 lds
buffer_load_dwordx4 v22, s[20:23], s7 offen offset:2048 lds
buffer_load_dwordx4 v23, s[20:23], s7 offen offset:3072 lds
s_add_u32 m0, m0, 4096
s_add_u32 s7, s7, 131072
s_waitcnt vmcnt(32)
buffer_load_dwordx4 v20, s[20:23], s7 offen lds
buffer_load_dwordx4 v21, s[20:23], s7 offen offset:1024 lds
buffer_load_dwordx4 v22, s[20:23], s7 offen offset:2048 lds
buffer_load_dwordx4 v23, s[20:23], s7 offen offset:3072 lds
s_add_u32 m0, m0, 4096
s_sub_u32 s7, s7, 98304
s_waitcnt vmcnt(32)
buffer_load_dwordx4 v20, s[20:23], s7 offen lds
buffer_load_dwordx4 v21, s[20:23], s7 offen offset:1024 lds
buffer_load_dwordx4 v22, s[20:23], s7 offen offset:2048 lds
buffer_load_dwordx4 v23, s[20:23], s7 offen offset:3072 lds
s_add_u32 m0, m0, 4096
s_add_u32 s7, s7, 131072
s_waitcnt vmcnt(32)
buffer_load_dwordx4 v20, s[20:23], s7 offen lds
buffer_load_dwordx4 v21, s[20:23], s7 offen offset:1024 lds
buffer_load_dwordx4 v22, s[20:23], s7 offen offset:2048 lds
buffer_load_dwordx4 v23, s[20:23], s7 offen offset:3072 lds
s_mov_b32 m0, 14336
s_add_u32 s92, s92, 4
buffer_load_dword off, s[36:39], s92 lds
s_mov_b32 m0, 0
s_add_u32 s7, s52, 0
s_waitcnt vmcnt(32)
buffer_load_dwordx4 v16, s[8:11], s7 offen lds
buffer_load_dwordx4 v17, s[8:11], s7 offen offset:1024 lds
buffer_load_dwordx4 v18, s[8:11], s7 offen offset:2048 lds
buffer_load_dwordx4 v19, s[8:11], s7 offen offset:3072 lds
s_add_u32 m0, m0, 4096
s_add_u32 s7, s7, 28672
ds_read_b32 v54, v53 offset:15360
s_waitcnt vmcnt(32)
buffer_load_dwordx4 v16, s[8:11], s7 offen lds
buffer_load_dwordx4 v17, s[8:11], s7 offen offset:1024 lds
buffer_load_dwordx4 v18, s[8:11], s7 offen offset:2048 lds
buffer_load_dwordx4 v19, s[8:11], s7 offen offset:3072 lds
s_add_u32 m0, m0, 4096
s_add_u32 s7, s7, 28672
v_cmp_gt_u32 vcc, 2, v54
s_waitcnt vmcnt(32)
buffer_load_dwordx4 v16, s[8:11], s7 offen lds
buffer_load_dwordx4 v17, s[8:11], s7 offen offset:1024 lds
buffer_load_dwordx4 v18, s[8:11], s7 offen offset:2048 lds
buffer_load_dwordx4 v19, s[8:11], s7 offen offset:3072 lds
s_mov_b32 m0, 14336
s_add_u32 s92, s92, 4
buffer_load_dword off, s[36:39], s92 lds
s_cbranch_vccnz L_iw12
L_ig12:
s_mov_b32 m0, 32768
s_add_u32 s7, s59, 262144
s_xor_b32 s7, s7, s43
s_waitcnt vmcnt(32)
buffer_load_dwordx4 v20, s[20:23], s7 offen lds
buffer_load_dwordx4 v21, s[20:23], s7 offen offset:1024 lds
buffer_load_dwordx4 v22, s[20:23], s7 offen offset:2048 lds
buffer_load_dwordx4 v23, s[20:23], s7 offen offset:3072 lds
s_add_u32 m0, m0, 4096
s_add_u32 s7, s7, 131072
s_waitcnt vmcnt(32)
buffer_load_dwordx4 v20, s[20:23], s7 offen lds
buffer_load_dwordx4 v21, s[20:23], s7 offen offset:1024 lds
buffer_load_dwordx4 v22, s[20:23], s7 offen offset:2048 lds
buffer_load_dwordx4 v23, s[20:23], s7 offen offset:3072 lds
s_add_u32 m0, m0, 4096
s_sub_u32 s7, s7, 98304
ds_read_b32 v54, v53 offset:15360
s_waitcnt vmcnt(32)
buffer_load_dwordx4 v20, s[20:23], s7 offen lds
buffer_load_dwordx4 v21, s[20:23], s7 offen offset:1024 lds
buffer_load_dwordx4 v22, s[20:23], s7 offen offset:2048 lds
buffer_load_dwordx4 v23, s[20:23], s7 offen offset:3072 lds
s_add_u32 m0, m0, 4096
s_add_u32 s7, s7, 131072
v_cmp_gt_u32 vcc, 3, v54
s_waitcnt vmcnt(32)
buffer_load_dwordx4 v20, s[20:23], s7 offen lds
buffer_load_dwordx4 v21, s[20:23], s7 offen offset:1024 lds
buffer_load_dwordx4 v22, s[20:23], s7 offen offset:2048 lds
buffer_load_dwordx4 v23, s[20:23], s7 offen offset:3072 lds
s_mov_b32 m0, 14336
s_add_u32 s92, s92, 4
buffer_load_dword off, s[36:39], s92 lds
s_cbranch_vccnz L_iw13
L_ig13:
s_mov_b32 m0, 49152
s_add_u32 s7, s60, 0
s_xor_b32 s7, s7, s43
s_waitcnt vmcnt(32)
buffer_load_dwordx4 v20, s[20:23], s7 offen lds
buffer_load_dwordx4 v21, s[20:23], s7 offen offset:1024 lds
buffer_load_dwordx4 v22, s[20:23], s7 offen offset:2048 lds
buffer_load_dwordx4 v23, s[20:23], s7 offen offset:3072 lds
s_add_u32 m0, m0, 4096
s_add_u32 s7, s7, 131072
s_waitcnt vmcnt(32)
buffer_load_dwordx4 v20, s[20:23], s7 offen lds
buffer_load_dwordx4 v21, s[20:23], s7 offen offset:1024 lds
buffer_load_dwordx4 v22, s[20:23], s7 offen offset:2048 lds
buffer_load_dwordx4 v23, s[20:23], s7 offen offset:3072 lds
s_add_u32 m0, m0, 4096
s_sub_u32 s7, s7, 98304
s_waitcnt vmcnt(32)
buffer_load_dwordx4 v20, s[20:23], s7 offen lds
buffer_load_dwordx4 v21, s[20:23], s7 offen offset:1024 lds
buffer_load_dwordx4 v22, s[20:23], s7 offen offset:2048 lds
buffer_load_dwordx4 v23, s[20:23], s7 offen offset:3072 lds
s_add_u32 m0, m0, 4096
s_add_u32 s7, s7, 131072
s_waitcnt vmcnt(32)
buffer_load_dwordx4 v20, s[20:23], s7 offen lds
buffer_load_dwordx4 v21, s[20:23], s7 offen offset:1024 lds
buffer_load_dwordx4 v22, s[20:23], s7 offen offset:2048 lds
buffer_load_dwordx4 v23, s[20:23], s7 offen offset:3072 lds
s_mov_b32 m0, 14336
s_add_u32 s92, s92, 4
buffer_load_dword off, s[36:39], s92 lds
s_mov_b32 m0, 65536
s_add_u32 s7, s53, 0
s_waitcnt vmcnt(32)
buffer_load_dwordx4 v16, s[8:11], s7 offen lds
buffer_load_dwordx4 v17, s[8:11], s7 offen offset:1024 lds
buffer_load_dwordx4 v18, s[8:11], s7 offen offset:2048 lds
buffer_load_dwordx4 v19, s[8:11], s7 offen offset:3072 lds
s_add_u32 m0, m0, 4096
s_add_u32 s7, s7, 28672
s_waitcnt vmcnt(32)
buffer_load_dwordx4 v16, s[8:11], s7 offen lds
buffer_load_dwordx4 v17, s[8:11], s7 offen offset:1024 lds
buffer_load_dwordx4 v18, s[8:11], s7 offen offset:2048 lds
buffer_load_dwordx4 v19, s[8:11], s7 offen offset:3072 lds
s_add_u32 m0, m0, 4096
s_add_u32 s7, s7, 28672
s_waitcnt vmcnt(32)
buffer_load_dwordx4 v16, s[8:11], s7 offen lds
buffer_load_dwordx4 v17, s[8:11], s7 offen offset:1024 lds
buffer_load_dwordx4 v18, s[8:11], s7 offen offset:2048 lds
buffer_load_dwordx4 v19, s[8:11], s7 offen offset:3072 lds
s_mov_b32 m0, 14336
s_add_u32 s92, s92, 4
buffer_load_dword off, s[36:39], s92 lds
s_mov_b32 m0, 81920
s_add_u32 s7, s60, 262144
s_xor_b32 s7, s7, s43
s_waitcnt vmcnt(32)
buffer_load_dwordx4 v20, s[20:23], s7 offen lds
buffer_load_dwordx4 v21, s[20:23], s7 offen offset:1024 lds
buffer_load_dwordx4 v22, s[20:23], s7 offen offset:2048 lds
buffer_load_dwordx4 v23, s[20:23], s7 offen offset:3072 lds
s_add_u32 m0, m0, 4096
s_add_u32 s7, s7, 131072
s_waitcnt vmcnt(32)
buffer_load_dwordx4 v20, s[20:23], s7 offen lds
buffer_load_dwordx4 v21, s[20:23], s7 offen offset:1024 lds
buffer_load_dwordx4 v22, s[20:23], s7 offen offset:2048 lds
buffer_load_dwordx4 v23, s[20:23], s7 offen offset:3072 lds
s_add_u32 m0, m0, 4096
s_sub_u32 s7, s7, 98304
ds_read_b32 v54, v53 offset:15360
s_waitcnt vmcnt(32)
buffer_load_dwordx4 v20, s[20:23], s7 offen lds
buffer_load_dwordx4 v21, s[20:23], s7 offen offset:1024 lds
buffer_load_dwordx4 v22, s[20:23], s7 offen offset:2048 lds
buffer_load_dwordx4 v23, s[20:23], s7 offen offset:3072 lds
s_add_u32 m0, m0, 4096
s_add_u32 s7, s7, 131072
v_cmp_gt_u32 vcc, 4, v54
s_waitcnt vmcnt(32)
buffer_load_dwordx4 v20, s[20:23], s7 offen lds
buffer_load_dwordx4 v21, s[20:23], s7 offen offset:1024 lds
buffer_load_dwordx4 v22, s[20:23], s7 offen offset:2048 lds
buffer_load_dwordx4 v23, s[20:23], s7 offen offset:3072 lds
s_mov_b32 m0, 14336
s_add_u32 s92, s92, 4
buffer_load_dword off, s[36:39], s92 lds
s_cbranch_vccnz L_iw16
L_ig16:
s_mov_b32 m0, 98304
s_add_u32 s7, s61, 0
s_xor_b32 s7, s7, s43
s_waitcnt vmcnt(32)
buffer_load_dwordx4 v20, s[20:23], s7 offen lds
buffer_load_dwordx4 v21, s[20:23], s7 offen offset:1024 lds
buffer_load_dwordx4 v22, s[20:23], s7 offen offset:2048 lds
buffer_load_dwordx4 v23, s[20:23], s7 offen offset:3072 lds
s_add_u32 m0, m0, 4096
s_add_u32 s7, s7, 131072
s_waitcnt vmcnt(32)
buffer_load_dwordx4 v20, s[20:23], s7 offen lds
buffer_load_dwordx4 v21, s[20:23], s7 offen offset:1024 lds
buffer_load_dwordx4 v22, s[20:23], s7 offen offset:2048 lds
buffer_load_dwordx4 v23, s[20:23], s7 offen offset:3072 lds
s_add_u32 m0, m0, 4096
s_sub_u32 s7, s7, 98304
ds_read_b32 v54, v53 offset:15360
s_waitcnt vmcnt(32)
buffer_load_dwordx4 v20, s[20:23], s7 offen lds
buffer_load_dwordx4 v21, s[20:23], s7 offen offset:1024 lds
buffer_load_dwordx4 v22, s[20:23], s7 offen offset:2048 lds
buffer_load_dwordx4 v23, s[20:23], s7 offen offset:3072 lds
s_add_u32 m0, m0, 4096
s_add_u32 s7, s7, 131072
v_cmp_gt_u32 vcc, 5, v54
s_waitcnt vmcnt(32)
buffer_load_dwordx4 v20, s[20:23], s7 offen lds
buffer_load_dwordx4 v21, s[20:23], s7 offen offset:1024 lds
buffer_load_dwordx4 v22, s[20:23], s7 offen offset:2048 lds
buffer_load_dwordx4 v23, s[20:23], s7 offen offset:3072 lds
s_mov_b32 m0, 14336
s_add_u32 s92, s92, 4
buffer_load_dword off, s[36:39], s92 lds
s_cbranch_vccnz L_iw17
L_ig17:
s_mov_b32 m0, 114688
s_add_u32 s7, s63, 0
s_waitcnt vmcnt(32)
buffer_load_dwordx4 v24, s[12:15], s7 offen nt lds
buffer_load_dwordx4 v25, s[12:15], s7 offen offset:1024 nt lds
buffer_load_dwordx4 v26, s[12:15], s7 offen offset:2048 nt lds
buffer_load_dwordx4 v27, s[12:15], s7 offen offset:3072 nt lds
s_add_u32 m0, m0, 4096
s_add_u32 s7, s7, 4096
s_waitcnt vmcnt(32)
buffer_load_dwordx4 v28, s[12:15], s7 offen nt lds
buffer_load_dwordx4 v29, s[12:15], s7 offen offset:1024 nt lds
buffer_load_dwordx4 v30, s[12:15], s7 offen offset:2048 nt lds
buffer_load_dwordx4 v31, s[12:15], s7 offen offset:3072 nt lds
s_add_u32 m0, m0, 4096
s_add_u32 s7, s7, 4096
ds_read_b32 v54, v53 offset:15360
s_waitcnt vmcnt(32)
buffer_load_dwordx4 v24, s[12:15], s7 offen nt lds
buffer_load_dwordx4 v25, s[12:15], s7 offen offset:1024 nt lds
buffer_load_dwordx4 v26, s[12:15], s7 offen offset:2048 nt lds
buffer_load_dwordx4 v27, s[12:15], s7 offen offset:3072 nt lds
s_add_u32 m0, m0, 4096
s_add_u32 s7, s7, 4096
v_cmp_gt_u32 vcc, 6, v54
s_waitcnt vmcnt(32)
buffer_load_dwordx4 v28, s[12:15], s7 offen nt lds
buffer_load_dwordx4 v29, s[12:15], s7 offen offset:1024 nt lds
buffer_load_dwordx4 v30, s[12:15], s7 offen offset:2048 nt lds
buffer_load_dwordx4 v31, s[12:15], s7 offen offset:3072 nt lds
s_mov_b32 m0, 14336
s_add_u32 s92, s92, 4
buffer_load_dword off, s[36:39], s92 lds
s_cbranch_vccnz L_iw18
L_ig18:
s_mov_b32 m0, 131072
s_add_u32 s7, s63, 16384
s_waitcnt vmcnt(32)
buffer_load_dwordx4 v24, s[12:15], s7 offen nt lds
buffer_load_dwordx4 v25, s[12:15], s7 offen offset:1024 nt lds
buffer_load_dwordx4 v26, s[12:15], s7 offen offset:2048 nt lds
buffer_load_dwordx4 v27, s[12:15], s7 offen offset:3072 nt lds
s_add_u32 m0, m0, 4096
s_add_u32 s7, s7, 4096
s_waitcnt vmcnt(32)
buffer_load_dwordx4 v28, s[12:15], s7 offen nt lds
buffer_load_dwordx4 v29, s[12:15], s7 offen offset:1024 nt lds
buffer_load_dwordx4 v30, s[12:15], s7 offen offset:2048 nt lds
buffer_load_dwordx4 v31, s[12:15], s7 offen offset:3072 nt lds
s_add_u32 m0, m0, 4096
s_add_u32 s7, s7, 4096
s_waitcnt vmcnt(32)
buffer_load_dwordx4 v24, s[12:15], s7 offen nt lds
buffer_load_dwordx4 v25, s[12:15], s7 offen offset:1024 nt lds
buffer_load_dwordx4 v26, s[12:15], s7 offen offset:2048 nt lds
buffer_load_dwordx4 v27, s[12:15], s7 offen offset:3072 nt lds
s_add_u32 m0, m0, 4096
s_add_u32 s7, s7, 4096
s_waitcnt vmcnt(32)
buffer_load_dwordx4 v28, s[12:15], s7 offen nt lds
buffer_load_dwordx4 v29, s[12:15], s7 offen offset:1024 nt lds
buffer_load_dwordx4 v30, s[12:15], s7 offen offset:2048 nt lds
buffer_load_dwordx4 v31, s[12:15], s7 offen offset:3072 nt lds
s_mov_b32 m0, 14336
s_add_u32 s92, s92, 4
buffer_load_dword off, s[36:39], s92 lds
s_mov_b32 m0, 147456
s_add_u32 s7, s54, 0
s_waitcnt vmcnt(32)
buffer_load_dwordx4 v16, s[8:11], s7 offen lds
buffer_load_dwordx4 v17, s[8:11], s7 offen offset:1024 lds
buffer_load_dwordx4 v18, s[8:11], s7 offen offset:2048 lds
buffer_load_dwordx4 v19, s[8:11], s7 offen offset:3072 lds
s_add_u32 m0, m0, 4096
s_add_u32 s7, s7, 28672
ds_read_b32 v54, v53 offset:15360
s_waitcnt vmcnt(32)
buffer_load_dwordx4 v16, s[8:11], s7 offen lds
buffer_load_dwordx4 v17, s[8:11], s7 offen offset:1024 lds
buffer_load_dwordx4 v18, s[8:11], s7 offen offset:2048 lds
buffer_load_dwordx4 v19, s[8:11], s7 offen offset:3072 lds
s_add_u32 m0, m0, 4096
s_add_u32 s7, s7, 28672
v_cmp_gt_u32 vcc, 7, v54
s_waitcnt vmcnt(32)
buffer_load_dwordx4 v16, s[8:11], s7 offen lds
buffer_load_dwordx4 v17, s[8:11], s7 offen offset:1024 lds
buffer_load_dwordx4 v18, s[8:11], s7 offen offset:2048 lds
buffer_load_dwordx4 v19, s[8:11], s7 offen offset:3072 lds
s_mov_b32 m0, 14336
s_add_u32 s92, s92, 4
buffer_load_dword off, s[36:39], s92 lds
s_cbranch_vccnz L_iw20
L_ig20:
s_mov_b32 m0, 16384
s_add_u32 s7, s61, 262144
s_xor_b32 s7, s7, s43
s_waitcnt vmcnt(32)
buffer_load_dwordx4 v20, s[20:23], s7 offen lds
buffer_load_dwordx4 v21, s[20:23], s7 offen offset:1024 lds
buffer_load_dwordx4 v22, s[20:23], s7 offen offset:2048 lds
buffer_load_dwordx4 v23, s[20:23], s7 offen offset:3072 lds
s_add_u32 m0, m0, 4096
s_add_u32 s7, s7, 131072
s_waitcnt vmcnt(32)
buffer_load_dwordx4 v20, s[20:23], s7 offen lds
buffer_load_dwordx4 v21, s[20:23], s7 offen offset:1024 lds
buffer_load_dwordx4 v22, s[20:23], s7 offen offset:2048 lds
buffer_load_dwordx4 v23, s[20:23], s7 offen offset:3072 lds
s_add_u32 m0, m0, 4096
s_sub_u32 s7, s7, 98304
ds_read_b32 v54, v53 offset:15360
s_waitcnt vmcnt(32)
buffer_load_dwordx4 v20, s[20:23], s7 offen lds
buffer_load_dwordx4 v21, s[20:23], s7 offen offset:1024 lds
buffer_load_dwordx4 v22, s[20:23], s7 offen offset:2048 lds
buffer_load_dwordx4 v23, s[20:23], s7 offen offset:3072 lds
s_add_u32 m0, m0, 4096
s_add_u32 s7, s7, 131072
v_cmp_gt_u32 vcc, 8, v54
s_waitcnt vmcnt(32)
buffer_load_dwordx4 v20, s[20:23], s7 offen lds
buffer_load_dwordx4 v21, s[20:23], s7 offen offset:1024 lds
buffer_load_dwordx4 v22, s[20:23], s7 offen offset:2048 lds
buffer_load_dwordx4 v23, s[20:23], s7 offen offset:3072 lds
s_mov_b32 m0, 14336
s_add_u32 s92, s92, 4
buffer_load_dword off, s[36:39], s92 lds
s_cbranch_vccnz L_iw21
L_ig21:
s_mov_b32 m0, 32768
s_add_u32 s7, s62, 0
s_xor_b32 s7, s7, s43
s_waitcnt vmcnt(32)
buffer_load_dwordx4 v20, s[20:23], s7 offen lds
buffer_load_dwordx4 v21, s[20:23], s7 offen offset:1024 lds
buffer_load_dwordx4 v22, s[20:23], s7 offen offset:2048 lds
buffer_load_dwordx4 v23, s[20:23], s7 offen offset:3072 lds
s_add_u32 m0, m0, 4096
s_add_u32 s7, s7, 131072
s_waitcnt vmcnt(32)
buffer_load_dwordx4 v20, s[20:23], s7 offen lds
buffer_load_dwordx4 v21, s[20:23], s7 offen offset:1024 lds
buffer_load_dwordx4 v22, s[20:23], s7 offen offset:2048 lds
buffer_load_dwordx4 v23, s[20:23], s7 offen offset:3072 lds
s_add_u32 m0, m0, 4096
s_sub_u32 s7, s7, 98304
ds_read_b32 v54, v53 offset:15360
s_waitcnt vmcnt(32)
buffer_load_dwordx4 v20, s[20:23], s7 offen lds
buffer_load_dwordx4 v21, s[20:23], s7 offen offset:1024 lds
buffer_load_dwordx4 v22, s[20:23], s7 offen offset:2048 lds
buffer_load_dwordx4 v23, s[20:23], s7 offen offset:3072 lds
s_add_u32 m0, m0, 4096
s_add_u32 s7, s7, 131072
v_cmp_gt_u32 vcc, 9, v54
s_waitcnt vmcnt(32)
buffer_load_dwordx4 v20, s[20:23], s7 offen lds
buffer_load_dwordx4 v21, s[20:23], s7 offen offset:1024 lds
buffer_load_dwordx4 v22, s[20:23], s7 offen offset:2048 lds
buffer_load_dwordx4 v23, s[20:23], s7 offen offset:3072 lds
s_mov_b32 m0, 14336
s_add_u32 s92, s92, 4
buffer_load_dword off, s[36:39], s92 lds
s_cbranch_vccnz L_iw22
L_ig22:
s_mov_b32 m0, 49152
s_add_u32 s7, s62, 262144
s_xor_b32 s7, s7, s43
s_waitcnt vmcnt(32)
buffer_load_dwordx4 v20, s[20:23], s7 offen lds
buffer_load_dwordx4 v21, s[20:23], s7 offen offset:1024 lds
buffer_load_dwordx4 v22, s[20:23], s7 offen offset:2048 lds
buffer_load_dwordx4 v23, s[20:23], s7 offen offset:3072 lds
s_add_u32 m0, m0, 4096
s_add_u32 s7, s7, 131072
s_waitcnt vmcnt(32)
buffer_load_dwordx4 v20, s[20:23], s7 offen lds
buffer_load_dwordx4 v21, s[20:23], s7 offen offset:1024 lds
buffer_load_dwordx4 v22, s[20:23], s7 offen offset:2048 lds
buffer_load_dwordx4 v23, s[20:23], s7 offen offset:3072 lds
s_add_u32 m0, m0, 4096
s_sub_u32 s7, s7, 98304
ds_read_b32 v54, v53 offset:15360
s_waitcnt vmcnt(32)
buffer_load_dwordx4 v20, s[20:23], s7 offen lds
buffer_load_dwordx4 v21, s[20:23], s7 offen offset:1024 lds
buffer_load_dwordx4 v22, s[20:23], s7 offen offset:2048 lds
buffer_load_dwordx4 v23, s[20:23], s7 offen offset:3072 lds
s_add_u32 m0, m0, 4096
s_add_u32 s7, s7, 131072
v_cmp_gt_u32 vcc, 10, v54
s_waitcnt vmcnt(32)
buffer_load_dwordx4 v20, s[20:23], s7 offen lds
buffer_load_dwordx4 v21, s[20:23], s7 offen offset:1024 lds
buffer_load_dwordx4 v22, s[20:23], s7 offen offset:2048 lds
buffer_load_dwordx4 v23, s[20:23], s7 offen offset:3072 lds
s_mov_b32 m0, 14336
s_add_u32 s92, s92, 4
buffer_load_dword off, s[36:39], s92 lds
s_cbranch_vccnz L_iw23
L_ig23:
s_mov_b32 m0, 65536
s_add_u32 s7, s56, 512
s_xor_b32 s7, s7, s43
s_waitcnt vmcnt(32)
buffer_load_dwordx4 v20, s[20:23], s7 offen lds
buffer_load_dwordx4 v21, s[20:23], s7 offen offset:1024 lds
buffer_load_dwordx4 v22, s[20:23], s7 offen offset:2048 lds
buffer_load_dwordx4 v23, s[20:23], s7 offen offset:3072 lds
s_add_u32 m0, m0, 4096
s_add_u32 s7, s7, 131072
s_waitcnt vmcnt(32)
buffer_load_dwordx4 v20, s[20:23], s7 offen lds
buffer_load_dwordx4 v21, s[20:23], s7 offen offset:1024 lds
buffer_load_dwordx4 v22, s[20:23], s7 offen offset:2048 lds
buffer_load_dwordx4 v23, s[20:23], s7 offen offset:3072 lds
s_add_u32 m0, m0, 4096
s_sub_u32 s7, s7, 98304
s_waitcnt vmcnt(32)
buffer_load_dwordx4 v20, s[20:23], s7 offen lds
buffer_load_dwordx4 v21, s[20:23], s7 offen offset:1024 lds
buffer_load_dwordx4 v22, s[20:23], s7 offen offset:2048 lds
buffer_load_dwordx4 v23, s[20:23], s7 offen offset:3072 lds
s_add_u32 m0, m0, 4096
s_add_u32 s7, s7, 131072
s_waitcnt vmcnt(32)
buffer_load_dwordx4 v20, s[20:23], s7 offen lds
buffer_load_dwordx4 v21, s[20:23], s7 offen offset:1024 lds
buffer_load_dwordx4 v22, s[20:23], s7 offen offset:2048 lds
buffer_load_dwordx4 v23, s[20:23], s7 offen offset:3072 lds
s_mov_b32 m0, 14336
s_add_u32 s92, s92, 4
buffer_load_dword off, s[36:39], s92 lds
s_add_u32 s7, s56, 262656
s_xor_b32 s7, s7, s43
s_mov_b32 s6, 81930
s_call_b64 s[94:95], L_ldQ0
s_add_u32 s7, s63, 32768
s_mov_b32 s6, 98315
s_call_b64 s[94:95], L_ldK1
s_call_b64 s[94:95], L_stub5
s_add_u32 s7, s57, 512
s_xor_b32 s7, s7, s43
s_mov_b32 s6, 16396
s_call_b64 s[94:95], L_ldQ0
s_add_u32 s7, s63, 49152
s_mov_b32 s6, 147468
s_call_b64 s[94:95], L_ldK1
s_call_b64 s[94:95], L_stub6
s_add_u32 s7, s63, 65536
s_mov_b32 s6, 32781
s_call_b64 s[94:95], L_ldK2
s_call_b64 s[94:95], L_stub7
s_add_u32 s7, s57, 262656
s_xor_b32 s7, s7, s43
s_mov_b32 s6, 49166
s_call_b64 s[94:95], L_ldQ0
s_add_u32 s7, s63, 81920
s_mov_b32 s6, 65551
s_call_b64 s[94:95], L_ldK1
s_add_u32 s7, s63, 98304
s_mov_b32 s6, 114704
s_call_b64 s[94:95], L_ldK2
s_call_b64 s[94:95], L_stub8
s_add_u32 s7, s58, 512
s_xor_b32 s7, s7, s43
s_mov_b32 s6, 131089
s_call_b64 s[94:95], L_ldQ0
s_add_u32 s7, s63, 114688
s_mov_b32 s6, 81938
s_call_b64 s[94:95], L_ldK1
s_add_u32 s7, s63, 131072
s_mov_b32 s6, 98323
s_call_b64 s[94:95], L_ldK2
s_add_u32 s7, s58, 262656
s_xor_b32 s7, s7, s43
s_mov_b32 s6, 147476
s_call_b64 s[94:95], L_ldQ0
s_add_u32 s7, s63, 147456
s_mov_b32 s6, 16405
s_call_b64 s[94:95], L_ldK1
s_add_u32 s7, s63, 163840
s_mov_b32 s6, 32790
s_call_b64 s[94:95], L_ldK2
s_call_b64 s[94:95], L_stub9
s_add_u32 s7, s59, 512
s_xor_b32 s7, s7, s43
s_mov_b32 s6, 65559
s_call_b64 s[94:95], L_ldQ0
s_add_u32 s7, s63, 180224
s_mov_b32 s6, 49176
s_call_b64 s[94:95], L_ldK1
s_add_u32 s7, s63, 196608
s_mov_b32 s6, 114713
s_call_b64 s[94:95], L_ldK2
s_add_u32 s7, s59, 262656
s_xor_b32 s7, s7, s43
s_mov_b32 s6, 81946
s_call_b64 s[94:95], L_ldQ0
s_add_u32 s7, s63, 212992
s_mov_b32 s6, 131099
s_call_b64 s[94:95], L_ldK1
s_call_b64 s[94:95], L_stub10
s_add_u32 s7, s63, 229376
s_mov_b32 s6, 98332
s_call_b64 s[94:95], L_ldK2
s_add_u32 s7, s60, 512
s_xor_b32 s7, s7, s43
s_mov_b32 s6, 16413
s_call_b64 s[94:95], L_ldQ0
s_add_u32 s7, s63, 245760
s_mov_b32 s6, 147486
s_call_b64 s[94:95], L_ldK1
s_add_u32 s7, s63, 0
s_mov_b32 s6, 32799
s_call_b64 s[94:95], L_ldV3
s_call_b64 s[94:95], L_stub11
s_add_u32 s7, s60, 262656
s_xor_b32 s7, s7, s43
s_mov_b32 s6, 49184
s_call_b64 s[94:95], L_ldQ0
s_add_u32 s7, s63, 16384
s_mov_b32 s6, 65569
s_call_b64 s[94:95], L_ldV4
s_add_u32 s7, s63, 32768
s_mov_b32 s6, 114722
s_call_b64 s[94:95], L_ldV3
s_call_b64 s[94:95], L_stub12
s_add_u32 s7, s63, 49152
s_mov_b32 s6, 131107
s_call_b64 s[94:95], L_ldV5
s_add_u32 s7, s61, 512
s_xor_b32 s7, s7, s43
s_mov_b32 s6, 81956
s_call_b64 s[94:95], L_ldQ0
s_add_u32 s7, s63, 65536
s_mov_b32 s6, 98341
s_call_b64 s[94:95], L_ldV4
s_add_u32 s7, s63, 81920
s_mov_b32 s6, 147494
s_call_b64 s[94:95], L_ldV3
s_lshl_b32 s7, s42, 2
s_load_dword s5, s[86:87], s7
s_add_u32 s7, s61, 262656
s_xor_b32 s7, s7, s43
s_mov_b32 s6, 16423
s_call_b64 s[94:95], L_ldQ0
s_add_u32 s7, s63, 98304
s_mov_b32 s6, 32808
s_call_b64 s[94:95], L_ldV4
s_call_b64 s[94:95], L_stub13
s_add_u32 s7, s63, 114688
s_mov_b32 s6, 65577
s_call_b64 s[94:95], L_ldV3
s_waitcnt lgkmcnt(0)
s_cmp_eq_u32 s5, 0
s_mov_b32 s90, 0
s_cbranch_scc1 L_nr0
s_mov_b32 s90, 1
s_atomic_add s90, s[72:73], 64 glc
L_nr0:
s_add_u32 s7, s63, 131072
s_mov_b32 s6, 49194
s_call_b64 s[94:95], L_ldV5
s_add_u32 s7, s62, 512
s_xor_b32 s7, s7, s43
s_mov_b32 s6, 114731
s_call_b64 s[94:95], L_ldQ0
s_add_u32 s7, s63, 147456
s_mov_b32 s6, 131116
s_call_b64 s[94:95], L_ldV4
s_waitcnt lgkmcnt(0)
s_cmp_ge_u32 s90, 11
s_cselect_b32 s71, -1, 0
s_add_u32 s7, s63, 163840
s_mov_b32 s6, 98349
s_call_b64 s[94:95], L_ldV3
s_call_b64 s[94:95], L_stub14
s_add_u32 s7, s63, 180224
s_mov_b32 s6, 81966
s_call_b64 s[94:95], L_ldV5
s_add_u32 s7, s62, 262656
s_xor_b32 s7, s7, s43
s_mov_b32 s6, 147503
s_call_b64 s[94:95], L_ldQ0
s_add_u32 s7, s63, 196608
s_mov_b32 s6, 32816
s_call_b64 s[94:95], L_ldV4
s_add_u32 s7, s63, 212992
s_mov_b32 s6, 16433
s_call_b64 s[94:95], L_ldV3
s_add_u32 s7, s63, 229376
s_mov_b32 s6, 65586
s_call_b64 s[94:95], L_ldV5
s_add_u32 s7, s63, 245760
s_mov_b32 s6, 49203
s_call_b64 s[94:95], L_ldV5
s_call_b64 s[94:95], L_stub15
s_add_u32 s7, s76, 0
s_mov_b32 s6, 131124
s_call_b64 s[94:95], L_ldK6
s_add_u32 s7, s64, 0
s_mov_b32 s6, 114741
s_call_b64 s[94:95], L_ldC7
s_add_u32 s7, s76, 16384
s_mov_b32 s6, 98358
s_call_b64 s[94:95], L_ldK1
s_add_u32 s7, s76, 32768
s_mov_b32 s6, 81975
s_call_b64 s[94:95], L_ldK8
s_add_u32 s7, s65, 0
s_mov_b32 s6, 32824
s_call_b64 s[94:95], L_ldC7
s_add_u32 s7, s76, 49152
s_mov_b32 s6, 147513
s_call_b64 s[94:95], L_ldK1
s_call_b64 s[94:95], L_stub16
s_add_u32 s7, s76, 65536
s_mov_b32 s6, 16442
s_call_b64 s[94:95], L_ldK8
s_add_u32 s7, s76, 81920
s_mov_b32 s6, 65595
s_call_b64 s[94:95], L_ldK6
s_add_u32 s7, s66, 0
s_mov_b32 s6, 49212
s_call_b64 s[94:95], L_ldC7
s_add_u32 s7, s76, 98304
s_mov_b32 s6, 131133
s_call_b64 s[94:95], L_ldK1
s_call_b64 s[94:95], L_stub17
s_add_u32 s7, s76, 114688
s_mov_b32 s6, 98366
s_call_b64 s[94:95], L_ldK8
s_add_u32 s7, s64, 0
s_add_u32 s7, s7, s41
s_mov_b32 s6, 114751
s_call_b64 s[94:95], L_ldC7
s_add_u32 s7, s76, 131072
s_mov_b32 s6, 81984
s_call_b64 s[94:95], L_ldK1
s_add_u32 s7, s76, 147456
s_mov_b32 s6, 147521
s_call_b64 s[94:95], L_ldK8
s_call_b64 s[94:95], L_stub18
s_add_u32 s7, s65, 0
s_add_u32 s7, s7, s41
s_mov_b32 s6, 32834
s_call_b64 s[94:95], L_ldC7
s_add_u32 s7, s76, 163840
s_mov_b32 s6, 16451
s_call_b64 s[94:95], L_ldK1
s_add_u32 s7, s76, 180224
s_mov_b32 s6, 65604
s_call_b64 s[94:95], L_ldK8
s_add_u32 s7, s76, 196608
s_mov_b32 s6, 131141
s_call_b64 s[94:95], L_ldK6
s_add_u32 s7, s66, 0
s_add_u32 s7, s7, s41
s_mov_b32 s6, 49222
s_call_b64 s[94:95], L_ldC7
s_add_u32 s7, s76, 212992
s_mov_b32 s6, 98375
s_call_b64 s[94:95], L_ldK1
s_cmp_eq_u32 s5, 0
s_mov_b32 s90, 0
s_cbranch_scc1 L_nr1
s_mov_b32 s90, 1
s_atomic_add s90, s[72:73], 68 glc
L_nr1:
s_call_b64 s[94:95], L_stub19
s_add_u32 s7, s76, 229376
s_mov_b32 s6, 81992
s_call_b64 s[94:95], L_ldK8
s_add_u32 s7, s67, 0
s_mov_b32 s6, 114761
s_call_b64 s[94:95], L_ldC7
s_add_u32 s7, s76, 245760
s_mov_b32 s6, 147530
s_call_b64 s[94:95], L_ldK1
s_waitcnt lgkmcnt(0)
s_cmp_ge_u32 s90, 11
s_cselect_b32 s71, -1, 0
s_add_u32 s7, s67, 0
s_add_u32 s7, s7, s41
s_mov_b32 s6, 16459
s_call_b64 s[94:95], L_ldC7
s_add_u32 s7, s76, 0
s_mov_b32 s6, 32844
s_call_b64 s[94:95], L_ldV4
s_call_b64 s[94:95], L_stub20
s_add_u32 s7, s76, 16384
s_mov_b32 s6, 65613
s_call_b64 s[94:95], L_ldV9
s_add_u32 s7, s68, 0
s_mov_b32 s6, 131150
s_call_b64 s[94:95], L_ldC7
s_add_u32 s7, s76, 32768
s_mov_b32 s6, 98383
s_call_b64 s[94:95], L_ldV4
s_add_u32 s7, s76, 49152
s_mov_b32 s6, 49232
s_call_b64 s[94:95], L_ldV9
s_call_b64 s[94:95], L_stub21
s_add_u32 s7, s68, 0
s_add_u32 s7, s7, s41
s_mov_b32 s6, 82001
s_call_b64 s[94:95], L_ldC7
s_add_u32 s7, s76, 65536
s_mov_b32 s6, 147538
s_call_b64 s[94:95], L_ldV4
s_add_u32 s7, s76, 81920
s_mov_b32 s6, 114771
s_call_b64 s[94:95], L_ldV9
s_call_b64 s[94:95], L_stub22
s_add_u32 s7, s76, 98304
s_mov_b32 s6, 32852
s_call_b64 s[94:95], L_ldV10
s_add_u32 s7, s69, 0
s_mov_b32 s6, 16469
s_call_b64 s[94:95], L_ldC7
s_add_u32 s7, s76, 114688
s_mov_b32 s6, 65622
s_call_b64 s[94:95], L_ldV4
s_add_u32 s7, s76, 131072
s_mov_b32 s6, 98391
s_call_b64 s[94:95], L_ldV9
s_add_u32 s7, s69, 0
s_add_u32 s7, s7, s41
s_mov_b32 s6, 131160
s_call_b64 s[94:95], L_ldC7
s_add_u32 s7, s76, 147456
s_mov_b32 s6, 49241
s_call_b64 s[94:95], L_ldV4
s_call_b64 s[94:95], L_stub23
s_add_u32 s7, s76, 163840
s_mov_b32 s6, 147546
s_call_b64 s[94:95], L_ldV9
s_add_u32 s7, s70, 0
s_mov_b32 s6, 82011
s_call_b64 s[94:95], L_ldC7
s_add_u32 s7, s76, 180224
s_mov_b32 s6, 114780
s_call_b64 s[94:95], L_ldV4
s_call_b64 s[94:95], L_stub24
s_add_u32 s7, s76, 196608
s_mov_b32 s6, 32861
s_call_b64 s[94:95], L_ldV9
s_add_u32 s7, s70, 0
s_add_u32 s7, s7, s41
s_mov_b32 s6, 65630
s_call_b64 s[94:95], L_ldC7
s_add_u32 s7, s76, 212992
s_mov_b32 s6, 16479
s_call_b64 s[94:95], L_ldV4
s_add_u32 s7, s76, 229376
s_mov_b32 s6, 98400
s_call_b64 s[94:95], L_ldV9
s_add_u32 s7, s76, 245760
s_mov_b32 s6, 49249
s_call_b64 s[94:95], L_ldV10
s_add_u32 s7, s64, s77
s_mov_b32 s6, 131170
s_call_b64 s[94:95], L_ldC7
s_add_u32 s7, s64, s77
s_add_u32 s7, s7, s41
s_mov_b32 s6, 147555
s_call_b64 s[94:95], L_ldC7
s_add_u32 s7, s65, s77
s_mov_b32 s6, 114788
s_call_b64 s[94:95], L_ldC7
s_add_u32 s7, s65, s77
s_add_u32 s7, s7, s41
s_mov_b32 s6, 82021
s_call_b64 s[94:95], L_ldC7
s_add_u32 s7, s66, s77
s_mov_b32 s6, 32870
s_call_b64 s[94:95], L_ldC7
s_add_u32 s7, s66, s77
s_add_u32 s7, s7, s41
s_mov_b32 s6, 16487
s_call_b64 s[94:95], L_ldC7
s_add_u32 s7, s67, s77
s_mov_b32 s6, 65640
s_call_b64 s[94:95], L_ldC7
s_add_u32 s7, s67, s77
s_add_u32 s7, s7, s41
s_mov_b32 s6, 98409
s_call_b64 s[94:95], L_ldC7
s_add_u32 s7, s68, s77
s_mov_b32 s6, 49258
s_call_b64 s[94:95], L_ldC7
s_add_u32 s7, s68, s77
s_add_u32 s7, s7, s41
s_mov_b32 s6, 131179
s_call_b64 s[94:95], L_ldC7
s_add_u32 s7, s69, s77
s_mov_b32 s6, 147564
s_call_b64 s[94:95], L_ldC7
s_add_u32 s7, s69, s77
s_add_u32 s7, s7, s41
s_mov_b32 s6, 114797
s_call_b64 s[94:95], L_ldC7
s_add_u32 s7, s70, s77
s_mov_b32 s6, 82030
s_call_b64 s[94:95], L_ldC7
s_add_u32 s7, s70, s77
s_add_u32 s7, s7, s41
s_mov_b32 s6, 32879
s_call_b64 s[94:95], L_ldC7
s_waitcnt lgkmcnt(0)
v_mbcnt_lo_u32_b32 v1, -1, 0
v_mbcnt_hi_u32_b32 v1, -1, v1
s_mul_i32 s7, s42, 37
s_lshr_b32 s7, s7, 8
s_mul_i32 s7, s7, 7
s_sub_u32 s13, s42, s7
s_mul_i32 s5, s47, 5248
s_add_u32 s5, s5, 22020096
s_lshl_b32 s6, s40, 7
s_lshl_b32 s7, s42, 1
s_add_u32 s6, s6, s7
s_mul_i32 s6, s6, 86016
s_mul_i32 s7, s42, 172032
s_mul_i32 s91, s40, 896
s_add_u32 s7, s7, s91
s_mov_b32 s91, 0xffff0000
v_mov_b32 v9, 2147479552
s_mul_i32 s93, s45, 192
s_add_u32 s93, s93, 0
v_add_u32 v8, s93, v1
v_lshrrev_b32 v13, 8, v8
v_mul_u32_u24 v6, 43, v13
v_lshrrev_b32 v6, 7, v6
v_mul_u32_u24 v7, 3, v6
v_sub_u32 v13, v13, v7
v_bfe_u32 v7, v8, 6, 1
v_lshl_add_u32 v13, v13, 1, v7
v_and_b32 v7, 15, v8
v_lshl_add_u32 v13, v13, 4, v7
v_mul_u32_u24 v13, 1792, v13
v_add_u32 v6, s13, v6
v_subrev_u32 v7, 7, v6
v_min_u32 v6, v6, v7
v_lshl_add_u32 v13, v6, 7, v13
v_bfe_u32 v7, v8, 7, 1
v_lshl_add_u32 v13, v7, 6, v13
v_bfe_u32 v7, v8, 4, 1
v_lshl_add_u32 v13, v7, 5, v13
v_bfe_u32 v7, v8, 5, 1
v_lshl_add_u32 v13, v7, 4, v13
v_lshlrev_b32 v10, 4, v8
v_add_u32 v8, s93, v1
v_add_u32 v8, 64, v8
v_lshrrev_b32 v14, 8, v8
v_mul_u32_u24 v6, 43, v14
v_lshrrev_b32 v6, 7, v6
v_mul_u32_u24 v7, 3, v6
v_sub_u32 v14, v14, v7
v_bfe_u32 v7, v8, 6, 1
v_lshl_add_u32 v14, v14, 1, v7
v_and_b32 v7, 15, v8
v_lshl_add_u32 v14, v14, 4, v7
v_mul_u32_u24 v14, 1792, v14
v_add_u32 v6, s13, v6
v_subrev_u32 v7, 7, v6
v_min_u32 v6, v6, v7
v_lshl_add_u32 v14, v6, 7, v14
v_bfe_u32 v7, v8, 7, 1
v_lshl_add_u32 v14, v7, 6, v14
v_bfe_u32 v7, v8, 4, 1
v_lshl_add_u32 v14, v7, 5, v14
v_bfe_u32 v7, v8, 5, 1
v_lshl_add_u32 v14, v7, 4, v14
v_lshlrev_b32 v11, 4, v8
v_add_u32 v8, s93, v1
v_add_u32 v8, 128, v8
v_lshrrev_b32 v15, 8, v8
v_mul_u32_u24 v6, 43, v15
v_lshrrev_b32 v6, 7, v6
v_mul_u32_u24 v7, 3, v6
v_sub_u32 v15, v15, v7
v_bfe_u32 v7, v8, 6, 1
v_lshl_add_u32 v15, v15, 1, v7
v_and_b32 v7, 15, v8
v_lshl_add_u32 v15, v15, 4, v7
v_mul_u32_u24 v15, 1792, v15
v_add_u32 v6, s13, v6
v_subrev_u32 v7, 7, v6
v_min_u32 v6, v6, v7
v_lshl_add_u32 v15, v6, 7, v15
v_bfe_u32 v7, v8, 7, 1
v_lshl_add_u32 v15, v7, 6, v15
v_bfe_u32 v7, v8, 4, 1
v_lshl_add_u32 v15, v7, 5, v15
v_bfe_u32 v7, v8, 5, 1
v_lshl_add_u32 v15, v7, 4, v15
v_lshlrev_b32 v12, 4, v8
s_add_u32 s72, s88, s5
s_addc_u32 s73, s89, 0
s_mov_b32 s92, 0
L_sqw0:
s_mov_b32 s90, 0
s_atomic_add s90, s[72:73], 0 glc
s_add_u32 s92, s92, 1
L_sww0:
s_waitcnt lgkmcnt(0)
s_bitcmp1_b32 s92, 22
s_cbranch_scc1 L_sxw0
s_cmp_lt_u32 s90, 24
s_cbranch_scc1 L_sqw0
L_sxw0:
s_add_u32 s93, s6, 0
buffer_load_dwordx4 v[64:67], v10, s[28:31], s93 offen sc1
s_add_u32 s93, s6, 86016
buffer_load_dwordx4 v[68:71], v10, s[28:31], s93 offen sc1
s_add_u32 s93, s6, 2752512
buffer_load_dwordx4 v[72:75], v10, s[28:31], s93 offen sc1
s_add_u32 s93, s6, 2838528
buffer_load_dwordx4 v[76:79], v10, s[28:31], s93 offen sc1
s_add_u32 s93, s6, 5505024
buffer_load_dwordx4 v[80:83], v10, s[28:31], s93 offen sc1
s_add_u32 s93, s6, 5591040
buffer_load_dwordx4 v[84:87], v10, s[28:31], s93 offen sc1
s_add_u32 s93, s6, 8257536
buffer_load_dwordx4 v[88:91], v10, s[28:31], s93 offen sc1
s_add_u32 s93, s6, 8343552
buffer_load_dwordx4 v[92:95], v10, s[28:31], s93 offen sc1
s_add_u32 s93, s6, 0
buffer_load_dwordx4 v[96:99], v11, s[28:31], s93 offen sc1
s_add_u32 s93, s6, 86016
buffer_load_dwordx4 v[100:103], v11, s[28:31], s93 offen sc1
s_add_u32 s93, s6, 2752512
buffer_load_dwordx4 v[104:107], v11, s[28:31], s93 offen sc1
s_add_u32 s93, s6, 2838528
buffer_load_dwordx4 v[108:111], v11, s[28:31], s93 offen sc1
s_add_u32 s93, s6, 5505024
buffer_load_dwordx4 v[112:115], v11, s[28:31], s93 offen sc1
s_add_u32 s93, s6, 5591040
buffer_load_dwordx4 v[116:119], v11, s[28:31], s93 offen sc1
s_add_u32 s93, s6, 8257536
buffer_load_dwordx4 v[120:123], v11, s[28:31], s93 offen sc1
s_add_u32 s93, s6, 8343552
buffer_load_dwordx4 v[124:127], v11, s[28:31], s93 offen sc1
s_add_u32 s93, s6, 0
buffer_load_dwordx4 v[128:131], v12, s[28:31], s93 offen sc1
s_add_u32 s93, s6, 86016
buffer_load_dwordx4 v[132:135], v12, s[28:31], s93 offen sc1
s_add_u32 s93, s6, 2752512
buffer_load_dwordx4 v[136:139], v12, s[28:31], s93 offen sc1
s_add_u32 s93, s6, 2838528
buffer_load_dwordx4 v[140:143], v12, s[28:31], s93 offen sc1
s_add_u32 s93, s6, 5505024
buffer_load_dwordx4 v[144:147], v12, s[28:31], s93 offen sc1
s_add_u32 s93, s6, 5591040
buffer_load_dwordx4 v[148:151], v12, s[28:31], s93 offen sc1
s_add_u32 s93, s6, 8257536
buffer_load_dwordx4 v[152:155], v12, s[28:31], s93 offen sc1
s_add_u32 s93, s6, 8343552
buffer_load_dwordx4 v[156:159], v12, s[28:31], s93 offen sc1
s_waitcnt vmcnt(23)
v_lshlrev_b32 v16, 16, v64
v_and_b32 v17, s91, v64
v_lshlrev_b32 v18, 16, v65
v_and_b32 v19, s91, v65
v_lshlrev_b32 v20, 16, v66
v_and_b32 v21, s91, v66
v_lshlrev_b32 v22, 16, v67
v_and_b32 v23, s91, v67
s_waitcnt vmcnt(22)
v_lshlrev_b32 v2, 16, v68
v_and_b32 v3, s91, v68
v_pk_add_f32 v[16:17], v[16:17], v[2:3]
v_lshlrev_b32 v6, 16, v69
v_and_b32 v7, s91, v69
v_pk_add_f32 v[18:19], v[18:19], v[6:7]
v_lshlrev_b32 v2, 16, v70
v_and_b32 v3, s91, v70
v_pk_add_f32 v[20:21], v[20:21], v[2:3]
v_lshlrev_b32 v6, 16, v71
v_and_b32 v7, s91, v71
v_pk_add_f32 v[22:23], v[22:23], v[6:7]
s_waitcnt vmcnt(21)
v_lshlrev_b32 v2, 16, v72
v_and_b32 v3, s91, v72
v_pk_add_f32 v[16:17], v[16:17], v[2:3]
v_lshlrev_b32 v6, 16, v73
v_and_b32 v7, s91, v73
v_pk_add_f32 v[18:19], v[18:19], v[6:7]
v_lshlrev_b32 v2, 16, v74
v_and_b32 v3, s91, v74
v_pk_add_f32 v[20:21], v[20:21], v[2:3]
v_lshlrev_b32 v6, 16, v75
v_and_b32 v7, s91, v75
v_pk_add_f32 v[22:23], v[22:23], v[6:7]
s_waitcnt vmcnt(20)
v_lshlrev_b32 v2, 16, v76
v_and_b32 v3, s91, v76
v_pk_add_f32 v[16:17], v[16:17], v[2:3]
v_lshlrev_b32 v6, 16, v77
v_and_b32 v7, s91, v77
v_pk_add_f32 v[18:19], v[18:19], v[6:7]
v_lshlrev_b32 v2, 16, v78
v_and_b32 v3, s91, v78
v_pk_add_f32 v[20:21], v[20:21], v[2:3]
v_lshlrev_b32 v6, 16, v79
v_and_b32 v7, s91, v79
v_pk_add_f32 v[22:23], v[22:23], v[6:7]
s_waitcnt vmcnt(19)
v_lshlrev_b32 v2, 16, v80
v_and_b32 v3, s91, v80
v_pk_add_f32 v[16:17], v[16:17], v[2:3]
v_lshlrev_b32 v6, 16, v81
v_and_b32 v7, s91, v81
v_pk_add_f32 v[18:19], v[18:19], v[6:7]
v_lshlrev_b32 v2, 16, v82
v_and_b32 v3, s91, v82
v_pk_add_f32 v[20:21], v[20:21], v[2:3]
v_lshlrev_b32 v6, 16, v83
v_and_b32 v7, s91, v83
v_pk_add_f32 v[22:23], v[22:23], v[6:7]
s_waitcnt vmcnt(18)
v_lshlrev_b32 v2, 16, v84
v_and_b32 v3, s91, v84
v_pk_add_f32 v[16:17], v[16:17], v[2:3]
v_lshlrev_b32 v6, 16, v85
v_and_b32 v7, s91, v85
v_pk_add_f32 v[18:19], v[18:19], v[6:7]
v_lshlrev_b32 v2, 16, v86
v_and_b32 v3, s91, v86
v_pk_add_f32 v[20:21], v[20:21], v[2:3]
v_lshlrev_b32 v6, 16, v87
v_and_b32 v7, s91, v87
v_pk_add_f32 v[22:23], v[22:23], v[6:7]
s_waitcnt vmcnt(17)
v_lshlrev_b32 v2, 16, v88
v_and_b32 v3, s91, v88
v_pk_add_f32 v[16:17], v[16:17], v[2:3]
v_lshlrev_b32 v6, 16, v89
v_and_b32 v7, s91, v89
v_pk_add_f32 v[18:19], v[18:19], v[6:7]
v_lshlrev_b32 v2, 16, v90
v_and_b32 v3, s91, v90
v_pk_add_f32 v[20:21], v[20:21], v[2:3]
v_lshlrev_b32 v6, 16, v91
v_and_b32 v7, s91, v91
v_pk_add_f32 v[22:23], v[22:23], v[6:7]
s_waitcnt vmcnt(16)
v_lshlrev_b32 v2, 16, v92
v_and_b32 v3, s91, v92
v_pk_add_f32 v[16:17], v[16:17], v[2:3]
v_lshlrev_b32 v6, 16, v93
v_and_b32 v7, s91, v93
v_pk_add_f32 v[18:19], v[18:19], v[6:7]
v_lshlrev_b32 v2, 16, v94
v_and_b32 v3, s91, v94
v_pk_add_f32 v[20:21], v[20:21], v[2:3]
v_lshlrev_b32 v6, 16, v95
v_and_b32 v7, s91, v95
v_pk_add_f32 v[22:23], v[22:23], v[6:7]
s_nop 0
v_cvt_pk_bf16_f32 v24, v16, v17
v_cvt_pk_bf16_f32 v25, v18, v19
v_cvt_pk_bf16_f32 v26, v20, v21
v_cvt_pk_bf16_f32 v27, v22, v23
s_nop 1
v_permlane16_swap_b32 v24, v26
v_permlane16_swap_b32 v25, v27
buffer_store_dwordx4 v[24:27], v13, s[32:35], s7 offen
s_waitcnt vmcnt(16)
v_lshlrev_b32 v16, 16, v96
v_and_b32 v17, s91, v96
v_lshlrev_b32 v18, 16, v97
v_and_b32 v19, s91, v97
v_lshlrev_b32 v20, 16, v98
v_and_b32 v21, s91, v98
v_lshlrev_b32 v22, 16, v99
v_and_b32 v23, s91, v99
s_waitcnt vmcnt(15)
v_lshlrev_b32 v2, 16, v100
v_and_b32 v3, s91, v100
v_pk_add_f32 v[16:17], v[16:17], v[2:3]
v_lshlrev_b32 v6, 16, v101
v_and_b32 v7, s91, v101
v_pk_add_f32 v[18:19], v[18:19], v[6:7]
v_lshlrev_b32 v2, 16, v102
v_and_b32 v3, s91, v102
v_pk_add_f32 v[20:21], v[20:21], v[2:3]
v_lshlrev_b32 v6, 16, v103
v_and_b32 v7, s91, v103
v_pk_add_f32 v[22:23], v[22:23], v[6:7]
s_waitcnt vmcnt(14)
v_lshlrev_b32 v2, 16, v104
v_and_b32 v3, s91, v104
v_pk_add_f32 v[16:17], v[16:17], v[2:3]
v_lshlrev_b32 v6, 16, v105
v_and_b32 v7, s91, v105
v_pk_add_f32 v[18:19], v[18:19], v[6:7]
v_lshlrev_b32 v2, 16, v106
v_and_b32 v3, s91, v106
v_pk_add_f32 v[20:21], v[20:21], v[2:3]
v_lshlrev_b32 v6, 16, v107
v_and_b32 v7, s91, v107
v_pk_add_f32 v[22:23], v[22:23], v[6:7]
s_waitcnt vmcnt(13)
v_lshlrev_b32 v2, 16, v108
v_and_b32 v3, s91, v108
v_pk_add_f32 v[16:17], v[16:17], v[2:3]
v_lshlrev_b32 v6, 16, v109
v_and_b32 v7, s91, v109
v_pk_add_f32 v[18:19], v[18:19], v[6:7]
v_lshlrev_b32 v2, 16, v110
v_and_b32 v3, s91, v110
v_pk_add_f32 v[20:21], v[20:21], v[2:3]
v_lshlrev_b32 v6, 16, v111
v_and_b32 v7, s91, v111
v_pk_add_f32 v[22:23], v[22:23], v[6:7]
s_waitcnt vmcnt(12)
v_lshlrev_b32 v2, 16, v112
v_and_b32 v3, s91, v112
v_pk_add_f32 v[16:17], v[16:17], v[2:3]
v_lshlrev_b32 v6, 16, v113
v_and_b32 v7, s91, v113
v_pk_add_f32 v[18:19], v[18:19], v[6:7]
v_lshlrev_b32 v2, 16, v114
v_and_b32 v3, s91, v114
v_pk_add_f32 v[20:21], v[20:21], v[2:3]
v_lshlrev_b32 v6, 16, v115
v_and_b32 v7, s91, v115
v_pk_add_f32 v[22:23], v[22:23], v[6:7]
s_waitcnt vmcnt(11)
v_lshlrev_b32 v2, 16, v116
v_and_b32 v3, s91, v116
v_pk_add_f32 v[16:17], v[16:17], v[2:3]
v_lshlrev_b32 v6, 16, v117
v_and_b32 v7, s91, v117
v_pk_add_f32 v[18:19], v[18:19], v[6:7]
v_lshlrev_b32 v2, 16, v118
v_and_b32 v3, s91, v118
v_pk_add_f32 v[20:21], v[20:21], v[2:3]
v_lshlrev_b32 v6, 16, v119
v_and_b32 v7, s91, v119
v_pk_add_f32 v[22:23], v[22:23], v[6:7]
s_waitcnt vmcnt(10)
v_lshlrev_b32 v2, 16, v120
v_and_b32 v3, s91, v120
v_pk_add_f32 v[16:17], v[16:17], v[2:3]
v_lshlrev_b32 v6, 16, v121
v_and_b32 v7, s91, v121
v_pk_add_f32 v[18:19], v[18:19], v[6:7]
v_lshlrev_b32 v2, 16, v122
v_and_b32 v3, s91, v122
v_pk_add_f32 v[20:21], v[20:21], v[2:3]
v_lshlrev_b32 v6, 16, v123
v_and_b32 v7, s91, v123
v_pk_add_f32 v[22:23], v[22:23], v[6:7]
s_waitcnt vmcnt(9)
v_lshlrev_b32 v2, 16, v124
v_and_b32 v3, s91, v124
v_pk_add_f32 v[16:17], v[16:17], v[2:3]
v_lshlrev_b32 v6, 16, v125
v_and_b32 v7, s91, v125
v_pk_add_f32 v[18:19], v[18:19], v[6:7]
v_lshlrev_b32 v2, 16, v126
v_and_b32 v3, s91, v126
v_pk_add_f32 v[20:21], v[20:21], v[2:3]
v_lshlrev_b32 v6, 16, v127
v_and_b32 v7, s91, v127
v_pk_add_f32 v[22:23], v[22:23], v[6:7]
s_nop 0
v_cvt_pk_bf16_f32 v28, v16, v17
v_cvt_pk_bf16_f32 v29, v18, v19
v_cvt_pk_bf16_f32 v30, v20, v21
v_cvt_pk_bf16_f32 v31, v22, v23
s_nop 1
v_permlane16_swap_b32 v28, v30
v_permlane16_swap_b32 v29, v31
buffer_store_dwordx4 v[28:31], v14, s[32:35], s7 offen
s_waitcnt vmcnt(9)
v_lshlrev_b32 v16, 16, v128
v_and_b32 v17, s91, v128
v_lshlrev_b32 v18, 16, v129
v_and_b32 v19, s91, v129
v_lshlrev_b32 v20, 16, v130
v_and_b32 v21, s91, v130
v_lshlrev_b32 v22, 16, v131
v_and_b32 v23, s91, v131
s_waitcnt vmcnt(8)
v_lshlrev_b32 v2, 16, v132
v_and_b32 v3, s91, v132
v_pk_add_f32 v[16:17], v[16:17], v[2:3]
v_lshlrev_b32 v6, 16, v133
v_and_b32 v7, s91, v133
v_pk_add_f32 v[18:19], v[18:19], v[6:7]
v_lshlrev_b32 v2, 16, v134
v_and_b32 v3, s91, v134
v_pk_add_f32 v[20:21], v[20:21], v[2:3]
v_lshlrev_b32 v6, 16, v135
v_and_b32 v7, s91, v135
v_pk_add_f32 v[22:23], v[22:23], v[6:7]
s_waitcnt vmcnt(7)
v_lshlrev_b32 v2, 16, v136
v_and_b32 v3, s91, v136
v_pk_add_f32 v[16:17], v[16:17], v[2:3]
v_lshlrev_b32 v6, 16, v137
v_and_b32 v7, s91, v137
v_pk_add_f32 v[18:19], v[18:19], v[6:7]
v_lshlrev_b32 v2, 16, v138
v_and_b32 v3, s91, v138
v_pk_add_f32 v[20:21], v[20:21], v[2:3]
v_lshlrev_b32 v6, 16, v139
v_and_b32 v7, s91, v139
v_pk_add_f32 v[22:23], v[22:23], v[6:7]
s_waitcnt vmcnt(6)
v_lshlrev_b32 v2, 16, v140
v_and_b32 v3, s91, v140
v_pk_add_f32 v[16:17], v[16:17], v[2:3]
v_lshlrev_b32 v6, 16, v141
v_and_b32 v7, s91, v141
v_pk_add_f32 v[18:19], v[18:19], v[6:7]
v_lshlrev_b32 v2, 16, v142
v_and_b32 v3, s91, v142
v_pk_add_f32 v[20:21], v[20:21], v[2:3]
v_lshlrev_b32 v6, 16, v143
v_and_b32 v7, s91, v143
v_pk_add_f32 v[22:23], v[22:23], v[6:7]
s_waitcnt vmcnt(5)
v_lshlrev_b32 v2, 16, v144
v_and_b32 v3, s91, v144
v_pk_add_f32 v[16:17], v[16:17], v[2:3]
v_lshlrev_b32 v6, 16, v145
v_and_b32 v7, s91, v145
v_pk_add_f32 v[18:19], v[18:19], v[6:7]
v_lshlrev_b32 v2, 16, v146
v_and_b32 v3, s91, v146
v_pk_add_f32 v[20:21], v[20:21], v[2:3]
v_lshlrev_b32 v6, 16, v147
v_and_b32 v7, s91, v147
v_pk_add_f32 v[22:23], v[22:23], v[6:7]
s_waitcnt vmcnt(4)
v_lshlrev_b32 v2, 16, v148
v_and_b32 v3, s91, v148
v_pk_add_f32 v[16:17], v[16:17], v[2:3]
v_lshlrev_b32 v6, 16, v149
v_and_b32 v7, s91, v149
v_pk_add_f32 v[18:19], v[18:19], v[6:7]
v_lshlrev_b32 v2, 16, v150
v_and_b32 v3, s91, v150
v_pk_add_f32 v[20:21], v[20:21], v[2:3]
v_lshlrev_b32 v6, 16, v151
v_and_b32 v7, s91, v151
v_pk_add_f32 v[22:23], v[22:23], v[6:7]
s_waitcnt vmcnt(3)
v_lshlrev_b32 v2, 16, v152
v_and_b32 v3, s91, v152
v_pk_add_f32 v[16:17], v[16:17], v[2:3]
v_lshlrev_b32 v6, 16, v153
v_and_b32 v7, s91, v153
v_pk_add_f32 v[18:19], v[18:19], v[6:7]
v_lshlrev_b32 v2, 16, v154
v_and_b32 v3, s91, v154
v_pk_add_f32 v[20:21], v[20:21], v[2:3]
v_lshlrev_b32 v6, 16, v155
v_and_b32 v7, s91, v155
v_pk_add_f32 v[22:23], v[22:23], v[6:7]
s_waitcnt vmcnt(2)
v_lshlrev_b32 v2, 16, v156
v_and_b32 v3, s91, v156
v_pk_add_f32 v[16:17], v[16:17], v[2:3]
v_lshlrev_b32 v6, 16, v157
v_and_b32 v7, s91, v157
v_pk_add_f32 v[18:19], v[18:19], v[6:7]
v_lshlrev_b32 v2, 16, v158
v_and_b32 v3, s91, v158
v_pk_add_f32 v[20:21], v[20:21], v[2:3]
v_lshlrev_b32 v6, 16, v159
v_and_b32 v7, s91, v159
v_pk_add_f32 v[22:23], v[22:23], v[6:7]
s_nop 0
v_cvt_pk_bf16_f32 v32, v16, v17
v_cvt_pk_bf16_f32 v33, v18, v19
v_cvt_pk_bf16_f32 v34, v20, v21
v_cvt_pk_bf16_f32 v35, v22, v23
s_nop 1
v_permlane16_swap_b32 v32, v34
v_permlane16_swap_b32 v33, v35
buffer_store_dwordx4 v[32:35], v15, s[32:35], s7 offen
s_mul_i32 s93, s45, 96
s_add_u32 s93, s93, 1536
v_add_u32 v8, s93, v1
v_lshrrev_b32 v13, 8, v8
v_mul_u32_u24 v6, 43, v13
v_lshrrev_b32 v6, 7, v6
v_mul_u32_u24 v7, 3, v6
v_sub_u32 v13, v13, v7
v_bfe_u32 v7, v8, 6, 1
v_lshl_add_u32 v13, v13, 1, v7
v_and_b32 v7, 15, v8
v_lshl_add_u32 v13, v13, 4, v7
v_mul_u32_u24 v13, 1792, v13
v_add_u32 v6, s13, v6
v_subrev_u32 v7, 7, v6
v_min_u32 v6, v6, v7
v_lshl_add_u32 v13, v6, 7, v13
v_bfe_u32 v7, v8, 7, 1
v_lshl_add_u32 v13, v7, 6, v13
v_bfe_u32 v7, v8, 4, 1
v_lshl_add_u32 v13, v7, 5, v13
v_bfe_u32 v7, v8, 5, 1
v_lshl_add_u32 v13, v7, 4, v13
v_lshlrev_b32 v10, 4, v8
v_add_u32 v8, s93, v1
v_add_u32 v8, 64, v8
v_lshrrev_b32 v14, 8, v8
v_mul_u32_u24 v6, 43, v14
v_lshrrev_b32 v6, 7, v6
v_mul_u32_u24 v7, 3, v6
v_sub_u32 v14, v14, v7
v_bfe_u32 v7, v8, 6, 1
v_lshl_add_u32 v14, v14, 1, v7
v_and_b32 v7, 15, v8
v_lshl_add_u32 v14, v14, 4, v7
v_mul_u32_u24 v14, 1792, v14
v_add_u32 v6, s13, v6
v_subrev_u32 v7, 7, v6
v_min_u32 v6, v6, v7
v_lshl_add_u32 v14, v6, 7, v14
v_bfe_u32 v7, v8, 7, 1
v_lshl_add_u32 v14, v7, 6, v14
v_bfe_u32 v7, v8, 4, 1
v_lshl_add_u32 v14, v7, 5, v14
v_bfe_u32 v7, v8, 5, 1
v_lshl_add_u32 v14, v7, 4, v14
v_lshlrev_b32 v11, 4, v8
v_cmp_gt_u32 vcc, 32, v1
s_nop 1
v_cndmask_b32 v11, v9, v11, vcc
v_cndmask_b32 v14, v9, v14, vcc
s_mov_b32 s92, 0
L_sqw1:
s_mov_b32 s90, 0
s_atomic_add s90, s[72:73], 128 glc
s_add_u32 s92, s92, 1
L_sww1:
s_waitcnt lgkmcnt(0)
s_bitcmp1_b32 s92, 22
s_cbranch_scc1 L_sxw1
s_cmp_lt_u32 s90, 24
s_cbranch_scc1 L_sqw1
L_sxw1:
s_add_u32 s93, s6, 0
buffer_load_dwordx4 v[64:67], v10, s[28:31], s93 offen sc1
s_add_u32 s93, s6, 86016
buffer_load_dwordx4 v[68:71], v10, s[28:31], s93 offen sc1
s_add_u32 s93, s6, 2752512
buffer_load_dwordx4 v[72:75], v10, s[28:31], s93 offen sc1
s_add_u32 s93, s6, 2838528
buffer_load_dwordx4 v[76:79], v10, s[28:31], s93 offen sc1
s_add_u32 s93, s6, 5505024
buffer_load_dwordx4 v[80:83], v10, s[28:31], s93 offen sc1
s_add_u32 s93, s6, 5591040
buffer_load_dwordx4 v[84:87], v10, s[28:31], s93 offen sc1
s_add_u32 s93, s6, 8257536
buffer_load_dwordx4 v[88:91], v10, s[28:31], s93 offen sc1
s_add_u32 s93, s6, 8343552
buffer_load_dwordx4 v[92:95], v10, s[28:31], s93 offen sc1
s_add_u32 s93, s6, 0
buffer_load_dwordx4 v[96:99], v11, s[28:31], s93 offen sc1
s_add_u32 s93, s6, 86016
buffer_load_dwordx4 v[100:103], v11, s[28:31], s93 offen sc1
s_add_u32 s93, s6, 2752512
buffer_load_dwordx4 v[104:107], v11, s[28:31], s93 offen sc1
s_add_u32 s93, s6, 2838528
buffer_load_dwordx4 v[108:111], v11, s[28:31], s93 offen sc1
s_add_u32 s93, s6, 5505024
buffer_load_dwordx4 v[112:115], v11, s[28:31], s93 offen sc1
s_add_u32 s93, s6, 5591040
buffer_load_dwordx4 v[116:119], v11, s[28:31], s93 offen sc1
s_add_u32 s93, s6, 8257536
buffer_load_dwordx4 v[120:123], v11, s[28:31], s93 offen sc1
s_add_u32 s93, s6, 8343552
buffer_load_dwordx4 v[124:127], v11, s[28:31], s93 offen sc1
s_waitcnt vmcnt(15)
v_lshlrev_b32 v16, 16, v64
v_and_b32 v17, s91, v64
v_lshlrev_b32 v18, 16, v65
v_and_b32 v19, s91, v65
v_lshlrev_b32 v20, 16, v66
v_and_b32 v21, s91, v66
v_lshlrev_b32 v22, 16, v67
v_and_b32 v23, s91, v67
s_waitcnt vmcnt(14)
v_lshlrev_b32 v2, 16, v68
v_and_b32 v3, s91, v68
v_pk_add_f32 v[16:17], v[16:17], v[2:3]
v_lshlrev_b32 v6, 16, v69
v_and_b32 v7, s91, v69
v_pk_add_f32 v[18:19], v[18:19], v[6:7]
v_lshlrev_b32 v2, 16, v70
v_and_b32 v3, s91, v70
v_pk_add_f32 v[20:21], v[20:21], v[2:3]
v_lshlrev_b32 v6, 16, v71
v_and_b32 v7, s91, v71
v_pk_add_f32 v[22:23], v[22:23], v[6:7]
s_waitcnt vmcnt(13)
v_lshlrev_b32 v2, 16, v72
v_and_b32 v3, s91, v72
v_pk_add_f32 v[16:17], v[16:17], v[2:3]
v_lshlrev_b32 v6, 16, v73
v_and_b32 v7, s91, v73
v_pk_add_f32 v[18:19], v[18:19], v[6:7]
v_lshlrev_b32 v2, 16, v74
v_and_b32 v3, s91, v74
v_pk_add_f32 v[20:21], v[20:21], v[2:3]
v_lshlrev_b32 v6, 16, v75
v_and_b32 v7, s91, v75
v_pk_add_f32 v[22:23], v[22:23], v[6:7]
s_waitcnt vmcnt(12)
v_lshlrev_b32 v2, 16, v76
v_and_b32 v3, s91, v76
v_pk_add_f32 v[16:17], v[16:17], v[2:3]
v_lshlrev_b32 v6, 16, v77
v_and_b32 v7, s91, v77
v_pk_add_f32 v[18:19], v[18:19], v[6:7]
v_lshlrev_b32 v2, 16, v78
v_and_b32 v3, s91, v78
v_pk_add_f32 v[20:21], v[20:21], v[2:3]
v_lshlrev_b32 v6, 16, v79
v_and_b32 v7, s91, v79
v_pk_add_f32 v[22:23], v[22:23], v[6:7]
s_waitcnt vmcnt(11)
v_lshlrev_b32 v2, 16, v80
v_and_b32 v3, s91, v80
v_pk_add_f32 v[16:17], v[16:17], v[2:3]
v_lshlrev_b32 v6, 16, v81
v_and_b32 v7, s91, v81
v_pk_add_f32 v[18:19], v[18:19], v[6:7]
v_lshlrev_b32 v2, 16, v82
v_and_b32 v3, s91, v82
v_pk_add_f32 v[20:21], v[20:21], v[2:3]
v_lshlrev_b32 v6, 16, v83
v_and_b32 v7, s91, v83
v_pk_add_f32 v[22:23], v[22:23], v[6:7]
s_waitcnt vmcnt(10)
v_lshlrev_b32 v2, 16, v84
v_and_b32 v3, s91, v84
v_pk_add_f32 v[16:17], v[16:17], v[2:3]
v_lshlrev_b32 v6, 16, v85
v_and_b32 v7, s91, v85
v_pk_add_f32 v[18:19], v[18:19], v[6:7]
v_lshlrev_b32 v2, 16, v86
v_and_b32 v3, s91, v86
v_pk_add_f32 v[20:21], v[20:21], v[2:3]
v_lshlrev_b32 v6, 16, v87
v_and_b32 v7, s91, v87
v_pk_add_f32 v[22:23], v[22:23], v[6:7]
s_waitcnt vmcnt(9)
v_lshlrev_b32 v2, 16, v88
v_and_b32 v3, s91, v88
v_pk_add_f32 v[16:17], v[16:17], v[2:3]
v_lshlrev_b32 v6, 16, v89
v_and_b32 v7, s91, v89
v_pk_add_f32 v[18:19], v[18:19], v[6:7]
v_lshlrev_b32 v2, 16, v90
v_and_b32 v3, s91, v90
v_pk_add_f32 v[20:21], v[20:21], v[2:3]
v_lshlrev_b32 v6, 16, v91
v_and_b32 v7, s91, v91
v_pk_add_f32 v[22:23], v[22:23], v[6:7]
s_waitcnt vmcnt(8)
v_lshlrev_b32 v2, 16, v92
v_and_b32 v3, s91, v92
v_pk_add_f32 v[16:17], v[16:17], v[2:3]
v_lshlrev_b32 v6, 16, v93
v_and_b32 v7, s91, v93
v_pk_add_f32 v[18:19], v[18:19], v[6:7]
v_lshlrev_b32 v2, 16, v94
v_and_b32 v3, s91, v94
v_pk_add_f32 v[20:21], v[20:21], v[2:3]
v_lshlrev_b32 v6, 16, v95
v_and_b32 v7, s91, v95
v_pk_add_f32 v[22:23], v[22:23], v[6:7]
s_nop 0
v_cvt_pk_bf16_f32 v24, v16, v17
v_cvt_pk_bf16_f32 v25, v18, v19
v_cvt_pk_bf16_f32 v26, v20, v21
v_cvt_pk_bf16_f32 v27, v22, v23
s_nop 1
v_permlane16_swap_b32 v24, v26
v_permlane16_swap_b32 v25, v27
buffer_store_dwordx4 v[24:27], v13, s[32:35], s7 offen
s_waitcnt vmcnt(8)
v_lshlrev_b32 v16, 16, v96
v_and_b32 v17, s91, v96
v_lshlrev_b32 v18, 16, v97
v_and_b32 v19, s91, v97
v_lshlrev_b32 v20, 16, v98
v_and_b32 v21, s91, v98
v_lshlrev_b32 v22, 16, v99
v_and_b32 v23, s91, v99
s_waitcnt vmcnt(7)
v_lshlrev_b32 v2, 16, v100
v_and_b32 v3, s91, v100
v_pk_add_f32 v[16:17], v[16:17], v[2:3]
v_lshlrev_b32 v6, 16, v101
v_and_b32 v7, s91, v101
v_pk_add_f32 v[18:19], v[18:19], v[6:7]
v_lshlrev_b32 v2, 16, v102
v_and_b32 v3, s91, v102
v_pk_add_f32 v[20:21], v[20:21], v[2:3]
v_lshlrev_b32 v6, 16, v103
v_and_b32 v7, s91, v103
v_pk_add_f32 v[22:23], v[22:23], v[6:7]
s_waitcnt vmcnt(6)
v_lshlrev_b32 v2, 16, v104
v_and_b32 v3, s91, v104
v_pk_add_f32 v[16:17], v[16:17], v[2:3]
v_lshlrev_b32 v6, 16, v105
v_and_b32 v7, s91, v105
v_pk_add_f32 v[18:19], v[18:19], v[6:7]
v_lshlrev_b32 v2, 16, v106
v_and_b32 v3, s91, v106
v_pk_add_f32 v[20:21], v[20:21], v[2:3]
v_lshlrev_b32 v6, 16, v107
v_and_b32 v7, s91, v107
v_pk_add_f32 v[22:23], v[22:23], v[6:7]
s_waitcnt vmcnt(5)
v_lshlrev_b32 v2, 16, v108
v_and_b32 v3, s91, v108
v_pk_add_f32 v[16:17], v[16:17], v[2:3]
v_lshlrev_b32 v6, 16, v109
v_and_b32 v7, s91, v109
v_pk_add_f32 v[18:19], v[18:19], v[6:7]
v_lshlrev_b32 v2, 16, v110
v_and_b32 v3, s91, v110
v_pk_add_f32 v[20:21], v[20:21], v[2:3]
v_lshlrev_b32 v6, 16, v111
v_and_b32 v7, s91, v111
v_pk_add_f32 v[22:23], v[22:23], v[6:7]
s_waitcnt vmcnt(4)
v_lshlrev_b32 v2, 16, v112
v_and_b32 v3, s91, v112
v_pk_add_f32 v[16:17], v[16:17], v[2:3]
v_lshlrev_b32 v6, 16, v113
v_and_b32 v7, s91, v113
v_pk_add_f32 v[18:19], v[18:19], v[6:7]
v_lshlrev_b32 v2, 16, v114
v_and_b32 v3, s91, v114
v_pk_add_f32 v[20:21], v[20:21], v[2:3]
v_lshlrev_b32 v6, 16, v115
v_and_b32 v7, s91, v115
v_pk_add_f32 v[22:23], v[22:23], v[6:7]
s_waitcnt vmcnt(3)
v_lshlrev_b32 v2, 16, v116
v_and_b32 v3, s91, v116
v_pk_add_f32 v[16:17], v[16:17], v[2:3]
v_lshlrev_b32 v6, 16, v117
v_and_b32 v7, s91, v117
v_pk_add_f32 v[18:19], v[18:19], v[6:7]
v_lshlrev_b32 v2, 16, v118
v_and_b32 v3, s91, v118
v_pk_add_f32 v[20:21], v[20:21], v[2:3]
v_lshlrev_b32 v6, 16, v119
v_and_b32 v7, s91, v119
v_pk_add_f32 v[22:23], v[22:23], v[6:7]
s_waitcnt vmcnt(2)
v_lshlrev_b32 v2, 16, v120
v_and_b32 v3, s91, v120
v_pk_add_f32 v[16:17], v[16:17], v[2:3]
v_lshlrev_b32 v6, 16, v121
v_and_b32 v7, s91, v121
v_pk_add_f32 v[18:19], v[18:19], v[6:7]
v_lshlrev_b32 v2, 16, v122
v_and_b32 v3, s91, v122
v_pk_add_f32 v[20:21], v[20:21], v[2:3]
v_lshlrev_b32 v6, 16, v123
v_and_b32 v7, s91, v123
v_pk_add_f32 v[22:23], v[22:23], v[6:7]
s_waitcnt vmcnt(1)
v_lshlrev_b32 v2, 16, v124
v_and_b32 v3, s91, v124
v_pk_add_f32 v[16:17], v[16:17], v[2:3]
v_lshlrev_b32 v6, 16, v125
v_and_b32 v7, s91, v125
v_pk_add_f32 v[18:19], v[18:19], v[6:7]
v_lshlrev_b32 v2, 16, v126
v_and_b32 v3, s91, v126
v_pk_add_f32 v[20:21], v[20:21], v[2:3]
v_lshlrev_b32 v6, 16, v127
v_and_b32 v7, s91, v127
v_pk_add_f32 v[22:23], v[22:23], v[6:7]
s_nop 0
v_cvt_pk_bf16_f32 v28, v16, v17
v_cvt_pk_bf16_f32 v29, v18, v19
v_cvt_pk_bf16_f32 v30, v20, v21
v_cvt_pk_bf16_f32 v31, v22, v23
s_nop 1
v_permlane16_swap_b32 v28, v30
v_permlane16_swap_b32 v29, v31
buffer_store_dwordx4 v[28:31], v14, s[32:35], s7 offen
s_endpgm
L_iw10:
ds_read_b32 v54, v53 offset:15360
s_waitcnt lgkmcnt(0)
v_cmp_gt_u32 vcc, 1, v54
s_cbranch_vccnz L_iw10
s_branch L_ig10
L_iw12:
ds_read_b32 v54, v53 offset:15360
s_waitcnt lgkmcnt(0)
v_cmp_gt_u32 vcc, 2, v54
s_cbranch_vccnz L_iw12
s_branch L_ig12
L_iw13:
ds_read_b32 v54, v53 offset:15360
s_waitcnt lgkmcnt(0)
v_cmp_gt_u32 vcc, 3, v54
s_cbranch_vccnz L_iw13
s_branch L_ig13
L_iw16:
ds_read_b32 v54, v53 offset:15360
s_waitcnt lgkmcnt(0)
v_cmp_gt_u32 vcc, 4, v54
s_cbranch_vccnz L_iw16
s_branch L_ig16
L_iw17:
ds_read_b32 v54, v53 offset:15360
s_waitcnt lgkmcnt(0)
v_cmp_gt_u32 vcc, 5, v54
s_cbranch_vccnz L_iw17
s_branch L_ig17
L_iw18:
ds_read_b32 v54, v53 offset:15360
s_waitcnt lgkmcnt(0)
v_cmp_gt_u32 vcc, 6, v54
s_cbranch_vccnz L_iw18
s_branch L_ig18
L_iw20:
ds_read_b32 v54, v53 offset:15360
s_waitcnt lgkmcnt(0)
v_cmp_gt_u32 vcc, 7, v54
s_cbranch_vccnz L_iw20
s_branch L_ig20
L_iw21:
ds_read_b32 v54, v53 offset:15360
s_waitcnt lgkmcnt(0)
v_cmp_gt_u32 vcc, 8, v54
s_cbranch_vccnz L_iw21
s_branch L_ig21
L_iw22:
ds_read_b32 v54, v53 offset:15360
s_waitcnt lgkmcnt(0)
v_cmp_gt_u32 vcc, 9, v54
s_cbranch_vccnz L_iw22
s_branch L_ig22
L_iw23:
ds_read_b32 v54, v53 offset:15360
s_waitcnt lgkmcnt(0)
v_cmp_gt_u32 vcc, 10, v54
s_cbranch_vccnz L_iw23
s_branch L_ig23
L_ldQ0w:
ds_read_b32 v54, v53 offset:15360
s_waitcnt lgkmcnt(0)
L_ldQ0:
s_and_b32 s91, s6, 0xff
s_andn2_b32 m0, s6, 0xff
v_cmp_gt_u32 vcc, s91, v54
s_cbranch_vccnz L_ldQ0w
L_ldQ0g:
L_ldQ0v0:
s_waitcnt vmcnt(34)
buffer_load_dwordx4 v20, s[20:23], s7 offen lds
buffer_load_dwordx4 v21, s[20:23], s7 offen offset:1024 lds
s_waitcnt vmcnt(34)
buffer_load_dwordx4 v22, s[20:23], s7 offen offset:2048 lds
buffer_load_dwordx4 v23, s[20:23], s7 offen offset:3072 lds
s_add_u32 m0, m0, 4096
s_add_u32 s7, s7, 131072
s_waitcnt vmcnt(34)
buffer_load_dwordx4 v20, s[20:23], s7 offen lds
buffer_load_dwordx4 v21, s[20:23], s7 offen offset:1024 lds
s_waitcnt vmcnt(34)
buffer_load_dwordx4 v22, s[20:23], s7 offen offset:2048 lds
buffer_load_dwordx4 v23, s[20:23], s7 offen offset:3072 lds
s_add_u32 m0, m0, 4096
s_sub_u32 s7, s7, 98304
s_waitcnt vmcnt(34)
buffer_load_dwordx4 v20, s[20:23], s7 offen lds
buffer_load_dwordx4 v21, s[20:23], s7 offen offset:1024 lds
s_waitcnt vmcnt(34)
buffer_load_dwordx4 v22, s[20:23], s7 offen offset:2048 lds
buffer_load_dwordx4 v23, s[20:23], s7 offen offset:3072 lds
s_add_u32 m0, m0, 4096
s_add_u32 s7, s7, 131072
ds_read_b32 v54, v53 offset:15360
s_waitcnt vmcnt(34)
buffer_load_dwordx4 v20, s[20:23], s7 offen lds
buffer_load_dwordx4 v21, s[20:23], s7 offen offset:1024 lds
s_waitcnt vmcnt(34)
buffer_load_dwordx4 v22, s[20:23], s7 offen offset:2048 lds
buffer_load_dwordx4 v23, s[20:23], s7 offen offset:3072 lds
s_mov_b32 m0, 14336
s_add_u32 s92, s92, 4
buffer_load_dword off, s[36:39], s92 lds
s_setpc_b64 s[94:95]
L_ldK1w:
ds_read_b32 v54, v53 offset:15360
s_waitcnt lgkmcnt(0)
L_ldK1:
s_and_b32 s91, s6, 0xff
s_andn2_b32 m0, s6, 0xff
v_cmp_gt_u32 vcc, s91, v54
s_cbranch_vccnz L_ldK1w
L_ldK1g:
L_ldK1v0:
s_waitcnt vmcnt(34)
buffer_load_dwordx4 v24, s[12:15], s7 offen nt lds
buffer_load_dwordx4 v25, s[12:15], s7 offen offset:1024 nt lds
s_waitcnt vmcnt(34)
buffer_load_dwordx4 v26, s[12:15], s7 offen offset:2048 nt lds
buffer_load_dwordx4 v27, s[12:15], s7 offen offset:3072 nt lds
s_add_u32 m0, m0, 4096
s_add_u32 s7, s7, 4096
s_waitcnt vmcnt(34)
buffer_load_dwordx4 v28, s[12:15], s7 offen nt lds
buffer_load_dwordx4 v29, s[12:15], s7 offen offset:1024 nt lds
s_waitcnt vmcnt(34)
buffer_load_dwordx4 v30, s[12:15], s7 offen offset:2048 nt lds
buffer_load_dwordx4 v31, s[12:15], s7 offen offset:3072 nt lds
s_add_u32 m0, m0, 4096
s_add_u32 s7, s7, 4096
s_waitcnt vmcnt(34)
buffer_load_dwordx4 v24, s[12:15], s7 offen nt lds
buffer_load_dwordx4 v25, s[12:15], s7 offen offset:1024 nt lds
s_waitcnt vmcnt(34)
buffer_load_dwordx4 v26, s[12:15], s7 offen offset:2048 nt lds
buffer_load_dwordx4 v27, s[12:15], s7 offen offset:3072 nt lds
s_add_u32 m0, m0, 4096
s_add_u32 s7, s7, 4096
ds_read_b32 v54, v53 offset:15360
s_waitcnt vmcnt(34)
buffer_load_dwordx4 v28, s[12:15], s7 offen nt lds
buffer_load_dwordx4 v29, s[12:15], s7 offen offset:1024 nt lds
s_waitcnt vmcnt(34)
buffer_load_dwordx4 v30, s[12:15], s7 offen offset:2048 nt lds
buffer_load_dwordx4 v31, s[12:15], s7 offen offset:3072 nt lds
s_mov_b32 m0, 14336
s_add_u32 s92, s92, 4
buffer_load_dword off, s[36:39], s92 lds
s_setpc_b64 s[94:95]
L_ldK2w:
ds_read_b32 v54, v53 offset:15360
s_waitcnt lgkmcnt(0)
L_ldK2:
s_and_b32 s91, s6, 0xff
s_andn2_b32 m0, s6, 0xff
v_cmp_gt_u32 vcc, s91, v54
s_cbranch_vccnz L_ldK2w
L_ldK2g:
s_cmp_lt_u32 s92, s71
s_cbranch_scc1 L_ldK2v1
L_ldK2v0:
s_waitcnt vmcnt(34)
buffer_load_dwordx4 v24, s[12:15], s7 offen nt lds
buffer_load_dwordx4 v25, s[12:15], s7 offen offset:1024 nt lds
s_waitcnt vmcnt(34)
buffer_load_dwordx4 v26, s[12:15], s7 offen offset:2048 nt lds
buffer_load_dwordx4 v27, s[12:15], s7 offen offset:3072 nt lds
s_add_u32 m0, m0, 4096
s_add_u32 s7, s7, 4096
s_waitcnt vmcnt(34)
buffer_load_dwordx4 v28, s[12:15], s7 offen nt lds
buffer_load_dwordx4 v29, s[12:15], s7 offen offset:1024 nt lds
s_waitcnt vmcnt(34)
buffer_load_dwordx4 v30, s[12:15], s7 offen offset:2048 nt lds
buffer_load_dwordx4 v31, s[12:15], s7 offen offset:3072 nt lds
s_add_u32 m0, m0, 4096
s_add_u32 s7, s7, 4096
s_waitcnt vmcnt(23)
buffer_load_dwordx4 v24, s[12:15], s7 offen nt lds
buffer_load_dwordx4 v25, s[12:15], s7 offen offset:1024 nt lds
s_waitcnt vmcnt(23)
buffer_load_dwordx4 v26, s[12:15], s7 offen offset:2048 nt lds
buffer_load_dwordx4 v27, s[12:15], s7 offen offset:3072 nt lds
s_add_u32 m0, m0, 4096
s_add_u32 s7, s7, 4096
ds_read_b32 v54, v53 offset:15360
s_waitcnt vmcnt(23)
buffer_load_dwordx4 v28, s[12:15], s7 offen nt lds
buffer_load_dwordx4 v29, s[12:15], s7 offen offset:1024 nt lds
s_waitcnt vmcnt(23)
buffer_load_dwordx4 v30, s[12:15], s7 offen offset:2048 nt lds
buffer_load_dwordx4 v31, s[12:15], s7 offen offset:3072 nt lds
s_mov_b32 m0, 14336
s_add_u32 s92, s92, 4
buffer_load_dword off, s[36:39], s92 lds
s_setpc_b64 s[94:95]
L_ldK2v1:
s_waitcnt vmcnt(34)
buffer_load_dwordx4 v24, s[12:15], s7 offen nt lds
buffer_load_dwordx4 v25, s[12:15], s7 offen offset:1024 nt lds
s_waitcnt vmcnt(34)
buffer_load_dwordx4 v26, s[12:15], s7 offen offset:2048 nt lds
buffer_load_dwordx4 v27, s[12:15], s7 offen offset:3072 nt lds
s_add_u32 m0, m0, 4096
s_add_u32 s7, s7, 4096
s_waitcnt vmcnt(34)
buffer_load_dwordx4 v28, s[12:15], s7 offen nt lds
buffer_load_dwordx4 v29, s[12:15], s7 offen offset:1024 nt lds
s_waitcnt vmcnt(34)
buffer_load_dwordx4 v30, s[12:15], s7 offen offset:2048 nt lds
buffer_load_dwordx4 v31, s[12:15], s7 offen offset:3072 nt lds
s_add_u32 m0, m0, 4096
s_add_u32 s7, s7, 4096
s_waitcnt vmcnt(34)
buffer_load_dwordx4 v24, s[12:15], s7 offen nt lds
buffer_load_dwordx4 v25, s[12:15], s7 offen offset:1024 nt lds
s_waitcnt vmcnt(34)
buffer_load_dwordx4 v26, s[12:15], s7 offen offset:2048 nt lds
buffer_load_dwordx4 v27, s[12:15], s7 offen offset:3072 nt lds
s_add_u32 m0, m0, 4096
s_add_u32 s7, s7, 4096
ds_read_b32 v54, v53 offset:15360
s_waitcnt vmcnt(34)
buffer_load_dwordx4 v28, s[12:15], s7 offen nt lds
buffer_load_dwordx4 v29, s[12:15], s7 offen offset:1024 nt lds
s_waitcnt vmcnt(29)
buffer_load_dwordx4 v30, s[12:15], s7 offen offset:2048 nt lds
buffer_load_dwordx4 v31, s[12:15], s7 offen offset:3072 nt lds
s_mov_b32 m0, 14336
s_add_u32 s92, s92, 4
buffer_load_dword off, s[36:39], s92 lds
s_setpc_b64 s[94:95]
L_ldV3w:
ds_read_b32 v54, v53 offset:15360
s_waitcnt lgkmcnt(0)
L_ldV3:
s_and_b32 s91, s6, 0xff
s_andn2_b32 m0, s6, 0xff
v_cmp_gt_u32 vcc, s91, v54
s_cbranch_vccnz L_ldV3w
L_ldV3g:
s_cmp_lt_u32 s92, s71
s_cbranch_scc1 L_ldV3v1
L_ldV3v0:
s_waitcnt vmcnt(34)
buffer_load_dwordx4 v32, s[16:19], s7 offen nt lds
buffer_load_dwordx4 v33, s[16:19], s7 offen offset:1024 nt lds
s_waitcnt vmcnt(34)
buffer_load_dwordx4 v34, s[16:19], s7 offen offset:2048 nt lds
buffer_load_dwordx4 v35, s[16:19], s7 offen offset:3072 nt lds
s_add_u32 m0, m0, 4096
s_add_u32 s7, s7, 4096
s_waitcnt vmcnt(34)
buffer_load_dwordx4 v32, s[16:19], s7 offen nt lds
buffer_load_dwordx4 v33, s[16:19], s7 offen offset:1024 nt lds
s_waitcnt vmcnt(34)
buffer_load_dwordx4 v34, s[16:19], s7 offen offset:2048 nt lds
buffer_load_dwordx4 v35, s[16:19], s7 offen offset:3072 nt lds
s_add_u32 m0, m0, 4096
s_add_u32 s7, s7, 4096
s_waitcnt vmcnt(23)
buffer_load_dwordx4 v32, s[16:19], s7 offen nt lds
buffer_load_dwordx4 v33, s[16:19], s7 offen offset:1024 nt lds
s_waitcnt vmcnt(23)
buffer_load_dwordx4 v34, s[16:19], s7 offen offset:2048 nt lds
buffer_load_dwordx4 v35, s[16:19], s7 offen offset:3072 nt lds
s_add_u32 m0, m0, 4096
s_add_u32 s7, s7, 4096
ds_read_b32 v54, v53 offset:15360
s_waitcnt vmcnt(23)
buffer_load_dwordx4 v32, s[16:19], s7 offen nt lds
buffer_load_dwordx4 v33, s[16:19], s7 offen offset:1024 nt lds
s_waitcnt vmcnt(23)
buffer_load_dwordx4 v34, s[16:19], s7 offen offset:2048 nt lds
buffer_load_dwordx4 v35, s[16:19], s7 offen offset:3072 nt lds
s_mov_b32 m0, 14336
s_add_u32 s92, s92, 4
buffer_load_dword off, s[36:39], s92 lds
s_setpc_b64 s[94:95]
L_ldV3v1:
s_waitcnt vmcnt(34)
buffer_load_dwordx4 v32, s[16:19], s7 offen nt lds
buffer_load_dwordx4 v33, s[16:19], s7 offen offset:1024 nt lds
s_waitcnt vmcnt(34)
buffer_load_dwordx4 v34, s[16:19], s7 offen offset:2048 nt lds
buffer_load_dwordx4 v35, s[16:19], s7 offen offset:3072 nt lds
s_add_u32 m0, m0, 4096
s_add_u32 s7, s7, 4096
s_waitcnt vmcnt(34)
buffer_load_dwordx4 v32, s[16:19], s7 offen nt lds
buffer_load_dwordx4 v33, s[16:19], s7 offen offset:1024 nt lds
s_waitcnt vmcnt(34)
buffer_load_dwordx4 v34, s[16:19], s7 offen offset:2048 nt lds
buffer_load_dwordx4 v35, s[16:19], s7 offen offset:3072 nt lds
s_add_u32 m0, m0, 4096
s_add_u32 s7, s7, 4096
s_waitcnt vmcnt(34)
buffer_load_dwordx4 v32, s[16:19], s7 offen nt lds
buffer_load_dwordx4 v33, s[16:19], s7 offen offset:1024 nt lds
s_waitcnt vmcnt(34)
buffer_load_dwordx4 v34, s[16:19], s7 offen offset:2048 nt lds
buffer_load_dwordx4 v35, s[16:19], s7 offen offset:3072 nt lds
s_add_u32 m0, m0, 4096
s_add_u32 s7, s7, 4096
ds_read_b32 v54, v53 offset:15360
s_waitcnt vmcnt(34)
buffer_load_dwordx4 v32, s[16:19], s7 offen nt lds
buffer_load_dwordx4 v33, s[16:19], s7 offen offset:1024 nt lds
s_waitcnt vmcnt(29)
buffer_load_dwordx4 v34, s[16:19], s7 offen offset:2048 nt lds
buffer_load_dwordx4 v35, s[16:19], s7 offen offset:3072 nt lds
s_mov_b32 m0, 14336
s_add_u32 s92, s92, 4
buffer_load_dword off, s[36:39], s92 lds
s_setpc_b64 s[94:95]
L_ldV4w:
ds_read_b32 v54, v53 offset:15360
s_waitcnt lgkmcnt(0)
L_ldV4:
s_and_b32 s91, s6, 0xff
s_andn2_b32 m0, s6, 0xff
v_cmp_gt_u32 vcc, s91, v54
s_cbranch_vccnz L_ldV4w
L_ldV4g:
L_ldV4v0:
s_waitcnt vmcnt(34)
buffer_load_dwordx4 v32, s[16:19], s7 offen nt lds
buffer_load_dwordx4 v33, s[16:19], s7 offen offset:1024 nt lds
s_waitcnt vmcnt(34)
buffer_load_dwordx4 v34, s[16:19], s7 offen offset:2048 nt lds
buffer_load_dwordx4 v35, s[16:19], s7 offen offset:3072 nt lds
s_add_u32 m0, m0, 4096
s_add_u32 s7, s7, 4096
s_waitcnt vmcnt(34)
buffer_load_dwordx4 v32, s[16:19], s7 offen nt lds
buffer_load_dwordx4 v33, s[16:19], s7 offen offset:1024 nt lds
s_waitcnt vmcnt(34)
buffer_load_dwordx4 v34, s[16:19], s7 offen offset:2048 nt lds
buffer_load_dwordx4 v35, s[16:19], s7 offen offset:3072 nt lds
s_add_u32 m0, m0, 4096
s_add_u32 s7, s7, 4096
s_waitcnt vmcnt(34)
buffer_load_dwordx4 v32, s[16:19], s7 offen nt lds
buffer_load_dwordx4 v33, s[16:19], s7 offen offset:1024 nt lds
s_waitcnt vmcnt(34)
buffer_load_dwordx4 v34, s[16:19], s7 offen offset:2048 nt lds
buffer_load_dwordx4 v35, s[16:19], s7 offen offset:3072 nt lds
s_add_u32 m0, m0, 4096
s_add_u32 s7, s7, 4096
ds_read_b32 v54, v53 offset:15360
s_waitcnt vmcnt(34)
buffer_load_dwordx4 v32, s[16:19], s7 offen nt lds
buffer_load_dwordx4 v33, s[16:19], s7 offen offset:1024 nt lds
s_waitcnt vmcnt(34)
buffer_load_dwordx4 v34, s[16:19], s7 offen offset:2048 nt lds
buffer_load_dwordx4 v35, s[16:19], s7 offen offset:3072 nt lds
s_mov_b32 m0, 14336
s_add_u32 s92, s92, 4
buffer_load_dword off, s[36:39], s92 lds
s_setpc_b64 s[94:95]
L_ldV5w:
ds_read_b32 v54, v53 offset:15360
s_waitcnt lgkmcnt(0)
L_ldV5:
s_and_b32 s91, s6, 0xff
s_andn2_b32 m0, s6, 0xff
v_cmp_gt_u32 vcc, s91, v54
s_cbranch_vccnz L_ldV5w
L_ldV5g:
s_cmp_lt_u32 s92, s71
s_cbranch_scc1 L_ldV5v1
L_ldV5v0:
s_waitcnt vmcnt(24)
buffer_load_dwordx4 v32, s[16:19], s7 offen nt lds
buffer_load_dwordx4 v33, s[16:19], s7 offen offset:1024 nt lds
s_waitcnt vmcnt(24)
buffer_load_dwordx4 v34, s[16:19], s7 offen offset:2048 nt lds
buffer_load_dwordx4 v35, s[16:19], s7 offen offset:3072 nt lds
s_add_u32 m0, m0, 4096
s_add_u32 s7, s7, 4096
s_waitcnt vmcnt(24)
buffer_load_dwordx4 v32, s[16:19], s7 offen nt lds
buffer_load_dwordx4 v33, s[16:19], s7 offen offset:1024 nt lds
s_waitcnt vmcnt(24)
buffer_load_dwordx4 v34, s[16:19], s7 offen offset:2048 nt lds
buffer_load_dwordx4 v35, s[16:19], s7 offen offset:3072 nt lds
s_add_u32 m0, m0, 4096
s_add_u32 s7, s7, 4096
s_waitcnt vmcnt(23)
buffer_load_dwordx4 v32, s[16:19], s7 offen nt lds
buffer_load_dwordx4 v33, s[16:19], s7 offen offset:1024 nt lds
s_waitcnt vmcnt(23)
buffer_load_dwordx4 v34, s[16:19], s7 offen offset:2048 nt lds
buffer_load_dwordx4 v35, s[16:19], s7 offen offset:3072 nt lds
s_add_u32 m0, m0, 4096
s_add_u32 s7, s7, 4096
ds_read_b32 v54, v53 offset:15360
s_waitcnt vmcnt(23)
buffer_load_dwordx4 v32, s[16:19], s7 offen nt lds
buffer_load_dwordx4 v33, s[16:19], s7 offen offset:1024 nt lds
s_waitcnt vmcnt(23)
buffer_load_dwordx4 v34, s[16:19], s7 offen offset:2048 nt lds
buffer_load_dwordx4 v35, s[16:19], s7 offen offset:3072 nt lds
s_mov_b32 m0, 14336
s_add_u32 s92, s92, 4
buffer_load_dword off, s[36:39], s92 lds
s_setpc_b64 s[94:95]
L_ldV5v1:
s_waitcnt vmcnt(30)
buffer_load_dwordx4 v32, s[16:19], s7 offen nt lds
buffer_load_dwordx4 v33, s[16:19], s7 offen offset:1024 nt lds
s_waitcnt vmcnt(30)
buffer_load_dwordx4 v34, s[16:19], s7 offen offset:2048 nt lds
buffer_load_dwordx4 v35, s[16:19], s7 offen offset:3072 nt lds
s_add_u32 m0, m0, 4096
s_add_u32 s7, s7, 4096
s_waitcnt vmcnt(30)
buffer_load_dwordx4 v32, s[16:19], s7 offen nt lds
buffer_load_dwordx4 v33, s[16:19], s7 offen offset:1024 nt lds
s_waitcnt vmcnt(30)
buffer_load_dwordx4 v34, s[16:19], s7 offen offset:2048 nt lds
buffer_load_dwordx4 v35, s[16:19], s7 offen offset:3072 nt lds
s_add_u32 m0, m0, 4096
s_add_u32 s7, s7, 4096
s_waitcnt vmcnt(30)
buffer_load_dwordx4 v32, s[16:19], s7 offen nt lds
buffer_load_dwordx4 v33, s[16:19], s7 offen offset:1024 nt lds
s_waitcnt vmcnt(30)
buffer_load_dwordx4 v34, s[16:19], s7 offen offset:2048 nt lds
buffer_load_dwordx4 v35, s[16:19], s7 offen offset:3072 nt lds
s_add_u32 m0, m0, 4096
s_add_u32 s7, s7, 4096
ds_read_b32 v54, v53 offset:15360
s_waitcnt vmcnt(30)
buffer_load_dwordx4 v32, s[16:19], s7 offen nt lds
buffer_load_dwordx4 v33, s[16:19], s7 offen offset:1024 nt lds
s_waitcnt vmcnt(29)
buffer_load_dwordx4 v34, s[16:19], s7 offen offset:2048 nt lds
buffer_load_dwordx4 v35, s[16:19], s7 offen offset:3072 nt lds
s_mov_b32 m0, 14336
s_add_u32 s92, s92, 4
buffer_load_dword off, s[36:39], s92 lds
s_setpc_b64 s[94:95]
L_ldK6w:
ds_read_b32 v54, v53 offset:15360
s_waitcnt lgkmcnt(0)
L_ldK6:
s_and_b32 s91, s6, 0xff
s_andn2_b32 m0, s6, 0xff
v_cmp_gt_u32 vcc, s91, v54
s_cbranch_vccnz L_ldK6w
L_ldK6g:
s_cmp_lt_u32 s92, s71
s_cbranch_scc1 L_ldK6v1
L_ldK6v0:
s_waitcnt vmcnt(23)
buffer_load_dwordx4 v24, s[12:15], s7 offen nt lds
buffer_load_dwordx4 v25, s[12:15], s7 offen offset:1024 nt lds
s_waitcnt vmcnt(23)
buffer_load_dwordx4 v26, s[12:15], s7 offen offset:2048 nt lds
buffer_load_dwordx4 v27, s[12:15], s7 offen offset:3072 nt lds
s_add_u32 m0, m0, 4096
s_add_u32 s7, s7, 4096
s_waitcnt vmcnt(23)
buffer_load_dwordx4 v28, s[12:15], s7 offen nt lds
buffer_load_dwordx4 v29, s[12:15], s7 offen offset:1024 nt lds
s_waitcnt vmcnt(22)
buffer_load_dwordx4 v30, s[12:15], s7 offen offset:2048 nt lds
buffer_load_dwordx4 v31, s[12:15], s7 offen offset:3072 nt lds
s_add_u32 m0, m0, 4096
s_add_u32 s7, s7, 4096
s_waitcnt vmcnt(22)
buffer_load_dwordx4 v24, s[12:15], s7 offen nt lds
buffer_load_dwordx4 v25, s[12:15], s7 offen offset:1024 nt lds
s_waitcnt vmcnt(22)
buffer_load_dwordx4 v26, s[12:15], s7 offen offset:2048 nt lds
buffer_load_dwordx4 v27, s[12:15], s7 offen offset:3072 nt lds
s_add_u32 m0, m0, 4096
s_add_u32 s7, s7, 4096
ds_read_b32 v54, v53 offset:15360
s_waitcnt vmcnt(22)
buffer_load_dwordx4 v28, s[12:15], s7 offen nt lds
buffer_load_dwordx4 v29, s[12:15], s7 offen offset:1024 nt lds
s_waitcnt vmcnt(22)
buffer_load_dwordx4 v30, s[12:15], s7 offen offset:2048 nt lds
buffer_load_dwordx4 v31, s[12:15], s7 offen offset:3072 nt lds
s_mov_b32 m0, 14336
s_add_u32 s92, s92, 4
buffer_load_dword off, s[36:39], s92 lds
s_setpc_b64 s[94:95]
L_ldK6v1:
s_waitcnt vmcnt(29)
buffer_load_dwordx4 v24, s[12:15], s7 offen nt lds
buffer_load_dwordx4 v25, s[12:15], s7 offen offset:1024 nt lds
s_waitcnt vmcnt(29)
buffer_load_dwordx4 v26, s[12:15], s7 offen offset:2048 nt lds
buffer_load_dwordx4 v27, s[12:15], s7 offen offset:3072 nt lds
s_add_u32 m0, m0, 4096
s_add_u32 s7, s7, 4096
s_waitcnt vmcnt(29)
buffer_load_dwordx4 v28, s[12:15], s7 offen nt lds
buffer_load_dwordx4 v29, s[12:15], s7 offen offset:1024 nt lds
s_waitcnt vmcnt(29)
buffer_load_dwordx4 v30, s[12:15], s7 offen offset:2048 nt lds
buffer_load_dwordx4 v31, s[12:15], s7 offen offset:3072 nt lds
s_add_u32 m0, m0, 4096
s_add_u32 s7, s7, 4096
s_waitcnt vmcnt(29)
buffer_load_dwordx4 v24, s[12:15], s7 offen nt lds
buffer_load_dwordx4 v25, s[12:15], s7 offen offset:1024 nt lds
s_waitcnt vmcnt(29)
buffer_load_dwordx4 v26, s[12:15], s7 offen offset:2048 nt lds
buffer_load_dwordx4 v27, s[12:15], s7 offen offset:3072 nt lds
s_add_u32 m0, m0, 4096
s_add_u32 s7, s7, 4096
ds_read_b32 v54, v53 offset:15360
s_waitcnt vmcnt(28)
buffer_load_dwordx4 v28, s[12:15], s7 offen nt lds
buffer_load_dwordx4 v29, s[12:15], s7 offen offset:1024 nt lds
s_waitcnt vmcnt(28)
buffer_load_dwordx4 v30, s[12:15], s7 offen offset:2048 nt lds
buffer_load_dwordx4 v31, s[12:15], s7 offen offset:3072 nt lds
s_mov_b32 m0, 14336
s_add_u32 s92, s92, 4
buffer_load_dword off, s[36:39], s92 lds
s_setpc_b64 s[94:95]
L_ldC7w:
ds_read_b32 v54, v53 offset:15360
s_waitcnt lgkmcnt(0)
L_ldC7:
s_and_b32 s91, s6, 0xff
s_andn2_b32 m0, s6, 0xff
v_cmp_gt_u32 vcc, s91, v54
s_cbranch_vccnz L_ldC7w
L_ldC7g:
L_ldC7v0:
s_waitcnt vmcnt(34)
buffer_load_dwordx4 v44, s[24:27], s7 offen lds
buffer_load_dwordx4 v45, s[24:27], s7 offen offset:1024 lds
s_waitcnt vmcnt(34)
buffer_load_dwordx4 v46, s[24:27], s7 offen offset:2048 lds
buffer_load_dwordx4 v47, s[24:27], s7 offen offset:3072 lds
s_add_u32 m0, m0, 4096
s_add_u32 s7, s7, 28672
s_waitcnt vmcnt(34)
buffer_load_dwordx4 v44, s[24:27], s7 offen lds
buffer_load_dwordx4 v45, s[24:27], s7 offen offset:1024 lds
s_waitcnt vmcnt(34)
buffer_load_dwordx4 v46, s[24:27], s7 offen offset:2048 lds
buffer_load_dwordx4 v47, s[24:27], s7 offen offset:3072 lds
s_add_u32 m0, m0, 4096
s_add_u32 s7, s7, 28672
s_waitcnt vmcnt(34)
buffer_load_dwordx4 v44, s[24:27], s7 offen lds
buffer_load_dwordx4 v45, s[24:27], s7 offen offset:1024 lds
s_waitcnt vmcnt(34)
buffer_load_dwordx4 v46, s[24:27], s7 offen offset:2048 lds
buffer_load_dwordx4 v47, s[24:27], s7 offen offset:3072 lds
s_add_u32 m0, m0, 4096
s_add_u32 s7, s7, 28672
ds_read_b32 v54, v53 offset:15360
s_waitcnt vmcnt(34)
buffer_load_dwordx4 v44, s[24:27], s7 offen lds
buffer_load_dwordx4 v45, s[24:27], s7 offen offset:1024 lds
s_waitcnt vmcnt(34)
buffer_load_dwordx4 v46, s[24:27], s7 offen offset:2048 lds
buffer_load_dwordx4 v47, s[24:27], s7 offen offset:3072 lds
s_mov_b32 m0, 14336
s_add_u32 s92, s92, 4
buffer_load_dword off, s[36:39], s92 lds
s_setpc_b64 s[94:95]
L_ldK8w:
ds_read_b32 v54, v53 offset:15360
s_waitcnt lgkmcnt(0)
L_ldK8:
s_and_b32 s91, s6, 0xff
s_andn2_b32 m0, s6, 0xff
v_cmp_gt_u32 vcc, s91, v54
s_cbranch_vccnz L_ldK8w
L_ldK8g:
s_cmp_lt_u32 s92, s71
s_cbranch_scc1 L_ldK8v1
L_ldK8v0:
s_waitcnt vmcnt(34)
buffer_load_dwordx4 v24, s[12:15], s7 offen nt lds
buffer_load_dwordx4 v25, s[12:15], s7 offen offset:1024 nt lds
s_waitcnt vmcnt(34)
buffer_load_dwordx4 v26, s[12:15], s7 offen offset:2048 nt lds
buffer_load_dwordx4 v27, s[12:15], s7 offen offset:3072 nt lds
s_add_u32 m0, m0, 4096
s_add_u32 s7, s7, 4096
s_waitcnt vmcnt(34)
buffer_load_dwordx4 v28, s[12:15], s7 offen nt lds
buffer_load_dwordx4 v29, s[12:15], s7 offen offset:1024 nt lds
s_waitcnt vmcnt(22)
buffer_load_dwordx4 v30, s[12:15], s7 offen offset:2048 nt lds
buffer_load_dwordx4 v31, s[12:15], s7 offen offset:3072 nt lds
s_add_u32 m0, m0, 4096
s_add_u32 s7, s7, 4096
s_waitcnt vmcnt(22)
buffer_load_dwordx4 v24, s[12:15], s7 offen nt lds
buffer_load_dwordx4 v25, s[12:15], s7 offen offset:1024 nt lds
s_waitcnt vmcnt(22)
buffer_load_dwordx4 v26, s[12:15], s7 offen offset:2048 nt lds
buffer_load_dwordx4 v27, s[12:15], s7 offen offset:3072 nt lds
s_add_u32 m0, m0, 4096
s_add_u32 s7, s7, 4096
ds_read_b32 v54, v53 offset:15360
s_waitcnt vmcnt(22)
buffer_load_dwordx4 v28, s[12:15], s7 offen nt lds
buffer_load_dwordx4 v29, s[12:15], s7 offen offset:1024 nt lds
s_waitcnt vmcnt(22)
buffer_load_dwordx4 v30, s[12:15], s7 offen offset:2048 nt lds
buffer_load_dwordx4 v31, s[12:15], s7 offen offset:3072 nt lds
s_mov_b32 m0, 14336
s_add_u32 s92, s92, 4
buffer_load_dword off, s[36:39], s92 lds
s_setpc_b64 s[94:95]
L_ldK8v1:
s_waitcnt vmcnt(34)
buffer_load_dwordx4 v24, s[12:15], s7 offen nt lds
buffer_load_dwordx4 v25, s[12:15], s7 offen offset:1024 nt lds
s_waitcnt vmcnt(34)
buffer_load_dwordx4 v26, s[12:15], s7 offen offset:2048 nt lds
buffer_load_dwordx4 v27, s[12:15], s7 offen offset:3072 nt lds
s_add_u32 m0, m0, 4096
s_add_u32 s7, s7, 4096
s_waitcnt vmcnt(34)
buffer_load_dwordx4 v28, s[12:15], s7 offen nt lds
buffer_load_dwordx4 v29, s[12:15], s7 offen offset:1024 nt lds
s_waitcnt vmcnt(34)
buffer_load_dwordx4 v30, s[12:15], s7 offen offset:2048 nt lds
buffer_load_dwordx4 v31, s[12:15], s7 offen offset:3072 nt lds
s_add_u32 m0, m0, 4096
s_add_u32 s7, s7, 4096
s_waitcnt vmcnt(34)
buffer_load_dwordx4 v24, s[12:15], s7 offen nt lds
buffer_load_dwordx4 v25, s[12:15], s7 offen offset:1024 nt lds
s_waitcnt vmcnt(34)
buffer_load_dwordx4 v26, s[12:15], s7 offen offset:2048 nt lds
buffer_load_dwordx4 v27, s[12:15], s7 offen offset:3072 nt lds
s_add_u32 m0, m0, 4096
s_add_u32 s7, s7, 4096
ds_read_b32 v54, v53 offset:15360
s_waitcnt vmcnt(28)
buffer_load_dwordx4 v28, s[12:15], s7 offen nt lds
buffer_load_dwordx4 v29, s[12:15], s7 offen offset:1024 nt lds
s_waitcnt vmcnt(28)
buffer_load_dwordx4 v30, s[12:15], s7 offen offset:2048 nt lds
buffer_load_dwordx4 v31, s[12:15], s7 offen offset:3072 nt lds
s_mov_b32 m0, 14336
s_add_u32 s92, s92, 4
buffer_load_dword off, s[36:39], s92 lds
s_setpc_b64 s[94:95]
L_ldV9w:
ds_read_b32 v54, v53 offset:15360
s_waitcnt lgkmcnt(0)
L_ldV9:
s_and_b32 s91, s6, 0xff
s_andn2_b32 m0, s6, 0xff
v_cmp_gt_u32 vcc, s91, v54
s_cbranch_vccnz L_ldV9w
L_ldV9g:
s_cmp_lt_u32 s92, s71
s_cbranch_scc1 L_ldV9v1
L_ldV9v0:
s_waitcnt vmcnt(34)
buffer_load_dwordx4 v32, s[16:19], s7 offen nt lds
buffer_load_dwordx4 v33, s[16:19], s7 offen offset:1024 nt lds
s_waitcnt vmcnt(34)
buffer_load_dwordx4 v34, s[16:19], s7 offen offset:2048 nt lds
buffer_load_dwordx4 v35, s[16:19], s7 offen offset:3072 nt lds
s_add_u32 m0, m0, 4096
s_add_u32 s7, s7, 4096
s_waitcnt vmcnt(34)
buffer_load_dwordx4 v32, s[16:19], s7 offen nt lds
buffer_load_dwordx4 v33, s[16:19], s7 offen offset:1024 nt lds
s_waitcnt vmcnt(22)
buffer_load_dwordx4 v34, s[16:19], s7 offen offset:2048 nt lds
buffer_load_dwordx4 v35, s[16:19], s7 offen offset:3072 nt lds
s_add_u32 m0, m0, 4096
s_add_u32 s7, s7, 4096
s_waitcnt vmcnt(22)
buffer_load_dwordx4 v32, s[16:19], s7 offen nt lds
buffer_load_dwordx4 v33, s[16:19], s7 offen offset:1024 nt lds
s_waitcnt vmcnt(22)
buffer_load_dwordx4 v34, s[16:19], s7 offen offset:2048 nt lds
buffer_load_dwordx4 v35, s[16:19], s7 offen offset:3072 nt lds
s_add_u32 m0, m0, 4096
s_add_u32 s7, s7, 4096
ds_read_b32 v54, v53 offset:15360
s_waitcnt vmcnt(22)
buffer_load_dwordx4 v32, s[16:19], s7 offen nt lds
buffer_load_dwordx4 v33, s[16:19], s7 offen offset:1024 nt lds
s_waitcnt vmcnt(22)
buffer_load_dwordx4 v34, s[16:19], s7 offen offset:2048 nt lds
buffer_load_dwordx4 v35, s[16:19], s7 offen offset:3072 nt lds
s_mov_b32 m0, 14336
s_add_u32 s92, s92, 4
buffer_load_dword off, s[36:39], s92 lds
s_setpc_b64 s[94:95]
L_ldV9v1:
s_waitcnt vmcnt(34)
buffer_load_dwordx4 v32, s[16:19], s7 offen nt lds
buffer_load_dwordx4 v33, s[16:19], s7 offen offset:1024 nt lds
s_waitcnt vmcnt(34)
buffer_load_dwordx4 v34, s[16:19], s7 offen offset:2048 nt lds
buffer_load_dwordx4 v35, s[16:19], s7 offen offset:3072 nt lds
s_add_u32 m0, m0, 4096
s_add_u32 s7, s7, 4096
s_waitcnt vmcnt(34)
buffer_load_dwordx4 v32, s[16:19], s7 offen nt lds
buffer_load_dwordx4 v33, s[16:19], s7 offen offset:1024 nt lds
s_waitcnt vmcnt(34)
buffer_load_dwordx4 v34, s[16:19], s7 offen offset:2048 nt lds
buffer_load_dwordx4 v35, s[16:19], s7 offen offset:3072 nt lds
s_add_u32 m0, m0, 4096
s_add_u32 s7, s7, 4096
s_waitcnt vmcnt(34)
buffer_load_dwordx4 v32, s[16:19], s7 offen nt lds
buffer_load_dwordx4 v33, s[16:19], s7 offen offset:1024 nt lds
s_waitcnt vmcnt(34)
buffer_load_dwordx4 v34, s[16:19], s7 offen offset:2048 nt lds
buffer_load_dwordx4 v35, s[16:19], s7 offen offset:3072 nt lds
s_add_u32 m0, m0, 4096
s_add_u32 s7, s7, 4096
ds_read_b32 v54, v53 offset:15360
s_waitcnt vmcnt(28)
buffer_load_dwordx4 v32, s[16:19], s7 offen nt lds
buffer_load_dwordx4 v33, s[16:19], s7 offen offset:1024 nt lds
s_waitcnt vmcnt(28)
buffer_load_dwordx4 v34, s[16:19], s7 offen offset:2048 nt lds
buffer_load_dwordx4 v35, s[16:19], s7 offen offset:3072 nt lds
s_mov_b32 m0, 14336
s_add_u32 s92, s92, 4
buffer_load_dword off, s[36:39], s92 lds
s_setpc_b64 s[94:95]
L_ldV10w:
ds_read_b32 v54, v53 offset:15360
s_waitcnt lgkmcnt(0)
L_ldV10:
s_and_b32 s91, s6, 0xff
s_andn2_b32 m0, s6, 0xff
v_cmp_gt_u32 vcc, s91, v54
s_cbranch_vccnz L_ldV10w
L_ldV10g:
s_cmp_lt_u32 s92, s71
s_cbranch_scc1 L_ldV10v1
L_ldV10v0:
s_waitcnt vmcnt(23)
buffer_load_dwordx4 v32, s[16:19], s7 offen nt lds
buffer_load_dwordx4 v33, s[16:19], s7 offen offset:1024 nt lds
s_waitcnt vmcnt(23)
buffer_load_dwordx4 v34, s[16:19], s7 offen offset:2048 nt lds
buffer_load_dwordx4 v35, s[16:19], s7 offen offset:3072 nt lds
s_add_u32 m0, m0, 4096
s_add_u32 s7, s7, 4096
s_waitcnt vmcnt(23)
buffer_load_dwordx4 v32, s[16:19], s7 offen nt lds
buffer_load_dwordx4 v33, s[16:19], s7 offen offset:1024 nt lds
s_waitcnt vmcnt(22)
buffer_load_dwordx4 v34, s[16:19], s7 offen offset:2048 nt lds
buffer_load_dwordx4 v35, s[16:19], s7 offen offset:3072 nt lds
s_add_u32 m0, m0, 4096
s_add_u32 s7, s7, 4096
s_waitcnt vmcnt(22)
buffer_load_dwordx4 v32, s[16:19], s7 offen nt lds
buffer_load_dwordx4 v33, s[16:19], s7 offen offset:1024 nt lds
s_waitcnt vmcnt(22)
buffer_load_dwordx4 v34, s[16:19], s7 offen offset:2048 nt lds
buffer_load_dwordx4 v35, s[16:19], s7 offen offset:3072 nt lds
s_add_u32 m0, m0, 4096
s_add_u32 s7, s7, 4096
ds_read_b32 v54, v53 offset:15360
s_waitcnt vmcnt(22)
buffer_load_dwordx4 v32, s[16:19], s7 offen nt lds
buffer_load_dwordx4 v33, s[16:19], s7 offen offset:1024 nt lds
s_waitcnt vmcnt(22)
buffer_load_dwordx4 v34, s[16:19], s7 offen offset:2048 nt lds
buffer_load_dwordx4 v35, s[16:19], s7 offen offset:3072 nt lds
s_mov_b32 m0, 14336
s_add_u32 s92, s92, 4
buffer_load_dword off, s[36:39], s92 lds
s_setpc_b64 s[94:95]
L_ldV10v1:
s_waitcnt vmcnt(29)
buffer_load_dwordx4 v32, s[16:19], s7 offen nt lds
buffer_load_dwordx4 v33, s[16:19], s7 offen offset:1024 nt lds
s_waitcnt vmcnt(29)
buffer_load_dwordx4 v34, s[16:19], s7 offen offset:2048 nt lds
buffer_load_dwordx4 v35, s[16:19], s7 offen offset:3072 nt lds
s_add_u32 m0, m0, 4096
s_add_u32 s7, s7, 4096
s_waitcnt vmcnt(29)
buffer_load_dwordx4 v32, s[16:19], s7 offen nt lds
buffer_load_dwordx4 v33, s[16:19], s7 offen offset:1024 nt lds
s_waitcnt vmcnt(29)
buffer_load_dwordx4 v34, s[16:19], s7 offen offset:2048 nt lds
buffer_load_dwordx4 v35, s[16:19], s7 offen offset:3072 nt lds
s_add_u32 m0, m0, 4096
s_add_u32 s7, s7, 4096
s_waitcnt vmcnt(29)
buffer_load_dwordx4 v32, s[16:19], s7 offen nt lds
buffer_load_dwordx4 v33, s[16:19], s7 offen offset:1024 nt lds
s_waitcnt vmcnt(29)
buffer_load_dwordx4 v34, s[16:19], s7 offen offset:2048 nt lds
buffer_load_dwordx4 v35, s[16:19], s7 offen offset:3072 nt lds
s_add_u32 m0, m0, 4096
s_add_u32 s7, s7, 4096
ds_read_b32 v54, v53 offset:15360
s_waitcnt vmcnt(28)
buffer_load_dwordx4 v32, s[16:19], s7 offen nt lds
buffer_load_dwordx4 v33, s[16:19], s7 offen offset:1024 nt lds
s_waitcnt vmcnt(28)
buffer_load_dwordx4 v34, s[16:19], s7 offen offset:2048 nt lds
buffer_load_dwordx4 v35, s[16:19], s7 offen offset:3072 nt lds
s_mov_b32 m0, 14336
s_add_u32 s92, s92, 4
buffer_load_dword off, s[36:39], s92 lds
s_setpc_b64 s[94:95]
.p2align 6
L_comp:
s_lshl_b32 s4, s3, 8
s_add_u32 m0, s4, 14336
v_mov_b32 v4, 0
ds_write_addtid_b32 v4
ds_write_addtid_b32 v4 offset:1024
s_add_u32 m0, s4, 15360
s_waitcnt lgkmcnt(0)
s_barrier
v_and_b32 v4, 15, v0
v_lshrrev_b32 v5, 4, v0
v_lshrrev_b32 v6, 2, v0
v_lshrrev_b32 v7, 1, v4
v_xor_b32 v7, v7, v5
v_lshlrev_b32 v7, 4, v7
v_lshl_add_u32 v3, v4, 7, v7
s_lshl_b32 s4, s3, 12
v_add_u32 v3, s4, v3
s_mul_i32 s5, s42, 37
s_bfe_u32 s5, s5, 0x10008
s_lshl_b32 s5, s5, 6
v_xor_b32 v3, s5, v3
v_bfe_u32 v7, v0, 4, 1
v_lshrrev_b32 v10, 5, v0
v_lshl_add_u32 v7, v7, 1, v10
v_xor_b32 v7, v7, v4
v_lshlrev_b32 v7, 4, v7
v_lshl_add_u32 v9, v4, 9, v7
v_and_b32 v7, 7, v6
v_lshlrev_b32 v7, 5, v7
v_lshl_add_u32 v7, v6, 9, v7
v_and_b32 v10, 3, v0
v_lshl_add_u32 v1, v10, 3, v7
s_mov_b32 s48, 0x3db8aa3b
s_mov_b32 s50, 0xffff0000
s_mov_b32 s21, 0x3f803f80
s_and_b32 s46, s2, 7
s_lshl_b32 s46, s46, 5
s_lshr_b32 s7, s2, 3
s_add_u32 s46, s46, s7
s_lshl_b32 s47, s40, 4
s_add_u32 s47, s47, s42
s_mov_b32 s30, 285868032
s_mov_b32 s31, 0x20000
s_mov_b32 s34, 2752512
s_mov_b32 s35, 0x20000
s_mov_b32 s38, 256
s_mov_b32 s39, 0x20000
s_mul_i32 s49, s46, 86016
s_add_u32 s49, s49, s4
s_mov_b64 s[28:29], s[88:89]
s_mov_b64 s[32:33], s[84:85]
s_mov_b64 s[36:37], s[86:87]
s_mul_i32 s6, s47, 5248
s_add_u32 s6, s6, 22020096
s_add_u32 s16, s88, s6
s_addc_u32 s17, s89, 0
s_mul_i32 s5, s3, 128
s_add_u32 s22, s6, s5
s_mov_b32 s23, s6
s_add_u32 s18, s16, s5
s_addc_u32 s19, s17, 0
s_mov_b32 s20, 1
s_mov_b32 s90, 1
s_lshl_b32 s5, s45, 2
s_add_u32 s5, s5, s3
s_cmp_eq_u32 s5, 1
s_cselect_b32 s5, 0, 2147479552
v_lshl_add_u32 v32, v0, 4, s5
v_mov_b32 v36, 0
v_mov_b32 v37, 0
v_mov_b32 v38, 0
v_mov_b32 v39, 0
v_lshrrev_b32 v41, 3, v0
v_mul_u32_u24 v41, 0, v41
v_add_u32 v41, v41, v32
buffer_store_dwordx4 v[36:39], v41, s[28:31], s6 offen sc1
s_lshl_b32 s4, s47, 2
v_lshlrev_b32 v32, 8, v32
v_add_u32 v32, s4, v32
v_mov_b32 v33, 1
s_mov_b32 s51, 0
s_getpc_b64 s[8:9]
L_tpc:
s_add_u32 s8, s8, L_tab-L_tpc
s_addc_u32 s9, s9, 0
s_mov_b32 s10, 1024
s_mov_b32 s11, 0x20000
s_mov_b32 s12, 0
v_mov_b32 v8, 0
s_cmp_lg_u32 s3, 2
s_cbranch_scc1 L_pg0
s_call_b64 s[94:95], L_stub1
s_call_b64 s[94:95], L_stub2
s_call_b64 s[94:95], L_stub3
s_call_b64 s[94:95], L_stub4
s_branch L_pg0
L_sp0:
v_mov_b32 v8, 0
ds_read_b32 v8, v8 offset:14336
s_waitcnt lgkmcnt(0)
v_cmp_le_u32 vcc, 2, v8
s_cbranch_vccz L_sp0
s_branch L_ok0
L_sp1:
v_mov_b32 v8, 0
ds_read_b32 v8, v8 offset:14336
s_waitcnt lgkmcnt(0)
v_cmp_le_u32 vcc, 3, v8
s_cbranch_vccz L_sp1
s_branch L_ok1
L_sp2:
v_mov_b32 v8, 0
ds_read_b32 v8, v8 offset:14336
s_waitcnt lgkmcnt(0)
v_cmp_le_u32 vcc, 6, v8
s_cbranch_vccz L_sp2
s_branch L_ok2
L_sp3:
v_mov_b32 v8, 0
ds_read_b32 v8, v8 offset:14336
s_waitcnt lgkmcnt(0)
v_cmp_le_u32 vcc, 7, v8
s_cbranch_vccz L_sp3
s_branch L_ok3
L_sp4:
v_mov_b32 v8, 0
ds_read_b32 v8, v8 offset:14336
s_waitcnt lgkmcnt(0)
v_cmp_le_u32 vcc, 8, v8
s_cbranch_vccz L_sp4
s_branch L_ok4
L_sp5:
v_mov_b32 v8, 0
ds_read_b32 v8, v8 offset:14336
s_waitcnt lgkmcnt(0)
v_cmp_le_u32 vcc, 10, v8
s_cbranch_vccz L_sp5
s_branch L_ok5
.p2align 12
L_stub0:
s_setpc_b64 s[94:95]
L_pg0:
v_cmp_le_u32 vcc, 2, v8
v_xor_b32 v4, 16384, v1
s_cbranch_vccz L_sp0
L_ok0:
v_xor_b32 v0, 0, v3
ds_read_b128 a[0:3], v0
ds_read_b128 a[4:7], v0 offset:2048
ds_read_b64_tr_b16 v[12:13], v4
ds_read_b64_tr_b16 v[14:15], v4 offset:8192
ds_read_b64_tr_b16 v[16:17], v4 offset:256
ds_read_b64_tr_b16 v[18:19], v4 offset:8448
v_xor_b32 v5, 16416, v1
ds_read_b64_tr_b16 v[20:21], v5
ds_read_b64_tr_b16 v[22:23], v5 offset:8192
ds_read_b64_tr_b16 v[24:25], v5 offset:256
ds_read_b64_tr_b16 v[26:27], v5 offset:8448
v_xor_b32 v4, 16448, v1
s_waitcnt lgkmcnt(4)
v_mfma_f32_16x16x32_bf16 v[128:131], v[12:15], a[0:3], 0
ds_read_b64_tr_b16 v[28:29], v4
v_xor_b32 v2, 64, v3
v_mfma_f32_16x16x32_bf16 v[132:135], v[12:15], a[4:7], 0
ds_read_b64_tr_b16 v[30:31], v4 offset:8192
ds_read_b128 a[8:11], v2
v_mfma_f32_16x16x32_bf16 v[192:195], v[16:19], a[0:3], 0
ds_read_b64_tr_b16 v[12:13], v4 offset:256
v_xor_b32 v5, 16480, v1
v_mfma_f32_16x16x32_bf16 v[196:199], v[16:19], a[4:7], 0
ds_read_b64_tr_b16 v[14:15], v4 offset:8448
s_waitcnt lgkmcnt(5)
v_mfma_f32_16x16x32_bf16 v[136:139], v[20:23], a[0:3], 0
ds_read_b64_tr_b16 v[16:17], v5
v_mov_b32 v8, 0
v_mfma_f32_16x16x32_bf16 v[140:143], v[20:23], a[4:7], 0
ds_read_b64_tr_b16 v[18:19], v5 offset:8192
ds_read_b128 a[12:15], v2 offset:2048
v_mfma_f32_16x16x32_bf16 v[200:203], v[24:27], a[0:3], 0
ds_read_b64_tr_b16 v[20:21], v5 offset:256
v_xor_b32 v4, 16512, v1
v_mfma_f32_16x16x32_bf16 v[204:207], v[24:27], a[4:7], 0
ds_read_b64_tr_b16 v[22:23], v5 offset:8448
s_waitcnt lgkmcnt(5)
v_mfma_f32_16x16x32_bf16 v[144:147], v[28:31], a[0:3], 0
ds_read_b64_tr_b16 v[24:25], v4
v_mfma_f32_16x16x32_bf16 v[148:151], v[28:31], a[4:7], 0
ds_read_b64_tr_b16 v[26:27], v4 offset:8192
ds_read_b32 v8, v8 offset:14336
v_mfma_f32_16x16x32_bf16 v[208:211], v[12:15], a[0:3], 0
ds_read_b64_tr_b16 v[28:29], v4 offset:256
v_xor_b32 v5, 16544, v1
v_mfma_f32_16x16x32_bf16 v[212:215], v[12:15], a[4:7], 0
ds_read_b64_tr_b16 v[30:31], v4 offset:8448
s_waitcnt lgkmcnt(5)
v_mfma_f32_16x16x32_bf16 v[152:155], v[16:19], a[0:3], 0
ds_read_b64_tr_b16 v[12:13], v5
v_mfma_f32_16x16x32_bf16 v[156:159], v[16:19], a[4:7], 0
ds_read_b64_tr_b16 v[14:15], v5 offset:8192
v_mfma_f32_16x16x32_bf16 v[216:219], v[20:23], a[0:3], 0
ds_read_b64_tr_b16 v[16:17], v5 offset:256
v_xor_b32 v4, 16576, v1
v_mfma_f32_16x16x32_bf16 v[220:223], v[20:23], a[4:7], 0
ds_read_b64_tr_b16 v[18:19], v5 offset:8448
s_waitcnt lgkmcnt(4)
v_mfma_f32_16x16x32_bf16 v[160:163], v[24:27], a[0:3], 0
ds_read_b64_tr_b16 v[20:21], v4
v_cmp_le_u32 vcc, 3, v8
v_mfma_f32_16x16x32_bf16 v[164:167], v[24:27], a[4:7], 0
ds_read_b64_tr_b16 v[22:23], v4 offset:8192
v_mfma_f32_16x16x32_bf16 v[224:227], v[28:31], a[0:3], 0
ds_read_b64_tr_b16 v[24:25], v4 offset:256
v_xor_b32 v5, 16608, v1
v_mfma_f32_16x16x32_bf16 v[228:231], v[28:31], a[4:7], 0
ds_read_b64_tr_b16 v[26:27], v4 offset:8448
s_waitcnt lgkmcnt(4)
v_mfma_f32_16x16x32_bf16 v[168:171], v[12:15], a[0:3], 0
ds_read_b64_tr_b16 v[28:29], v5
ds_read_b64_tr_b16 v[30:31], v5 offset:8192
v_mfma_f32_16x16x32_bf16 v[172:175], v[12:15], a[4:7], 0
s_cbranch_vccz L_sp1
L_ok1:
v_mfma_f32_16x16x32_bf16 v[232:235], v[16:19], a[0:3], 0
ds_read_b64_tr_b16 v[12:13], v5 offset:256
v_xor_b32 v4, 32768, v1
v_mfma_f32_16x16x32_bf16 v[236:239], v[16:19], a[4:7], 0
ds_read_b64_tr_b16 v[14:15], v5 offset:8448
s_waitcnt lgkmcnt(4)
v_mfma_f32_16x16x32_bf16 v[176:179], v[20:23], a[0:3], 0
ds_read_b64_tr_b16 v[16:17], v4
v_mfma_f32_16x16x32_bf16 v[180:183], v[20:23], a[4:7], 0
ds_read_b64_tr_b16 v[18:19], v4 offset:8192
v_mfma_f32_16x16x32_bf16 v[240:243], v[24:27], a[0:3], 0
ds_read_b64_tr_b16 v[20:21], v4 offset:256
v_xor_b32 v5, 32800, v1
v_mfma_f32_16x16x32_bf16 v[244:247], v[24:27], a[4:7], 0
ds_read_b64_tr_b16 v[22:23], v4 offset:8448
s_waitcnt lgkmcnt(4)
v_mfma_f32_16x16x32_bf16 v[184:187], v[28:31], a[0:3], 0
ds_read_b64_tr_b16 v[24:25], v5
s_movk_i32 s12, 4
v_mfma_f32_16x16x32_bf16 v[188:191], v[28:31], a[4:7], 0
ds_read_b64_tr_b16 v[26:27], v5 offset:8192
v_mfma_f32_16x16x32_bf16 v[248:251], v[12:15], a[0:3], 0
ds_read_b64_tr_b16 v[28:29], v5 offset:256
v_xor_b32 v4, 32832, v1
v_mfma_f32_16x16x32_bf16 v[252:255], v[12:15], a[4:7], 0
ds_read_b64_tr_b16 v[30:31], v5 offset:8448
s_waitcnt lgkmcnt(4)
v_mfma_f32_16x16x32_bf16 v[128:131], v[16:19], a[8:11], v[128:131]
ds_read_b64_tr_b16 v[12:13], v4
ds_read_b64_tr_b16 v[14:15], v4 offset:8192
v_mfma_f32_16x16x32_bf16 v[132:135], v[16:19], a[12:15], v[132:135]
buffer_load_dword off, s[8:11], s12 lds
v_mfma_f32_16x16x32_bf16 v[192:195], v[20:23], a[8:11], v[192:195]
ds_read_b64_tr_b16 v[16:17], v4 offset:256
v_xor_b32 v5, 32864, v1
v_mfma_f32_16x16x32_bf16 v[196:199], v[20:23], a[12:15], v[196:199]
ds_read_b64_tr_b16 v[18:19], v4 offset:8448
s_waitcnt lgkmcnt(4)
v_mfma_f32_16x16x32_bf16 v[136:139], v[24:27], a[8:11], v[136:139]
ds_read_b64_tr_b16 v[20:21], v5
v_mov_b32 v8, 0
v_mfma_f32_16x16x32_bf16 v[140:143], v[24:27], a[12:15], v[140:143]
ds_read_b64_tr_b16 v[22:23], v5 offset:8192
v_mfma_f32_16x16x32_bf16 v[200:203], v[28:31], a[8:11], v[200:203]
ds_read_b64_tr_b16 v[24:25], v5 offset:256
v_xor_b32 v4, 32896, v1
v_mfma_f32_16x16x32_bf16 v[204:207], v[28:31], a[12:15], v[204:207]
ds_read_b64_tr_b16 v[26:27], v5 offset:8448
s_waitcnt lgkmcnt(4)
v_mfma_f32_16x16x32_bf16 v[144:147], v[12:15], a[8:11], v[144:147]
ds_read_b64_tr_b16 v[28:29], v4
v_mfma_f32_16x16x32_bf16 v[148:151], v[12:15], a[12:15], v[148:151]
ds_read_b64_tr_b16 v[30:31], v4 offset:8192
ds_read_b32 v8, v8 offset:14336
v_mfma_f32_16x16x32_bf16 v[208:211], v[16:19], a[8:11], v[208:211]
ds_read_b64_tr_b16 v[12:13], v4 offset:256
v_xor_b32 v5, 32928, v1
v_mfma_f32_16x16x32_bf16 v[212:215], v[16:19], a[12:15], v[212:215]
ds_read_b64_tr_b16 v[14:15], v4 offset:8448
s_waitcnt lgkmcnt(5)
v_mfma_f32_16x16x32_bf16 v[152:155], v[20:23], a[8:11], v[152:155]
ds_read_b64_tr_b16 v[16:17], v5
v_mfma_f32_16x16x32_bf16 v[156:159], v[20:23], a[12:15], v[156:159]
ds_read_b64_tr_b16 v[18:19], v5 offset:8192
v_mfma_f32_16x16x32_bf16 v[216:219], v[24:27], a[8:11], v[216:219]
ds_read_b64_tr_b16 v[20:21], v5 offset:256
v_xor_b32 v4, 32960, v1
v_mfma_f32_16x16x32_bf16 v[220:223], v[24:27], a[12:15], v[220:223]
ds_read_b64_tr_b16 v[22:23], v5 offset:8448
s_waitcnt lgkmcnt(4)
v_mfma_f32_16x16x32_bf16 v[160:163], v[28:31], a[8:11], v[160:163]
ds_read_b64_tr_b16 v[24:25], v4
v_cmp_le_u32 vcc, 6, v8
v_mfma_f32_16x16x32_bf16 v[164:167], v[28:31], a[12:15], v[164:167]
ds_read_b64_tr_b16 v[26:27], v4 offset:8192
v_mfma_f32_16x16x32_bf16 v[224:227], v[12:15], a[8:11], v[224:227]
ds_read_b64_tr_b16 v[28:29], v4 offset:256
v_xor_b32 v5, 32992, v1
v_mfma_f32_16x16x32_bf16 v[228:231], v[12:15], a[12:15], v[228:231]
ds_read_b64_tr_b16 v[30:31], v4 offset:8448
s_waitcnt lgkmcnt(4)
v_mfma_f32_16x16x32_bf16 v[168:171], v[16:19], a[8:11], v[168:171]
ds_read_b64_tr_b16 v[12:13], v5
ds_read_b64_tr_b16 v[14:15], v5 offset:8192
v_mfma_f32_16x16x32_bf16 v[172:175], v[16:19], a[12:15], v[172:175]
s_cbranch_vccz L_sp2
L_ok2:
v_mfma_f32_16x16x32_bf16 v[232:235], v[20:23], a[8:11], v[232:235]
ds_read_b64_tr_b16 v[16:17], v5 offset:256
v_xor_b32 v4, 81920, v1
v_mfma_f32_16x16x32_bf16 v[236:239], v[20:23], a[12:15], v[236:239]
ds_read_b64_tr_b16 v[18:19], v5 offset:8448
s_waitcnt lgkmcnt(4)
v_mfma_f32_16x16x32_bf16 v[176:179], v[24:27], a[8:11], v[176:179]
v_xor_b32 v0, 49152, v3
ds_read_b128 a[16:19], v0
v_mfma_f32_16x16x32_bf16 v[180:183], v[24:27], a[12:15], v[180:183]
ds_read_b128 a[20:23], v0 offset:2048
ds_read_b64_tr_b16 v[20:21], v4
ds_read_b64_tr_b16 v[22:23], v4 offset:8192
v_mfma_f32_16x16x32_bf16 v[240:243], v[28:31], a[8:11], v[240:243]
ds_read_b64_tr_b16 v[24:25], v4 offset:256
v_xor_b32 v5, 81952, v1
v_mfma_f32_16x16x32_bf16 v[244:247], v[28:31], a[12:15], v[244:247]
ds_read_b64_tr_b16 v[26:27], v4 offset:8448
s_waitcnt lgkmcnt(6)
v_mfma_f32_16x16x32_bf16 v[184:187], v[12:15], a[8:11], v[184:187]
ds_read_b64_tr_b16 v[28:29], v5
s_movk_i32 s12, 8
v_mfma_f32_16x16x32_bf16 v[188:191], v[12:15], a[12:15], v[188:191]
ds_read_b64_tr_b16 v[30:31], v5 offset:8192
v_xor_b32 v0, 65536, v3
v_mfma_f32_16x16x32_bf16 v[248:251], v[16:19], a[8:11], v[248:251]
ds_read_b64_tr_b16 v[12:13], v5 offset:256
v_xor_b32 v4, 81984, v1
v_mfma_f32_16x16x32_bf16 v[252:255], v[16:19], a[12:15], v[252:255]
ds_read_b64_tr_b16 v[14:15], v5 offset:8448
ds_read_b128 a[32:35], v0
s_waitcnt lgkmcnt(5)
v_mfma_f32_16x16x32_bf16 v[128:131], v[20:23], a[16:19], v[128:131]
ds_read_b64_tr_b16 v[16:17], v4
ds_read_b64_tr_b16 v[18:19], v4 offset:8192
v_mfma_f32_16x16x32_bf16 v[132:135], v[20:23], a[20:23], v[132:135]
buffer_load_dword off, s[8:11], s12 lds
v_mfma_f32_16x16x32_bf16 v[192:195], v[24:27], a[16:19], v[192:195]
ds_read_b64_tr_b16 v[20:21], v4 offset:256
v_xor_b32 v5, 82016, v1
v_mfma_f32_16x16x32_bf16 v[196:199], v[24:27], a[20:23], v[196:199]
ds_read_b64_tr_b16 v[22:23], v4 offset:8448
s_waitcnt lgkmcnt(5)
v_mfma_f32_16x16x32_bf16 v[136:139], v[28:31], a[16:19], v[136:139]
ds_read_b64_tr_b16 v[24:25], v5
v_mov_b32 v8, 0
v_mfma_f32_16x16x32_bf16 v[140:143], v[28:31], a[20:23], v[140:143]
ds_read_b64_tr_b16 v[26:27], v5 offset:8192
ds_read_b128 a[36:39], v0 offset:2048
v_mfma_f32_16x16x32_bf16 v[200:203], v[12:15], a[16:19], v[200:203]
ds_read_b64_tr_b16 v[28:29], v5 offset:256
v_xor_b32 v4, 82048, v1
v_mfma_f32_16x16x32_bf16 v[204:207], v[12:15], a[20:23], v[204:207]
ds_read_b64_tr_b16 v[30:31], v5 offset:8448
v_xor_b32 v2, 65600, v3
s_waitcnt lgkmcnt(5)
v_mfma_f32_16x16x32_bf16 v[144:147], v[16:19], a[16:19], v[144:147]
ds_read_b64_tr_b16 v[12:13], v4
ds_read_b128 a[40:43], v2
v_mfma_f32_16x16x32_bf16 v[148:151], v[16:19], a[20:23], v[148:151]
ds_read_b64_tr_b16 v[14:15], v4 offset:8192
ds_read_b32 v8, v8 offset:14336
v_mfma_f32_16x16x32_bf16 v[208:211], v[20:23], a[16:19], v[208:211]
ds_read_b64_tr_b16 v[16:17], v4 offset:256
v_xor_b32 v5, 82080, v1
v_mfma_f32_16x16x32_bf16 v[212:215], v[20:23], a[20:23], v[212:215]
ds_read_b64_tr_b16 v[18:19], v4 offset:8448
s_waitcnt lgkmcnt(6)
v_mfma_f32_16x16x32_bf16 v[152:155], v[24:27], a[16:19], v[152:155]
ds_read_b64_tr_b16 v[20:21], v5
ds_read_b128 a[44:47], v2 offset:2048
v_mfma_f32_16x16x32_bf16 v[156:159], v[24:27], a[20:23], v[156:159]
ds_read_b64_tr_b16 v[22:23], v5 offset:8192
v_xor_b32 v2, 49216, v3
v_mfma_f32_16x16x32_bf16 v[216:219], v[28:31], a[16:19], v[216:219]
ds_read_b64_tr_b16 v[24:25], v5 offset:256
v_xor_b32 v4, 82112, v1
v_mfma_f32_16x16x32_bf16 v[220:223], v[28:31], a[20:23], v[220:223]
ds_read_b64_tr_b16 v[26:27], v5 offset:8448
s_waitcnt lgkmcnt(5)
v_mfma_f32_16x16x32_bf16 v[160:163], v[12:15], a[16:19], v[160:163]
ds_read_b64_tr_b16 v[28:29], v4
v_cmp_le_u32 vcc, 7, v8
v_mfma_f32_16x16x32_bf16 v[164:167], v[12:15], a[20:23], v[164:167]
ds_read_b64_tr_b16 v[30:31], v4 offset:8192
ds_read_b128 a[24:27], v2
ds_read_b128 a[28:31], v2 offset:2048
v_mfma_f32_16x16x32_bf16 v[224:227], v[16:19], a[16:19], v[224:227]
ds_read_b64_tr_b16 v[12:13], v4 offset:256
v_xor_b32 v5, 82144, v1
v_mfma_f32_16x16x32_bf16 v[228:231], v[16:19], a[20:23], v[228:231]
ds_read_b64_tr_b16 v[14:15], v4 offset:8448
s_waitcnt lgkmcnt(6)
v_mfma_f32_16x16x32_bf16 v[168:171], v[20:23], a[16:19], v[168:171]
ds_read_b64_tr_b16 v[16:17], v5
ds_read_b64_tr_b16 v[18:19], v5 offset:8192
v_mfma_f32_16x16x32_bf16 v[172:175], v[20:23], a[20:23], v[172:175]
s_cbranch_vccz L_sp3
L_ok3:
v_mfma_f32_16x16x32_bf16 v[232:235], v[24:27], a[16:19], v[232:235]
ds_read_b64_tr_b16 v[20:21], v5 offset:256
v_xor_b32 v4, 98304, v1
v_mfma_f32_16x16x32_bf16 v[236:239], v[24:27], a[20:23], v[236:239]
ds_read_b64_tr_b16 v[22:23], v5 offset:8448
s_waitcnt lgkmcnt(4)
v_mfma_f32_16x16x32_bf16 v[176:179], v[28:31], a[16:19], v[176:179]
ds_read_b64_tr_b16 v[24:25], v4
v_mfma_f32_16x16x32_bf16 v[180:183], v[28:31], a[20:23], v[180:183]
ds_read_b64_tr_b16 v[26:27], v4 offset:8192
v_mfma_f32_16x16x32_bf16 v[240:243], v[12:15], a[16:19], v[240:243]
ds_read_b64_tr_b16 v[28:29], v4 offset:256
v_xor_b32 v5, 98336, v1
v_mfma_f32_16x16x32_bf16 v[244:247], v[12:15], a[20:23], v[244:247]
ds_read_b64_tr_b16 v[30:31], v4 offset:8448
s_waitcnt lgkmcnt(4)
v_mfma_f32_16x16x32_bf16 v[184:187], v[16:19], a[16:19], v[184:187]
ds_read_b64_tr_b16 v[12:13], v5
s_movk_i32 s12, 12
v_mfma_f32_16x16x32_bf16 v[188:191], v[16:19], a[20:23], v[188:191]
ds_read_b64_tr_b16 v[14:15], v5 offset:8192
v_mfma_f32_16x16x32_bf16 v[248:251], v[20:23], a[16:19], v[248:251]
ds_read_b64_tr_b16 v[16:17], v5 offset:256
v_xor_b32 v4, 98368, v1
v_mfma_f32_16x16x32_bf16 v[252:255], v[20:23], a[20:23], v[252:255]
ds_read_b64_tr_b16 v[18:19], v5 offset:8448
s_waitcnt lgkmcnt(4)
v_mfma_f32_16x16x32_bf16 v[128:131], v[24:27], a[24:27], v[128:131]
ds_read_b64_tr_b16 v[20:21], v4
ds_read_b64_tr_b16 v[22:23], v4 offset:8192
v_mfma_f32_16x16x32_bf16 v[132:135], v[24:27], a[28:31], v[132:135]
buffer_load_dword off, s[8:11], s12 lds
v_mfma_f32_16x16x32_bf16 v[192:195], v[28:31], a[24:27], v[192:195]
ds_read_b64_tr_b16 v[24:25], v4 offset:256
v_xor_b32 v5, 98400, v1
v_mfma_f32_16x16x32_bf16 v[196:199], v[28:31], a[28:31], v[196:199]
ds_read_b64_tr_b16 v[26:27], v4 offset:8448
s_waitcnt lgkmcnt(4)
v_mfma_f32_16x16x32_bf16 v[136:139], v[12:15], a[24:27], v[136:139]
ds_read_b64_tr_b16 v[28:29], v5
v_mov_b32 v8, 0
v_mfma_f32_16x16x32_bf16 v[140:143], v[12:15], a[28:31], v[140:143]
ds_read_b64_tr_b16 v[30:31], v5 offset:8192
v_mfma_f32_16x16x32_bf16 v[200:203], v[16:19], a[24:27], v[200:203]
ds_read_b64_tr_b16 v[12:13], v5 offset:256
v_xor_b32 v4, 98432, v1
v_mfma_f32_16x16x32_bf16 v[204:207], v[16:19], a[28:31], v[204:207]
ds_read_b64_tr_b16 v[14:15], v5 offset:8448
s_waitcnt lgkmcnt(4)
v_mfma_f32_16x16x32_bf16 v[144:147], v[20:23], a[24:27], v[144:147]
ds_read_b64_tr_b16 v[16:17], v4
v_mfma_f32_16x16x32_bf16 v[148:151], v[20:23], a[28:31], v[148:151]
ds_read_b64_tr_b16 v[18:19], v4 offset:8192
ds_read_b32 v8, v8 offset:14336
v_mfma_f32_16x16x32_bf16 v[208:211], v[24:27], a[24:27], v[208:211]
ds_read_b64_tr_b16 v[20:21], v4 offset:256
v_xor_b32 v5, 98464, v1
v_mfma_f32_16x16x32_bf16 v[212:215], v[24:27], a[28:31], v[212:215]
ds_read_b64_tr_b16 v[22:23], v4 offset:8448
s_waitcnt lgkmcnt(5)
v_mfma_f32_16x16x32_bf16 v[152:155], v[28:31], a[24:27], v[152:155]
ds_read_b64_tr_b16 v[24:25], v5
s_waitcnt vmcnt(3)
v_mfma_f32_16x16x32_bf16 v[156:159], v[28:31], a[28:31], v[156:159]
ds_read_b64_tr_b16 v[26:27], v5 offset:8192
buffer_store_dword v33, v32, s[36:39], 0 offen sc1
v_mfma_f32_16x16x32_bf16 v[216:219], v[12:15], a[24:27], v[216:219]
ds_read_b64_tr_b16 v[28:29], v5 offset:256
v_xor_b32 v4, 98496, v1
v_mfma_f32_16x16x32_bf16 v[220:223], v[12:15], a[28:31], v[220:223]
ds_read_b64_tr_b16 v[30:31], v5 offset:8448
s_waitcnt lgkmcnt(4)
v_mfma_f32_16x16x32_bf16 v[160:163], v[16:19], a[24:27], v[160:163]
ds_read_b64_tr_b16 v[12:13], v4
v_cmp_le_u32 vcc, 8, v8
v_mfma_f32_16x16x32_bf16 v[164:167], v[16:19], a[28:31], v[164:167]
ds_read_b64_tr_b16 v[14:15], v4 offset:8192
v_mfma_f32_16x16x32_bf16 v[224:227], v[20:23], a[24:27], v[224:227]
ds_read_b64_tr_b16 v[16:17], v4 offset:256
v_xor_b32 v5, 98528, v1
v_mfma_f32_16x16x32_bf16 v[228:231], v[20:23], a[28:31], v[228:231]
ds_read_b64_tr_b16 v[18:19], v4 offset:8448
s_waitcnt lgkmcnt(4)
v_mfma_f32_16x16x32_bf16 v[168:171], v[24:27], a[24:27], v[168:171]
ds_read_b64_tr_b16 v[20:21], v5
ds_read_b64_tr_b16 v[22:23], v5 offset:8192
v_mfma_f32_16x16x32_bf16 v[172:175], v[24:27], a[28:31], v[172:175]
s_cbranch_vccz L_sp4
L_ok4:
v_mfma_f32_16x16x32_bf16 v[232:235], v[28:31], a[24:27], v[232:235]
ds_read_b64_tr_b16 v[24:25], v5 offset:256
v_xor_b32 v4, 114688, v1
v_mfma_f32_16x16x32_bf16 v[236:239], v[28:31], a[28:31], v[236:239]
ds_read_b64_tr_b16 v[26:27], v5 offset:8448
s_waitcnt lgkmcnt(4)
v_mfma_f32_16x16x32_bf16 v[176:179], v[12:15], a[24:27], v[176:179]
ds_read_b64_tr_b16 v[28:29], v4
v_mfma_f32_16x16x32_bf16 v[180:183], v[12:15], a[28:31], v[180:183]
ds_read_b64_tr_b16 v[30:31], v4 offset:8192
v_mfma_f32_16x16x32_bf16 v[240:243], v[16:19], a[24:27], v[240:243]
ds_read_b64_tr_b16 v[12:13], v4 offset:256
v_xor_b32 v5, 114720, v1
v_mfma_f32_16x16x32_bf16 v[244:247], v[16:19], a[28:31], v[244:247]
ds_read_b64_tr_b16 v[14:15], v4 offset:8448
s_waitcnt lgkmcnt(4)
v_mfma_f32_16x16x32_bf16 v[184:187], v[20:23], a[24:27], v[184:187]
ds_read_b64_tr_b16 v[16:17], v5
s_movk_i32 s12, 16
v_mfma_f32_16x16x32_bf16 v[188:191], v[20:23], a[28:31], v[188:191]
ds_read_b64_tr_b16 v[18:19], v5 offset:8192
v_mfma_f32_16x16x32_bf16 v[248:251], v[24:27], a[24:27], v[248:251]
ds_read_b64_tr_b16 v[20:21], v5 offset:256
v_xor_b32 v4, 114752, v1
v_mfma_f32_16x16x32_bf16 v[252:255], v[24:27], a[28:31], v[252:255]
ds_read_b64_tr_b16 v[22:23], v5 offset:8448
s_waitcnt lgkmcnt(4)
v_mfma_f32_16x16x32_bf16 v[128:131], v[28:31], a[32:35], v[128:131]
ds_read_b64_tr_b16 v[24:25], v4
ds_read_b64_tr_b16 v[26:27], v4 offset:8192
v_mfma_f32_16x16x32_bf16 v[132:135], v[28:31], a[36:39], v[132:135]
buffer_load_dword off, s[8:11], s12 lds
v_mfma_f32_16x16x32_bf16 v[192:195], v[12:15], a[32:35], v[192:195]
ds_read_b64_tr_b16 v[28:29], v4 offset:256
v_xor_b32 v5, 114784, v1
v_mfma_f32_16x16x32_bf16 v[196:199], v[12:15], a[36:39], v[196:199]
ds_read_b64_tr_b16 v[30:31], v4 offset:8448
s_waitcnt lgkmcnt(4)
v_mfma_f32_16x16x32_bf16 v[136:139], v[16:19], a[32:35], v[136:139]
ds_read_b64_tr_b16 v[12:13], v5
v_mov_b32 v8, 0
v_mfma_f32_16x16x32_bf16 v[140:143], v[16:19], a[36:39], v[140:143]
ds_read_b64_tr_b16 v[14:15], v5 offset:8192
v_mfma_f32_16x16x32_bf16 v[200:203], v[20:23], a[32:35], v[200:203]
ds_read_b64_tr_b16 v[16:17], v5 offset:256
v_xor_b32 v4, 114816, v1
v_mfma_f32_16x16x32_bf16 v[204:207], v[20:23], a[36:39], v[204:207]
ds_read_b64_tr_b16 v[18:19], v5 offset:8448
s_waitcnt lgkmcnt(4)
v_mfma_f32_16x16x32_bf16 v[144:147], v[24:27], a[32:35], v[144:147]
ds_read_b64_tr_b16 v[20:21], v4
v_mfma_f32_16x16x32_bf16 v[148:151], v[24:27], a[36:39], v[148:151]
ds_read_b64_tr_b16 v[22:23], v4 offset:8192
ds_read_b32 v8, v8 offset:14336
v_mfma_f32_16x16x32_bf16 v[208:211], v[28:31], a[32:35], v[208:211]
ds_read_b64_tr_b16 v[24:25], v4 offset:256
v_xor_b32 v5, 114848, v1
v_mfma_f32_16x16x32_bf16 v[212:215], v[28:31], a[36:39], v[212:215]
ds_read_b64_tr_b16 v[26:27], v4 offset:8448
s_waitcnt lgkmcnt(5)
v_mfma_f32_16x16x32_bf16 v[152:155], v[12:15], a[32:35], v[152:155]
ds_read_b64_tr_b16 v[28:29], v5
v_mfma_f32_16x16x32_bf16 v[156:159], v[12:15], a[36:39], v[156:159]
ds_read_b64_tr_b16 v[30:31], v5 offset:8192
v_mfma_f32_16x16x32_bf16 v[216:219], v[16:19], a[32:35], v[216:219]
ds_read_b64_tr_b16 v[12:13], v5 offset:256
v_xor_b32 v4, 114880, v1
v_mfma_f32_16x16x32_bf16 v[220:223], v[16:19], a[36:39], v[220:223]
ds_read_b64_tr_b16 v[14:15], v5 offset:8448
s_waitcnt lgkmcnt(4)
v_mfma_f32_16x16x32_bf16 v[160:163], v[20:23], a[32:35], v[160:163]
ds_read_b64_tr_b16 v[16:17], v4
v_cmp_le_u32 vcc, 10, v8
v_mfma_f32_16x16x32_bf16 v[164:167], v[20:23], a[36:39], v[164:167]
ds_read_b64_tr_b16 v[18:19], v4 offset:8192
v_mfma_f32_16x16x32_bf16 v[224:227], v[24:27], a[32:35], v[224:227]
ds_read_b64_tr_b16 v[20:21], v4 offset:256
v_xor_b32 v5, 114912, v1
v_mfma_f32_16x16x32_bf16 v[228:231], v[24:27], a[36:39], v[228:231]
ds_read_b64_tr_b16 v[22:23], v4 offset:8448
s_waitcnt lgkmcnt(4)
v_mfma_f32_16x16x32_bf16 v[168:171], v[28:31], a[32:35], v[168:171]
ds_read_b64_tr_b16 v[24:25], v5
ds_read_b64_tr_b16 v[26:27], v5 offset:8192
v_mfma_f32_16x16x32_bf16 v[172:175], v[28:31], a[36:39], v[172:175]
s_cbranch_vccz L_sp5
L_ok5:
v_mfma_f32_16x16x32_bf16 v[232:235], v[12:15], a[32:35], v[232:235]
ds_read_b64_tr_b16 v[28:29], v5 offset:256
v_xor_b32 v4, 147456, v1
v_mfma_f32_16x16x32_bf16 v[236:239], v[12:15], a[36:39], v[236:239]
ds_read_b64_tr_b16 v[30:31], v5 offset:8448
s_waitcnt lgkmcnt(4)
v_mfma_f32_16x16x32_bf16 v[176:179], v[16:19], a[32:35], v[176:179]
ds_read_b64_tr_b16 v[12:13], v4
v_mfma_f32_16x16x32_bf16 v[180:183], v[16:19], a[36:39], v[180:183]
ds_read_b64_tr_b16 v[14:15], v4 offset:8192
v_mfma_f32_16x16x32_bf16 v[240:243], v[20:23], a[32:35], v[240:243]
ds_read_b64_tr_b16 v[16:17], v4 offset:256
v_xor_b32 v5, 147488, v1
v_mfma_f32_16x16x32_bf16 v[244:247], v[20:23], a[36:39], v[244:247]
ds_read_b64_tr_b16 v[18:19], v4 offset:8448
s_waitcnt lgkmcnt(4)
v_mfma_f32_16x16x32_bf16 v[184:187], v[24:27], a[32:35], v[184:187]
ds_read_b64_tr_b16 v[20:21], v5
s_movk_i32 s12, 20
v_mfma_f32_16x16x32_bf16 v[188:191], v[24:27], a[36:39], v[188:191]
ds_read_b64_tr_b16 v[22:23], v5 offset:8192
v_xor_b32 v0, 131072, v3
v_mfma_f32_16x16x32_bf16 v[248:251], v[28:31], a[32:35], v[248:251]
ds_read_b64_tr_b16 v[24:25], v5 offset:256
v_xor_b32 v4, 147520, v1
v_mfma_f32_16x16x32_bf16 v[252:255], v[28:31], a[36:39], v[252:255]
ds_read_b64_tr_b16 v[26:27], v5 offset:8448
s_waitcnt lgkmcnt(4)
v_mfma_f32_16x16x32_bf16 v[128:131], v[12:15], a[40:43], v[128:131]
ds_read_b64_tr_b16 v[28:29], v4
ds_read_b64_tr_b16 v[30:31], v4 offset:8192
v_mfma_f32_16x16x32_bf16 v[132:135], v[12:15], a[44:47], v[132:135]
buffer_load_dword off, s[8:11], s12 lds
v_mfma_f32_16x16x32_bf16 v[192:195], v[16:19], a[40:43], v[192:195]
ds_read_b64_tr_b16 v[12:13], v4 offset:256
v_xor_b32 v5, 147552, v1
v_mfma_f32_16x16x32_bf16 v[196:199], v[16:19], a[44:47], v[196:199]
ds_read_b64_tr_b16 v[14:15], v4 offset:8448
s_waitcnt lgkmcnt(4)
v_mfma_f32_16x16x32_bf16 v[136:139], v[20:23], a[40:43], v[136:139]
ds_read_b64_tr_b16 v[16:17], v5
v_mov_b32 v8, 0
v_mfma_f32_16x16x32_bf16 v[140:143], v[20:23], a[44:47], v[140:143]
ds_read_b64_tr_b16 v[18:19], v5 offset:8192
ds_read_b128 a[48:51], v0
v_mfma_f32_16x16x32_bf16 v[200:203], v[24:27], a[40:43], v[200:203]
ds_read_b64_tr_b16 v[20:21], v5 offset:256
v_xor_b32 v4, 147584, v1
v_mfma_f32_16x16x32_bf16 v[204:207], v[24:27], a[44:47], v[204:207]
ds_read_b64_tr_b16 v[22:23], v5 offset:8448
s_waitcnt lgkmcnt(5)
v_mfma_f32_16x16x32_bf16 v[144:147], v[28:31], a[40:43], v[144:147]
ds_read_b64_tr_b16 v[24:25], v4
ds_read_b128 a[52:55], v0 offset:2048
v_mfma_f32_16x16x32_bf16 v[148:151], v[28:31], a[44:47], v[148:151]
ds_read_b64_tr_b16 v[26:27], v4 offset:8192
ds_read_b32 v8, v8 offset:14336
v_mfma_f32_16x16x32_bf16 v[208:211], v[12:15], a[40:43], v[208:211]
ds_read_b64_tr_b16 v[28:29], v4 offset:256
v_xor_b32 v5, 147616, v1
v_mfma_f32_16x16x32_bf16 v[212:215], v[12:15], a[44:47], v[212:215]
ds_read_b64_tr_b16 v[30:31], v4 offset:8448
s_waitcnt lgkmcnt(6)
v_mfma_f32_16x16x32_bf16 v[152:155], v[16:19], a[40:43], v[152:155]
ds_read_b64_tr_b16 v[12:13], v5
v_xor_b32 v2, 131136, v3
v_mfma_f32_16x16x32_bf16 v[156:159], v[16:19], a[44:47], v[156:159]
ds_read_b64_tr_b16 v[14:15], v5 offset:8192
ds_read_b128 a[56:59], v2
v_mfma_f32_16x16x32_bf16 v[216:219], v[20:23], a[40:43], v[216:219]
ds_read_b64_tr_b16 v[16:17], v5 offset:256
v_xor_b32 v4, 147648, v1
v_mfma_f32_16x16x32_bf16 v[220:223], v[20:23], a[44:47], v[220:223]
ds_read_b64_tr_b16 v[18:19], v5 offset:8448
s_waitcnt lgkmcnt(5)
v_mfma_f32_16x16x32_bf16 v[160:163], v[24:27], a[40:43], v[160:163]
s_branch L_pg1
L_sp6:
v_mov_b32 v8, 0
ds_read_b32 v8, v8 offset:14336
s_waitcnt lgkmcnt(0)
v_cmp_le_u32 vcc, 11, v8
s_cbranch_vccz L_sp6
s_branch L_ok6
L_sp7:
v_mov_b32 v8, 0
ds_read_b32 v8, v8 offset:14336
s_waitcnt lgkmcnt(0)
v_cmp_le_u32 vcc, 13, v8
s_cbranch_vccz L_sp7
s_branch L_ok7
L_sp8:
v_mov_b32 v8, 0
ds_read_b32 v8, v8 offset:14336
s_waitcnt lgkmcnt(0)
v_cmp_le_u32 vcc, 14, v8
s_cbranch_vccz L_sp8
s_branch L_ok8
L_sp9:
v_mov_b32 v8, 0
ds_read_b32 v8, v8 offset:14336
s_waitcnt lgkmcnt(0)
v_cmp_le_u32 vcc, 16, v8
s_cbranch_vccz L_sp9
s_branch L_ok9
L_sp10:
v_mov_b32 v8, 0
ds_read_b32 v8, v8 offset:14336
s_waitcnt lgkmcnt(0)
v_cmp_le_u32 vcc, 17, v8
s_cbranch_vccz L_sp10
s_branch L_ok10
L_sp11:
v_mov_b32 v8, 0
ds_read_b32 v8, v8 offset:14336
s_waitcnt lgkmcnt(0)
v_cmp_le_u32 vcc, 21, v8
s_cbranch_vccz L_sp11
s_branch L_ok11
.p2align 12
L_stub1:
s_setpc_b64 s[94:95]
L_pg1:
ds_read_b64_tr_b16 v[20:21], v4
v_cmp_le_u32 vcc, 11, v8
v_mfma_f32_16x16x32_bf16 v[164:167], v[24:27], a[44:47], v[164:167]
ds_read_b64_tr_b16 v[22:23], v4 offset:8192
ds_read_b128 a[60:63], v2 offset:2048
v_mfma_f32_16x16x32_bf16 v[224:227], v[28:31], a[40:43], v[224:227]
ds_read_b64_tr_b16 v[24:25], v4 offset:256
v_xor_b32 v5, 147680, v1
v_mfma_f32_16x16x32_bf16 v[228:231], v[28:31], a[44:47], v[228:231]
ds_read_b64_tr_b16 v[26:27], v4 offset:8448
s_waitcnt lgkmcnt(5)
v_mfma_f32_16x16x32_bf16 v[168:171], v[12:15], a[40:43], v[168:171]
ds_read_b64_tr_b16 v[28:29], v5
ds_read_b64_tr_b16 v[30:31], v5 offset:8192
v_mfma_f32_16x16x32_bf16 v[172:175], v[12:15], a[44:47], v[172:175]
s_cbranch_vccz L_sp6
L_ok6:
v_mfma_f32_16x16x32_bf16 v[232:235], v[16:19], a[40:43], v[232:235]
ds_read_b64_tr_b16 v[12:13], v5 offset:256
v_xor_b32 v4, 16384, v1
v_mfma_f32_16x16x32_bf16 v[236:239], v[16:19], a[44:47], v[236:239]
ds_read_b64_tr_b16 v[14:15], v5 offset:8448
s_waitcnt lgkmcnt(4)
v_mfma_f32_16x16x32_bf16 v[176:179], v[20:23], a[40:43], v[176:179]
ds_read_b64_tr_b16 v[16:17], v4
v_mfma_f32_16x16x32_bf16 v[180:183], v[20:23], a[44:47], v[180:183]
ds_read_b64_tr_b16 v[18:19], v4 offset:8192
v_mfma_f32_16x16x32_bf16 v[240:243], v[24:27], a[40:43], v[240:243]
ds_read_b64_tr_b16 v[20:21], v4 offset:256
v_xor_b32 v5, 16416, v1
v_mfma_f32_16x16x32_bf16 v[244:247], v[24:27], a[44:47], v[244:247]
ds_read_b64_tr_b16 v[22:23], v4 offset:8448
s_waitcnt lgkmcnt(4)
v_mfma_f32_16x16x32_bf16 v[184:187], v[28:31], a[40:43], v[184:187]
ds_read_b64_tr_b16 v[24:25], v5
s_movk_i32 s12, 24
v_mfma_f32_16x16x32_bf16 v[188:191], v[28:31], a[44:47], v[188:191]
ds_read_b64_tr_b16 v[26:27], v5 offset:8192
v_mfma_f32_16x16x32_bf16 v[248:251], v[12:15], a[40:43], v[248:251]
ds_read_b64_tr_b16 v[28:29], v5 offset:256
v_xor_b32 v4, 16448, v1
v_mfma_f32_16x16x32_bf16 v[252:255], v[12:15], a[44:47], v[252:255]
ds_read_b64_tr_b16 v[30:31], v5 offset:8448
s_waitcnt lgkmcnt(4)
v_mfma_f32_16x16x32_bf16 v[128:131], v[16:19], a[48:51], v[128:131]
ds_read_b64_tr_b16 v[12:13], v4
ds_read_b64_tr_b16 v[14:15], v4 offset:8192
v_mfma_f32_16x16x32_bf16 v[132:135], v[16:19], a[52:55], v[132:135]
buffer_load_dword off, s[8:11], s12 lds
v_mfma_f32_16x16x32_bf16 v[192:195], v[20:23], a[48:51], v[192:195]
ds_read_b64_tr_b16 v[16:17], v4 offset:256
v_xor_b32 v5, 16480, v1
v_mfma_f32_16x16x32_bf16 v[196:199], v[20:23], a[52:55], v[196:199]
ds_read_b64_tr_b16 v[18:19], v4 offset:8448
s_waitcnt lgkmcnt(4)
v_mfma_f32_16x16x32_bf16 v[136:139], v[24:27], a[48:51], v[136:139]
ds_read_b64_tr_b16 v[20:21], v5
v_mov_b32 v8, 0
v_mfma_f32_16x16x32_bf16 v[140:143], v[24:27], a[52:55], v[140:143]
ds_read_b64_tr_b16 v[22:23], v5 offset:8192
v_mfma_f32_16x16x32_bf16 v[200:203], v[28:31], a[48:51], v[200:203]
ds_read_b64_tr_b16 v[24:25], v5 offset:256
v_xor_b32 v4, 16512, v1
v_mfma_f32_16x16x32_bf16 v[204:207], v[28:31], a[52:55], v[204:207]
ds_read_b64_tr_b16 v[26:27], v5 offset:8448
s_waitcnt lgkmcnt(4)
v_mfma_f32_16x16x32_bf16 v[144:147], v[12:15], a[48:51], v[144:147]
ds_read_b64_tr_b16 v[28:29], v4
v_mfma_f32_16x16x32_bf16 v[148:151], v[12:15], a[52:55], v[148:151]
ds_read_b64_tr_b16 v[30:31], v4 offset:8192
ds_read_b32 v8, v8 offset:14336
v_mfma_f32_16x16x32_bf16 v[208:211], v[16:19], a[48:51], v[208:211]
ds_read_b64_tr_b16 v[12:13], v4 offset:256
v_xor_b32 v5, 16544, v1
v_mfma_f32_16x16x32_bf16 v[212:215], v[16:19], a[52:55], v[212:215]
ds_read_b64_tr_b16 v[14:15], v4 offset:8448
s_waitcnt lgkmcnt(5)
v_mfma_f32_16x16x32_bf16 v[152:155], v[20:23], a[48:51], v[152:155]
ds_read_b64_tr_b16 v[16:17], v5
v_mfma_f32_16x16x32_bf16 v[156:159], v[20:23], a[52:55], v[156:159]
ds_read_b64_tr_b16 v[18:19], v5 offset:8192
v_mfma_f32_16x16x32_bf16 v[216:219], v[24:27], a[48:51], v[216:219]
ds_read_b64_tr_b16 v[20:21], v5 offset:256
v_xor_b32 v4, 16576, v1
v_mfma_f32_16x16x32_bf16 v[220:223], v[24:27], a[52:55], v[220:223]
ds_read_b64_tr_b16 v[22:23], v5 offset:8448
s_waitcnt lgkmcnt(4)
v_mfma_f32_16x16x32_bf16 v[160:163], v[28:31], a[48:51], v[160:163]
ds_read_b64_tr_b16 v[24:25], v4
v_cmp_le_u32 vcc, 13, v8
v_mfma_f32_16x16x32_bf16 v[164:167], v[28:31], a[52:55], v[164:167]
ds_read_b64_tr_b16 v[26:27], v4 offset:8192
v_mfma_f32_16x16x32_bf16 v[224:227], v[12:15], a[48:51], v[224:227]
ds_read_b64_tr_b16 v[28:29], v4 offset:256
v_xor_b32 v5, 16608, v1
v_mfma_f32_16x16x32_bf16 v[228:231], v[12:15], a[52:55], v[228:231]
ds_read_b64_tr_b16 v[30:31], v4 offset:8448
s_waitcnt lgkmcnt(4)
v_mfma_f32_16x16x32_bf16 v[168:171], v[16:19], a[48:51], v[168:171]
ds_read_b64_tr_b16 v[12:13], v5
ds_read_b64_tr_b16 v[14:15], v5 offset:8192
v_mfma_f32_16x16x32_bf16 v[172:175], v[16:19], a[52:55], v[172:175]
s_cbranch_vccz L_sp7
L_ok7:
v_mfma_f32_16x16x32_bf16 v[232:235], v[20:23], a[48:51], v[232:235]
ds_read_b64_tr_b16 v[16:17], v5 offset:256
v_xor_b32 v4, 32768, v1
v_mfma_f32_16x16x32_bf16 v[236:239], v[20:23], a[52:55], v[236:239]
ds_read_b64_tr_b16 v[18:19], v5 offset:8448
s_waitcnt lgkmcnt(4)
v_mfma_f32_16x16x32_bf16 v[176:179], v[24:27], a[48:51], v[176:179]
ds_read_b64_tr_b16 v[20:21], v4
v_mfma_f32_16x16x32_bf16 v[180:183], v[24:27], a[52:55], v[180:183]
ds_read_b64_tr_b16 v[22:23], v4 offset:8192
v_mfma_f32_16x16x32_bf16 v[240:243], v[28:31], a[48:51], v[240:243]
ds_read_b64_tr_b16 v[24:25], v4 offset:256
v_xor_b32 v5, 32800, v1
v_mfma_f32_16x16x32_bf16 v[244:247], v[28:31], a[52:55], v[244:247]
ds_read_b64_tr_b16 v[26:27], v4 offset:8448
s_waitcnt lgkmcnt(4)
v_mfma_f32_16x16x32_bf16 v[184:187], v[12:15], a[48:51], v[184:187]
ds_read_b64_tr_b16 v[28:29], v5
s_movk_i32 s12, 28
v_mfma_f32_16x16x32_bf16 v[188:191], v[12:15], a[52:55], v[188:191]
ds_read_b64_tr_b16 v[30:31], v5 offset:8192
v_xor_b32 v0, 0, v3
v_mfma_f32_16x16x32_bf16 v[248:251], v[16:19], a[48:51], v[248:251]
ds_read_b64_tr_b16 v[12:13], v5 offset:256
v_xor_b32 v4, 32832, v1
v_mfma_f32_16x16x32_bf16 v[252:255], v[16:19], a[52:55], v[252:255]
ds_read_b64_tr_b16 v[14:15], v5 offset:8448
s_waitcnt lgkmcnt(4)
v_mfma_f32_16x16x32_bf16 v[128:131], v[20:23], a[56:59], v[128:131]
ds_read_b64_tr_b16 v[16:17], v4
ds_read_b64_tr_b16 v[18:19], v4 offset:8192
v_mfma_f32_16x16x32_bf16 v[132:135], v[20:23], a[60:63], v[132:135]
buffer_load_dword off, s[8:11], s12 lds
v_mfma_f32_16x16x32_bf16 v[192:195], v[24:27], a[56:59], v[192:195]
ds_read_b64_tr_b16 v[20:21], v4 offset:256
v_xor_b32 v5, 32864, v1
v_mfma_f32_16x16x32_bf16 v[196:199], v[24:27], a[60:63], v[196:199]
ds_read_b64_tr_b16 v[22:23], v4 offset:8448
s_waitcnt lgkmcnt(4)
v_mfma_f32_16x16x32_bf16 v[136:139], v[28:31], a[56:59], v[136:139]
ds_read_b64_tr_b16 v[24:25], v5
v_mov_b32 v8, 0
v_mfma_f32_16x16x32_bf16 v[140:143], v[28:31], a[60:63], v[140:143]
ds_read_b64_tr_b16 v[26:27], v5 offset:8192
ds_read_b128 a[64:67], v0
v_mfma_f32_16x16x32_bf16 v[200:203], v[12:15], a[56:59], v[200:203]
ds_read_b64_tr_b16 v[28:29], v5 offset:256
v_xor_b32 v4, 32896, v1
v_mfma_f32_16x16x32_bf16 v[204:207], v[12:15], a[60:63], v[204:207]
ds_read_b64_tr_b16 v[30:31], v5 offset:8448
s_waitcnt lgkmcnt(5)
v_mfma_f32_16x16x32_bf16 v[144:147], v[16:19], a[56:59], v[144:147]
ds_read_b64_tr_b16 v[12:13], v4
ds_read_b128 a[68:71], v0 offset:2048
v_mfma_f32_16x16x32_bf16 v[148:151], v[16:19], a[60:63], v[148:151]
ds_read_b64_tr_b16 v[14:15], v4 offset:8192
ds_read_b32 v8, v8 offset:14336
v_mfma_f32_16x16x32_bf16 v[208:211], v[20:23], a[56:59], v[208:211]
ds_read_b64_tr_b16 v[16:17], v4 offset:256
v_xor_b32 v5, 32928, v1
v_mfma_f32_16x16x32_bf16 v[212:215], v[20:23], a[60:63], v[212:215]
ds_read_b64_tr_b16 v[18:19], v4 offset:8448
s_waitcnt lgkmcnt(6)
v_mfma_f32_16x16x32_bf16 v[152:155], v[24:27], a[56:59], v[152:155]
ds_read_b64_tr_b16 v[20:21], v5
v_xor_b32 v2, 64, v3
v_mfma_f32_16x16x32_bf16 v[156:159], v[24:27], a[60:63], v[156:159]
ds_read_b64_tr_b16 v[22:23], v5 offset:8192
ds_read_b128 a[72:75], v2
v_mfma_f32_16x16x32_bf16 v[216:219], v[28:31], a[56:59], v[216:219]
ds_read_b64_tr_b16 v[24:25], v5 offset:256
v_xor_b32 v4, 32960, v1
v_mfma_f32_16x16x32_bf16 v[220:223], v[28:31], a[60:63], v[220:223]
ds_read_b64_tr_b16 v[26:27], v5 offset:8448
s_waitcnt lgkmcnt(5)
v_mfma_f32_16x16x32_bf16 v[160:163], v[12:15], a[56:59], v[160:163]
ds_read_b64_tr_b16 v[28:29], v4
v_cmp_le_u32 vcc, 14, v8
v_mfma_f32_16x16x32_bf16 v[164:167], v[12:15], a[60:63], v[164:167]
ds_read_b64_tr_b16 v[30:31], v4 offset:8192
ds_read_b128 a[76:79], v2 offset:2048
v_mfma_f32_16x16x32_bf16 v[224:227], v[16:19], a[56:59], v[224:227]
ds_read_b64_tr_b16 v[12:13], v4 offset:256
v_xor_b32 v5, 32992, v1
v_mfma_f32_16x16x32_bf16 v[228:231], v[16:19], a[60:63], v[228:231]
ds_read_b64_tr_b16 v[14:15], v4 offset:8448
s_waitcnt lgkmcnt(5)
v_mfma_f32_16x16x32_bf16 v[168:171], v[20:23], a[56:59], v[168:171]
ds_read_b64_tr_b16 v[16:17], v5
ds_read_b64_tr_b16 v[18:19], v5 offset:8192
v_mfma_f32_16x16x32_bf16 v[172:175], v[20:23], a[60:63], v[172:175]
s_cbranch_vccz L_sp8
L_ok8:
v_mfma_f32_16x16x32_bf16 v[232:235], v[24:27], a[56:59], v[232:235]
ds_read_b64_tr_b16 v[20:21], v5 offset:256
v_xor_b32 v4, 49152, v1
v_mfma_f32_16x16x32_bf16 v[236:239], v[24:27], a[60:63], v[236:239]
ds_read_b64_tr_b16 v[22:23], v5 offset:8448
s_waitcnt lgkmcnt(4)
v_mfma_f32_16x16x32_bf16 v[176:179], v[28:31], a[56:59], v[176:179]
ds_read_b64_tr_b16 v[24:25], v4
v_mfma_f32_16x16x32_bf16 v[180:183], v[28:31], a[60:63], v[180:183]
ds_read_b64_tr_b16 v[26:27], v4 offset:8192
v_mfma_f32_16x16x32_bf16 v[240:243], v[12:15], a[56:59], v[240:243]
ds_read_b64_tr_b16 v[28:29], v4 offset:256
v_xor_b32 v5, 49184, v1
v_mfma_f32_16x16x32_bf16 v[244:247], v[12:15], a[60:63], v[244:247]
ds_read_b64_tr_b16 v[30:31], v4 offset:8448
s_waitcnt lgkmcnt(4)
v_mfma_f32_16x16x32_bf16 v[184:187], v[16:19], a[56:59], v[184:187]
ds_read_b64_tr_b16 v[12:13], v5
s_movk_i32 s12, 32
v_mfma_f32_16x16x32_bf16 v[188:191], v[16:19], a[60:63], v[188:191]
ds_read_b64_tr_b16 v[14:15], v5 offset:8192
v_mfma_f32_16x16x32_bf16 v[248:251], v[20:23], a[56:59], v[248:251]
ds_read_b64_tr_b16 v[16:17], v5 offset:256
v_xor_b32 v4, 49216, v1
v_mfma_f32_16x16x32_bf16 v[252:255], v[20:23], a[60:63], v[252:255]
ds_read_b64_tr_b16 v[18:19], v5 offset:8448
s_waitcnt lgkmcnt(4)
v_mfma_f32_16x16x32_bf16 v[128:131], v[24:27], a[64:67], v[128:131]
ds_read_b64_tr_b16 v[20:21], v4
ds_read_b64_tr_b16 v[22:23], v4 offset:8192
v_mfma_f32_16x16x32_bf16 v[132:135], v[24:27], a[68:71], v[132:135]
buffer_load_dword off, s[8:11], s12 lds
v_mfma_f32_16x16x32_bf16 v[192:195], v[28:31], a[64:67], v[192:195]
ds_read_b64_tr_b16 v[24:25], v4 offset:256
v_xor_b32 v5, 49248, v1
v_mfma_f32_16x16x32_bf16 v[196:199], v[28:31], a[68:71], v[196:199]
ds_read_b64_tr_b16 v[26:27], v4 offset:8448
s_waitcnt lgkmcnt(4)
v_mfma_f32_16x16x32_bf16 v[136:139], v[12:15], a[64:67], v[136:139]
ds_read_b64_tr_b16 v[28:29], v5
v_mov_b32 v8, 0
v_mfma_f32_16x16x32_bf16 v[140:143], v[12:15], a[68:71], v[140:143]
ds_read_b64_tr_b16 v[30:31], v5 offset:8192
v_mfma_f32_16x16x32_bf16 v[200:203], v[16:19], a[64:67], v[200:203]
ds_read_b64_tr_b16 v[12:13], v5 offset:256
v_xor_b32 v4, 49280, v1
v_mfma_f32_16x16x32_bf16 v[204:207], v[16:19], a[68:71], v[204:207]
ds_read_b64_tr_b16 v[14:15], v5 offset:8448
s_waitcnt lgkmcnt(4)
v_mfma_f32_16x16x32_bf16 v[144:147], v[20:23], a[64:67], v[144:147]
ds_read_b64_tr_b16 v[16:17], v4
v_mfma_f32_16x16x32_bf16 v[148:151], v[20:23], a[68:71], v[148:151]
ds_read_b64_tr_b16 v[18:19], v4 offset:8192
ds_read_b32 v8, v8 offset:14336
v_mfma_f32_16x16x32_bf16 v[208:211], v[24:27], a[64:67], v[208:211]
ds_read_b64_tr_b16 v[20:21], v4 offset:256
v_xor_b32 v5, 49312, v1
v_mfma_f32_16x16x32_bf16 v[212:215], v[24:27], a[68:71], v[212:215]
ds_read_b64_tr_b16 v[22:23], v4 offset:8448
s_waitcnt lgkmcnt(5)
v_mfma_f32_16x16x32_bf16 v[152:155], v[28:31], a[64:67], v[152:155]
ds_read_b64_tr_b16 v[24:25], v5
v_mfma_f32_16x16x32_bf16 v[156:159], v[28:31], a[68:71], v[156:159]
ds_read_b64_tr_b16 v[26:27], v5 offset:8192
v_mfma_f32_16x16x32_bf16 v[216:219], v[12:15], a[64:67], v[216:219]
ds_read_b64_tr_b16 v[28:29], v5 offset:256
v_xor_b32 v4, 49344, v1
v_mfma_f32_16x16x32_bf16 v[220:223], v[12:15], a[68:71], v[220:223]
ds_read_b64_tr_b16 v[30:31], v5 offset:8448
s_waitcnt lgkmcnt(4)
v_mfma_f32_16x16x32_bf16 v[160:163], v[16:19], a[64:67], v[160:163]
ds_read_b64_tr_b16 v[12:13], v4
v_cmp_le_u32 vcc, 16, v8
v_mfma_f32_16x16x32_bf16 v[164:167], v[16:19], a[68:71], v[164:167]
ds_read_b64_tr_b16 v[14:15], v4 offset:8192
v_mfma_f32_16x16x32_bf16 v[224:227], v[20:23], a[64:67], v[224:227]
ds_read_b64_tr_b16 v[16:17], v4 offset:256
v_xor_b32 v5, 49376, v1
v_mfma_f32_16x16x32_bf16 v[228:231], v[20:23], a[68:71], v[228:231]
ds_read_b64_tr_b16 v[18:19], v4 offset:8448
s_waitcnt lgkmcnt(4)
v_mfma_f32_16x16x32_bf16 v[168:171], v[24:27], a[64:67], v[168:171]
ds_read_b64_tr_b16 v[20:21], v5
ds_read_b64_tr_b16 v[22:23], v5 offset:8192
v_mfma_f32_16x16x32_bf16 v[172:175], v[24:27], a[68:71], v[172:175]
s_cbranch_vccz L_sp9
L_ok9:
v_mfma_f32_16x16x32_bf16 v[232:235], v[28:31], a[64:67], v[232:235]
ds_read_b64_tr_b16 v[24:25], v5 offset:256
v_xor_b32 v4, 81920, v1
v_mfma_f32_16x16x32_bf16 v[236:239], v[28:31], a[68:71], v[236:239]
ds_read_b64_tr_b16 v[26:27], v5 offset:8448
s_waitcnt lgkmcnt(4)
v_mfma_f32_16x16x32_bf16 v[176:179], v[12:15], a[64:67], v[176:179]
ds_read_b64_tr_b16 v[28:29], v4
v_mfma_f32_16x16x32_bf16 v[180:183], v[12:15], a[68:71], v[180:183]
ds_read_b64_tr_b16 v[30:31], v4 offset:8192
v_mfma_f32_16x16x32_bf16 v[240:243], v[16:19], a[64:67], v[240:243]
ds_read_b64_tr_b16 v[12:13], v4 offset:256
v_xor_b32 v5, 81952, v1
v_mfma_f32_16x16x32_bf16 v[244:247], v[16:19], a[68:71], v[244:247]
ds_read_b64_tr_b16 v[14:15], v4 offset:8448
s_waitcnt lgkmcnt(4)
v_mfma_f32_16x16x32_bf16 v[184:187], v[20:23], a[64:67], v[184:187]
ds_read_b64_tr_b16 v[16:17], v5
s_movk_i32 s12, 36
v_mfma_f32_16x16x32_bf16 v[188:191], v[20:23], a[68:71], v[188:191]
ds_read_b64_tr_b16 v[18:19], v5 offset:8192
v_xor_b32 v0, 65536, v3
v_mfma_f32_16x16x32_bf16 v[248:251], v[24:27], a[64:67], v[248:251]
ds_read_b64_tr_b16 v[20:21], v5 offset:256
v_xor_b32 v4, 81984, v1
v_mfma_f32_16x16x32_bf16 v[252:255], v[24:27], a[68:71], v[252:255]
ds_read_b64_tr_b16 v[22:23], v5 offset:8448
s_waitcnt lgkmcnt(4)
v_mfma_f32_16x16x32_bf16 v[128:131], v[28:31], a[72:75], v[128:131]
ds_read_b64_tr_b16 v[24:25], v4
ds_read_b64_tr_b16 v[26:27], v4 offset:8192
v_mfma_f32_16x16x32_bf16 v[132:135], v[28:31], a[76:79], v[132:135]
buffer_load_dword off, s[8:11], s12 lds
v_mfma_f32_16x16x32_bf16 v[192:195], v[12:15], a[72:75], v[192:195]
ds_read_b64_tr_b16 v[28:29], v4 offset:256
v_xor_b32 v5, 82016, v1
v_mfma_f32_16x16x32_bf16 v[196:199], v[12:15], a[76:79], v[196:199]
ds_read_b64_tr_b16 v[30:31], v4 offset:8448
s_waitcnt lgkmcnt(4)
v_mfma_f32_16x16x32_bf16 v[136:139], v[16:19], a[72:75], v[136:139]
ds_read_b64_tr_b16 v[12:13], v5
v_mov_b32 v8, 0
v_mfma_f32_16x16x32_bf16 v[140:143], v[16:19], a[76:79], v[140:143]
ds_read_b64_tr_b16 v[14:15], v5 offset:8192
ds_read_b128 a[80:83], v0
v_mfma_f32_16x16x32_bf16 v[200:203], v[20:23], a[72:75], v[200:203]
ds_read_b64_tr_b16 v[16:17], v5 offset:256
v_xor_b32 v4, 82048, v1
v_mfma_f32_16x16x32_bf16 v[204:207], v[20:23], a[76:79], v[204:207]
ds_read_b64_tr_b16 v[18:19], v5 offset:8448
s_waitcnt lgkmcnt(5)
v_mfma_f32_16x16x32_bf16 v[144:147], v[24:27], a[72:75], v[144:147]
ds_read_b64_tr_b16 v[20:21], v4
ds_read_b128 a[84:87], v0 offset:2048
v_mfma_f32_16x16x32_bf16 v[148:151], v[24:27], a[76:79], v[148:151]
ds_read_b64_tr_b16 v[22:23], v4 offset:8192
ds_read_b32 v8, v8 offset:14336
v_mfma_f32_16x16x32_bf16 v[208:211], v[28:31], a[72:75], v[208:211]
ds_read_b64_tr_b16 v[24:25], v4 offset:256
v_xor_b32 v5, 82080, v1
v_mfma_f32_16x16x32_bf16 v[212:215], v[28:31], a[76:79], v[212:215]
ds_read_b64_tr_b16 v[26:27], v4 offset:8448
s_waitcnt lgkmcnt(6)
v_mfma_f32_16x16x32_bf16 v[152:155], v[12:15], a[72:75], v[152:155]
ds_read_b64_tr_b16 v[28:29], v5
v_xor_b32 v2, 65600, v3
v_mfma_f32_16x16x32_bf16 v[156:159], v[12:15], a[76:79], v[156:159]
ds_read_b64_tr_b16 v[30:31], v5 offset:8192
ds_read_b128 a[88:91], v2
v_mfma_f32_16x16x32_bf16 v[216:219], v[16:19], a[72:75], v[216:219]
ds_read_b64_tr_b16 v[12:13], v5 offset:256
v_xor_b32 v4, 82112, v1
v_mfma_f32_16x16x32_bf16 v[220:223], v[16:19], a[76:79], v[220:223]
ds_read_b64_tr_b16 v[14:15], v5 offset:8448
s_waitcnt lgkmcnt(5)
v_mfma_f32_16x16x32_bf16 v[160:163], v[20:23], a[72:75], v[160:163]
ds_read_b64_tr_b16 v[16:17], v4
v_cmp_le_u32 vcc, 17, v8
v_mfma_f32_16x16x32_bf16 v[164:167], v[20:23], a[76:79], v[164:167]
ds_read_b64_tr_b16 v[18:19], v4 offset:8192
ds_read_b128 a[92:95], v2 offset:2048
v_mfma_f32_16x16x32_bf16 v[224:227], v[24:27], a[72:75], v[224:227]
ds_read_b64_tr_b16 v[20:21], v4 offset:256
v_xor_b32 v5, 82144, v1
v_mfma_f32_16x16x32_bf16 v[228:231], v[24:27], a[76:79], v[228:231]
ds_read_b64_tr_b16 v[22:23], v4 offset:8448
s_waitcnt lgkmcnt(5)
v_mfma_f32_16x16x32_bf16 v[168:171], v[28:31], a[72:75], v[168:171]
ds_read_b64_tr_b16 v[24:25], v5
ds_read_b64_tr_b16 v[26:27], v5 offset:8192
v_mfma_f32_16x16x32_bf16 v[172:175], v[28:31], a[76:79], v[172:175]
s_cbranch_vccz L_sp10
L_ok10:
v_mfma_f32_16x16x32_bf16 v[232:235], v[12:15], a[72:75], v[232:235]
ds_read_b64_tr_b16 v[28:29], v5 offset:256
v_xor_b32 v4, 98304, v1
v_mfma_f32_16x16x32_bf16 v[236:239], v[12:15], a[76:79], v[236:239]
ds_read_b64_tr_b16 v[30:31], v5 offset:8448
s_waitcnt lgkmcnt(4)
v_mfma_f32_16x16x32_bf16 v[176:179], v[16:19], a[72:75], v[176:179]
ds_read_b64_tr_b16 v[12:13], v4
v_mfma_f32_16x16x32_bf16 v[180:183], v[16:19], a[76:79], v[180:183]
ds_read_b64_tr_b16 v[14:15], v4 offset:8192
v_mfma_f32_16x16x32_bf16 v[240:243], v[20:23], a[72:75], v[240:243]
ds_read_b64_tr_b16 v[16:17], v4 offset:256
v_xor_b32 v5, 98336, v1
v_mfma_f32_16x16x32_bf16 v[244:247], v[20:23], a[76:79], v[244:247]
ds_read_b64_tr_b16 v[18:19], v4 offset:8448
s_waitcnt lgkmcnt(4)
v_mfma_f32_16x16x32_bf16 v[184:187], v[24:27], a[72:75], v[184:187]
ds_read_b64_tr_b16 v[20:21], v5
s_movk_i32 s12, 40
v_mfma_f32_16x16x32_bf16 v[188:191], v[24:27], a[76:79], v[188:191]
ds_read_b64_tr_b16 v[22:23], v5 offset:8192
v_mfma_f32_16x16x32_bf16 v[248:251], v[28:31], a[72:75], v[248:251]
ds_read_b64_tr_b16 v[24:25], v5 offset:256
v_xor_b32 v4, 98368, v1
v_mfma_f32_16x16x32_bf16 v[252:255], v[28:31], a[76:79], v[252:255]
ds_read_b64_tr_b16 v[26:27], v5 offset:8448
s_waitcnt lgkmcnt(4)
v_mfma_f32_16x16x32_bf16 v[128:131], v[12:15], a[80:83], v[128:131]
ds_read_b64_tr_b16 v[28:29], v4
ds_read_b64_tr_b16 v[30:31], v4 offset:8192
v_mfma_f32_16x16x32_bf16 v[132:135], v[12:15], a[84:87], v[132:135]
buffer_load_dword off, s[8:11], s12 lds
v_mfma_f32_16x16x32_bf16 v[192:195], v[16:19], a[80:83], v[192:195]
ds_read_b64_tr_b16 v[12:13], v4 offset:256
v_xor_b32 v5, 98400, v1
v_mfma_f32_16x16x32_bf16 v[196:199], v[16:19], a[84:87], v[196:199]
ds_read_b64_tr_b16 v[14:15], v4 offset:8448
s_waitcnt lgkmcnt(4)
v_mfma_f32_16x16x32_bf16 v[136:139], v[20:23], a[80:83], v[136:139]
ds_read_b64_tr_b16 v[16:17], v5
v_mov_b32 v8, 0
v_mfma_f32_16x16x32_bf16 v[140:143], v[20:23], a[84:87], v[140:143]
ds_read_b64_tr_b16 v[18:19], v5 offset:8192
v_mfma_f32_16x16x32_bf16 v[200:203], v[24:27], a[80:83], v[200:203]
ds_read_b64_tr_b16 v[20:21], v5 offset:256
v_xor_b32 v4, 98432, v1
v_mfma_f32_16x16x32_bf16 v[204:207], v[24:27], a[84:87], v[204:207]
ds_read_b64_tr_b16 v[22:23], v5 offset:8448
s_waitcnt lgkmcnt(4)
v_mfma_f32_16x16x32_bf16 v[144:147], v[28:31], a[80:83], v[144:147]
ds_read_b64_tr_b16 v[24:25], v4
v_mfma_f32_16x16x32_bf16 v[148:151], v[28:31], a[84:87], v[148:151]
ds_read_b64_tr_b16 v[26:27], v4 offset:8192
ds_read_b32 v8, v8 offset:14336
v_mfma_f32_16x16x32_bf16 v[208:211], v[12:15], a[80:83], v[208:211]
ds_read_b64_tr_b16 v[28:29], v4 offset:256
v_xor_b32 v5, 98464, v1
v_mfma_f32_16x16x32_bf16 v[212:215], v[12:15], a[84:87], v[212:215]
ds_read_b64_tr_b16 v[30:31], v4 offset:8448
s_waitcnt lgkmcnt(5)
v_mfma_f32_16x16x32_bf16 v[152:155], v[16:19], a[80:83], v[152:155]
ds_read_b64_tr_b16 v[12:13], v5
v_mfma_f32_16x16x32_bf16 v[156:159], v[16:19], a[84:87], v[156:159]
ds_read_b64_tr_b16 v[14:15], v5 offset:8192
v_mfma_f32_16x16x32_bf16 v[216:219], v[20:23], a[80:83], v[216:219]
ds_read_b64_tr_b16 v[16:17], v5 offset:256
v_xor_b32 v4, 98496, v1
v_mfma_f32_16x16x32_bf16 v[220:223], v[20:23], a[84:87], v[220:223]
ds_read_b64_tr_b16 v[18:19], v5 offset:8448
s_waitcnt lgkmcnt(4)
v_mfma_f32_16x16x32_bf16 v[160:163], v[24:27], a[80:83], v[160:163]
ds_read_b64_tr_b16 v[20:21], v4
v_cmp_le_u32 vcc, 21, v8
v_mfma_f32_16x16x32_bf16 v[164:167], v[24:27], a[84:87], v[164:167]
ds_read_b64_tr_b16 v[22:23], v4 offset:8192
v_mfma_f32_16x16x32_bf16 v[224:227], v[28:31], a[80:83], v[224:227]
ds_read_b64_tr_b16 v[24:25], v4 offset:256
v_xor_b32 v5, 98528, v1
v_mfma_f32_16x16x32_bf16 v[228:231], v[28:31], a[84:87], v[228:231]
ds_read_b64_tr_b16 v[26:27], v4 offset:8448
s_waitcnt lgkmcnt(4)
v_mfma_f32_16x16x32_bf16 v[168:171], v[12:15], a[80:83], v[168:171]
ds_read_b64_tr_b16 v[28:29], v5
ds_read_b64_tr_b16 v[30:31], v5 offset:8192
v_mfma_f32_16x16x32_bf16 v[172:175], v[12:15], a[84:87], v[172:175]
s_cbranch_vccz L_sp11
L_ok11:
v_mfma_f32_16x16x32_bf16 v[232:235], v[16:19], a[80:83], v[232:235]
ds_read_b64_tr_b16 v[12:13], v5 offset:256
v_xor_b32 v4, 16384, v1
v_mfma_f32_16x16x32_bf16 v[236:239], v[16:19], a[84:87], v[236:239]
ds_read_b64_tr_b16 v[14:15], v5 offset:8448
s_waitcnt lgkmcnt(4)
v_mfma_f32_16x16x32_bf16 v[176:179], v[20:23], a[80:83], v[176:179]
ds_read_b64_tr_b16 v[16:17], v4
v_mfma_f32_16x16x32_bf16 v[180:183], v[20:23], a[84:87], v[180:183]
ds_read_b64_tr_b16 v[18:19], v4 offset:8192
v_mfma_f32_16x16x32_bf16 v[240:243], v[24:27], a[80:83], v[240:243]
ds_read_b64_tr_b16 v[20:21], v4 offset:256
v_xor_b32 v5, 16416, v1
v_mfma_f32_16x16x32_bf16 v[244:247], v[24:27], a[84:87], v[244:247]
ds_read_b64_tr_b16 v[22:23], v4 offset:8448
s_waitcnt lgkmcnt(4)
v_mfma_f32_16x16x32_bf16 v[184:187], v[28:31], a[80:83], v[184:187]
ds_read_b64_tr_b16 v[24:25], v5
s_movk_i32 s12, 44
v_mfma_f32_16x16x32_bf16 v[188:191], v[28:31], a[84:87], v[188:191]
ds_read_b64_tr_b16 v[26:27], v5 offset:8192
v_xor_b32 v0, 147456, v3
v_mfma_f32_16x16x32_bf16 v[248:251], v[12:15], a[80:83], v[248:251]
ds_read_b64_tr_b16 v[28:29], v5 offset:256
v_xor_b32 v4, 16448, v1
v_mfma_f32_16x16x32_bf16 v[252:255], v[12:15], a[84:87], v[252:255]
ds_read_b64_tr_b16 v[30:31], v5 offset:8448
s_waitcnt lgkmcnt(4)
v_mfma_f32_16x16x32_bf16 v[128:131], v[16:19], a[88:91], v[128:131]
ds_read_b64_tr_b16 v[12:13], v4
ds_read_b64_tr_b16 v[14:15], v4 offset:8192
v_mfma_f32_16x16x32_bf16 v[132:135], v[16:19], a[92:95], v[132:135]
buffer_load_dword off, s[8:11], s12 lds
v_mfma_f32_16x16x32_bf16 v[192:195], v[20:23], a[88:91], v[192:195]
ds_read_b64_tr_b16 v[16:17], v4 offset:256
v_xor_b32 v5, 16480, v1
v_mfma_f32_16x16x32_bf16 v[196:199], v[20:23], a[92:95], v[196:199]
ds_read_b64_tr_b16 v[18:19], v4 offset:8448
s_waitcnt lgkmcnt(4)
v_mfma_f32_16x16x32_bf16 v[136:139], v[24:27], a[88:91], v[136:139]
ds_read_b64_tr_b16 v[20:21], v5
v_mov_b32 v8, 0
v_mfma_f32_16x16x32_bf16 v[140:143], v[24:27], a[92:95], v[140:143]
ds_read_b64_tr_b16 v[22:23], v5 offset:8192
ds_read_b128 a[96:99], v0
v_mfma_f32_16x16x32_bf16 v[200:203], v[28:31], a[88:91], v[200:203]
ds_read_b64_tr_b16 v[24:25], v5 offset:256
v_xor_b32 v4, 16512, v1
v_mfma_f32_16x16x32_bf16 v[204:207], v[28:31], a[92:95], v[204:207]
ds_read_b64_tr_b16 v[26:27], v5 offset:8448
s_waitcnt lgkmcnt(5)
v_mfma_f32_16x16x32_bf16 v[144:147], v[12:15], a[88:91], v[144:147]
ds_read_b64_tr_b16 v[28:29], v4
ds_read_b128 a[100:103], v0 offset:2048
v_mfma_f32_16x16x32_bf16 v[148:151], v[12:15], a[92:95], v[148:151]
s_branch L_pg2
L_sp12:
v_mov_b32 v8, 0
ds_read_b32 v8, v8 offset:14336
s_waitcnt lgkmcnt(0)
v_cmp_le_u32 vcc, 22, v8
s_cbranch_vccz L_sp12
s_branch L_ok12
L_sp13:
v_mov_b32 v8, 0
ds_read_b32 v8, v8 offset:14336
s_waitcnt lgkmcnt(0)
v_cmp_le_u32 vcc, 23, v8
s_cbranch_vccz L_sp13
s_branch L_ok13
L_sp14:
v_mov_b32 v8, 0
ds_read_b32 v8, v8 offset:14336
s_waitcnt lgkmcnt(0)
v_cmp_le_u32 vcc, 24, v8
s_cbranch_vccz L_sp14
s_branch L_ok14
.p2align 12
L_stub2:
s_setpc_b64 s[94:95]
L_pg2:
ds_read_b64_tr_b16 v[30:31], v4 offset:8192
ds_read_b32 v8, v8 offset:14336
v_mfma_f32_16x16x32_bf16 v[208:211], v[16:19], a[88:91], v[208:211]
ds_read_b64_tr_b16 v[12:13], v4 offset:256
v_xor_b32 v5, 16544, v1
v_mfma_f32_16x16x32_bf16 v[212:215], v[16:19], a[92:95], v[212:215]
ds_read_b64_tr_b16 v[14:15], v4 offset:8448
s_waitcnt lgkmcnt(6)
v_mfma_f32_16x16x32_bf16 v[152:155], v[20:23], a[88:91], v[152:155]
ds_read_b64_tr_b16 v[16:17], v5
v_xor_b32 v2, 147520, v3
v_mfma_f32_16x16x32_bf16 v[156:159], v[20:23], a[92:95], v[156:159]
ds_read_b64_tr_b16 v[18:19], v5 offset:8192
ds_read_b128 a[104:107], v2
v_mfma_f32_16x16x32_bf16 v[216:219], v[24:27], a[88:91], v[216:219]
ds_read_b64_tr_b16 v[20:21], v5 offset:256
v_xor_b32 v4, 16576, v1
v_mfma_f32_16x16x32_bf16 v[220:223], v[24:27], a[92:95], v[220:223]
ds_read_b64_tr_b16 v[22:23], v5 offset:8448
s_waitcnt lgkmcnt(5)
v_mfma_f32_16x16x32_bf16 v[160:163], v[28:31], a[88:91], v[160:163]
ds_read_b64_tr_b16 v[24:25], v4
v_cmp_le_u32 vcc, 22, v8
v_mfma_f32_16x16x32_bf16 v[164:167], v[28:31], a[92:95], v[164:167]
ds_read_b64_tr_b16 v[26:27], v4 offset:8192
ds_read_b128 a[108:111], v2 offset:2048
v_mfma_f32_16x16x32_bf16 v[224:227], v[12:15], a[88:91], v[224:227]
ds_read_b64_tr_b16 v[28:29], v4 offset:256
v_xor_b32 v5, 16608, v1
v_mfma_f32_16x16x32_bf16 v[228:231], v[12:15], a[92:95], v[228:231]
ds_read_b64_tr_b16 v[30:31], v4 offset:8448
s_waitcnt lgkmcnt(5)
v_mfma_f32_16x16x32_bf16 v[168:171], v[16:19], a[88:91], v[168:171]
ds_read_b64_tr_b16 v[12:13], v5
ds_read_b64_tr_b16 v[14:15], v5 offset:8192
v_mfma_f32_16x16x32_bf16 v[172:175], v[16:19], a[92:95], v[172:175]
s_cbranch_vccz L_sp12
L_ok12:
v_mfma_f32_16x16x32_bf16 v[232:235], v[20:23], a[88:91], v[232:235]
ds_read_b64_tr_b16 v[16:17], v5 offset:256
v_xor_b32 v4, 32768, v1
v_mfma_f32_16x16x32_bf16 v[236:239], v[20:23], a[92:95], v[236:239]
ds_read_b64_tr_b16 v[18:19], v5 offset:8448
s_waitcnt lgkmcnt(4)
v_mfma_f32_16x16x32_bf16 v[176:179], v[24:27], a[88:91], v[176:179]
ds_read_b64_tr_b16 v[20:21], v4
v_mfma_f32_16x16x32_bf16 v[180:183], v[24:27], a[92:95], v[180:183]
ds_read_b64_tr_b16 v[22:23], v4 offset:8192
v_mfma_f32_16x16x32_bf16 v[240:243], v[28:31], a[88:91], v[240:243]
ds_read_b64_tr_b16 v[24:25], v4 offset:256
v_xor_b32 v5, 32800, v1
v_mfma_f32_16x16x32_bf16 v[244:247], v[28:31], a[92:95], v[244:247]
ds_read_b64_tr_b16 v[26:27], v4 offset:8448
s_waitcnt lgkmcnt(4)
v_mfma_f32_16x16x32_bf16 v[184:187], v[12:15], a[88:91], v[184:187]
ds_read_b64_tr_b16 v[28:29], v5
s_movk_i32 s12, 48
v_mfma_f32_16x16x32_bf16 v[188:191], v[12:15], a[92:95], v[188:191]
ds_read_b64_tr_b16 v[30:31], v5 offset:8192
v_mfma_f32_16x16x32_bf16 v[248:251], v[16:19], a[88:91], v[248:251]
ds_read_b64_tr_b16 v[12:13], v5 offset:256
v_xor_b32 v4, 32832, v1
v_mfma_f32_16x16x32_bf16 v[252:255], v[16:19], a[92:95], v[252:255]
ds_read_b64_tr_b16 v[14:15], v5 offset:8448
s_waitcnt lgkmcnt(4)
v_mfma_f32_16x16x32_bf16 v[128:131], v[20:23], a[96:99], v[128:131]
ds_read_b64_tr_b16 v[16:17], v4
ds_read_b64_tr_b16 v[18:19], v4 offset:8192
v_mfma_f32_16x16x32_bf16 v[132:135], v[20:23], a[100:103], v[132:135]
buffer_load_dword off, s[8:11], s12 lds
v_mfma_f32_16x16x32_bf16 v[192:195], v[24:27], a[96:99], v[192:195]
ds_read_b64_tr_b16 v[20:21], v4 offset:256
v_xor_b32 v5, 32864, v1
v_mfma_f32_16x16x32_bf16 v[196:199], v[24:27], a[100:103], v[196:199]
ds_read_b64_tr_b16 v[22:23], v4 offset:8448
s_waitcnt lgkmcnt(4)
v_mfma_f32_16x16x32_bf16 v[136:139], v[28:31], a[96:99], v[136:139]
ds_read_b64_tr_b16 v[24:25], v5
v_mov_b32 v8, 0
v_mfma_f32_16x16x32_bf16 v[140:143], v[28:31], a[100:103], v[140:143]
ds_read_b64_tr_b16 v[26:27], v5 offset:8192
v_mfma_f32_16x16x32_bf16 v[200:203], v[12:15], a[96:99], v[200:203]
ds_read_b64_tr_b16 v[28:29], v5 offset:256
v_xor_b32 v4, 32896, v1
v_mfma_f32_16x16x32_bf16 v[204:207], v[12:15], a[100:103], v[204:207]
ds_read_b64_tr_b16 v[30:31], v5 offset:8448
s_waitcnt lgkmcnt(4)
v_mfma_f32_16x16x32_bf16 v[144:147], v[16:19], a[96:99], v[144:147]
ds_read_b64_tr_b16 v[12:13], v4
v_mfma_f32_16x16x32_bf16 v[148:151], v[16:19], a[100:103], v[148:151]
ds_read_b64_tr_b16 v[14:15], v4 offset:8192
ds_read_b32 v8, v8 offset:14336
v_mfma_f32_16x16x32_bf16 v[208:211], v[20:23], a[96:99], v[208:211]
ds_read_b64_tr_b16 v[16:17], v4 offset:256
v_xor_b32 v5, 32928, v1
v_mfma_f32_16x16x32_bf16 v[212:215], v[20:23], a[100:103], v[212:215]
ds_read_b64_tr_b16 v[18:19], v4 offset:8448
s_waitcnt lgkmcnt(5)
v_mfma_f32_16x16x32_bf16 v[152:155], v[24:27], a[96:99], v[152:155]
ds_read_b64_tr_b16 v[20:21], v5
v_mfma_f32_16x16x32_bf16 v[156:159], v[24:27], a[100:103], v[156:159]
ds_read_b64_tr_b16 v[22:23], v5 offset:8192
v_mfma_f32_16x16x32_bf16 v[216:219], v[28:31], a[96:99], v[216:219]
ds_read_b64_tr_b16 v[24:25], v5 offset:256
v_xor_b32 v4, 32960, v1
v_mfma_f32_16x16x32_bf16 v[220:223], v[28:31], a[100:103], v[220:223]
ds_read_b64_tr_b16 v[26:27], v5 offset:8448
s_waitcnt lgkmcnt(4)
v_mfma_f32_16x16x32_bf16 v[160:163], v[12:15], a[96:99], v[160:163]
ds_read_b64_tr_b16 v[28:29], v4
v_cmp_le_u32 vcc, 23, v8
v_mfma_f32_16x16x32_bf16 v[164:167], v[12:15], a[100:103], v[164:167]
ds_read_b64_tr_b16 v[30:31], v4 offset:8192
v_mfma_f32_16x16x32_bf16 v[224:227], v[16:19], a[96:99], v[224:227]
ds_read_b64_tr_b16 v[12:13], v4 offset:256
v_xor_b32 v5, 32992, v1
v_mfma_f32_16x16x32_bf16 v[228:231], v[16:19], a[100:103], v[228:231]
ds_read_b64_tr_b16 v[14:15], v4 offset:8448
s_waitcnt lgkmcnt(4)
v_mfma_f32_16x16x32_bf16 v[168:171], v[20:23], a[96:99], v[168:171]
ds_read_b64_tr_b16 v[16:17], v5
ds_read_b64_tr_b16 v[18:19], v5 offset:8192
v_mfma_f32_16x16x32_bf16 v[172:175], v[20:23], a[100:103], v[172:175]
s_cbranch_vccz L_sp13
L_ok13:
v_mfma_f32_16x16x32_bf16 v[232:235], v[24:27], a[96:99], v[232:235]
ds_read_b64_tr_b16 v[20:21], v5 offset:256
v_xor_b32 v4, 49152, v1
v_mfma_f32_16x16x32_bf16 v[236:239], v[24:27], a[100:103], v[236:239]
ds_read_b64_tr_b16 v[22:23], v5 offset:8448
s_waitcnt lgkmcnt(4)
v_mfma_f32_16x16x32_bf16 v[176:179], v[28:31], a[96:99], v[176:179]
ds_read_b64_tr_b16 v[24:25], v4
v_mfma_f32_16x16x32_bf16 v[180:183], v[28:31], a[100:103], v[180:183]
ds_read_b64_tr_b16 v[26:27], v4 offset:8192
v_mfma_f32_16x16x32_bf16 v[240:243], v[12:15], a[96:99], v[240:243]
ds_read_b64_tr_b16 v[28:29], v4 offset:256
v_xor_b32 v5, 49184, v1
v_mfma_f32_16x16x32_bf16 v[244:247], v[12:15], a[100:103], v[244:247]
ds_read_b64_tr_b16 v[30:31], v4 offset:8448
s_waitcnt lgkmcnt(4)
v_mfma_f32_16x16x32_bf16 v[184:187], v[16:19], a[96:99], v[184:187]
ds_read_b64_tr_b16 v[12:13], v5
s_movk_i32 s12, 52
v_mfma_f32_16x16x32_bf16 v[188:191], v[16:19], a[100:103], v[188:191]
ds_read_b64_tr_b16 v[14:15], v5 offset:8192
v_mfma_f32_16x16x32_bf16 v[248:251], v[20:23], a[96:99], v[248:251]
ds_read_b64_tr_b16 v[16:17], v5 offset:256
v_xor_b32 v4, 49216, v1
v_mfma_f32_16x16x32_bf16 v[252:255], v[20:23], a[100:103], v[252:255]
ds_read_b64_tr_b16 v[18:19], v5 offset:8448
s_waitcnt lgkmcnt(4)
v_mfma_f32_16x16x32_bf16 v[128:131], v[24:27], a[104:107], v[128:131]
ds_read_b64_tr_b16 v[20:21], v4
ds_read_b64_tr_b16 v[22:23], v4 offset:8192
v_mfma_f32_16x16x32_bf16 v[132:135], v[24:27], a[108:111], v[132:135]
buffer_load_dword off, s[8:11], s12 lds
v_mfma_f32_16x16x32_bf16 v[192:195], v[28:31], a[104:107], v[192:195]
ds_read_b64_tr_b16 v[24:25], v4 offset:256
v_xor_b32 v5, 49248, v1
v_mfma_f32_16x16x32_bf16 v[196:199], v[28:31], a[108:111], v[196:199]
ds_read_b64_tr_b16 v[26:27], v4 offset:8448
s_waitcnt lgkmcnt(4)
v_mfma_f32_16x16x32_bf16 v[136:139], v[12:15], a[104:107], v[136:139]
ds_read_b64_tr_b16 v[28:29], v5
v_mov_b32 v8, 0
v_mfma_f32_16x16x32_bf16 v[140:143], v[12:15], a[108:111], v[140:143]
ds_read_b64_tr_b16 v[30:31], v5 offset:8192
v_mfma_f32_16x16x32_bf16 v[200:203], v[16:19], a[104:107], v[200:203]
ds_read_b64_tr_b16 v[12:13], v5 offset:256
v_xor_b32 v4, 49280, v1
v_mfma_f32_16x16x32_bf16 v[204:207], v[16:19], a[108:111], v[204:207]
ds_read_b64_tr_b16 v[14:15], v5 offset:8448
s_waitcnt lgkmcnt(4)
v_mfma_f32_16x16x32_bf16 v[144:147], v[20:23], a[104:107], v[144:147]
ds_read_b64_tr_b16 v[16:17], v4
v_mfma_f32_16x16x32_bf16 v[148:151], v[20:23], a[108:111], v[148:151]
ds_read_b64_tr_b16 v[18:19], v4 offset:8192
ds_read_b32 v8, v8 offset:14336
v_mfma_f32_16x16x32_bf16 v[208:211], v[24:27], a[104:107], v[208:211]
ds_read_b64_tr_b16 v[20:21], v4 offset:256
v_xor_b32 v5, 49312, v1
v_mfma_f32_16x16x32_bf16 v[212:215], v[24:27], a[108:111], v[212:215]
ds_read_b64_tr_b16 v[22:23], v4 offset:8448
s_waitcnt lgkmcnt(5)
v_mfma_f32_16x16x32_bf16 v[152:155], v[28:31], a[104:107], v[152:155]
ds_read_b64_tr_b16 v[24:25], v5
v_mfma_f32_16x16x32_bf16 v[156:159], v[28:31], a[108:111], v[156:159]
ds_read_b64_tr_b16 v[26:27], v5 offset:8192
v_mfma_f32_16x16x32_bf16 v[216:219], v[12:15], a[104:107], v[216:219]
ds_read_b64_tr_b16 v[28:29], v5 offset:256
v_xor_b32 v4, 49344, v1
v_mfma_f32_16x16x32_bf16 v[220:223], v[12:15], a[108:111], v[220:223]
ds_read_b64_tr_b16 v[30:31], v5 offset:8448
s_waitcnt lgkmcnt(4)
v_mfma_f32_16x16x32_bf16 v[160:163], v[16:19], a[104:107], v[160:163]
ds_read_b64_tr_b16 v[12:13], v4
v_cmp_le_u32 vcc, 24, v8
v_mfma_f32_16x16x32_bf16 v[164:167], v[16:19], a[108:111], v[164:167]
ds_read_b64_tr_b16 v[14:15], v4 offset:8192
v_mfma_f32_16x16x32_bf16 v[224:227], v[20:23], a[104:107], v[224:227]
ds_read_b64_tr_b16 v[16:17], v4 offset:256
v_xor_b32 v5, 49376, v1
v_mfma_f32_16x16x32_bf16 v[228:231], v[20:23], a[108:111], v[228:231]
ds_read_b64_tr_b16 v[18:19], v4 offset:8448
s_waitcnt lgkmcnt(4)
v_mfma_f32_16x16x32_bf16 v[168:171], v[24:27], a[104:107], v[168:171]
ds_read_b64_tr_b16 v[20:21], v5
ds_read_b64_tr_b16 v[22:23], v5 offset:8192
v_mfma_f32_16x16x32_bf16 v[172:175], v[24:27], a[108:111], v[172:175]
s_cbranch_vccz L_sp14
L_ok14:
v_mfma_f32_16x16x32_bf16 v[232:235], v[28:31], a[104:107], v[232:235]
ds_read_b64_tr_b16 v[24:25], v5 offset:256
v_xor_b32 v4, 65536, v1
v_mfma_f32_16x16x32_bf16 v[236:239], v[28:31], a[108:111], v[236:239]
ds_read_b64_tr_b16 v[26:27], v5 offset:8448
s_waitcnt lgkmcnt(4)
v_mfma_f32_16x16x32_bf16 v[176:179], v[12:15], a[104:107], v[176:179]
ds_read_b64_tr_b16 v[28:29], v4
v_mfma_f32_16x16x32_bf16 v[180:183], v[12:15], a[108:111], v[180:183]
ds_read_b64_tr_b16 v[30:31], v4 offset:8192
v_mfma_f32_16x16x32_bf16 v[240:243], v[16:19], a[104:107], v[240:243]
ds_read_b64_tr_b16 v[12:13], v4 offset:256
v_xor_b32 v5, 65568, v1
v_mfma_f32_16x16x32_bf16 v[244:247], v[16:19], a[108:111], v[244:247]
ds_read_b64_tr_b16 v[14:15], v4 offset:8448
s_waitcnt lgkmcnt(4)
v_mfma_f32_16x16x32_bf16 v[184:187], v[20:23], a[104:107], v[184:187]
ds_read_b64_tr_b16 v[16:17], v5
s_movk_i32 s12, 56
v_mfma_f32_16x16x32_bf16 v[188:191], v[20:23], a[108:111], v[188:191]
ds_read_b64_tr_b16 v[18:19], v5 offset:8192
v_mfma_f32_16x16x32_bf16 v[248:251], v[24:27], a[104:107], v[248:251]
ds_read_b64_tr_b16 v[20:21], v5 offset:256
v_xor_b32 v4, 65600, v1
v_mfma_f32_16x16x32_bf16 v[252:255], v[24:27], a[108:111], v[252:255]
ds_read_b64_tr_b16 v[22:23], v5 offset:8448
s_waitcnt lgkmcnt(4)
v_mfma_f32_16x16x32_bf16 a[128:131], v[28:31], a[0:3], 0
ds_read_b64_tr_b16 v[24:25], v4
ds_read_b64_tr_b16 v[26:27], v4 offset:8192
v_mfma_f32_16x16x32_bf16 a[132:135], v[28:31], a[4:7], 0
buffer_load_dword off, s[8:11], s12 lds
v_mfma_f32_16x16x32_bf16 a[192:195], v[12:15], a[0:3], 0
ds_read_b64_tr_b16 v[28:29], v4 offset:256
v_xor_b32 v5, 65632, v1
v_mfma_f32_16x16x32_bf16 a[196:199], v[12:15], a[4:7], 0
ds_read_b64_tr_b16 v[30:31], v4 offset:8448
v_cvt_pk_bf16_f32 v64, v128, v129
v_cvt_pk_bf16_f32 v65, v130, v131
v_cvt_pk_bf16_f32 v66, v136, v137
v_cvt_pk_bf16_f32 v67, v138, v139
v_cvt_pk_bf16_f32 v68, v132, v133
s_waitcnt lgkmcnt(4)
v_mfma_f32_16x16x32_bf16 a[136:139], v[16:19], a[0:3], 0
ds_read_b64_tr_b16 v[12:13], v5
v_cvt_pk_bf16_f32 v69, v134, v135
v_mfma_f32_16x16x32_bf16 a[140:143], v[16:19], a[4:7], 0
ds_read_b64_tr_b16 v[14:15], v5 offset:8192
v_cvt_pk_bf16_f32 v70, v140, v141
v_cvt_pk_bf16_f32 v71, v142, v143
v_permlane16_swap_b32 v64, v66
v_mfma_f32_16x16x32_bf16 a[200:203], v[20:23], a[0:3], 0
ds_read_b64_tr_b16 v[16:17], v5 offset:256
v_xor_b32 v4, 65664, v1
v_mfma_f32_16x16x32_bf16 a[204:207], v[20:23], a[4:7], 0
ds_read_b64_tr_b16 v[18:19], v5 offset:8448
v_permlane16_swap_b32 v65, v67
v_permlane16_swap_b32 v68, v70
s_waitcnt lgkmcnt(4)
v_mfma_f32_16x16x32_bf16 a[144:147], v[24:27], a[0:3], 0
ds_read_b64_tr_b16 v[20:21], v4
v_permlane16_swap_b32 v69, v71
v_mfma_f32_16x16x32_bf16 a[148:151], v[24:27], a[4:7], 0
ds_read_b64_tr_b16 v[22:23], v4 offset:8192
v_cvt_pk_bf16_f32 v96, v192, v193
v_cvt_pk_bf16_f32 v97, v194, v195
v_mfma_f32_16x16x32_bf16 a[208:211], v[28:31], a[0:3], 0
ds_read_b64_tr_b16 v[24:25], v4 offset:256
v_xor_b32 v5, 65696, v1
v_mfma_f32_16x16x32_bf16 a[212:215], v[28:31], a[4:7], 0
ds_read_b64_tr_b16 v[26:27], v4 offset:8448
v_cvt_pk_bf16_f32 v98, v200, v201
v_cvt_pk_bf16_f32 v99, v202, v203
v_cvt_pk_bf16_f32 v100, v196, v197
v_cvt_pk_bf16_f32 v101, v198, v199
v_cvt_pk_bf16_f32 v102, v204, v205
s_waitcnt lgkmcnt(4)
v_mfma_f32_16x16x32_bf16 a[152:155], v[12:15], a[0:3], 0
ds_read_b64_tr_b16 v[28:29], v5
v_cvt_pk_bf16_f32 v103, v206, v207
v_mfma_f32_16x16x32_bf16 a[156:159], v[12:15], a[4:7], 0
ds_read_b64_tr_b16 v[30:31], v5 offset:8192
v_permlane16_swap_b32 v96, v98
v_permlane16_swap_b32 v97, v99
v_mfma_f32_16x16x32_bf16 a[216:219], v[16:19], a[0:3], 0
ds_read_b64_tr_b16 v[12:13], v5 offset:256
v_xor_b32 v4, 65728, v1
v_mfma_f32_16x16x32_bf16 a[220:223], v[16:19], a[4:7], 0
ds_read_b64_tr_b16 v[14:15], v5 offset:8448
v_permlane16_swap_b32 v100, v102
s_waitcnt lgkmcnt(4)
v_mfma_f32_16x16x32_bf16 a[160:163], v[20:23], a[0:3], 0
ds_read_b64_tr_b16 v[16:17], v4
v_permlane16_swap_b32 v101, v103
v_mfma_f32_16x16x32_bf16 a[164:167], v[20:23], a[4:7], 0
ds_read_b64_tr_b16 v[18:19], v4 offset:8192
v_cvt_pk_bf16_f32 v72, v144, v145
v_cvt_pk_bf16_f32 v73, v146, v147
v_cvt_pk_bf16_f32 v74, v152, v153
v_cvt_pk_bf16_f32 v75, v154, v155
v_mfma_f32_16x16x32_bf16 a[224:227], v[24:27], a[0:3], 0
ds_read_b64_tr_b16 v[20:21], v4 offset:256
v_xor_b32 v5, 65760, v1
v_mfma_f32_16x16x32_bf16 a[228:231], v[24:27], a[4:7], 0
ds_read_b64_tr_b16 v[22:23], v4 offset:8448
v_cvt_pk_bf16_f32 v76, v148, v149
v_cvt_pk_bf16_f32 v77, v150, v151
v_cvt_pk_bf16_f32 v78, v156, v157
v_cvt_pk_bf16_f32 v79, v158, v159
s_waitcnt lgkmcnt(4)
v_mfma_f32_16x16x32_bf16 a[168:171], v[28:31], a[0:3], 0
ds_read_b64_tr_b16 v[24:25], v5
v_permlane16_swap_b32 v72, v74
v_mfma_f32_16x16x32_bf16 a[172:175], v[28:31], a[4:7], 0
ds_read_b64_tr_b16 v[26:27], v5 offset:8192
v_permlane16_swap_b32 v73, v75
v_mfma_f32_16x16x32_bf16 a[232:235], v[12:15], a[0:3], 0
ds_read_b64_tr_b16 v[28:29], v5 offset:256
v_xor_b32 v4, 114688, v9
v_mfma_f32_16x16x32_bf16 a[236:239], v[12:15], a[4:7], 0
ds_read_b64_tr_b16 v[30:31], v5 offset:8448
v_permlane16_swap_b32 v76, v78
v_permlane16_swap_b32 v77, v79
s_waitcnt lgkmcnt(4)
v_mfma_f32_16x16x32_bf16 a[176:179], v[16:19], a[0:3], 0
ds_read_b128 v[12:15], v4
v_cvt_pk_bf16_f32 v104, v208, v209
v_mfma_f32_16x16x32_bf16 a[180:183], v[16:19], a[4:7], 0
v_cvt_pk_bf16_f32 v105, v210, v211
v_cvt_pk_bf16_f32 v106, v216, v217
v_cvt_pk_bf16_f32 v107, v218, v219
v_cvt_pk_bf16_f32 v108, v212, v213
v_cvt_pk_bf16_f32 v109, v214, v215
v_cvt_pk_bf16_f32 v110, v220, v221
v_mfma_f32_16x16x32_bf16 a[240:243], v[20:23], a[0:3], 0
ds_read_b128 v[16:19], v4 offset:8192
v_cvt_pk_bf16_f32 v111, v222, v223
v_mfma_f32_16x16x32_bf16 a[244:247], v[20:23], a[4:7], 0
v_permlane16_swap_b32 v104, v106
v_permlane16_swap_b32 v105, v107
s_waitcnt lgkmcnt(2)
v_mfma_f32_16x16x32_bf16 a[184:187], v[24:27], a[0:3], 0
ds_read_b128 v[20:23], v4 offset:256
s_movk_i32 s12, 60
v_mfma_f32_16x16x32_bf16 a[188:191], v[24:27], a[4:7], 0
v_permlane16_swap_b32 v108, v110
v_permlane16_swap_b32 v109, v111
v_mfma_f32_16x16x32_bf16 a[248:251], v[28:31], a[0:3], 0
ds_read_b128 v[24:27], v4 offset:8448
v_xor_b32 v4, 114752, v9
v_mfma_f32_16x16x32_bf16 a[252:255], v[28:31], a[4:7], 0
v_cvt_pk_bf16_f32 v80, v160, v161
v_cvt_pk_bf16_f32 v81, v162, v163
s_waitcnt lgkmcnt(2)
v_mfma_f32_16x16x32_bf16 v[32:35], v[12:15], v[64:67], 0
ds_read_b128 v[28:31], v4
v_cvt_pk_bf16_f32 v82, v168, v169
v_mfma_f32_16x16x32_bf16 v[40:43], v[12:15], v[68:71], 0
buffer_load_dword off, s[8:11], s12 lds
v_mfma_f32_16x16x32_bf16 v[36:39], v[16:19], v[64:67], 0
ds_read_b128 v[12:15], v4 offset:8192
v_cvt_pk_bf16_f32 v83, v170, v171
v_mfma_f32_16x16x32_bf16 v[44:47], v[16:19], v[68:71], 0
v_cvt_pk_bf16_f32 v84, v164, v165
v_cvt_pk_bf16_f32 v85, v166, v167
v_cvt_pk_bf16_f32 v112, v224, v225
v_cvt_pk_bf16_f32 v113, v226, v227
s_waitcnt lgkmcnt(2)
v_mfma_f32_16x16x32_bf16 v[32:35], v[20:23], v[96:99], v[32:35]
ds_read_b128 v[16:19], v4 offset:256
v_cvt_pk_bf16_f32 v86, v172, v173
v_mfma_f32_16x16x32_bf16 v[40:43], v[20:23], v[100:103], v[40:43]
v_cvt_pk_bf16_f32 v87, v174, v175
v_cvt_pk_bf16_f32 v114, v232, v233
v_cvt_pk_bf16_f32 v115, v234, v235
v_cvt_pk_bf16_f32 v116, v228, v229
v_mfma_f32_16x16x32_bf16 v[36:39], v[24:27], v[96:99], v[36:39]
ds_read_b128 v[20:23], v4 offset:8448
v_xor_b32 v4, 114816, v9
v_mfma_f32_16x16x32_bf16 v[44:47], v[24:27], v[100:103], v[44:47]
v_permlane16_swap_b32 v80, v82
v_cvt_pk_bf16_f32 v117, v230, v231
v_cvt_pk_bf16_f32 v118, v236, v237
v_cvt_pk_bf16_f32 v88, v176, v177
v_cvt_pk_bf16_f32 v89, v178, v179
s_waitcnt lgkmcnt(2)
v_mfma_f32_16x16x32_bf16 v[32:35], v[28:31], v[72:75], v[32:35]
ds_read_b128 v[24:27], v4
v_permlane16_swap_b32 v81, v83
v_mfma_f32_16x16x32_bf16 v[40:43], v[28:31], v[76:79], v[40:43]
v_cvt_pk_bf16_f32 v119, v238, v239
v_cvt_pk_bf16_f32 v90, v184, v185
v_cvt_pk_bf16_f32 v91, v186, v187
v_mfma_f32_16x16x32_bf16 v[36:39], v[12:15], v[72:75], v[36:39]
ds_read_b128 v[28:31], v4 offset:8192
v_permlane16_swap_b32 v84, v86
v_mfma_f32_16x16x32_bf16 v[44:47], v[12:15], v[76:79], v[44:47]
v_permlane16_swap_b32 v112, v114
v_cvt_pk_bf16_f32 v92, v180, v181
v_cvt_pk_bf16_f32 v93, v182, v183
v_cvt_pk_bf16_f32 v120, v240, v241
v_cvt_pk_bf16_f32 v121, v242, v243
s_waitcnt lgkmcnt(2)
v_mfma_f32_16x16x32_bf16 v[32:35], v[16:19], v[104:107], v[32:35]
ds_read_b128 v[12:15], v4 offset:256
v_permlane16_swap_b32 v85, v87
v_mfma_f32_16x16x32_bf16 v[40:43], v[16:19], v[108:111], v[40:43]
v_cvt_pk_bf16_f32 v94, v188, v189
v_cvt_pk_bf16_f32 v95, v190, v191
v_cvt_pk_bf16_f32 v122, v248, v249
v_cvt_pk_bf16_f32 v123, v250, v251
v_mfma_f32_16x16x32_bf16 v[36:39], v[20:23], v[104:107], v[36:39]
ds_read_b128 v[16:19], v4 offset:8448
v_xor_b32 v4, 114880, v9
v_mfma_f32_16x16x32_bf16 v[44:47], v[20:23], v[108:111], v[44:47]
v_permlane16_swap_b32 v113, v115
v_cvt_pk_bf16_f32 v124, v244, v245
v_cvt_pk_bf16_f32 v125, v246, v247
s_waitcnt lgkmcnt(2)
v_mfma_f32_16x16x32_bf16 v[32:35], v[24:27], v[80:83], v[32:35]
ds_read_b128 v[20:23], v4
v_permlane16_swap_b32 v116, v118
v_mfma_f32_16x16x32_bf16 v[40:43], v[24:27], v[84:87], v[40:43]
v_permlane16_swap_b32 v117, v119
v_permlane16_swap_b32 v88, v90
v_cvt_pk_bf16_f32 v126, v252, v253
v_cvt_pk_bf16_f32 v127, v254, v255
v_mov_b32 v0, 0xff800000
v_mov_b32 v2, 0xff800000
v_mfma_f32_16x16x32_bf16 v[36:39], v[28:31], v[80:83], v[36:39]
ds_read_b128 v[24:27], v4 offset:8192
v_permlane16_swap_b32 v89, v91
v_mfma_f32_16x16x32_bf16 v[44:47], v[28:31], v[84:87], v[44:47]
v_permlane16_swap_b32 v120, v122
s_waitcnt lgkmcnt(2)
v_mfma_f32_16x16x32_bf16 v[32:35], v[12:15], v[112:115], v[32:35]
ds_read_b128 v[28:31], v4 offset:256
v_permlane16_swap_b32 v92, v94
v_mfma_f32_16x16x32_bf16 v[40:43], v[12:15], v[116:119], v[40:43]
v_permlane16_swap_b32 v93, v95
v_mfma_f32_16x16x32_bf16 v[36:39], v[16:19], v[112:115], v[36:39]
ds_read_b128 v[12:15], v4 offset:8448
v_xor_b32 v4, 131072, v9
v_mfma_f32_16x16x32_bf16 v[44:47], v[16:19], v[116:119], v[44:47]
v_permlane16_swap_b32 v121, v123
s_waitcnt lgkmcnt(2)
v_mfma_f32_16x16x32_bf16 v[32:35], v[20:23], v[88:91], v[32:35]
ds_read_b128 v[16:19], v4
v_permlane16_swap_b32 v124, v126
v_mfma_f32_16x16x32_bf16 v[40:43], v[20:23], v[92:95], v[40:43]
v_permlane16_swap_b32 v125, v127
v_mfma_f32_16x16x32_bf16 v[36:39], v[24:27], v[88:91], v[36:39]
ds_read_b128 v[20:23], v4 offset:8192
v_mfma_f32_16x16x32_bf16 v[44:47], v[24:27], v[92:95], v[44:47]
s_waitcnt lgkmcnt(2)
v_mfma_f32_16x16x32_bf16 v[32:35], v[28:31], v[120:123], v[32:35]
ds_read_b128 v[24:27], v4 offset:256
s_movk_i32 s12, 64
v_mfma_f32_16x16x32_bf16 v[40:43], v[28:31], v[124:127], v[40:43]
v_mfma_f32_16x16x32_bf16 v[36:39], v[12:15], v[120:123], v[36:39]
ds_read_b128 v[28:31], v4 offset:8448
v_xor_b32 v4, 131136, v9
v_mfma_f32_16x16x32_bf16 v[44:47], v[12:15], v[124:127], v[44:47]
s_waitcnt lgkmcnt(2)
v_mfma_f32_16x16x32_bf16 v[48:51], v[16:19], v[64:67], 0
ds_read_b128 v[12:15], v4
v_mfma_f32_16x16x32_bf16 v[56:59], v[16:19], v[68:71], 0
buffer_load_dword off, s[8:11], s12 lds
v_mfma_f32_16x16x32_bf16 v[52:55], v[20:23], v[64:67], 0
ds_read_b128 v[16:19], v4 offset:8192
v_max3_f32 v0, v32, v33, v0
v_mfma_f32_16x16x32_bf16 v[60:63], v[20:23], v[68:71], 0
v_cvt_pk_bf16_f32 v128, v32, v33
s_waitcnt lgkmcnt(2)
v_mfma_f32_16x16x32_bf16 v[48:51], v[24:27], v[96:99], v[48:51]
ds_read_b128 v[20:23], v4 offset:256
v_mov_b32 v8, 0
v_mfma_f32_16x16x32_bf16 v[56:59], v[24:27], v[100:103], v[56:59]
v_max3_f32 v2, v40, v41, v2
v_cvt_pk_bf16_f32 v132, v40, v41
v_mfma_f32_16x16x32_bf16 v[52:55], v[28:31], v[96:99], v[52:55]
ds_read_b128 v[24:27], v4 offset:8448
v_xor_b32 v4, 131200, v9
v_mfma_f32_16x16x32_bf16 v[60:63], v[28:31], v[100:103], v[60:63]
v_max3_f32 v0, v34, v35, v0
s_waitcnt lgkmcnt(2)
v_mfma_f32_16x16x32_bf16 v[48:51], v[12:15], v[72:75], v[48:51]
ds_read_b128 v[28:31], v4
v_cvt_pk_bf16_f32 v129, v34, v35
v_mfma_f32_16x16x32_bf16 v[56:59], v[12:15], v[76:79], v[56:59]
ds_read_b32 v8, v8 offset:14336
v_max3_f32 v2, v42, v43, v2
v_mfma_f32_16x16x32_bf16 v[52:55], v[16:19], v[72:75], v[52:55]
ds_read_b128 v[12:15], v4 offset:8192
v_cvt_pk_bf16_f32 v133, v42, v43
v_mfma_f32_16x16x32_bf16 v[60:63], v[16:19], v[76:79], v[60:63]
v_max3_f32 v0, v36, v37, v0
s_waitcnt lgkmcnt(3)
v_mfma_f32_16x16x32_bf16 v[48:51], v[20:23], v[104:107], v[48:51]
ds_read_b128 v[16:19], v4 offset:256
v_cvt_pk_bf16_f32 v130, v36, v37
v_mfma_f32_16x16x32_bf16 v[56:59], v[20:23], v[108:111], v[56:59]
v_max3_f32 v2, v44, v45, v2
v_cvt_pk_bf16_f32 v134, v44, v45
v_mfma_f32_16x16x32_bf16 v[52:55], v[24:27], v[104:107], v[52:55]
ds_read_b128 v[20:23], v4 offset:8448
v_xor_b32 v4, 131264, v9
v_mfma_f32_16x16x32_bf16 v[60:63], v[24:27], v[108:111], v[60:63]
v_max3_f32 v0, v38, v39, v0
s_waitcnt lgkmcnt(2)
v_mfma_f32_16x16x32_bf16 v[48:51], v[28:31], v[80:83], v[48:51]
s_branch L_pg3
L_sp17:
v_mov_b32 v8, 0
ds_read_b32 v8, v8 offset:14336
s_waitcnt lgkmcnt(0)
v_cmp_le_u32 vcc, 25, v8
s_cbranch_vccz L_sp17
s_branch L_ok17
L_sp18:
v_mov_b32 v8, 0
ds_read_b32 v8, v8 offset:14336
s_waitcnt lgkmcnt(0)
v_cmp_le_u32 vcc, 26, v8
s_cbranch_vccz L_sp18
s_branch L_ok18
L_sp19:
v_mov_b32 v8, 0
ds_read_b32 v8, v8 offset:14336
s_waitcnt lgkmcnt(0)
v_cmp_le_u32 vcc, 28, v8
s_cbranch_vccz L_sp19
s_branch L_ok19
L_sp21:
v_mov_b32 v8, 0
ds_read_b32 v8, v8 offset:14336
s_waitcnt lgkmcnt(0)
v_cmp_le_u32 vcc, 29, v8
s_cbranch_vccz L_sp21
s_branch L_ok21
L_sp22:
v_mov_b32 v8, 0
ds_read_b32 v8, v8 offset:14336
s_waitcnt lgkmcnt(0)
v_cmp_le_u32 vcc, 31, v8
s_cbranch_vccz L_sp22
s_branch L_ok22
.p2align 12
L_stub3:
s_setpc_b64 s[94:95]
L_pg3:
ds_read_b128 v[24:27], v4
v_cmp_le_u32 vcc, 25, v8
v_mfma_f32_16x16x32_bf16 v[56:59], v[28:31], v[84:87], v[56:59]
v_cvt_pk_bf16_f32 v131, v38, v39
v_max3_f32 v2, v46, v47, v2
v_mfma_f32_16x16x32_bf16 v[52:55], v[12:15], v[80:83], v[52:55]
ds_read_b128 v[28:31], v4 offset:8192
v_cvt_pk_bf16_f32 v135, v46, v47
v_mfma_f32_16x16x32_bf16 v[60:63], v[12:15], v[84:87], v[60:63]
s_waitcnt lgkmcnt(2)
v_mfma_f32_16x16x32_bf16 v[48:51], v[16:19], v[112:115], v[48:51]
ds_read_b128 v[12:15], v4 offset:256
v_mfma_f32_16x16x32_bf16 v[56:59], v[16:19], v[116:119], v[56:59]
s_cbranch_vccz L_sp17
L_ok17:
v_mfma_f32_16x16x32_bf16 v[52:55], v[20:23], v[112:115], v[52:55]
ds_read_b128 v[16:19], v4 offset:8448
v_xor_b32 v4, 81920, v1
v_mfma_f32_16x16x32_bf16 v[60:63], v[20:23], v[116:119], v[60:63]
s_waitcnt lgkmcnt(2)
v_mfma_f32_16x16x32_bf16 v[48:51], v[24:27], v[88:91], v[48:51]
ds_read_b64_tr_b16 v[20:21], v4
v_mfma_f32_16x16x32_bf16 v[56:59], v[24:27], v[92:95], v[56:59]
ds_read_b64_tr_b16 v[22:23], v4 offset:8192
v_mfma_f32_16x16x32_bf16 v[52:55], v[28:31], v[88:91], v[52:55]
ds_read_b64_tr_b16 v[24:25], v4 offset:256
v_xor_b32 v5, 81952, v1
v_mfma_f32_16x16x32_bf16 v[60:63], v[28:31], v[92:95], v[60:63]
ds_read_b64_tr_b16 v[26:27], v4 offset:8448
s_waitcnt lgkmcnt(4)
v_mfma_f32_16x16x32_bf16 v[48:51], v[12:15], v[120:123], v[48:51]
ds_read_b64_tr_b16 v[28:29], v5
s_movk_i32 s12, 68
v_mfma_f32_16x16x32_bf16 v[56:59], v[12:15], v[124:127], v[56:59]
ds_read_b64_tr_b16 v[30:31], v5 offset:8192
v_mfma_f32_16x16x32_bf16 v[52:55], v[16:19], v[120:123], v[52:55]
ds_read_b64_tr_b16 v[12:13], v5 offset:256
v_xor_b32 v4, 81984, v1
v_mfma_f32_16x16x32_bf16 v[60:63], v[16:19], v[124:127], v[60:63]
ds_read_b64_tr_b16 v[14:15], v5 offset:8448
s_waitcnt lgkmcnt(4)
v_mfma_f32_16x16x32_bf16 a[128:131], v[20:23], a[8:11], a[128:131]
ds_read_b64_tr_b16 v[16:17], v4
ds_read_b64_tr_b16 v[18:19], v4 offset:8192
v_mfma_f32_16x16x32_bf16 a[132:135], v[20:23], a[12:15], a[132:135]
buffer_load_dword off, s[8:11], s12 lds
v_mfma_f32_16x16x32_bf16 a[192:195], v[24:27], a[8:11], a[192:195]
ds_read_b64_tr_b16 v[20:21], v4 offset:256
v_xor_b32 v5, 82016, v1
v_mfma_f32_16x16x32_bf16 a[196:199], v[24:27], a[12:15], a[196:199]
ds_read_b64_tr_b16 v[22:23], v4 offset:8448
s_waitcnt lgkmcnt(4)
v_mfma_f32_16x16x32_bf16 a[136:139], v[28:31], a[8:11], a[136:139]
ds_read_b64_tr_b16 v[24:25], v5
v_mov_b32 v8, 0
v_mfma_f32_16x16x32_bf16 a[140:143], v[28:31], a[12:15], a[140:143]
ds_read_b64_tr_b16 v[26:27], v5 offset:8192
v_max3_f32 v0, v48, v49, v0
v_mfma_f32_16x16x32_bf16 a[200:203], v[12:15], a[8:11], a[200:203]
ds_read_b64_tr_b16 v[28:29], v5 offset:256
v_xor_b32 v4, 82048, v1
v_mfma_f32_16x16x32_bf16 a[204:207], v[12:15], a[12:15], a[204:207]
ds_read_b64_tr_b16 v[30:31], v5 offset:8448
s_waitcnt lgkmcnt(4)
v_mfma_f32_16x16x32_bf16 a[144:147], v[16:19], a[8:11], a[144:147]
ds_read_b64_tr_b16 v[12:13], v4
v_cvt_pk_bf16_f32 v136, v48, v49
v_mfma_f32_16x16x32_bf16 a[148:151], v[16:19], a[12:15], a[148:151]
ds_read_b64_tr_b16 v[14:15], v4 offset:8192
ds_read_b32 v8, v8 offset:14336
v_mfma_f32_16x16x32_bf16 a[208:211], v[20:23], a[8:11], a[208:211]
ds_read_b64_tr_b16 v[16:17], v4 offset:256
v_xor_b32 v5, 82080, v1
v_mfma_f32_16x16x32_bf16 a[212:215], v[20:23], a[12:15], a[212:215]
ds_read_b64_tr_b16 v[18:19], v4 offset:8448
s_waitcnt lgkmcnt(5)
v_mfma_f32_16x16x32_bf16 a[152:155], v[24:27], a[8:11], a[152:155]
ds_read_b64_tr_b16 v[20:21], v5
v_max3_f32 v2, v56, v57, v2
v_mfma_f32_16x16x32_bf16 a[156:159], v[24:27], a[12:15], a[156:159]
ds_read_b64_tr_b16 v[22:23], v5 offset:8192
v_cvt_pk_bf16_f32 v140, v56, v57
v_mfma_f32_16x16x32_bf16 a[216:219], v[28:31], a[8:11], a[216:219]
ds_read_b64_tr_b16 v[24:25], v5 offset:256
v_xor_b32 v4, 82112, v1
v_mfma_f32_16x16x32_bf16 a[220:223], v[28:31], a[12:15], a[220:223]
ds_read_b64_tr_b16 v[26:27], v5 offset:8448
s_waitcnt lgkmcnt(4)
v_mfma_f32_16x16x32_bf16 a[160:163], v[12:15], a[8:11], a[160:163]
ds_read_b64_tr_b16 v[28:29], v4
v_cmp_le_u32 vcc, 26, v8
v_mfma_f32_16x16x32_bf16 a[164:167], v[12:15], a[12:15], a[164:167]
ds_read_b64_tr_b16 v[30:31], v4 offset:8192
v_max3_f32 v0, v50, v51, v0
v_mfma_f32_16x16x32_bf16 a[224:227], v[16:19], a[8:11], a[224:227]
ds_read_b64_tr_b16 v[12:13], v4 offset:256
v_xor_b32 v5, 82144, v1
v_mfma_f32_16x16x32_bf16 a[228:231], v[16:19], a[12:15], a[228:231]
ds_read_b64_tr_b16 v[14:15], v4 offset:8448
s_waitcnt lgkmcnt(4)
v_mfma_f32_16x16x32_bf16 a[168:171], v[20:23], a[8:11], a[168:171]
ds_read_b64_tr_b16 v[16:17], v5
ds_read_b64_tr_b16 v[18:19], v5 offset:8192
v_mfma_f32_16x16x32_bf16 a[172:175], v[20:23], a[12:15], a[172:175]
s_cbranch_vccz L_sp18
L_ok18:
v_mfma_f32_16x16x32_bf16 a[232:235], v[24:27], a[8:11], a[232:235]
ds_read_b64_tr_b16 v[20:21], v5 offset:256
v_xor_b32 v4, 98304, v9
v_mfma_f32_16x16x32_bf16 a[236:239], v[24:27], a[12:15], a[236:239]
ds_read_b64_tr_b16 v[22:23], v5 offset:8448
s_waitcnt lgkmcnt(4)
v_mfma_f32_16x16x32_bf16 a[176:179], v[28:31], a[8:11], a[176:179]
ds_read_b128 v[24:27], v4
v_cvt_pk_bf16_f32 v137, v50, v51
v_mfma_f32_16x16x32_bf16 a[180:183], v[28:31], a[12:15], a[180:183]
v_max3_f32 v2, v58, v59, v2
v_cvt_pk_bf16_f32 v141, v58, v59
v_mfma_f32_16x16x32_bf16 a[240:243], v[12:15], a[8:11], a[240:243]
ds_read_b128 v[28:31], v4 offset:8192
v_max3_f32 v0, v52, v53, v0
v_mfma_f32_16x16x32_bf16 a[244:247], v[12:15], a[12:15], a[244:247]
v_cvt_pk_bf16_f32 v138, v52, v53
s_waitcnt lgkmcnt(2)
v_mfma_f32_16x16x32_bf16 a[184:187], v[16:19], a[8:11], a[184:187]
ds_read_b128 v[12:15], v4 offset:256
s_movk_i32 s12, 72
v_mfma_f32_16x16x32_bf16 a[188:191], v[16:19], a[12:15], a[188:191]
v_max3_f32 v2, v60, v61, v2
v_cvt_pk_bf16_f32 v142, v60, v61
v_mfma_f32_16x16x32_bf16 a[248:251], v[20:23], a[8:11], a[248:251]
ds_read_b128 v[16:19], v4 offset:8448
v_xor_b32 v4, 98368, v9
v_mfma_f32_16x16x32_bf16 a[252:255], v[20:23], a[12:15], a[252:255]
v_max3_f32 v0, v54, v55, v0
s_waitcnt lgkmcnt(2)
v_mfma_f32_16x16x32_bf16 v[32:35], v[24:27], v[64:67], 0
ds_read_b128 v[20:23], v4
v_cvt_pk_bf16_f32 v139, v54, v55
v_mfma_f32_16x16x32_bf16 v[40:43], v[24:27], v[68:71], 0
buffer_load_dword off, s[8:11], s12 lds
v_mfma_f32_16x16x32_bf16 v[36:39], v[28:31], v[64:67], 0
ds_read_b128 v[24:27], v4 offset:8192
v_max3_f32 v2, v62, v63, v2
v_mfma_f32_16x16x32_bf16 v[44:47], v[28:31], v[68:71], 0
v_cvt_pk_bf16_f32 v143, v62, v63
s_waitcnt lgkmcnt(2)
v_mfma_f32_16x16x32_bf16 v[32:35], v[12:15], v[96:99], v[32:35]
ds_read_b128 v[28:31], v4 offset:256
v_mov_b32 v8, 0
v_mfma_f32_16x16x32_bf16 v[40:43], v[12:15], v[100:103], v[40:43]
v_mfma_f32_16x16x32_bf16 v[36:39], v[16:19], v[96:99], v[36:39]
ds_read_b128 v[12:15], v4 offset:8448
v_xor_b32 v4, 98432, v9
v_mfma_f32_16x16x32_bf16 v[44:47], v[16:19], v[100:103], v[44:47]
s_waitcnt lgkmcnt(2)
v_mfma_f32_16x16x32_bf16 v[32:35], v[20:23], v[72:75], v[32:35]
ds_read_b128 v[16:19], v4
v_mfma_f32_16x16x32_bf16 v[40:43], v[20:23], v[76:79], v[40:43]
ds_read_b32 v8, v8 offset:14336
v_mfma_f32_16x16x32_bf16 v[36:39], v[24:27], v[72:75], v[36:39]
ds_read_b128 v[20:23], v4 offset:8192
v_mfma_f32_16x16x32_bf16 v[44:47], v[24:27], v[76:79], v[44:47]
s_waitcnt lgkmcnt(3)
v_mfma_f32_16x16x32_bf16 v[32:35], v[28:31], v[104:107], v[32:35]
ds_read_b128 v[24:27], v4 offset:256
v_mfma_f32_16x16x32_bf16 v[40:43], v[28:31], v[108:111], v[40:43]
v_mfma_f32_16x16x32_bf16 v[36:39], v[12:15], v[104:107], v[36:39]
ds_read_b128 v[28:31], v4 offset:8448
v_xor_b32 v4, 98496, v9
v_mfma_f32_16x16x32_bf16 v[44:47], v[12:15], v[108:111], v[44:47]
s_waitcnt lgkmcnt(2)
v_mfma_f32_16x16x32_bf16 v[32:35], v[16:19], v[80:83], v[32:35]
ds_read_b128 v[12:15], v4
v_cmp_le_u32 vcc, 28, v8
v_mfma_f32_16x16x32_bf16 v[40:43], v[16:19], v[84:87], v[40:43]
v_mfma_f32_16x16x32_bf16 v[36:39], v[20:23], v[80:83], v[36:39]
ds_read_b128 v[16:19], v4 offset:8192
v_mfma_f32_16x16x32_bf16 v[44:47], v[20:23], v[84:87], v[44:47]
s_waitcnt lgkmcnt(2)
v_mfma_f32_16x16x32_bf16 v[32:35], v[24:27], v[112:115], v[32:35]
ds_read_b128 v[20:23], v4 offset:256
v_mfma_f32_16x16x32_bf16 v[40:43], v[24:27], v[116:119], v[40:43]
s_cbranch_vccz L_sp19
L_ok19:
v_mfma_f32_16x16x32_bf16 v[36:39], v[28:31], v[112:115], v[36:39]
ds_read_b128 v[24:27], v4 offset:8448
v_xor_b32 v4, 147456, v9
v_mfma_f32_16x16x32_bf16 v[44:47], v[28:31], v[116:119], v[44:47]
s_waitcnt lgkmcnt(2)
v_mfma_f32_16x16x32_bf16 v[32:35], v[12:15], v[88:91], v[32:35]
ds_read_b128 v[28:31], v4
v_mfma_f32_16x16x32_bf16 v[40:43], v[12:15], v[92:95], v[40:43]
v_mfma_f32_16x16x32_bf16 v[36:39], v[16:19], v[88:91], v[36:39]
ds_read_b128 v[12:15], v4 offset:8192
v_mfma_f32_16x16x32_bf16 v[44:47], v[16:19], v[92:95], v[44:47]
s_waitcnt lgkmcnt(2)
v_mfma_f32_16x16x32_bf16 v[32:35], v[20:23], v[120:123], v[32:35]
ds_read_b128 v[16:19], v4 offset:256
s_movk_i32 s12, 76
v_mfma_f32_16x16x32_bf16 v[40:43], v[20:23], v[124:127], v[40:43]
v_mfma_f32_16x16x32_bf16 v[36:39], v[24:27], v[120:123], v[36:39]
ds_read_b128 v[20:23], v4 offset:8448
v_xor_b32 v4, 147520, v9
v_mfma_f32_16x16x32_bf16 v[44:47], v[24:27], v[124:127], v[44:47]
s_waitcnt lgkmcnt(2)
v_mfma_f32_16x16x32_bf16 v[48:51], v[28:31], v[64:67], 0
ds_read_b128 v[24:27], v4
v_mfma_f32_16x16x32_bf16 v[56:59], v[28:31], v[68:71], 0
buffer_load_dword off, s[8:11], s12 lds
v_mfma_f32_16x16x32_bf16 v[52:55], v[12:15], v[64:67], 0
ds_read_b128 v[28:31], v4 offset:8192
v_max3_f32 v0, v32, v33, v0
v_mfma_f32_16x16x32_bf16 v[60:63], v[12:15], v[68:71], 0
v_cvt_pk_bf16_f32 v144, v32, v33
s_waitcnt lgkmcnt(2)
v_mfma_f32_16x16x32_bf16 v[48:51], v[16:19], v[96:99], v[48:51]
ds_read_b128 v[12:15], v4 offset:256
v_max3_f32 v2, v40, v41, v2
v_mfma_f32_16x16x32_bf16 v[56:59], v[16:19], v[100:103], v[56:59]
v_cvt_pk_bf16_f32 v148, v40, v41
v_max3_f32 v0, v34, v35, v0
v_mfma_f32_16x16x32_bf16 v[52:55], v[20:23], v[96:99], v[52:55]
ds_read_b128 v[16:19], v4 offset:8448
v_xor_b32 v4, 147584, v9
v_mfma_f32_16x16x32_bf16 v[60:63], v[20:23], v[100:103], v[60:63]
v_cvt_pk_bf16_f32 v145, v34, v35
s_waitcnt lgkmcnt(2)
v_mfma_f32_16x16x32_bf16 v[48:51], v[24:27], v[72:75], v[48:51]
ds_read_b128 v[20:23], v4
v_max3_f32 v2, v42, v43, v2
v_mfma_f32_16x16x32_bf16 v[56:59], v[24:27], v[76:79], v[56:59]
v_cvt_pk_bf16_f32 v149, v42, v43
v_max3_f32 v0, v36, v37, v0
v_mfma_f32_16x16x32_bf16 v[52:55], v[28:31], v[72:75], v[52:55]
ds_read_b128 v[24:27], v4 offset:8192
v_cvt_pk_bf16_f32 v146, v36, v37
v_mfma_f32_16x16x32_bf16 v[60:63], v[28:31], v[76:79], v[60:63]
v_max3_f32 v2, v44, v45, v2
s_waitcnt lgkmcnt(2)
v_mfma_f32_16x16x32_bf16 v[48:51], v[12:15], v[104:107], v[48:51]
ds_read_b128 v[28:31], v4 offset:256
v_cvt_pk_bf16_f32 v150, v44, v45
v_mfma_f32_16x16x32_bf16 v[56:59], v[12:15], v[108:111], v[56:59]
v_max3_f32 v0, v38, v39, v0
v_cvt_pk_bf16_f32 v147, v38, v39
v_mfma_f32_16x16x32_bf16 v[52:55], v[16:19], v[104:107], v[52:55]
ds_read_b128 v[12:15], v4 offset:8448
v_xor_b32 v4, 147648, v9
v_mfma_f32_16x16x32_bf16 v[60:63], v[16:19], v[108:111], v[60:63]
v_max3_f32 v2, v46, v47, v2
s_waitcnt lgkmcnt(2)
v_mfma_f32_16x16x32_bf16 v[48:51], v[20:23], v[80:83], v[48:51]
ds_read_b128 v[16:19], v4
v_cvt_pk_bf16_f32 v151, v46, v47
v_mfma_f32_16x16x32_bf16 v[56:59], v[20:23], v[84:87], v[56:59]
v_mfma_f32_16x16x32_bf16 v[52:55], v[24:27], v[80:83], v[52:55]
ds_read_b128 v[20:23], v4 offset:8192
v_mfma_f32_16x16x32_bf16 v[60:63], v[24:27], v[84:87], v[60:63]
s_waitcnt lgkmcnt(2)
v_mfma_f32_16x16x32_bf16 v[48:51], v[28:31], v[112:115], v[48:51]
ds_read_b128 v[24:27], v4 offset:256
v_mfma_f32_16x16x32_bf16 v[56:59], v[28:31], v[116:119], v[56:59]
v_mfma_f32_16x16x32_bf16 v[52:55], v[12:15], v[112:115], v[52:55]
ds_read_b128 v[28:31], v4 offset:8448
v_xor_b32 v4, 16384, v1
v_mfma_f32_16x16x32_bf16 v[60:63], v[12:15], v[116:119], v[60:63]
s_waitcnt lgkmcnt(2)
v_mfma_f32_16x16x32_bf16 v[48:51], v[16:19], v[88:91], v[48:51]
ds_read_b64_tr_b16 v[12:13], v4
v_mfma_f32_16x16x32_bf16 v[56:59], v[16:19], v[92:95], v[56:59]
ds_read_b64_tr_b16 v[14:15], v4 offset:8192
v_mfma_f32_16x16x32_bf16 v[52:55], v[20:23], v[88:91], v[52:55]
ds_read_b64_tr_b16 v[16:17], v4 offset:256
v_xor_b32 v5, 16416, v1
v_mfma_f32_16x16x32_bf16 v[60:63], v[20:23], v[92:95], v[60:63]
ds_read_b64_tr_b16 v[18:19], v4 offset:8448
s_waitcnt lgkmcnt(4)
v_mfma_f32_16x16x32_bf16 v[48:51], v[24:27], v[120:123], v[48:51]
ds_read_b64_tr_b16 v[20:21], v5
s_movk_i32 s12, 80
v_mfma_f32_16x16x32_bf16 v[56:59], v[24:27], v[124:127], v[56:59]
ds_read_b64_tr_b16 v[22:23], v5 offset:8192
v_mfma_f32_16x16x32_bf16 v[52:55], v[28:31], v[120:123], v[52:55]
ds_read_b64_tr_b16 v[24:25], v5 offset:256
v_xor_b32 v4, 16448, v1
v_mfma_f32_16x16x32_bf16 v[60:63], v[28:31], v[124:127], v[60:63]
ds_read_b64_tr_b16 v[26:27], v5 offset:8448
s_waitcnt lgkmcnt(4)
v_mfma_f32_16x16x32_bf16 a[128:131], v[12:15], a[16:19], a[128:131]
ds_read_b64_tr_b16 v[28:29], v4
ds_read_b64_tr_b16 v[30:31], v4 offset:8192
v_mfma_f32_16x16x32_bf16 a[132:135], v[12:15], a[20:23], a[132:135]
buffer_load_dword off, s[8:11], s12 lds
v_mfma_f32_16x16x32_bf16 a[192:195], v[16:19], a[16:19], a[192:195]
ds_read_b64_tr_b16 v[12:13], v4 offset:256
v_xor_b32 v5, 16480, v1
v_mfma_f32_16x16x32_bf16 a[196:199], v[16:19], a[20:23], a[196:199]
ds_read_b64_tr_b16 v[14:15], v4 offset:8448
s_waitcnt lgkmcnt(4)
v_mfma_f32_16x16x32_bf16 a[136:139], v[20:23], a[16:19], a[136:139]
ds_read_b64_tr_b16 v[16:17], v5
v_mov_b32 v8, 0
v_mfma_f32_16x16x32_bf16 a[140:143], v[20:23], a[20:23], a[140:143]
ds_read_b64_tr_b16 v[18:19], v5 offset:8192
v_max3_f32 v0, v48, v49, v0
v_mfma_f32_16x16x32_bf16 a[200:203], v[24:27], a[16:19], a[200:203]
ds_read_b64_tr_b16 v[20:21], v5 offset:256
v_xor_b32 v4, 16512, v1
v_mfma_f32_16x16x32_bf16 a[204:207], v[24:27], a[20:23], a[204:207]
ds_read_b64_tr_b16 v[22:23], v5 offset:8448
s_waitcnt lgkmcnt(4)
v_mfma_f32_16x16x32_bf16 a[144:147], v[28:31], a[16:19], a[144:147]
ds_read_b64_tr_b16 v[24:25], v4
v_cvt_pk_bf16_f32 v152, v48, v49
v_mfma_f32_16x16x32_bf16 a[148:151], v[28:31], a[20:23], a[148:151]
ds_read_b64_tr_b16 v[26:27], v4 offset:8192
ds_read_b32 v8, v8 offset:14336
v_mfma_f32_16x16x32_bf16 a[208:211], v[12:15], a[16:19], a[208:211]
ds_read_b64_tr_b16 v[28:29], v4 offset:256
v_xor_b32 v5, 16544, v1
v_mfma_f32_16x16x32_bf16 a[212:215], v[12:15], a[20:23], a[212:215]
ds_read_b64_tr_b16 v[30:31], v4 offset:8448
s_waitcnt lgkmcnt(5)
v_mfma_f32_16x16x32_bf16 a[152:155], v[16:19], a[16:19], a[152:155]
ds_read_b64_tr_b16 v[12:13], v5
v_max3_f32 v2, v56, v57, v2
v_mfma_f32_16x16x32_bf16 a[156:159], v[16:19], a[20:23], a[156:159]
ds_read_b64_tr_b16 v[14:15], v5 offset:8192
v_cvt_pk_bf16_f32 v156, v56, v57
v_mfma_f32_16x16x32_bf16 a[216:219], v[20:23], a[16:19], a[216:219]
ds_read_b64_tr_b16 v[16:17], v5 offset:256
v_xor_b32 v4, 16576, v1
v_mfma_f32_16x16x32_bf16 a[220:223], v[20:23], a[20:23], a[220:223]
ds_read_b64_tr_b16 v[18:19], v5 offset:8448
s_waitcnt lgkmcnt(4)
v_mfma_f32_16x16x32_bf16 a[160:163], v[24:27], a[16:19], a[160:163]
ds_read_b64_tr_b16 v[20:21], v4
v_cmp_le_u32 vcc, 29, v8
v_mfma_f32_16x16x32_bf16 a[164:167], v[24:27], a[20:23], a[164:167]
ds_read_b64_tr_b16 v[22:23], v4 offset:8192
v_max3_f32 v0, v50, v51, v0
v_mfma_f32_16x16x32_bf16 a[224:227], v[28:31], a[16:19], a[224:227]
ds_read_b64_tr_b16 v[24:25], v4 offset:256
v_xor_b32 v5, 16608, v1
v_mfma_f32_16x16x32_bf16 a[228:231], v[28:31], a[20:23], a[228:231]
ds_read_b64_tr_b16 v[26:27], v4 offset:8448
s_waitcnt lgkmcnt(4)
v_mfma_f32_16x16x32_bf16 a[168:171], v[12:15], a[16:19], a[168:171]
ds_read_b64_tr_b16 v[28:29], v5
ds_read_b64_tr_b16 v[30:31], v5 offset:8192
v_mfma_f32_16x16x32_bf16 a[172:175], v[12:15], a[20:23], a[172:175]
s_cbranch_vccz L_sp21
L_ok21:
v_mfma_f32_16x16x32_bf16 a[232:235], v[16:19], a[16:19], a[232:235]
ds_read_b64_tr_b16 v[12:13], v5 offset:256
v_xor_b32 v4, 32768, v9
v_mfma_f32_16x16x32_bf16 a[236:239], v[16:19], a[20:23], a[236:239]
ds_read_b64_tr_b16 v[14:15], v5 offset:8448
s_waitcnt lgkmcnt(4)
v_mfma_f32_16x16x32_bf16 a[176:179], v[20:23], a[16:19], a[176:179]
ds_read_b128 v[16:19], v4
v_cvt_pk_bf16_f32 v153, v50, v51
v_mfma_f32_16x16x32_bf16 a[180:183], v[20:23], a[20:23], a[180:183]
v_max3_f32 v2, v58, v59, v2
v_cvt_pk_bf16_f32 v157, v58, v59
v_mfma_f32_16x16x32_bf16 a[240:243], v[24:27], a[16:19], a[240:243]
ds_read_b128 v[20:23], v4 offset:8192
v_max3_f32 v0, v52, v53, v0
v_mfma_f32_16x16x32_bf16 a[244:247], v[24:27], a[20:23], a[244:247]
v_cvt_pk_bf16_f32 v154, v52, v53
s_waitcnt lgkmcnt(2)
v_mfma_f32_16x16x32_bf16 a[184:187], v[28:31], a[16:19], a[184:187]
ds_read_b128 v[24:27], v4 offset:256
s_movk_i32 s12, 84
v_mfma_f32_16x16x32_bf16 a[188:191], v[28:31], a[20:23], a[188:191]
v_max3_f32 v2, v60, v61, v2
v_cvt_pk_bf16_f32 v158, v60, v61
v_mfma_f32_16x16x32_bf16 a[248:251], v[12:15], a[16:19], a[248:251]
ds_read_b128 v[28:31], v4 offset:8448
v_xor_b32 v4, 32832, v9
v_mfma_f32_16x16x32_bf16 a[252:255], v[12:15], a[20:23], a[252:255]
v_max3_f32 v0, v54, v55, v0
s_waitcnt lgkmcnt(2)
v_mfma_f32_16x16x32_bf16 v[32:35], v[16:19], v[64:67], 0
ds_read_b128 v[12:15], v4
v_mbcnt_lo_u32_b32 v10, -1, 0
v_mfma_f32_16x16x32_bf16 v[40:43], v[16:19], v[68:71], 0
buffer_load_dword off, s[8:11], s12 lds
v_mfma_f32_16x16x32_bf16 v[36:39], v[20:23], v[64:67], 0
ds_read_b128 v[16:19], v4 offset:8192
v_mbcnt_hi_u32_b32 v10, -1, v10
v_mfma_f32_16x16x32_bf16 v[44:47], v[20:23], v[68:71], 0
v_lshrrev_b32 v11, 2, v10
s_waitcnt lgkmcnt(2)
v_mfma_f32_16x16x32_bf16 v[32:35], v[24:27], v[96:99], v[32:35]
ds_read_b128 v[20:23], v4 offset:256
v_mov_b32 v8, 0
v_mfma_f32_16x16x32_bf16 v[40:43], v[24:27], v[100:103], v[40:43]
v_lshlrev_b32 v3, 7, v11
v_bfe_u32 v11, v10, 3, 2
v_mfma_f32_16x16x32_bf16 v[36:39], v[28:31], v[96:99], v[36:39]
ds_read_b128 v[24:27], v4 offset:8448
v_xor_b32 v4, 32896, v9
v_mfma_f32_16x16x32_bf16 v[44:47], v[28:31], v[100:103], v[44:47]
v_lshl_add_u32 v3, v11, 5, v3
s_waitcnt lgkmcnt(2)
v_mfma_f32_16x16x32_bf16 v[32:35], v[12:15], v[72:75], v[32:35]
ds_read_b128 v[28:31], v4
v_and_b32 v11, 3, v10
v_mfma_f32_16x16x32_bf16 v[40:43], v[12:15], v[76:79], v[40:43]
ds_read_b32 v8, v8 offset:14336
v_lshl_add_u32 v3, v11, 3, v3
v_mfma_f32_16x16x32_bf16 v[36:39], v[16:19], v[72:75], v[36:39]
ds_read_b128 v[12:15], v4 offset:8192
v_cvt_pk_bf16_f32 v155, v54, v55
v_mfma_f32_16x16x32_bf16 v[44:47], v[16:19], v[76:79], v[44:47]
v_max3_f32 v2, v62, v63, v2
s_waitcnt lgkmcnt(3)
v_mfma_f32_16x16x32_bf16 v[32:35], v[20:23], v[104:107], v[32:35]
ds_read_b128 v[16:19], v4 offset:256
v_cvt_pk_bf16_f32 v159, v62, v63
v_mfma_f32_16x16x32_bf16 v[40:43], v[20:23], v[108:111], v[40:43]
v_mfma_f32_16x16x32_bf16 v[36:39], v[24:27], v[104:107], v[36:39]
ds_read_b128 v[20:23], v4 offset:8448
v_xor_b32 v4, 32960, v9
v_mfma_f32_16x16x32_bf16 v[44:47], v[24:27], v[108:111], v[44:47]
s_waitcnt lgkmcnt(2)
v_mfma_f32_16x16x32_bf16 v[32:35], v[28:31], v[80:83], v[32:35]
ds_read_b128 v[24:27], v4
v_cmp_le_u32 vcc, 31, v8
v_mfma_f32_16x16x32_bf16 v[40:43], v[28:31], v[84:87], v[40:43]
v_mfma_f32_16x16x32_bf16 v[36:39], v[12:15], v[80:83], v[36:39]
ds_read_b128 v[28:31], v4 offset:8192
v_mfma_f32_16x16x32_bf16 v[44:47], v[12:15], v[84:87], v[44:47]
s_waitcnt lgkmcnt(2)
v_mfma_f32_16x16x32_bf16 v[32:35], v[16:19], v[112:115], v[32:35]
ds_read_b128 v[12:15], v4 offset:256
v_mfma_f32_16x16x32_bf16 v[40:43], v[16:19], v[116:119], v[40:43]
s_cbranch_vccz L_sp22
L_ok22:
v_mfma_f32_16x16x32_bf16 v[36:39], v[20:23], v[112:115], v[36:39]
ds_read_b128 v[16:19], v4 offset:8448
v_xor_b32 v4, 65536, v9
v_mfma_f32_16x16x32_bf16 v[44:47], v[20:23], v[116:119], v[44:47]
s_waitcnt lgkmcnt(2)
v_mfma_f32_16x16x32_bf16 v[32:35], v[24:27], v[88:91], v[32:35]
ds_read_b128 v[20:23], v4
v_mfma_f32_16x16x32_bf16 v[40:43], v[24:27], v[92:95], v[40:43]
v_mfma_f32_16x16x32_bf16 v[36:39], v[28:31], v[88:91], v[36:39]
ds_read_b128 v[24:27], v4 offset:8192
v_mfma_f32_16x16x32_bf16 v[44:47], v[28:31], v[92:95], v[44:47]
s_waitcnt lgkmcnt(2)
v_mfma_f32_16x16x32_bf16 v[32:35], v[12:15], v[120:123], v[32:35]
ds_read_b128 v[28:31], v4 offset:256
s_movk_i32 s12, 88
v_mfma_f32_16x16x32_bf16 v[40:43], v[12:15], v[124:127], v[40:43]
v_mfma_f32_16x16x32_bf16 v[36:39], v[16:19], v[120:123], v[36:39]
ds_read_b128 v[12:15], v4 offset:8448
v_xor_b32 v4, 65600, v9
v_mfma_f32_16x16x32_bf16 v[44:47], v[16:19], v[124:127], v[44:47]
s_waitcnt lgkmcnt(2)
v_mfma_f32_16x16x32_bf16 v[48:51], v[20:23], v[64:67], 0
ds_read_b128 v[16:19], v4
v_mfma_f32_16x16x32_bf16 v[56:59], v[20:23], v[68:71], 0
buffer_load_dword off, s[8:11], s12 lds
v_mfma_f32_16x16x32_bf16 v[52:55], v[24:27], v[64:67], 0
ds_read_b128 v[20:23], v4 offset:8192
v_max3_f32 v0, v32, v33, v0
v_mfma_f32_16x16x32_bf16 v[60:63], v[24:27], v[68:71], 0
v_cvt_pk_bf16_f32 v160, v32, v33
s_waitcnt lgkmcnt(2)
v_mfma_f32_16x16x32_bf16 v[48:51], v[28:31], v[96:99], v[48:51]
ds_read_b128 v[24:27], v4 offset:256
v_max3_f32 v2, v40, v41, v2
v_mfma_f32_16x16x32_bf16 v[56:59], v[28:31], v[100:103], v[56:59]
v_cvt_pk_bf16_f32 v164, v40, v41
v_max3_f32 v0, v34, v35, v0
v_mfma_f32_16x16x32_bf16 v[52:55], v[12:15], v[96:99], v[52:55]
ds_read_b128 v[28:31], v4 offset:8448
v_xor_b32 v4, 65664, v9
v_mfma_f32_16x16x32_bf16 v[60:63], v[12:15], v[100:103], v[60:63]
v_cvt_pk_bf16_f32 v161, v34, v35
s_waitcnt lgkmcnt(2)
v_mfma_f32_16x16x32_bf16 v[48:51], v[16:19], v[72:75], v[48:51]
ds_read_b128 v[12:15], v4
v_max3_f32 v2, v42, v43, v2
v_mfma_f32_16x16x32_bf16 v[56:59], v[16:19], v[76:79], v[56:59]
v_cvt_pk_bf16_f32 v165, v42, v43
v_max3_f32 v0, v36, v37, v0
v_mfma_f32_16x16x32_bf16 v[52:55], v[20:23], v[72:75], v[52:55]
ds_read_b128 v[16:19], v4 offset:8192
v_cvt_pk_bf16_f32 v162, v36, v37
v_mfma_f32_16x16x32_bf16 v[60:63], v[20:23], v[76:79], v[60:63]
v_max3_f32 v2, v44, v45, v2
s_waitcnt lgkmcnt(2)
v_mfma_f32_16x16x32_bf16 v[48:51], v[24:27], v[104:107], v[48:51]
ds_read_b128 v[20:23], v4 offset:256
v_cvt_pk_bf16_f32 v166, v44, v45
v_mfma_f32_16x16x32_bf16 v[56:59], v[24:27], v[108:111], v[56:59]
v_max3_f32 v0, v38, v39, v0
v_cvt_pk_bf16_f32 v163, v38, v39
v_mfma_f32_16x16x32_bf16 v[52:55], v[28:31], v[104:107], v[52:55]
ds_read_b128 v[24:27], v4 offset:8448
v_xor_b32 v4, 65728, v9
v_mfma_f32_16x16x32_bf16 v[60:63], v[28:31], v[108:111], v[60:63]
v_max3_f32 v2, v46, v47, v2
s_waitcnt lgkmcnt(2)
v_mfma_f32_16x16x32_bf16 v[48:51], v[12:15], v[80:83], v[48:51]
ds_read_b128 v[28:31], v4
v_cvt_pk_bf16_f32 v167, v46, v47
v_mfma_f32_16x16x32_bf16 v[56:59], v[12:15], v[84:87], v[56:59]
v_mfma_f32_16x16x32_bf16 v[52:55], v[16:19], v[80:83], v[52:55]
ds_read_b128 v[12:15], v4 offset:8192
v_mfma_f32_16x16x32_bf16 v[60:63], v[16:19], v[84:87], v[60:63]
s_waitcnt lgkmcnt(2)
v_mfma_f32_16x16x32_bf16 v[48:51], v[20:23], v[112:115], v[48:51]
s_branch L_pg4
L_sp24:
v_mov_b32 v8, 0
ds_read_b32 v8, v8 offset:14336
s_waitcnt lgkmcnt(0)
v_cmp_le_u32 vcc, 32, v8
s_cbranch_vccz L_sp24
s_branch L_ok24
L_sp25:
v_mov_b32 v8, 0
ds_read_b32 v8, v8 offset:14336
s_waitcnt lgkmcnt(0)
v_cmp_le_u32 vcc, 34, v8
s_cbranch_vccz L_sp25
s_branch L_ok25
L_sp27:
v_mov_b32 v8, 0
ds_read_b32 v8, v8 offset:14336
s_waitcnt lgkmcnt(0)
v_cmp_le_u32 vcc, 35, v8
s_cbranch_vccz L_sp27
s_branch L_ok27
L_sp28:
v_mov_b32 v8, 0
ds_read_b32 v8, v8 offset:14336
s_waitcnt lgkmcnt(0)
v_cmp_le_u32 vcc, 37, v8
s_cbranch_vccz L_sp28
s_branch L_ok28
.p2align 12
L_stub4:
s_setpc_b64 s[94:95]
L_pg4:
ds_read_b128 v[16:19], v4 offset:256
v_mfma_f32_16x16x32_bf16 v[56:59], v[20:23], v[116:119], v[56:59]
v_mfma_f32_16x16x32_bf16 v[52:55], v[24:27], v[112:115], v[52:55]
ds_read_b128 v[20:23], v4 offset:8448
v_xor_b32 v4, 49152, v1
v_mfma_f32_16x16x32_bf16 v[60:63], v[24:27], v[116:119], v[60:63]
s_waitcnt lgkmcnt(2)
v_mfma_f32_16x16x32_bf16 v[48:51], v[28:31], v[88:91], v[48:51]
ds_read_b64_tr_b16 v[24:25], v4
v_mfma_f32_16x16x32_bf16 v[56:59], v[28:31], v[92:95], v[56:59]
ds_read_b64_tr_b16 v[26:27], v4 offset:8192
v_mfma_f32_16x16x32_bf16 v[52:55], v[12:15], v[88:91], v[52:55]
ds_read_b64_tr_b16 v[28:29], v4 offset:256
v_xor_b32 v5, 49184, v1
v_mfma_f32_16x16x32_bf16 v[60:63], v[12:15], v[92:95], v[60:63]
ds_read_b64_tr_b16 v[30:31], v4 offset:8448
s_waitcnt lgkmcnt(4)
v_mfma_f32_16x16x32_bf16 v[48:51], v[16:19], v[120:123], v[48:51]
ds_read_b64_tr_b16 v[12:13], v5
s_movk_i32 s12, 92
v_mfma_f32_16x16x32_bf16 v[56:59], v[16:19], v[124:127], v[56:59]
ds_read_b64_tr_b16 v[14:15], v5 offset:8192
v_mfma_f32_16x16x32_bf16 v[52:55], v[20:23], v[120:123], v[52:55]
ds_read_b64_tr_b16 v[16:17], v5 offset:256
v_xor_b32 v4, 49216, v1
v_mfma_f32_16x16x32_bf16 v[60:63], v[20:23], v[124:127], v[60:63]
ds_read_b64_tr_b16 v[18:19], v5 offset:8448
s_waitcnt lgkmcnt(4)
v_mfma_f32_16x16x32_bf16 a[128:131], v[24:27], a[24:27], a[128:131]
ds_read_b64_tr_b16 v[20:21], v4
ds_read_b64_tr_b16 v[22:23], v4 offset:8192
v_mfma_f32_16x16x32_bf16 a[132:135], v[24:27], a[28:31], a[132:135]
buffer_load_dword off, s[8:11], s12 lds
v_mfma_f32_16x16x32_bf16 a[192:195], v[28:31], a[24:27], a[192:195]
ds_read_b64_tr_b16 v[24:25], v4 offset:256
v_xor_b32 v5, 49248, v1
v_mfma_f32_16x16x32_bf16 a[196:199], v[28:31], a[28:31], a[196:199]
ds_read_b64_tr_b16 v[26:27], v4 offset:8448
s_waitcnt lgkmcnt(4)
v_mfma_f32_16x16x32_bf16 a[136:139], v[12:15], a[24:27], a[136:139]
ds_read_b64_tr_b16 v[28:29], v5
v_mov_b32 v8, 0
v_mfma_f32_16x16x32_bf16 a[140:143], v[12:15], a[28:31], a[140:143]
ds_read_b64_tr_b16 v[30:31], v5 offset:8192
v_max3_f32 v0, v48, v49, v0
v_mfma_f32_16x16x32_bf16 a[200:203], v[16:19], a[24:27], a[200:203]
ds_read_b64_tr_b16 v[12:13], v5 offset:256
v_xor_b32 v4, 49280, v1
v_mfma_f32_16x16x32_bf16 a[204:207], v[16:19], a[28:31], a[204:207]
ds_read_b64_tr_b16 v[14:15], v5 offset:8448
s_waitcnt lgkmcnt(4)
v_mfma_f32_16x16x32_bf16 a[144:147], v[20:23], a[24:27], a[144:147]
ds_read_b64_tr_b16 v[16:17], v4
v_cvt_pk_bf16_f32 v168, v48, v49
v_mfma_f32_16x16x32_bf16 a[148:151], v[20:23], a[28:31], a[148:151]
ds_read_b64_tr_b16 v[18:19], v4 offset:8192
ds_read_b32 v8, v8 offset:14336
v_mfma_f32_16x16x32_bf16 a[208:211], v[24:27], a[24:27], a[208:211]
ds_read_b64_tr_b16 v[20:21], v4 offset:256
v_xor_b32 v5, 49312, v1
v_mfma_f32_16x16x32_bf16 a[212:215], v[24:27], a[28:31], a[212:215]
ds_read_b64_tr_b16 v[22:23], v4 offset:8448
s_waitcnt lgkmcnt(5)
v_mfma_f32_16x16x32_bf16 a[152:155], v[28:31], a[24:27], a[152:155]
ds_read_b64_tr_b16 v[24:25], v5
v_max3_f32 v2, v56, v57, v2
v_mfma_f32_16x16x32_bf16 a[156:159], v[28:31], a[28:31], a[156:159]
ds_read_b64_tr_b16 v[26:27], v5 offset:8192
v_cvt_pk_bf16_f32 v172, v56, v57
v_mfma_f32_16x16x32_bf16 a[216:219], v[12:15], a[24:27], a[216:219]
ds_read_b64_tr_b16 v[28:29], v5 offset:256
v_xor_b32 v4, 49344, v1
v_mfma_f32_16x16x32_bf16 a[220:223], v[12:15], a[28:31], a[220:223]
ds_read_b64_tr_b16 v[30:31], v5 offset:8448
s_waitcnt lgkmcnt(4)
v_mfma_f32_16x16x32_bf16 a[160:163], v[16:19], a[24:27], a[160:163]
ds_read_b64_tr_b16 v[12:13], v4
v_cmp_le_u32 vcc, 32, v8
v_mfma_f32_16x16x32_bf16 a[164:167], v[16:19], a[28:31], a[164:167]
ds_read_b64_tr_b16 v[14:15], v4 offset:8192
v_max3_f32 v0, v50, v51, v0
v_mfma_f32_16x16x32_bf16 a[224:227], v[20:23], a[24:27], a[224:227]
ds_read_b64_tr_b16 v[16:17], v4 offset:256
v_xor_b32 v5, 49376, v1
v_mfma_f32_16x16x32_bf16 a[228:231], v[20:23], a[28:31], a[228:231]
ds_read_b64_tr_b16 v[18:19], v4 offset:8448
s_waitcnt lgkmcnt(4)
v_mfma_f32_16x16x32_bf16 a[168:171], v[24:27], a[24:27], a[168:171]
ds_read_b64_tr_b16 v[20:21], v5
ds_read_b64_tr_b16 v[22:23], v5 offset:8192
v_mfma_f32_16x16x32_bf16 a[172:175], v[24:27], a[28:31], a[172:175]
s_cbranch_vccz L_sp24
L_ok24:
v_mfma_f32_16x16x32_bf16 a[232:235], v[28:31], a[24:27], a[232:235]
ds_read_b64_tr_b16 v[24:25], v5 offset:256
v_xor_b32 v4, 114688, v9
v_mfma_f32_16x16x32_bf16 a[236:239], v[28:31], a[28:31], a[236:239]
ds_read_b64_tr_b16 v[26:27], v5 offset:8448
s_waitcnt lgkmcnt(4)
v_mfma_f32_16x16x32_bf16 a[176:179], v[12:15], a[24:27], a[176:179]
ds_read_b128 v[28:31], v4
v_cvt_pk_bf16_f32 v169, v50, v51
v_mfma_f32_16x16x32_bf16 a[180:183], v[12:15], a[28:31], a[180:183]
v_max3_f32 v2, v58, v59, v2
v_cvt_pk_bf16_f32 v173, v58, v59
v_mfma_f32_16x16x32_bf16 a[240:243], v[16:19], a[24:27], a[240:243]
ds_read_b128 v[12:15], v4 offset:8192
v_max3_f32 v0, v52, v53, v0
v_mfma_f32_16x16x32_bf16 a[244:247], v[16:19], a[28:31], a[244:247]
v_cvt_pk_bf16_f32 v170, v52, v53
s_waitcnt lgkmcnt(2)
v_mfma_f32_16x16x32_bf16 a[184:187], v[20:23], a[24:27], a[184:187]
ds_read_b128 v[16:19], v4 offset:256
s_movk_i32 s12, 96
v_mfma_f32_16x16x32_bf16 a[188:191], v[20:23], a[28:31], a[188:191]
v_max3_f32 v2, v60, v61, v2
v_cvt_pk_bf16_f32 v174, v60, v61
v_mfma_f32_16x16x32_bf16 a[248:251], v[24:27], a[24:27], a[248:251]
ds_read_b128 v[20:23], v4 offset:8448
v_xor_b32 v4, 114752, v9
v_mfma_f32_16x16x32_bf16 a[252:255], v[24:27], a[28:31], a[252:255]
v_max3_f32 v0, v54, v55, v0
s_waitcnt lgkmcnt(2)
v_mfma_f32_16x16x32_bf16 v[32:35], v[28:31], v[64:67], 0
ds_read_b128 v[24:27], v4
v_cvt_pk_bf16_f32 v171, v54, v55
v_mfma_f32_16x16x32_bf16 v[40:43], v[28:31], v[68:71], 0
buffer_load_dword off, s[8:11], s12 lds
v_mfma_f32_16x16x32_bf16 v[36:39], v[12:15], v[64:67], 0
ds_read_b128 v[28:31], v4 offset:8192
v_max3_f32 v2, v62, v63, v2
v_mfma_f32_16x16x32_bf16 v[44:47], v[12:15], v[68:71], 0
v_cvt_pk_bf16_f32 v175, v62, v63
s_waitcnt lgkmcnt(2)
v_mfma_f32_16x16x32_bf16 v[32:35], v[16:19], v[96:99], v[32:35]
ds_read_b128 v[12:15], v4 offset:256
v_mov_b32 v8, 0
v_mfma_f32_16x16x32_bf16 v[40:43], v[16:19], v[100:103], v[40:43]
v_mfma_f32_16x16x32_bf16 v[36:39], v[20:23], v[96:99], v[36:39]
ds_read_b128 v[16:19], v4 offset:8448
v_xor_b32 v4, 114816, v9
v_mfma_f32_16x16x32_bf16 v[44:47], v[20:23], v[100:103], v[44:47]
s_waitcnt lgkmcnt(2)
v_mfma_f32_16x16x32_bf16 v[32:35], v[24:27], v[72:75], v[32:35]
ds_read_b128 v[20:23], v4
v_mfma_f32_16x16x32_bf16 v[40:43], v[24:27], v[76:79], v[40:43]
ds_read_b32 v8, v8 offset:14336
v_mfma_f32_16x16x32_bf16 v[36:39], v[28:31], v[72:75], v[36:39]
ds_read_b128 v[24:27], v4 offset:8192
v_mfma_f32_16x16x32_bf16 v[44:47], v[28:31], v[76:79], v[44:47]
s_waitcnt lgkmcnt(3)
v_mfma_f32_16x16x32_bf16 v[32:35], v[12:15], v[104:107], v[32:35]
ds_read_b128 v[28:31], v4 offset:256
v_mfma_f32_16x16x32_bf16 v[40:43], v[12:15], v[108:111], v[40:43]
v_mfma_f32_16x16x32_bf16 v[36:39], v[16:19], v[104:107], v[36:39]
ds_read_b128 v[12:15], v4 offset:8448
v_xor_b32 v4, 114880, v9
v_mfma_f32_16x16x32_bf16 v[44:47], v[16:19], v[108:111], v[44:47]
s_waitcnt lgkmcnt(2)
v_mfma_f32_16x16x32_bf16 v[32:35], v[20:23], v[80:83], v[32:35]
ds_read_b128 v[16:19], v4
v_cmp_le_u32 vcc, 34, v8
v_mfma_f32_16x16x32_bf16 v[40:43], v[20:23], v[84:87], v[40:43]
v_mfma_f32_16x16x32_bf16 v[36:39], v[24:27], v[80:83], v[36:39]
ds_read_b128 v[20:23], v4 offset:8192
v_mfma_f32_16x16x32_bf16 v[44:47], v[24:27], v[84:87], v[44:47]
s_waitcnt lgkmcnt(2)
v_mfma_f32_16x16x32_bf16 v[32:35], v[28:31], v[112:115], v[32:35]
ds_read_b128 v[24:27], v4 offset:256
v_mfma_f32_16x16x32_bf16 v[40:43], v[28:31], v[116:119], v[40:43]
s_cbranch_vccz L_sp25
L_ok25:
v_mfma_f32_16x16x32_bf16 v[36:39], v[12:15], v[112:115], v[36:39]
ds_read_b128 v[28:31], v4 offset:8448
v_xor_b32 v4, 81920, v9
v_mfma_f32_16x16x32_bf16 v[44:47], v[12:15], v[116:119], v[44:47]
s_waitcnt lgkmcnt(2)
v_mfma_f32_16x16x32_bf16 v[32:35], v[16:19], v[88:91], v[32:35]
ds_read_b128 v[12:15], v4
v_mfma_f32_16x16x32_bf16 v[40:43], v[16:19], v[92:95], v[40:43]
v_mfma_f32_16x16x32_bf16 v[36:39], v[20:23], v[88:91], v[36:39]
ds_read_b128 v[16:19], v4 offset:8192
v_mfma_f32_16x16x32_bf16 v[44:47], v[20:23], v[92:95], v[44:47]
s_waitcnt lgkmcnt(2)
v_mfma_f32_16x16x32_bf16 v[32:35], v[24:27], v[120:123], v[32:35]
ds_read_b128 v[20:23], v4 offset:256
s_movk_i32 s12, 100
v_mfma_f32_16x16x32_bf16 v[40:43], v[24:27], v[124:127], v[40:43]
v_mfma_f32_16x16x32_bf16 v[36:39], v[28:31], v[120:123], v[36:39]
ds_read_b128 v[24:27], v4 offset:8448
v_xor_b32 v4, 81984, v9
v_mfma_f32_16x16x32_bf16 v[44:47], v[28:31], v[124:127], v[44:47]
s_waitcnt lgkmcnt(2)
v_mfma_f32_16x16x32_bf16 v[48:51], v[12:15], v[64:67], 0
ds_read_b128 v[28:31], v4
v_mfma_f32_16x16x32_bf16 v[56:59], v[12:15], v[68:71], 0
buffer_load_dword off, s[8:11], s12 lds
v_mfma_f32_16x16x32_bf16 v[52:55], v[16:19], v[64:67], 0
ds_read_b128 v[12:15], v4 offset:8192
v_max3_f32 v0, v32, v33, v0
v_mfma_f32_16x16x32_bf16 v[60:63], v[16:19], v[68:71], 0
v_cvt_pk_bf16_f32 v176, v32, v33
s_waitcnt lgkmcnt(2)
v_mfma_f32_16x16x32_bf16 v[48:51], v[20:23], v[96:99], v[48:51]
ds_read_b128 v[16:19], v4 offset:256
v_max3_f32 v2, v40, v41, v2
v_mfma_f32_16x16x32_bf16 v[56:59], v[20:23], v[100:103], v[56:59]
v_cvt_pk_bf16_f32 v180, v40, v41
v_max3_f32 v0, v34, v35, v0
v_mfma_f32_16x16x32_bf16 v[52:55], v[24:27], v[96:99], v[52:55]
ds_read_b128 v[20:23], v4 offset:8448
v_xor_b32 v4, 82048, v9
v_mfma_f32_16x16x32_bf16 v[60:63], v[24:27], v[100:103], v[60:63]
v_cvt_pk_bf16_f32 v177, v34, v35
s_waitcnt lgkmcnt(2)
v_mfma_f32_16x16x32_bf16 v[48:51], v[28:31], v[72:75], v[48:51]
ds_read_b128 v[24:27], v4
v_max3_f32 v2, v42, v43, v2
v_mfma_f32_16x16x32_bf16 v[56:59], v[28:31], v[76:79], v[56:59]
v_cvt_pk_bf16_f32 v181, v42, v43
v_max3_f32 v0, v36, v37, v0
v_mfma_f32_16x16x32_bf16 v[52:55], v[12:15], v[72:75], v[52:55]
ds_read_b128 v[28:31], v4 offset:8192
v_cvt_pk_bf16_f32 v178, v36, v37
v_mfma_f32_16x16x32_bf16 v[60:63], v[12:15], v[76:79], v[60:63]
v_max3_f32 v2, v44, v45, v2
s_waitcnt lgkmcnt(2)
v_mfma_f32_16x16x32_bf16 v[48:51], v[16:19], v[104:107], v[48:51]
ds_read_b128 v[12:15], v4 offset:256
v_cvt_pk_bf16_f32 v182, v44, v45
v_mfma_f32_16x16x32_bf16 v[56:59], v[16:19], v[108:111], v[56:59]
v_max3_f32 v0, v38, v39, v0
v_cvt_pk_bf16_f32 v179, v38, v39
v_mfma_f32_16x16x32_bf16 v[52:55], v[20:23], v[104:107], v[52:55]
ds_read_b128 v[16:19], v4 offset:8448
v_xor_b32 v4, 82112, v9
v_mfma_f32_16x16x32_bf16 v[60:63], v[20:23], v[108:111], v[60:63]
v_max3_f32 v2, v46, v47, v2
s_waitcnt lgkmcnt(2)
v_mfma_f32_16x16x32_bf16 v[48:51], v[24:27], v[80:83], v[48:51]
ds_read_b128 v[20:23], v4
v_cvt_pk_bf16_f32 v183, v46, v47
v_mfma_f32_16x16x32_bf16 v[56:59], v[24:27], v[84:87], v[56:59]
v_mfma_f32_16x16x32_bf16 v[52:55], v[28:31], v[80:83], v[52:55]
ds_read_b128 v[24:27], v4 offset:8192
v_mfma_f32_16x16x32_bf16 v[60:63], v[28:31], v[84:87], v[60:63]
s_waitcnt lgkmcnt(2)
v_mfma_f32_16x16x32_bf16 v[48:51], v[12:15], v[112:115], v[48:51]
ds_read_b128 v[28:31], v4 offset:256
v_mfma_f32_16x16x32_bf16 v[56:59], v[12:15], v[116:119], v[56:59]
v_mfma_f32_16x16x32_bf16 v[52:55], v[16:19], v[112:115], v[52:55]
ds_read_b128 v[12:15], v4 offset:8448
v_xor_b32 v4, 131072, v1
v_mfma_f32_16x16x32_bf16 v[60:63], v[16:19], v[116:119], v[60:63]
s_waitcnt lgkmcnt(2)
v_mfma_f32_16x16x32_bf16 v[48:51], v[20:23], v[88:91], v[48:51]
ds_read_b64_tr_b16 v[16:17], v4
v_mfma_f32_16x16x32_bf16 v[56:59], v[20:23], v[92:95], v[56:59]
ds_read_b64_tr_b16 v[18:19], v4 offset:8192
v_mfma_f32_16x16x32_bf16 v[52:55], v[24:27], v[88:91], v[52:55]
ds_read_b64_tr_b16 v[20:21], v4 offset:256
v_xor_b32 v5, 131104, v1
v_mfma_f32_16x16x32_bf16 v[60:63], v[24:27], v[92:95], v[60:63]
ds_read_b64_tr_b16 v[22:23], v4 offset:8448
s_waitcnt lgkmcnt(4)
v_mfma_f32_16x16x32_bf16 v[48:51], v[28:31], v[120:123], v[48:51]
ds_read_b64_tr_b16 v[24:25], v5
s_movk_i32 s12, 104
v_mfma_f32_16x16x32_bf16 v[56:59], v[28:31], v[124:127], v[56:59]
ds_read_b64_tr_b16 v[26:27], v5 offset:8192
v_mfma_f32_16x16x32_bf16 v[52:55], v[12:15], v[120:123], v[52:55]
ds_read_b64_tr_b16 v[28:29], v5 offset:256
v_xor_b32 v4, 131136, v1
v_mfma_f32_16x16x32_bf16 v[60:63], v[12:15], v[124:127], v[60:63]
ds_read_b64_tr_b16 v[30:31], v5 offset:8448
s_waitcnt lgkmcnt(4)
v_mfma_f32_16x16x32_bf16 a[128:131], v[16:19], a[32:35], a[128:131]
ds_read_b64_tr_b16 v[12:13], v4
ds_read_b64_tr_b16 v[14:15], v4 offset:8192
v_mfma_f32_16x16x32_bf16 a[132:135], v[16:19], a[36:39], a[132:135]
buffer_load_dword off, s[8:11], s12 lds
v_mfma_f32_16x16x32_bf16 a[192:195], v[20:23], a[32:35], a[192:195]
ds_read_b64_tr_b16 v[16:17], v4 offset:256
v_xor_b32 v5, 131168, v1
v_mfma_f32_16x16x32_bf16 a[196:199], v[20:23], a[36:39], a[196:199]
ds_read_b64_tr_b16 v[18:19], v4 offset:8448
s_waitcnt lgkmcnt(4)
v_mfma_f32_16x16x32_bf16 a[136:139], v[24:27], a[32:35], a[136:139]
ds_read_b64_tr_b16 v[20:21], v5
v_mov_b32 v8, 0
v_mfma_f32_16x16x32_bf16 a[140:143], v[24:27], a[36:39], a[140:143]
ds_read_b64_tr_b16 v[22:23], v5 offset:8192
v_max3_f32 v0, v48, v49, v0
v_mfma_f32_16x16x32_bf16 a[200:203], v[28:31], a[32:35], a[200:203]
ds_read_b64_tr_b16 v[24:25], v5 offset:256
v_xor_b32 v4, 131200, v1
v_mfma_f32_16x16x32_bf16 a[204:207], v[28:31], a[36:39], a[204:207]
ds_read_b64_tr_b16 v[26:27], v5 offset:8448
s_waitcnt lgkmcnt(4)
v_mfma_f32_16x16x32_bf16 a[144:147], v[12:15], a[32:35], a[144:147]
ds_read_b64_tr_b16 v[28:29], v4
v_cvt_pk_bf16_f32 v184, v48, v49
v_mfma_f32_16x16x32_bf16 a[148:151], v[12:15], a[36:39], a[148:151]
ds_read_b64_tr_b16 v[30:31], v4 offset:8192
ds_read_b32 v8, v8 offset:14336
v_mfma_f32_16x16x32_bf16 a[208:211], v[16:19], a[32:35], a[208:211]
ds_read_b64_tr_b16 v[12:13], v4 offset:256
v_xor_b32 v5, 131232, v1
v_mfma_f32_16x16x32_bf16 a[212:215], v[16:19], a[36:39], a[212:215]
ds_read_b64_tr_b16 v[14:15], v4 offset:8448
s_waitcnt lgkmcnt(5)
v_mfma_f32_16x16x32_bf16 a[152:155], v[20:23], a[32:35], a[152:155]
ds_read_b64_tr_b16 v[16:17], v5
v_max3_f32 v2, v56, v57, v2
v_mfma_f32_16x16x32_bf16 a[156:159], v[20:23], a[36:39], a[156:159]
ds_read_b64_tr_b16 v[18:19], v5 offset:8192
v_cvt_pk_bf16_f32 v188, v56, v57
v_mfma_f32_16x16x32_bf16 a[216:219], v[24:27], a[32:35], a[216:219]
ds_read_b64_tr_b16 v[20:21], v5 offset:256
v_xor_b32 v4, 131264, v1
v_mfma_f32_16x16x32_bf16 a[220:223], v[24:27], a[36:39], a[220:223]
ds_read_b64_tr_b16 v[22:23], v5 offset:8448
s_waitcnt lgkmcnt(4)
v_mfma_f32_16x16x32_bf16 a[160:163], v[28:31], a[32:35], a[160:163]
ds_read_b64_tr_b16 v[24:25], v4
v_cmp_le_u32 vcc, 35, v8
v_mfma_f32_16x16x32_bf16 a[164:167], v[28:31], a[36:39], a[164:167]
ds_read_b64_tr_b16 v[26:27], v4 offset:8192
v_max3_f32 v0, v50, v51, v0
v_mfma_f32_16x16x32_bf16 a[224:227], v[12:15], a[32:35], a[224:227]
ds_read_b64_tr_b16 v[28:29], v4 offset:256
v_xor_b32 v5, 131296, v1
v_mfma_f32_16x16x32_bf16 a[228:231], v[12:15], a[36:39], a[228:231]
ds_read_b64_tr_b16 v[30:31], v4 offset:8448
s_waitcnt lgkmcnt(4)
v_mfma_f32_16x16x32_bf16 a[168:171], v[16:19], a[32:35], a[168:171]
ds_read_b64_tr_b16 v[12:13], v5
ds_read_b64_tr_b16 v[14:15], v5 offset:8192
v_mfma_f32_16x16x32_bf16 a[172:175], v[16:19], a[36:39], a[172:175]
s_cbranch_vccz L_sp27
L_ok27:
v_mfma_f32_16x16x32_bf16 a[232:235], v[20:23], a[32:35], a[232:235]
ds_read_b64_tr_b16 v[16:17], v5 offset:256
v_xor_b32 v4, 98304, v9
v_mfma_f32_16x16x32_bf16 a[236:239], v[20:23], a[36:39], a[236:239]
ds_read_b64_tr_b16 v[18:19], v5 offset:8448
s_waitcnt lgkmcnt(4)
v_mfma_f32_16x16x32_bf16 a[176:179], v[24:27], a[32:35], a[176:179]
ds_read_b128 v[20:23], v4
v_cvt_pk_bf16_f32 v185, v50, v51
v_mfma_f32_16x16x32_bf16 a[180:183], v[24:27], a[36:39], a[180:183]
v_max3_f32 v2, v58, v59, v2
v_cvt_pk_bf16_f32 v189, v58, v59
v_mfma_f32_16x16x32_bf16 a[240:243], v[28:31], a[32:35], a[240:243]
ds_read_b128 v[24:27], v4 offset:8192
v_max3_f32 v0, v52, v53, v0
v_mfma_f32_16x16x32_bf16 a[244:247], v[28:31], a[36:39], a[244:247]
v_cvt_pk_bf16_f32 v186, v52, v53
s_waitcnt lgkmcnt(2)
v_mfma_f32_16x16x32_bf16 a[184:187], v[12:15], a[32:35], a[184:187]
ds_read_b128 v[28:31], v4 offset:256
s_movk_i32 s12, 108
v_mfma_f32_16x16x32_bf16 a[188:191], v[12:15], a[36:39], a[188:191]
v_max3_f32 v2, v60, v61, v2
v_cvt_pk_bf16_f32 v190, v60, v61
v_mfma_f32_16x16x32_bf16 a[248:251], v[16:19], a[32:35], a[248:251]
ds_read_b128 v[12:15], v4 offset:8448
v_xor_b32 v4, 98368, v9
v_mfma_f32_16x16x32_bf16 a[252:255], v[16:19], a[36:39], a[252:255]
v_max3_f32 v0, v54, v55, v0
s_waitcnt lgkmcnt(2)
v_mfma_f32_16x16x32_bf16 v[32:35], v[20:23], v[64:67], 0
ds_read_b128 v[16:19], v4
v_cvt_pk_bf16_f32 v187, v54, v55
v_mfma_f32_16x16x32_bf16 v[40:43], v[20:23], v[68:71], 0
buffer_load_dword off, s[8:11], s12 lds
v_mfma_f32_16x16x32_bf16 v[36:39], v[24:27], v[64:67], 0
ds_read_b128 v[20:23], v4 offset:8192
v_max3_f32 v2, v62, v63, v2
v_mfma_f32_16x16x32_bf16 v[44:47], v[24:27], v[68:71], 0
v_cvt_pk_bf16_f32 v191, v62, v63
s_waitcnt lgkmcnt(2)
v_mfma_f32_16x16x32_bf16 v[32:35], v[28:31], v[96:99], v[32:35]
ds_read_b128 v[24:27], v4 offset:256
v_mov_b32 v8, 0
v_mfma_f32_16x16x32_bf16 v[40:43], v[28:31], v[100:103], v[40:43]
v_mfma_f32_16x16x32_bf16 v[36:39], v[12:15], v[96:99], v[36:39]
ds_read_b128 v[28:31], v4 offset:8448
v_xor_b32 v4, 98432, v9
v_mfma_f32_16x16x32_bf16 v[44:47], v[12:15], v[100:103], v[44:47]
s_waitcnt lgkmcnt(2)
v_mfma_f32_16x16x32_bf16 v[32:35], v[16:19], v[72:75], v[32:35]
ds_read_b128 v[12:15], v4
v_mfma_f32_16x16x32_bf16 v[40:43], v[16:19], v[76:79], v[40:43]
ds_read_b32 v8, v8 offset:14336
v_mfma_f32_16x16x32_bf16 v[36:39], v[20:23], v[72:75], v[36:39]
ds_read_b128 v[16:19], v4 offset:8192
v_mfma_f32_16x16x32_bf16 v[44:47], v[20:23], v[76:79], v[44:47]
s_waitcnt lgkmcnt(3)
v_mfma_f32_16x16x32_bf16 v[32:35], v[24:27], v[104:107], v[32:35]
ds_read_b128 v[20:23], v4 offset:256
v_mfma_f32_16x16x32_bf16 v[40:43], v[24:27], v[108:111], v[40:43]
v_mfma_f32_16x16x32_bf16 v[36:39], v[28:31], v[104:107], v[36:39]
ds_read_b128 v[24:27], v4 offset:8448
v_xor_b32 v4, 98496, v9
v_mfma_f32_16x16x32_bf16 v[44:47], v[28:31], v[108:111], v[44:47]
s_waitcnt lgkmcnt(2)
v_mfma_f32_16x16x32_bf16 v[32:35], v[12:15], v[80:83], v[32:35]
ds_read_b128 v[28:31], v4
v_cmp_le_u32 vcc, 37, v8
v_mfma_f32_16x16x32_bf16 v[40:43], v[12:15], v[84:87], v[40:43]
v_mfma_f32_16x16x32_bf16 v[36:39], v[16:19], v[80:83], v[36:39]
ds_read_b128 v[12:15], v4 offset:8192
v_mfma_f32_16x16x32_bf16 v[44:47], v[16:19], v[84:87], v[44:47]
s_waitcnt lgkmcnt(2)
v_mfma_f32_16x16x32_bf16 v[32:35], v[20:23], v[112:115], v[32:35]
ds_read_b128 v[16:19], v4 offset:256
v_mfma_f32_16x16x32_bf16 v[40:43], v[20:23], v[116:119], v[40:43]
s_cbranch_vccz L_sp28
L_ok28:
v_mfma_f32_16x16x32_bf16 v[36:39], v[24:27], v[112:115], v[36:39]
ds_read_b128 v[20:23], v4 offset:8448
v_xor_b32 v4, 16384, v9
v_mfma_f32_16x16x32_bf16 v[44:47], v[24:27], v[116:119], v[44:47]
s_waitcnt lgkmcnt(2)
v_mfma_f32_16x16x32_bf16 v[32:35], v[28:31], v[88:91], v[32:35]
ds_read_b128 v[24:27], v4
v_mfma_f32_16x16x32_bf16 v[40:43], v[28:31], v[92:95], v[40:43]
v_mfma_f32_16x16x32_bf16 v[36:39], v[12:15], v[88:91], v[36:39]
ds_read_b128 v[28:31], v4 offset:8192
v_mfma_f32_16x16x32_bf16 v[44:47], v[12:15], v[92:95], v[44:47]
s_waitcnt lgkmcnt(2)
v_mfma_f32_16x16x32_bf16 v[32:35], v[16:19], v[120:123], v[32:35]
ds_read_b128 v[12:15], v4 offset:256
s_movk_i32 s12, 112
v_mfma_f32_16x16x32_bf16 v[40:43], v[16:19], v[124:127], v[40:43]
v_mfma_f32_16x16x32_bf16 v[36:39], v[20:23], v[120:123], v[36:39]
ds_read_b128 v[16:19], v4 offset:8448
v_xor_b32 v4, 16448, v9
v_mfma_f32_16x16x32_bf16 v[44:47], v[20:23], v[124:127], v[44:47]
s_waitcnt lgkmcnt(2)
v_mfma_f32_16x16x32_bf16 v[48:51], v[24:27], v[64:67], 0
ds_read_b128 v[20:23], v4
v_mfma_f32_16x16x32_bf16 v[56:59], v[24:27], v[68:71], 0
buffer_load_dword off, s[8:11], s12 lds
v_mfma_f32_16x16x32_bf16 v[52:55], v[28:31], v[64:67], 0
ds_read_b128 v[24:27], v4 offset:8192
v_max3_f32 v0, v32, v33, v0
v_mfma_f32_16x16x32_bf16 v[60:63], v[28:31], v[68:71], 0
v_cvt_pk_bf16_f32 v192, v32, v33
s_waitcnt lgkmcnt(2)
v_mfma_f32_16x16x32_bf16 v[48:51], v[12:15], v[96:99], v[48:51]
ds_read_b128 v[28:31], v4 offset:256
v_max3_f32 v2, v40, v41, v2
v_mfma_f32_16x16x32_bf16 v[56:59], v[12:15], v[100:103], v[56:59]
v_cvt_pk_bf16_f32 v196, v40, v41
v_max3_f32 v0, v34, v35, v0
v_mfma_f32_16x16x32_bf16 v[52:55], v[16:19], v[96:99], v[52:55]
ds_read_b128 v[12:15], v4 offset:8448
v_xor_b32 v4, 16512, v9
v_mfma_f32_16x16x32_bf16 v[60:63], v[16:19], v[100:103], v[60:63]
v_cvt_pk_bf16_f32 v193, v34, v35
s_waitcnt lgkmcnt(2)
v_mfma_f32_16x16x32_bf16 v[48:51], v[20:23], v[72:75], v[48:51]
ds_read_b128 v[16:19], v4
v_max3_f32 v2, v42, v43, v2
v_mfma_f32_16x16x32_bf16 v[56:59], v[20:23], v[76:79], v[56:59]
v_cvt_pk_bf16_f32 v197, v42, v43
v_max3_f32 v0, v36, v37, v0
v_mfma_f32_16x16x32_bf16 v[52:55], v[24:27], v[72:75], v[52:55]
ds_read_b128 v[20:23], v4 offset:8192
v_cvt_pk_bf16_f32 v194, v36, v37
v_mfma_f32_16x16x32_bf16 v[60:63], v[24:27], v[76:79], v[60:63]
v_max3_f32 v2, v44, v45, v2
s_waitcnt lgkmcnt(2)
v_mfma_f32_16x16x32_bf16 v[48:51], v[28:31], v[104:107], v[48:51]
ds_read_b128 v[24:27], v4 offset:256
v_cvt_pk_bf16_f32 v198, v44, v45
v_mfma_f32_16x16x32_bf16 v[56:59], v[28:31], v[108:111], v[56:59]
v_max3_f32 v0, v38, v39, v0
v_cvt_pk_bf16_f32 v195, v38, v39
v_mfma_f32_16x16x32_bf16 v[52:55], v[12:15], v[104:107], v[52:55]
ds_read_b128 v[28:31], v4 offset:8448
v_xor_b32 v4, 16576, v9
v_mfma_f32_16x16x32_bf16 v[60:63], v[12:15], v[108:111], v[60:63]
v_max3_f32 v2, v46, v47, v2
s_waitcnt lgkmcnt(2)
v_mfma_f32_16x16x32_bf16 v[48:51], v[16:19], v[80:83], v[48:51]
ds_read_b128 v[12:15], v4
v_cvt_pk_bf16_f32 v199, v46, v47
v_mfma_f32_16x16x32_bf16 v[56:59], v[16:19], v[84:87], v[56:59]
v_mfma_f32_16x16x32_bf16 v[52:55], v[20:23], v[80:83], v[52:55]
ds_read_b128 v[16:19], v4 offset:8192
v_mfma_f32_16x16x32_bf16 v[60:63], v[20:23], v[84:87], v[60:63]
s_waitcnt lgkmcnt(2)
v_mfma_f32_16x16x32_bf16 v[48:51], v[24:27], v[112:115], v[48:51]
ds_read_b128 v[20:23], v4 offset:256
v_mfma_f32_16x16x32_bf16 v[56:59], v[24:27], v[116:119], v[56:59]
v_mfma_f32_16x16x32_bf16 v[52:55], v[28:31], v[112:115], v[52:55]
ds_read_b128 v[24:27], v4 offset:8448
v_xor_b32 v4, 147456, v1
v_mfma_f32_16x16x32_bf16 v[60:63], v[28:31], v[116:119], v[60:63]
s_waitcnt lgkmcnt(2)
v_mfma_f32_16x16x32_bf16 v[48:51], v[12:15], v[88:91], v[48:51]
ds_read_b64_tr_b16 v[28:29], v4
v_mfma_f32_16x16x32_bf16 v[56:59], v[12:15], v[92:95], v[56:59]
ds_read_b64_tr_b16 v[30:31], v4 offset:8192
v_mfma_f32_16x16x32_bf16 v[52:55], v[16:19], v[88:91], v[52:55]
ds_read_b64_tr_b16 v[12:13], v4 offset:256
v_xor_b32 v5, 147488, v1
v_mfma_f32_16x16x32_bf16 v[60:63], v[16:19], v[92:95], v[60:63]
ds_read_b64_tr_b16 v[14:15], v4 offset:8448
s_waitcnt lgkmcnt(4)
v_mfma_f32_16x16x32_bf16 v[48:51], v[20:23], v[120:123], v[48:51]
s_branch L_pg5
L_sp30:
v_mov_b32 v8, 0
ds_read_b32 v8, v8 offset:14336
s_waitcnt lgkmcnt(0)
v_cmp_le_u32 vcc, 38, v8
s_cbranch_vccz L_sp30
s_branch L_ok30
L_sp31:
v_mov_b32 v8, 0
ds_read_b32 v8, v8 offset:14336
s_waitcnt lgkmcnt(0)
v_cmp_le_u32 vcc, 40, v8
s_cbranch_vccz L_sp31
s_branch L_ok31
L_sp33:
v_mov_b32 v8, 0
ds_read_b32 v8, v8 offset:14336
s_waitcnt lgkmcnt(0)
v_cmp_le_u32 vcc, 41, v8
s_cbranch_vccz L_sp33
s_branch L_ok33
L_sp34:
v_mov_b32 v8, 0
ds_read_b32 v8, v8 offset:14336
s_waitcnt lgkmcnt(0)
v_cmp_le_u32 vcc, 43, v8
s_cbranch_vccz L_sp34
s_branch L_ok34
.p2align 12
L_stub5:
s_setpc_b64 s[94:95]
L_pg5:
ds_read_b64_tr_b16 v[16:17], v5
s_movk_i32 s12, 116
v_mfma_f32_16x16x32_bf16 v[56:59], v[20:23], v[124:127], v[56:59]
ds_read_b64_tr_b16 v[18:19], v5 offset:8192
v_mfma_f32_16x16x32_bf16 v[52:55], v[24:27], v[120:123], v[52:55]
ds_read_b64_tr_b16 v[20:21], v5 offset:256
v_xor_b32 v4, 147520, v1
v_mfma_f32_16x16x32_bf16 v[60:63], v[24:27], v[124:127], v[60:63]
ds_read_b64_tr_b16 v[22:23], v5 offset:8448
s_waitcnt lgkmcnt(4)
v_mfma_f32_16x16x32_bf16 a[128:131], v[28:31], a[40:43], a[128:131]
ds_read_b64_tr_b16 v[24:25], v4
ds_read_b64_tr_b16 v[26:27], v4 offset:8192
v_mfma_f32_16x16x32_bf16 a[132:135], v[28:31], a[44:47], a[132:135]
buffer_load_dword off, s[8:11], s12 lds
v_mfma_f32_16x16x32_bf16 a[192:195], v[12:15], a[40:43], a[192:195]
ds_read_b64_tr_b16 v[28:29], v4 offset:256
v_xor_b32 v5, 147552, v1
v_mfma_f32_16x16x32_bf16 a[196:199], v[12:15], a[44:47], a[196:199]
ds_read_b64_tr_b16 v[30:31], v4 offset:8448
s_waitcnt lgkmcnt(4)
v_mfma_f32_16x16x32_bf16 a[136:139], v[16:19], a[40:43], a[136:139]
ds_read_b64_tr_b16 v[12:13], v5
v_mov_b32 v8, 0
v_mfma_f32_16x16x32_bf16 a[140:143], v[16:19], a[44:47], a[140:143]
ds_read_b64_tr_b16 v[14:15], v5 offset:8192
v_max3_f32 v0, v48, v49, v0
v_mfma_f32_16x16x32_bf16 a[200:203], v[20:23], a[40:43], a[200:203]
ds_read_b64_tr_b16 v[16:17], v5 offset:256
v_xor_b32 v4, 147584, v1
v_mfma_f32_16x16x32_bf16 a[204:207], v[20:23], a[44:47], a[204:207]
ds_read_b64_tr_b16 v[18:19], v5 offset:8448
s_waitcnt lgkmcnt(4)
v_mfma_f32_16x16x32_bf16 a[144:147], v[24:27], a[40:43], a[144:147]
ds_read_b64_tr_b16 v[20:21], v4
v_cvt_pk_bf16_f32 v200, v48, v49
v_mfma_f32_16x16x32_bf16 a[148:151], v[24:27], a[44:47], a[148:151]
ds_read_b64_tr_b16 v[22:23], v4 offset:8192
ds_read_b32 v8, v8 offset:14336
v_mfma_f32_16x16x32_bf16 a[208:211], v[28:31], a[40:43], a[208:211]
ds_read_b64_tr_b16 v[24:25], v4 offset:256
v_xor_b32 v5, 147616, v1
v_mfma_f32_16x16x32_bf16 a[212:215], v[28:31], a[44:47], a[212:215]
ds_read_b64_tr_b16 v[26:27], v4 offset:8448
s_waitcnt lgkmcnt(5)
v_mfma_f32_16x16x32_bf16 a[152:155], v[12:15], a[40:43], a[152:155]
ds_read_b64_tr_b16 v[28:29], v5
v_max3_f32 v2, v56, v57, v2
v_mfma_f32_16x16x32_bf16 a[156:159], v[12:15], a[44:47], a[156:159]
ds_read_b64_tr_b16 v[30:31], v5 offset:8192
v_cvt_pk_bf16_f32 v204, v56, v57
v_mfma_f32_16x16x32_bf16 a[216:219], v[16:19], a[40:43], a[216:219]
ds_read_b64_tr_b16 v[12:13], v5 offset:256
v_xor_b32 v4, 147648, v1
v_mfma_f32_16x16x32_bf16 a[220:223], v[16:19], a[44:47], a[220:223]
ds_read_b64_tr_b16 v[14:15], v5 offset:8448
s_waitcnt lgkmcnt(4)
v_mfma_f32_16x16x32_bf16 a[160:163], v[20:23], a[40:43], a[160:163]
ds_read_b64_tr_b16 v[16:17], v4
v_cmp_le_u32 vcc, 38, v8
v_mfma_f32_16x16x32_bf16 a[164:167], v[20:23], a[44:47], a[164:167]
ds_read_b64_tr_b16 v[18:19], v4 offset:8192
v_max3_f32 v0, v50, v51, v0
v_mfma_f32_16x16x32_bf16 a[224:227], v[24:27], a[40:43], a[224:227]
ds_read_b64_tr_b16 v[20:21], v4 offset:256
v_xor_b32 v5, 147680, v1
v_mfma_f32_16x16x32_bf16 a[228:231], v[24:27], a[44:47], a[228:231]
ds_read_b64_tr_b16 v[22:23], v4 offset:8448
s_waitcnt lgkmcnt(4)
v_mfma_f32_16x16x32_bf16 a[168:171], v[28:31], a[40:43], a[168:171]
ds_read_b64_tr_b16 v[24:25], v5
ds_read_b64_tr_b16 v[26:27], v5 offset:8192
v_mfma_f32_16x16x32_bf16 a[172:175], v[28:31], a[44:47], a[172:175]
s_cbranch_vccz L_sp30
L_ok30:
v_mfma_f32_16x16x32_bf16 a[232:235], v[12:15], a[40:43], a[232:235]
ds_read_b64_tr_b16 v[28:29], v5 offset:256
v_xor_b32 v4, 32768, v9
v_mfma_f32_16x16x32_bf16 a[236:239], v[12:15], a[44:47], a[236:239]
ds_read_b64_tr_b16 v[30:31], v5 offset:8448
s_waitcnt lgkmcnt(4)
v_mfma_f32_16x16x32_bf16 a[176:179], v[16:19], a[40:43], a[176:179]
ds_read_b128 v[12:15], v4
v_cvt_pk_bf16_f32 v201, v50, v51
v_mfma_f32_16x16x32_bf16 a[180:183], v[16:19], a[44:47], a[180:183]
v_max3_f32 v2, v58, v59, v2
v_cvt_pk_bf16_f32 v205, v58, v59
v_mfma_f32_16x16x32_bf16 a[240:243], v[20:23], a[40:43], a[240:243]
ds_read_b128 v[16:19], v4 offset:8192
v_max3_f32 v0, v52, v53, v0
v_mfma_f32_16x16x32_bf16 a[244:247], v[20:23], a[44:47], a[244:247]
v_cvt_pk_bf16_f32 v202, v52, v53
s_waitcnt lgkmcnt(2)
v_mfma_f32_16x16x32_bf16 a[184:187], v[24:27], a[40:43], a[184:187]
ds_read_b128 v[20:23], v4 offset:256
s_movk_i32 s12, 120
v_mfma_f32_16x16x32_bf16 a[188:191], v[24:27], a[44:47], a[188:191]
v_max3_f32 v2, v60, v61, v2
v_cvt_pk_bf16_f32 v206, v60, v61
v_mfma_f32_16x16x32_bf16 a[248:251], v[28:31], a[40:43], a[248:251]
ds_read_b128 v[24:27], v4 offset:8448
v_xor_b32 v4, 32832, v9
v_mfma_f32_16x16x32_bf16 a[252:255], v[28:31], a[44:47], a[252:255]
v_max3_f32 v0, v54, v55, v0
s_waitcnt lgkmcnt(2)
v_mfma_f32_16x16x32_bf16 v[32:35], v[12:15], v[64:67], 0
ds_read_b128 v[28:31], v4
v_cvt_pk_bf16_f32 v203, v54, v55
v_mfma_f32_16x16x32_bf16 v[40:43], v[12:15], v[68:71], 0
buffer_load_dword off, s[8:11], s12 lds
v_mfma_f32_16x16x32_bf16 v[36:39], v[16:19], v[64:67], 0
ds_read_b128 v[12:15], v4 offset:8192
v_mov_b32 v10, 0x3f803f80
v_mfma_f32_16x16x32_bf16 v[44:47], v[16:19], v[68:71], 0
v_accvgpr_write_b32 a32, v10
s_waitcnt lgkmcnt(2)
v_mfma_f32_16x16x32_bf16 v[32:35], v[20:23], v[96:99], v[32:35]
ds_read_b128 v[16:19], v4 offset:256
v_mov_b32 v8, 0
v_mfma_f32_16x16x32_bf16 v[40:43], v[20:23], v[100:103], v[40:43]
v_accvgpr_write_b32 a33, v10
v_accvgpr_write_b32 a34, v10
v_mfma_f32_16x16x32_bf16 v[36:39], v[24:27], v[96:99], v[36:39]
ds_read_b128 v[20:23], v4 offset:8448
v_xor_b32 v4, 32896, v9
v_mfma_f32_16x16x32_bf16 v[44:47], v[24:27], v[100:103], v[44:47]
v_accvgpr_write_b32 a35, v10
s_waitcnt lgkmcnt(2)
v_mfma_f32_16x16x32_bf16 v[32:35], v[28:31], v[72:75], v[32:35]
ds_read_b128 v[24:27], v4
v_max3_f32 v2, v62, v63, v2
v_mfma_f32_16x16x32_bf16 v[40:43], v[28:31], v[76:79], v[40:43]
ds_read_b32 v8, v8 offset:14336
v_cvt_pk_bf16_f32 v207, v62, v63
v_mfma_f32_16x16x32_bf16 v[36:39], v[12:15], v[72:75], v[36:39]
ds_read_b128 v[28:31], v4 offset:8192
v_mfma_f32_16x16x32_bf16 v[44:47], v[12:15], v[76:79], v[44:47]
s_waitcnt lgkmcnt(3)
v_mfma_f32_16x16x32_bf16 v[32:35], v[16:19], v[104:107], v[32:35]
ds_read_b128 v[12:15], v4 offset:256
v_mfma_f32_16x16x32_bf16 v[40:43], v[16:19], v[108:111], v[40:43]
v_mfma_f32_16x16x32_bf16 v[36:39], v[20:23], v[104:107], v[36:39]
ds_read_b128 v[16:19], v4 offset:8448
v_xor_b32 v4, 32960, v9
v_mfma_f32_16x16x32_bf16 v[44:47], v[20:23], v[108:111], v[44:47]
s_waitcnt lgkmcnt(2)
v_mfma_f32_16x16x32_bf16 v[32:35], v[24:27], v[80:83], v[32:35]
ds_read_b128 v[20:23], v4
v_cmp_le_u32 vcc, 40, v8
v_mfma_f32_16x16x32_bf16 v[40:43], v[24:27], v[84:87], v[40:43]
v_mfma_f32_16x16x32_bf16 v[36:39], v[28:31], v[80:83], v[36:39]
ds_read_b128 v[24:27], v4 offset:8192
v_mfma_f32_16x16x32_bf16 v[44:47], v[28:31], v[84:87], v[44:47]
s_waitcnt lgkmcnt(2)
v_mfma_f32_16x16x32_bf16 v[32:35], v[12:15], v[112:115], v[32:35]
ds_read_b128 v[28:31], v4 offset:256
v_mfma_f32_16x16x32_bf16 v[40:43], v[12:15], v[116:119], v[40:43]
s_cbranch_vccz L_sp31
L_ok31:
v_mfma_f32_16x16x32_bf16 v[36:39], v[16:19], v[112:115], v[36:39]
ds_read_b128 v[12:15], v4 offset:8448
v_xor_b32 v4, 49152, v9
v_mfma_f32_16x16x32_bf16 v[44:47], v[16:19], v[116:119], v[44:47]
s_waitcnt lgkmcnt(2)
v_mfma_f32_16x16x32_bf16 v[32:35], v[20:23], v[88:91], v[32:35]
ds_read_b128 v[16:19], v4
v_mfma_f32_16x16x32_bf16 v[40:43], v[20:23], v[92:95], v[40:43]
v_mfma_f32_16x16x32_bf16 v[36:39], v[24:27], v[88:91], v[36:39]
ds_read_b128 v[20:23], v4 offset:8192
v_mfma_f32_16x16x32_bf16 v[44:47], v[24:27], v[92:95], v[44:47]
s_waitcnt lgkmcnt(2)
v_mfma_f32_16x16x32_bf16 v[32:35], v[28:31], v[120:123], v[32:35]
ds_read_b128 v[24:27], v4 offset:256
s_movk_i32 s12, 124
v_mfma_f32_16x16x32_bf16 v[40:43], v[28:31], v[124:127], v[40:43]
v_mfma_f32_16x16x32_bf16 v[36:39], v[12:15], v[120:123], v[36:39]
ds_read_b128 v[28:31], v4 offset:8448
v_xor_b32 v4, 49216, v9
v_mfma_f32_16x16x32_bf16 v[44:47], v[12:15], v[124:127], v[44:47]
s_waitcnt lgkmcnt(2)
v_mfma_f32_16x16x32_bf16 v[48:51], v[16:19], v[64:67], 0
ds_read_b128 v[12:15], v4
v_mfma_f32_16x16x32_bf16 v[56:59], v[16:19], v[68:71], 0
buffer_load_dword off, s[8:11], s12 lds
v_mfma_f32_16x16x32_bf16 v[52:55], v[20:23], v[64:67], 0
ds_read_b128 v[16:19], v4 offset:8192
v_max3_f32 v0, v32, v33, v0
v_mfma_f32_16x16x32_bf16 v[60:63], v[20:23], v[68:71], 0
v_cvt_pk_bf16_f32 v208, v32, v33
s_waitcnt lgkmcnt(2)
v_mfma_f32_16x16x32_bf16 v[48:51], v[24:27], v[96:99], v[48:51]
ds_read_b128 v[20:23], v4 offset:256
v_max3_f32 v2, v40, v41, v2
v_mfma_f32_16x16x32_bf16 v[56:59], v[24:27], v[100:103], v[56:59]
v_cvt_pk_bf16_f32 v212, v40, v41
v_max3_f32 v0, v34, v35, v0
v_mfma_f32_16x16x32_bf16 v[52:55], v[28:31], v[96:99], v[52:55]
ds_read_b128 v[24:27], v4 offset:8448
v_xor_b32 v4, 49280, v9
v_mfma_f32_16x16x32_bf16 v[60:63], v[28:31], v[100:103], v[60:63]
v_cvt_pk_bf16_f32 v209, v34, v35
s_waitcnt lgkmcnt(2)
v_mfma_f32_16x16x32_bf16 v[48:51], v[12:15], v[72:75], v[48:51]
ds_read_b128 v[28:31], v4
v_max3_f32 v2, v42, v43, v2
v_mfma_f32_16x16x32_bf16 v[56:59], v[12:15], v[76:79], v[56:59]
v_cvt_pk_bf16_f32 v213, v42, v43
v_max3_f32 v0, v36, v37, v0
v_mfma_f32_16x16x32_bf16 v[52:55], v[16:19], v[72:75], v[52:55]
ds_read_b128 v[12:15], v4 offset:8192
v_cvt_pk_bf16_f32 v210, v36, v37
v_mfma_f32_16x16x32_bf16 v[60:63], v[16:19], v[76:79], v[60:63]
v_max3_f32 v2, v44, v45, v2
s_waitcnt lgkmcnt(2)
v_mfma_f32_16x16x32_bf16 v[48:51], v[20:23], v[104:107], v[48:51]
ds_read_b128 v[16:19], v4 offset:256
v_cvt_pk_bf16_f32 v214, v44, v45
v_mfma_f32_16x16x32_bf16 v[56:59], v[20:23], v[108:111], v[56:59]
v_max3_f32 v0, v38, v39, v0
v_cvt_pk_bf16_f32 v211, v38, v39
v_mfma_f32_16x16x32_bf16 v[52:55], v[24:27], v[104:107], v[52:55]
ds_read_b128 v[20:23], v4 offset:8448
v_xor_b32 v4, 49344, v9
v_mfma_f32_16x16x32_bf16 v[60:63], v[24:27], v[108:111], v[60:63]
v_max3_f32 v2, v46, v47, v2
s_waitcnt lgkmcnt(2)
v_mfma_f32_16x16x32_bf16 v[48:51], v[28:31], v[80:83], v[48:51]
ds_read_b128 v[24:27], v4
v_cvt_pk_bf16_f32 v215, v46, v47
v_mfma_f32_16x16x32_bf16 v[56:59], v[28:31], v[84:87], v[56:59]
v_mfma_f32_16x16x32_bf16 v[52:55], v[12:15], v[80:83], v[52:55]
ds_read_b128 v[28:31], v4 offset:8192
v_mfma_f32_16x16x32_bf16 v[60:63], v[12:15], v[84:87], v[60:63]
s_waitcnt lgkmcnt(2)
v_mfma_f32_16x16x32_bf16 v[48:51], v[16:19], v[112:115], v[48:51]
ds_read_b128 v[12:15], v4 offset:256
v_mfma_f32_16x16x32_bf16 v[56:59], v[16:19], v[116:119], v[56:59]
v_mfma_f32_16x16x32_bf16 v[52:55], v[20:23], v[112:115], v[52:55]
ds_read_b128 v[16:19], v4 offset:8448
v_xor_b32 v4, 65536, v1
v_mfma_f32_16x16x32_bf16 v[60:63], v[20:23], v[116:119], v[60:63]
s_waitcnt lgkmcnt(2)
v_mfma_f32_16x16x32_bf16 v[48:51], v[24:27], v[88:91], v[48:51]
ds_read_b64_tr_b16 v[20:21], v4
v_mfma_f32_16x16x32_bf16 v[56:59], v[24:27], v[92:95], v[56:59]
ds_read_b64_tr_b16 v[22:23], v4 offset:8192
v_mfma_f32_16x16x32_bf16 v[52:55], v[28:31], v[88:91], v[52:55]
ds_read_b64_tr_b16 v[24:25], v4 offset:256
v_xor_b32 v5, 65568, v1
v_mfma_f32_16x16x32_bf16 v[60:63], v[28:31], v[92:95], v[60:63]
ds_read_b64_tr_b16 v[26:27], v4 offset:8448
s_waitcnt lgkmcnt(4)
v_mfma_f32_16x16x32_bf16 v[48:51], v[12:15], v[120:123], v[48:51]
ds_read_b64_tr_b16 v[28:29], v5
s_movk_i32 s12, 128
v_mfma_f32_16x16x32_bf16 v[56:59], v[12:15], v[124:127], v[56:59]
ds_read_b64_tr_b16 v[30:31], v5 offset:8192
v_mfma_f32_16x16x32_bf16 v[52:55], v[16:19], v[120:123], v[52:55]
ds_read_b64_tr_b16 v[12:13], v5 offset:256
v_xor_b32 v4, 65600, v1
v_mfma_f32_16x16x32_bf16 v[60:63], v[16:19], v[124:127], v[60:63]
ds_read_b64_tr_b16 v[14:15], v5 offset:8448
s_waitcnt lgkmcnt(4)
v_mfma_f32_16x16x32_bf16 a[128:131], v[20:23], a[48:51], a[128:131]
ds_read_b64_tr_b16 v[16:17], v4
ds_read_b64_tr_b16 v[18:19], v4 offset:8192
v_mfma_f32_16x16x32_bf16 a[132:135], v[20:23], a[52:55], a[132:135]
buffer_load_dword off, s[8:11], s12 lds
v_mfma_f32_16x16x32_bf16 a[192:195], v[24:27], a[48:51], a[192:195]
ds_read_b64_tr_b16 v[20:21], v4 offset:256
v_xor_b32 v5, 65632, v1
v_mfma_f32_16x16x32_bf16 a[196:199], v[24:27], a[52:55], a[196:199]
ds_read_b64_tr_b16 v[22:23], v4 offset:8448
s_waitcnt lgkmcnt(4)
v_mfma_f32_16x16x32_bf16 a[136:139], v[28:31], a[48:51], a[136:139]
ds_read_b64_tr_b16 v[24:25], v5
v_mov_b32 v8, 0
v_mfma_f32_16x16x32_bf16 a[140:143], v[28:31], a[52:55], a[140:143]
ds_read_b64_tr_b16 v[26:27], v5 offset:8192
v_max3_f32 v0, v48, v49, v0
v_mfma_f32_16x16x32_bf16 a[200:203], v[12:15], a[48:51], a[200:203]
ds_read_b64_tr_b16 v[28:29], v5 offset:256
v_xor_b32 v4, 65664, v1
v_mfma_f32_16x16x32_bf16 a[204:207], v[12:15], a[52:55], a[204:207]
ds_read_b64_tr_b16 v[30:31], v5 offset:8448
s_waitcnt lgkmcnt(4)
v_mfma_f32_16x16x32_bf16 a[144:147], v[16:19], a[48:51], a[144:147]
ds_read_b64_tr_b16 v[12:13], v4
v_cvt_pk_bf16_f32 v216, v48, v49
v_mfma_f32_16x16x32_bf16 a[148:151], v[16:19], a[52:55], a[148:151]
ds_read_b64_tr_b16 v[14:15], v4 offset:8192
ds_read_b32 v8, v8 offset:14336
v_mfma_f32_16x16x32_bf16 a[208:211], v[20:23], a[48:51], a[208:211]
ds_read_b64_tr_b16 v[16:17], v4 offset:256
v_xor_b32 v5, 65696, v1
v_mfma_f32_16x16x32_bf16 a[212:215], v[20:23], a[52:55], a[212:215]
ds_read_b64_tr_b16 v[18:19], v4 offset:8448
s_waitcnt lgkmcnt(5)
v_mfma_f32_16x16x32_bf16 a[152:155], v[24:27], a[48:51], a[152:155]
ds_read_b64_tr_b16 v[20:21], v5
v_max3_f32 v2, v56, v57, v2
v_mfma_f32_16x16x32_bf16 a[156:159], v[24:27], a[52:55], a[156:159]
ds_read_b64_tr_b16 v[22:23], v5 offset:8192
v_cvt_pk_bf16_f32 v220, v56, v57
v_mfma_f32_16x16x32_bf16 a[216:219], v[28:31], a[48:51], a[216:219]
ds_read_b64_tr_b16 v[24:25], v5 offset:256
v_xor_b32 v4, 65728, v1
v_mfma_f32_16x16x32_bf16 a[220:223], v[28:31], a[52:55], a[220:223]
ds_read_b64_tr_b16 v[26:27], v5 offset:8448
s_waitcnt lgkmcnt(4)
v_mfma_f32_16x16x32_bf16 a[160:163], v[12:15], a[48:51], a[160:163]
ds_read_b64_tr_b16 v[28:29], v4
v_cmp_le_u32 vcc, 41, v8
v_mfma_f32_16x16x32_bf16 a[164:167], v[12:15], a[52:55], a[164:167]
ds_read_b64_tr_b16 v[30:31], v4 offset:8192
v_max3_f32 v0, v50, v51, v0
v_mfma_f32_16x16x32_bf16 a[224:227], v[16:19], a[48:51], a[224:227]
ds_read_b64_tr_b16 v[12:13], v4 offset:256
v_xor_b32 v5, 65760, v1
v_mfma_f32_16x16x32_bf16 a[228:231], v[16:19], a[52:55], a[228:231]
ds_read_b64_tr_b16 v[14:15], v4 offset:8448
s_waitcnt lgkmcnt(4)
v_mfma_f32_16x16x32_bf16 a[168:171], v[20:23], a[48:51], a[168:171]
ds_read_b64_tr_b16 v[16:17], v5
ds_read_b64_tr_b16 v[18:19], v5 offset:8192
v_mfma_f32_16x16x32_bf16 a[172:175], v[20:23], a[52:55], a[172:175]
s_cbranch_vccz L_sp33
L_ok33:
v_mfma_f32_16x16x32_bf16 a[232:235], v[24:27], a[48:51], a[232:235]
ds_read_b64_tr_b16 v[20:21], v5 offset:256
v_xor_b32 v4, 114688, v9
v_mfma_f32_16x16x32_bf16 a[236:239], v[24:27], a[52:55], a[236:239]
ds_read_b64_tr_b16 v[22:23], v5 offset:8448
s_waitcnt lgkmcnt(4)
v_mfma_f32_16x16x32_bf16 a[176:179], v[28:31], a[48:51], a[176:179]
ds_read_b128 v[24:27], v4
v_cvt_pk_bf16_f32 v217, v50, v51
v_mfma_f32_16x16x32_bf16 a[180:183], v[28:31], a[52:55], a[180:183]
v_max3_f32 v2, v58, v59, v2
v_cvt_pk_bf16_f32 v221, v58, v59
v_mfma_f32_16x16x32_bf16 a[240:243], v[12:15], a[48:51], a[240:243]
ds_read_b128 v[28:31], v4 offset:8192
v_max3_f32 v0, v52, v53, v0
v_mfma_f32_16x16x32_bf16 a[244:247], v[12:15], a[52:55], a[244:247]
v_cvt_pk_bf16_f32 v218, v52, v53
s_waitcnt lgkmcnt(2)
v_mfma_f32_16x16x32_bf16 a[184:187], v[16:19], a[48:51], a[184:187]
ds_read_b128 v[12:15], v4 offset:256
s_movk_i32 s12, 132
v_mfma_f32_16x16x32_bf16 a[188:191], v[16:19], a[52:55], a[188:191]
v_max3_f32 v2, v60, v61, v2
v_cvt_pk_bf16_f32 v222, v60, v61
v_mfma_f32_16x16x32_bf16 a[248:251], v[20:23], a[48:51], a[248:251]
ds_read_b128 v[16:19], v4 offset:8448
v_xor_b32 v4, 114752, v9
v_mfma_f32_16x16x32_bf16 a[252:255], v[20:23], a[52:55], a[252:255]
v_max3_f32 v0, v54, v55, v0
s_waitcnt lgkmcnt(2)
v_mfma_f32_16x16x32_bf16 v[32:35], v[24:27], v[64:67], 0
ds_read_b128 v[20:23], v4
v_cvt_pk_bf16_f32 v219, v54, v55
v_mfma_f32_16x16x32_bf16 v[40:43], v[24:27], v[68:71], 0
buffer_load_dword off, s[8:11], s12 lds
v_mfma_f32_16x16x32_bf16 v[36:39], v[28:31], v[64:67], 0
ds_read_b128 v[24:27], v4 offset:8192
v_max3_f32 v2, v62, v63, v2
v_mfma_f32_16x16x32_bf16 v[44:47], v[28:31], v[68:71], 0
v_cvt_pk_bf16_f32 v223, v62, v63
s_waitcnt lgkmcnt(2)
v_mfma_f32_16x16x32_bf16 v[32:35], v[12:15], v[96:99], v[32:35]
ds_read_b128 v[28:31], v4 offset:256
v_mov_b32 v8, 0
v_mfma_f32_16x16x32_bf16 v[40:43], v[12:15], v[100:103], v[40:43]
v_mfma_f32_16x16x32_bf16 v[36:39], v[16:19], v[96:99], v[36:39]
ds_read_b128 v[12:15], v4 offset:8448
v_xor_b32 v4, 114816, v9
v_mfma_f32_16x16x32_bf16 v[44:47], v[16:19], v[100:103], v[44:47]
s_waitcnt lgkmcnt(2)
v_mfma_f32_16x16x32_bf16 v[32:35], v[20:23], v[72:75], v[32:35]
ds_read_b128 v[16:19], v4
v_mfma_f32_16x16x32_bf16 v[40:43], v[20:23], v[76:79], v[40:43]
ds_read_b32 v8, v8 offset:14336
v_mfma_f32_16x16x32_bf16 v[36:39], v[24:27], v[72:75], v[36:39]
ds_read_b128 v[20:23], v4 offset:8192
v_mfma_f32_16x16x32_bf16 v[44:47], v[24:27], v[76:79], v[44:47]
s_waitcnt lgkmcnt(3)
v_mfma_f32_16x16x32_bf16 v[32:35], v[28:31], v[104:107], v[32:35]
ds_read_b128 v[24:27], v4 offset:256
v_mfma_f32_16x16x32_bf16 v[40:43], v[28:31], v[108:111], v[40:43]
v_mfma_f32_16x16x32_bf16 v[36:39], v[12:15], v[104:107], v[36:39]
ds_read_b128 v[28:31], v4 offset:8448
v_xor_b32 v4, 114880, v9
v_mfma_f32_16x16x32_bf16 v[44:47], v[12:15], v[108:111], v[44:47]
s_waitcnt lgkmcnt(2)
v_mfma_f32_16x16x32_bf16 v[32:35], v[16:19], v[80:83], v[32:35]
ds_read_b128 v[12:15], v4
v_cmp_le_u32 vcc, 43, v8
v_mfma_f32_16x16x32_bf16 v[40:43], v[16:19], v[84:87], v[40:43]
v_mfma_f32_16x16x32_bf16 v[36:39], v[20:23], v[80:83], v[36:39]
ds_read_b128 v[16:19], v4 offset:8192
v_mfma_f32_16x16x32_bf16 v[44:47], v[20:23], v[84:87], v[44:47]
s_waitcnt lgkmcnt(2)
v_mfma_f32_16x16x32_bf16 v[32:35], v[24:27], v[112:115], v[32:35]
ds_read_b128 v[20:23], v4 offset:256
v_mfma_f32_16x16x32_bf16 v[40:43], v[24:27], v[116:119], v[40:43]
s_cbranch_vccz L_sp34
L_ok34:
v_mfma_f32_16x16x32_bf16 v[36:39], v[28:31], v[112:115], v[36:39]
ds_read_b128 v[24:27], v4 offset:8448
v_xor_b32 v4, 131072, v9
v_mfma_f32_16x16x32_bf16 v[44:47], v[28:31], v[116:119], v[44:47]
s_waitcnt lgkmcnt(2)
v_mfma_f32_16x16x32_bf16 v[32:35], v[12:15], v[88:91], v[32:35]
ds_read_b128 v[28:31], v4
v_mfma_f32_16x16x32_bf16 v[40:43], v[12:15], v[92:95], v[40:43]
v_mfma_f32_16x16x32_bf16 v[36:39], v[16:19], v[88:91], v[36:39]
ds_read_b128 v[12:15], v4 offset:8192
v_mfma_f32_16x16x32_bf16 v[44:47], v[16:19], v[92:95], v[44:47]
s_waitcnt lgkmcnt(2)
v_mfma_f32_16x16x32_bf16 v[32:35], v[20:23], v[120:123], v[32:35]
ds_read_b128 v[16:19], v4 offset:256
s_movk_i32 s12, 136
v_mfma_f32_16x16x32_bf16 v[40:43], v[20:23], v[124:127], v[40:43]
v_mfma_f32_16x16x32_bf16 v[36:39], v[24:27], v[120:123], v[36:39]
ds_read_b128 v[20:23], v4 offset:8448
v_xor_b32 v4, 131136, v9
v_mfma_f32_16x16x32_bf16 v[44:47], v[24:27], v[124:127], v[44:47]
s_waitcnt lgkmcnt(2)
v_mfma_f32_16x16x32_bf16 v[48:51], v[28:31], v[64:67], 0
ds_read_b128 v[24:27], v4
v_mfma_f32_16x16x32_bf16 v[56:59], v[28:31], v[68:71], 0
buffer_load_dword off, s[8:11], s12 lds
v_mfma_f32_16x16x32_bf16 v[52:55], v[12:15], v[64:67], 0
ds_read_b128 v[28:31], v4 offset:8192
v_max3_f32 v0, v32, v33, v0
v_mfma_f32_16x16x32_bf16 v[60:63], v[12:15], v[68:71], 0
v_cvt_pk_bf16_f32 v224, v32, v33
s_waitcnt lgkmcnt(2)
v_mfma_f32_16x16x32_bf16 v[48:51], v[16:19], v[96:99], v[48:51]
ds_read_b128 v[12:15], v4 offset:256
v_max3_f32 v2, v40, v41, v2
v_mfma_f32_16x16x32_bf16 v[56:59], v[16:19], v[100:103], v[56:59]
v_cvt_pk_bf16_f32 v228, v40, v41
v_max3_f32 v0, v34, v35, v0
v_mfma_f32_16x16x32_bf16 v[52:55], v[20:23], v[96:99], v[52:55]
ds_read_b128 v[16:19], v4 offset:8448
v_xor_b32 v4, 131200, v9
v_mfma_f32_16x16x32_bf16 v[60:63], v[20:23], v[100:103], v[60:63]
v_cvt_pk_bf16_f32 v225, v34, v35
s_waitcnt lgkmcnt(2)
v_mfma_f32_16x16x32_bf16 v[48:51], v[24:27], v[72:75], v[48:51]
ds_read_b128 v[20:23], v4
v_max3_f32 v2, v42, v43, v2
v_mfma_f32_16x16x32_bf16 v[56:59], v[24:27], v[76:79], v[56:59]
v_cvt_pk_bf16_f32 v229, v42, v43
v_max3_f32 v0, v36, v37, v0
v_mfma_f32_16x16x32_bf16 v[52:55], v[28:31], v[72:75], v[52:55]
ds_read_b128 v[24:27], v4 offset:8192
v_cvt_pk_bf16_f32 v226, v36, v37
v_mfma_f32_16x16x32_bf16 v[60:63], v[28:31], v[76:79], v[60:63]
v_max3_f32 v2, v44, v45, v2
s_waitcnt lgkmcnt(2)
v_mfma_f32_16x16x32_bf16 v[48:51], v[12:15], v[104:107], v[48:51]
ds_read_b128 v[28:31], v4 offset:256
v_cvt_pk_bf16_f32 v230, v44, v45
v_mfma_f32_16x16x32_bf16 v[56:59], v[12:15], v[108:111], v[56:59]
v_max3_f32 v0, v38, v39, v0
v_cvt_pk_bf16_f32 v227, v38, v39
v_mfma_f32_16x16x32_bf16 v[52:55], v[16:19], v[104:107], v[52:55]
ds_read_b128 v[12:15], v4 offset:8448
v_xor_b32 v4, 131264, v9
v_mfma_f32_16x16x32_bf16 v[60:63], v[16:19], v[108:111], v[60:63]
v_max3_f32 v2, v46, v47, v2
s_waitcnt lgkmcnt(2)
v_mfma_f32_16x16x32_bf16 v[48:51], v[20:23], v[80:83], v[48:51]
ds_read_b128 v[16:19], v4
v_cvt_pk_bf16_f32 v231, v46, v47
v_mfma_f32_16x16x32_bf16 v[56:59], v[20:23], v[84:87], v[56:59]
v_mfma_f32_16x16x32_bf16 v[52:55], v[24:27], v[80:83], v[52:55]
ds_read_b128 v[20:23], v4 offset:8192
v_mfma_f32_16x16x32_bf16 v[60:63], v[24:27], v[84:87], v[60:63]
s_waitcnt lgkmcnt(2)
v_mfma_f32_16x16x32_bf16 v[48:51], v[28:31], v[112:115], v[48:51]
ds_read_b128 v[24:27], v4 offset:256
v_mfma_f32_16x16x32_bf16 v[56:59], v[28:31], v[116:119], v[56:59]
v_mfma_f32_16x16x32_bf16 v[52:55], v[12:15], v[112:115], v[52:55]
ds_read_b128 v[28:31], v4 offset:8448
v_xor_b32 v4, 81920, v1
v_mfma_f32_16x16x32_bf16 v[60:63], v[12:15], v[116:119], v[60:63]
s_waitcnt lgkmcnt(2)
v_mfma_f32_16x16x32_bf16 v[48:51], v[16:19], v[88:91], v[48:51]
ds_read_b64_tr_b16 v[12:13], v4
v_mfma_f32_16x16x32_bf16 v[56:59], v[16:19], v[92:95], v[56:59]
ds_read_b64_tr_b16 v[14:15], v4 offset:8192
v_mfma_f32_16x16x32_bf16 v[52:55], v[20:23], v[88:91], v[52:55]
ds_read_b64_tr_b16 v[16:17], v4 offset:256
v_xor_b32 v5, 81952, v1
v_mfma_f32_16x16x32_bf16 v[60:63], v[20:23], v[92:95], v[60:63]
ds_read_b64_tr_b16 v[18:19], v4 offset:8448
s_waitcnt lgkmcnt(4)
v_mfma_f32_16x16x32_bf16 v[48:51], v[24:27], v[120:123], v[48:51]
ds_read_b64_tr_b16 v[20:21], v5
s_movk_i32 s12, 140
v_mfma_f32_16x16x32_bf16 v[56:59], v[24:27], v[124:127], v[56:59]
ds_read_b64_tr_b16 v[22:23], v5 offset:8192
v_mfma_f32_16x16x32_bf16 v[52:55], v[28:31], v[120:123], v[52:55]
ds_read_b64_tr_b16 v[24:25], v5 offset:256
v_xor_b32 v4, 81984, v1
v_mfma_f32_16x16x32_bf16 v[60:63], v[28:31], v[124:127], v[60:63]
ds_read_b64_tr_b16 v[26:27], v5 offset:8448
s_waitcnt lgkmcnt(4)
v_mfma_f32_16x16x32_bf16 a[128:131], v[12:15], a[56:59], a[128:131]
ds_read_b64_tr_b16 v[28:29], v4
ds_read_b64_tr_b16 v[30:31], v4 offset:8192
v_mfma_f32_16x16x32_bf16 a[132:135], v[12:15], a[60:63], a[132:135]
s_branch L_pg6
L_sp36:
v_mov_b32 v8, 0
ds_read_b32 v8, v8 offset:14336
s_waitcnt lgkmcnt(0)
v_cmp_le_u32 vcc, 44, v8
s_cbranch_vccz L_sp36
s_branch L_ok36
L_sp37:
v_mov_b32 v8, 0
ds_read_b32 v8, v8 offset:14336
s_waitcnt lgkmcnt(0)
v_cmp_le_u32 vcc, 46, v8
s_cbranch_vccz L_sp37
s_branch L_ok37
L_sp39:
v_mov_b32 v8, 0
ds_read_b32 v8, v8 offset:14336
s_waitcnt lgkmcnt(0)
v_cmp_le_u32 vcc, 47, v8
s_cbranch_vccz L_sp39
s_branch L_ok39
L_sp40:
v_mov_b32 v8, 0
ds_read_b32 v8, v8 offset:14336
s_waitcnt lgkmcnt(0)
v_cmp_le_u32 vcc, 49, v8
s_cbranch_vccz L_sp40
s_branch L_ok40
.p2align 12
L_stub6:
s_setpc_b64 s[94:95]
L_pg6:
buffer_load_dword off, s[8:11], s12 lds
v_mfma_f32_16x16x32_bf16 a[192:195], v[16:19], a[56:59], a[192:195]
ds_read_b64_tr_b16 v[12:13], v4 offset:256
v_xor_b32 v5, 82016, v1
v_mfma_f32_16x16x32_bf16 a[196:199], v[16:19], a[60:63], a[196:199]
ds_read_b64_tr_b16 v[14:15], v4 offset:8448
s_waitcnt lgkmcnt(4)
v_mfma_f32_16x16x32_bf16 a[136:139], v[20:23], a[56:59], a[136:139]
ds_read_b64_tr_b16 v[16:17], v5
v_mov_b32 v8, 0
v_mfma_f32_16x16x32_bf16 a[140:143], v[20:23], a[60:63], a[140:143]
ds_read_b64_tr_b16 v[18:19], v5 offset:8192
v_max3_f32 v0, v48, v49, v0
v_mfma_f32_16x16x32_bf16 a[200:203], v[24:27], a[56:59], a[200:203]
ds_read_b64_tr_b16 v[20:21], v5 offset:256
v_xor_b32 v4, 82048, v1
v_mfma_f32_16x16x32_bf16 a[204:207], v[24:27], a[60:63], a[204:207]
ds_read_b64_tr_b16 v[22:23], v5 offset:8448
s_waitcnt lgkmcnt(4)
v_mfma_f32_16x16x32_bf16 a[144:147], v[28:31], a[56:59], a[144:147]
ds_read_b64_tr_b16 v[24:25], v4
v_cvt_pk_bf16_f32 v232, v48, v49
v_mfma_f32_16x16x32_bf16 a[148:151], v[28:31], a[60:63], a[148:151]
ds_read_b64_tr_b16 v[26:27], v4 offset:8192
ds_read_b32 v8, v8 offset:14336
v_mfma_f32_16x16x32_bf16 a[208:211], v[12:15], a[56:59], a[208:211]
ds_read_b64_tr_b16 v[28:29], v4 offset:256
v_xor_b32 v5, 82080, v1
v_mfma_f32_16x16x32_bf16 a[212:215], v[12:15], a[60:63], a[212:215]
ds_read_b64_tr_b16 v[30:31], v4 offset:8448
s_waitcnt lgkmcnt(5)
v_mfma_f32_16x16x32_bf16 a[152:155], v[16:19], a[56:59], a[152:155]
ds_read_b64_tr_b16 v[12:13], v5
v_max3_f32 v2, v56, v57, v2
v_mfma_f32_16x16x32_bf16 a[156:159], v[16:19], a[60:63], a[156:159]
ds_read_b64_tr_b16 v[14:15], v5 offset:8192
v_cvt_pk_bf16_f32 v236, v56, v57
v_mfma_f32_16x16x32_bf16 a[216:219], v[20:23], a[56:59], a[216:219]
ds_read_b64_tr_b16 v[16:17], v5 offset:256
v_xor_b32 v4, 82112, v1
v_mfma_f32_16x16x32_bf16 a[220:223], v[20:23], a[60:63], a[220:223]
ds_read_b64_tr_b16 v[18:19], v5 offset:8448
s_waitcnt lgkmcnt(4)
v_mfma_f32_16x16x32_bf16 a[160:163], v[24:27], a[56:59], a[160:163]
ds_read_b64_tr_b16 v[20:21], v4
v_cmp_le_u32 vcc, 44, v8
v_mfma_f32_16x16x32_bf16 a[164:167], v[24:27], a[60:63], a[164:167]
ds_read_b64_tr_b16 v[22:23], v4 offset:8192
v_max3_f32 v0, v50, v51, v0
v_mfma_f32_16x16x32_bf16 a[224:227], v[28:31], a[56:59], a[224:227]
ds_read_b64_tr_b16 v[24:25], v4 offset:256
v_xor_b32 v5, 82144, v1
v_mfma_f32_16x16x32_bf16 a[228:231], v[28:31], a[60:63], a[228:231]
ds_read_b64_tr_b16 v[26:27], v4 offset:8448
s_waitcnt lgkmcnt(4)
v_mfma_f32_16x16x32_bf16 a[168:171], v[12:15], a[56:59], a[168:171]
ds_read_b64_tr_b16 v[28:29], v5
ds_read_b64_tr_b16 v[30:31], v5 offset:8192
v_mfma_f32_16x16x32_bf16 a[172:175], v[12:15], a[60:63], a[172:175]
s_cbranch_vccz L_sp36
L_ok36:
v_mfma_f32_16x16x32_bf16 a[232:235], v[16:19], a[56:59], a[232:235]
ds_read_b64_tr_b16 v[12:13], v5 offset:256
v_xor_b32 v4, 98304, v9
v_mfma_f32_16x16x32_bf16 a[236:239], v[16:19], a[60:63], a[236:239]
ds_read_b64_tr_b16 v[14:15], v5 offset:8448
s_waitcnt lgkmcnt(4)
v_mfma_f32_16x16x32_bf16 a[176:179], v[20:23], a[56:59], a[176:179]
ds_read_b128 v[16:19], v4
v_cvt_pk_bf16_f32 v233, v50, v51
v_mfma_f32_16x16x32_bf16 a[180:183], v[20:23], a[60:63], a[180:183]
v_max3_f32 v2, v58, v59, v2
v_cvt_pk_bf16_f32 v237, v58, v59
v_mfma_f32_16x16x32_bf16 a[240:243], v[24:27], a[56:59], a[240:243]
ds_read_b128 v[20:23], v4 offset:8192
v_max3_f32 v0, v52, v53, v0
v_mfma_f32_16x16x32_bf16 a[244:247], v[24:27], a[60:63], a[244:247]
v_cvt_pk_bf16_f32 v234, v52, v53
s_waitcnt lgkmcnt(2)
v_mfma_f32_16x16x32_bf16 a[184:187], v[28:31], a[56:59], a[184:187]
ds_read_b128 v[24:27], v4 offset:256
s_movk_i32 s12, 144
v_mfma_f32_16x16x32_bf16 a[188:191], v[28:31], a[60:63], a[188:191]
v_max3_f32 v2, v60, v61, v2
v_cvt_pk_bf16_f32 v238, v60, v61
v_mfma_f32_16x16x32_bf16 a[248:251], v[12:15], a[56:59], a[248:251]
ds_read_b128 v[28:31], v4 offset:8448
v_xor_b32 v4, 98368, v9
v_mfma_f32_16x16x32_bf16 a[252:255], v[12:15], a[60:63], a[252:255]
v_max3_f32 v0, v54, v55, v0
s_waitcnt lgkmcnt(2)
v_mfma_f32_16x16x32_bf16 v[32:35], v[16:19], v[64:67], 0
ds_read_b128 v[12:15], v4
v_cvt_pk_bf16_f32 v235, v54, v55
v_mfma_f32_16x16x32_bf16 v[40:43], v[16:19], v[68:71], 0
buffer_load_dword off, s[8:11], s12 lds
v_mfma_f32_16x16x32_bf16 v[36:39], v[20:23], v[64:67], 0
ds_read_b128 v[16:19], v4 offset:8192
v_max3_f32 v2, v62, v63, v2
v_mfma_f32_16x16x32_bf16 v[44:47], v[20:23], v[68:71], 0
v_cvt_pk_bf16_f32 v239, v62, v63
s_waitcnt lgkmcnt(2)
v_mfma_f32_16x16x32_bf16 v[32:35], v[24:27], v[96:99], v[32:35]
ds_read_b128 v[20:23], v4 offset:256
v_mov_b32 v8, 0
v_mfma_f32_16x16x32_bf16 v[40:43], v[24:27], v[100:103], v[40:43]
v_mfma_f32_16x16x32_bf16 v[36:39], v[28:31], v[96:99], v[36:39]
ds_read_b128 v[24:27], v4 offset:8448
v_xor_b32 v4, 98432, v9
v_mfma_f32_16x16x32_bf16 v[44:47], v[28:31], v[100:103], v[44:47]
s_waitcnt lgkmcnt(2)
v_mfma_f32_16x16x32_bf16 v[32:35], v[12:15], v[72:75], v[32:35]
ds_read_b128 v[28:31], v4
v_mfma_f32_16x16x32_bf16 v[40:43], v[12:15], v[76:79], v[40:43]
ds_read_b32 v8, v8 offset:14336
v_mfma_f32_16x16x32_bf16 v[36:39], v[16:19], v[72:75], v[36:39]
ds_read_b128 v[12:15], v4 offset:8192
v_mfma_f32_16x16x32_bf16 v[44:47], v[16:19], v[76:79], v[44:47]
s_waitcnt lgkmcnt(3)
v_mfma_f32_16x16x32_bf16 v[32:35], v[20:23], v[104:107], v[32:35]
ds_read_b128 v[16:19], v4 offset:256
v_mfma_f32_16x16x32_bf16 v[40:43], v[20:23], v[108:111], v[40:43]
v_mfma_f32_16x16x32_bf16 v[36:39], v[24:27], v[104:107], v[36:39]
ds_read_b128 v[20:23], v4 offset:8448
v_xor_b32 v4, 98496, v9
v_mfma_f32_16x16x32_bf16 v[44:47], v[24:27], v[108:111], v[44:47]
s_waitcnt lgkmcnt(2)
v_mfma_f32_16x16x32_bf16 v[32:35], v[28:31], v[80:83], v[32:35]
ds_read_b128 v[24:27], v4
v_cmp_le_u32 vcc, 46, v8
v_mfma_f32_16x16x32_bf16 v[40:43], v[28:31], v[84:87], v[40:43]
v_mfma_f32_16x16x32_bf16 v[36:39], v[12:15], v[80:83], v[36:39]
ds_read_b128 v[28:31], v4 offset:8192
v_mfma_f32_16x16x32_bf16 v[44:47], v[12:15], v[84:87], v[44:47]
s_waitcnt lgkmcnt(2)
v_mfma_f32_16x16x32_bf16 v[32:35], v[16:19], v[112:115], v[32:35]
ds_read_b128 v[12:15], v4 offset:256
v_mfma_f32_16x16x32_bf16 v[40:43], v[16:19], v[116:119], v[40:43]
s_cbranch_vccz L_sp37
L_ok37:
v_mfma_f32_16x16x32_bf16 v[36:39], v[20:23], v[112:115], v[36:39]
ds_read_b128 v[16:19], v4 offset:8448
v_xor_b32 v4, 147456, v9
v_mfma_f32_16x16x32_bf16 v[44:47], v[20:23], v[116:119], v[44:47]
s_waitcnt lgkmcnt(2)
v_mfma_f32_16x16x32_bf16 v[32:35], v[24:27], v[88:91], v[32:35]
ds_read_b128 v[20:23], v4
v_mfma_f32_16x16x32_bf16 v[40:43], v[24:27], v[92:95], v[40:43]
v_mfma_f32_16x16x32_bf16 v[36:39], v[28:31], v[88:91], v[36:39]
ds_read_b128 v[24:27], v4 offset:8192
v_mfma_f32_16x16x32_bf16 v[44:47], v[28:31], v[92:95], v[44:47]
s_waitcnt lgkmcnt(2)
v_mfma_f32_16x16x32_bf16 v[32:35], v[12:15], v[120:123], v[32:35]
ds_read_b128 v[28:31], v4 offset:256
s_movk_i32 s12, 148
v_mfma_f32_16x16x32_bf16 v[40:43], v[12:15], v[124:127], v[40:43]
v_mfma_f32_16x16x32_bf16 v[36:39], v[16:19], v[120:123], v[36:39]
ds_read_b128 v[12:15], v4 offset:8448
v_xor_b32 v4, 147520, v9
v_mfma_f32_16x16x32_bf16 v[44:47], v[16:19], v[124:127], v[44:47]
s_waitcnt lgkmcnt(2)
v_mfma_f32_16x16x32_bf16 v[48:51], v[20:23], v[64:67], 0
ds_read_b128 v[16:19], v4
v_mfma_f32_16x16x32_bf16 v[56:59], v[20:23], v[68:71], 0
buffer_load_dword off, s[8:11], s12 lds
v_mfma_f32_16x16x32_bf16 v[52:55], v[24:27], v[64:67], 0
ds_read_b128 v[20:23], v4 offset:8192
v_max3_f32 v0, v32, v33, v0
v_mfma_f32_16x16x32_bf16 v[60:63], v[24:27], v[68:71], 0
v_cvt_pk_bf16_f32 v240, v32, v33
s_waitcnt lgkmcnt(2)
v_mfma_f32_16x16x32_bf16 v[48:51], v[28:31], v[96:99], v[48:51]
ds_read_b128 v[24:27], v4 offset:256
v_max3_f32 v2, v40, v41, v2
v_mfma_f32_16x16x32_bf16 v[56:59], v[28:31], v[100:103], v[56:59]
v_cvt_pk_bf16_f32 v244, v40, v41
v_max3_f32 v0, v34, v35, v0
v_mfma_f32_16x16x32_bf16 v[52:55], v[12:15], v[96:99], v[52:55]
ds_read_b128 v[28:31], v4 offset:8448
v_xor_b32 v4, 147584, v9
v_mfma_f32_16x16x32_bf16 v[60:63], v[12:15], v[100:103], v[60:63]
v_cvt_pk_bf16_f32 v241, v34, v35
s_waitcnt lgkmcnt(2)
v_mfma_f32_16x16x32_bf16 v[48:51], v[16:19], v[72:75], v[48:51]
ds_read_b128 v[12:15], v4
v_max3_f32 v2, v42, v43, v2
v_mfma_f32_16x16x32_bf16 v[56:59], v[16:19], v[76:79], v[56:59]
v_cvt_pk_bf16_f32 v245, v42, v43
v_max3_f32 v0, v36, v37, v0
v_mfma_f32_16x16x32_bf16 v[52:55], v[20:23], v[72:75], v[52:55]
ds_read_b128 v[16:19], v4 offset:8192
v_cvt_pk_bf16_f32 v242, v36, v37
v_mfma_f32_16x16x32_bf16 v[60:63], v[20:23], v[76:79], v[60:63]
v_max3_f32 v2, v44, v45, v2
s_waitcnt lgkmcnt(2)
v_mfma_f32_16x16x32_bf16 v[48:51], v[24:27], v[104:107], v[48:51]
ds_read_b128 v[20:23], v4 offset:256
v_cvt_pk_bf16_f32 v246, v44, v45
v_mfma_f32_16x16x32_bf16 v[56:59], v[24:27], v[108:111], v[56:59]
v_max3_f32 v0, v38, v39, v0
v_cvt_pk_bf16_f32 v243, v38, v39
v_mfma_f32_16x16x32_bf16 v[52:55], v[28:31], v[104:107], v[52:55]
ds_read_b128 v[24:27], v4 offset:8448
v_xor_b32 v4, 147648, v9
v_mfma_f32_16x16x32_bf16 v[60:63], v[28:31], v[108:111], v[60:63]
v_max3_f32 v2, v46, v47, v2
s_waitcnt lgkmcnt(2)
v_mfma_f32_16x16x32_bf16 v[48:51], v[12:15], v[80:83], v[48:51]
ds_read_b128 v[28:31], v4
v_cvt_pk_bf16_f32 v247, v46, v47
v_mfma_f32_16x16x32_bf16 v[56:59], v[12:15], v[84:87], v[56:59]
v_mfma_f32_16x16x32_bf16 v[52:55], v[16:19], v[80:83], v[52:55]
ds_read_b128 v[12:15], v4 offset:8192
v_mfma_f32_16x16x32_bf16 v[60:63], v[16:19], v[84:87], v[60:63]
s_waitcnt lgkmcnt(2)
v_mfma_f32_16x16x32_bf16 v[48:51], v[20:23], v[112:115], v[48:51]
ds_read_b128 v[16:19], v4 offset:256
v_mfma_f32_16x16x32_bf16 v[56:59], v[20:23], v[116:119], v[56:59]
v_mfma_f32_16x16x32_bf16 v[52:55], v[24:27], v[112:115], v[52:55]
ds_read_b128 v[20:23], v4 offset:8448
v_xor_b32 v4, 16384, v1
v_mfma_f32_16x16x32_bf16 v[60:63], v[24:27], v[116:119], v[60:63]
s_waitcnt lgkmcnt(2)
v_mfma_f32_16x16x32_bf16 v[48:51], v[28:31], v[88:91], v[48:51]
ds_read_b64_tr_b16 v[24:25], v4
v_mfma_f32_16x16x32_bf16 v[56:59], v[28:31], v[92:95], v[56:59]
ds_read_b64_tr_b16 v[26:27], v4 offset:8192
v_mfma_f32_16x16x32_bf16 v[52:55], v[12:15], v[88:91], v[52:55]
ds_read_b64_tr_b16 v[28:29], v4 offset:256
v_xor_b32 v5, 16416, v1
v_mfma_f32_16x16x32_bf16 v[60:63], v[12:15], v[92:95], v[60:63]
ds_read_b64_tr_b16 v[30:31], v4 offset:8448
s_waitcnt lgkmcnt(4)
v_mfma_f32_16x16x32_bf16 v[48:51], v[16:19], v[120:123], v[48:51]
ds_read_b64_tr_b16 v[12:13], v5
s_movk_i32 s12, 152
v_mfma_f32_16x16x32_bf16 v[56:59], v[16:19], v[124:127], v[56:59]
ds_read_b64_tr_b16 v[14:15], v5 offset:8192
v_mfma_f32_16x16x32_bf16 v[52:55], v[20:23], v[120:123], v[52:55]
ds_read_b64_tr_b16 v[16:17], v5 offset:256
v_xor_b32 v4, 16448, v1
v_mfma_f32_16x16x32_bf16 v[60:63], v[20:23], v[124:127], v[60:63]
ds_read_b64_tr_b16 v[18:19], v5 offset:8448
s_waitcnt lgkmcnt(4)
v_mfma_f32_16x16x32_bf16 a[128:131], v[24:27], a[64:67], a[128:131]
ds_read_b64_tr_b16 v[20:21], v4
ds_read_b64_tr_b16 v[22:23], v4 offset:8192
v_mfma_f32_16x16x32_bf16 a[132:135], v[24:27], a[68:71], a[132:135]
buffer_load_dword off, s[8:11], s12 lds
v_mfma_f32_16x16x32_bf16 a[192:195], v[28:31], a[64:67], a[192:195]
ds_read_b64_tr_b16 v[24:25], v4 offset:256
v_xor_b32 v5, 16480, v1
v_mfma_f32_16x16x32_bf16 a[196:199], v[28:31], a[68:71], a[196:199]
ds_read_b64_tr_b16 v[26:27], v4 offset:8448
v_max3_f32 v0, v48, v49, v0
v_cvt_pk_bf16_f32 v248, v48, v49
v_max3_f32 v2, v56, v57, v2
v_cvt_pk_bf16_f32 v252, v56, v57
v_max3_f32 v0, v50, v51, v0
v_cvt_pk_bf16_f32 v249, v50, v51
v_max3_f32 v2, v58, v59, v2
s_waitcnt lgkmcnt(4)
v_mfma_f32_16x16x32_bf16 a[136:139], v[12:15], a[64:67], a[136:139]
ds_read_b64_tr_b16 v[28:29], v5
v_mov_b32 v8, 0
v_mfma_f32_16x16x32_bf16 a[140:143], v[12:15], a[68:71], a[140:143]
ds_read_b64_tr_b16 v[30:31], v5 offset:8192
v_cvt_pk_bf16_f32 v253, v58, v59
v_max3_f32 v0, v52, v53, v0
v_cvt_pk_bf16_f32 v250, v52, v53
v_max3_f32 v2, v60, v61, v2
v_cvt_pk_bf16_f32 v254, v60, v61
v_max3_f32 v0, v54, v55, v0
v_cvt_pk_bf16_f32 v251, v54, v55
v_max3_f32 v2, v62, v63, v2
v_mfma_f32_16x16x32_bf16 a[200:203], v[16:19], a[64:67], a[200:203]
ds_read_b64_tr_b16 v[12:13], v5 offset:256
v_xor_b32 v4, 16512, v1
v_mfma_f32_16x16x32_bf16 a[204:207], v[16:19], a[68:71], a[204:207]
ds_read_b64_tr_b16 v[14:15], v5 offset:8448
v_cvt_pk_bf16_f32 v255, v62, v63
v_permlane32_swap_b32 v0, v2
v_max_f32 v0, v0, v2
v_mov_b32 v2, v0
s_waitcnt lgkmcnt(4)
v_mfma_f32_16x16x32_bf16 a[144:147], v[20:23], a[64:67], a[144:147]
ds_read_b64_tr_b16 v[16:17], v4
v_permlane16_swap_b32 v0, v2
v_mfma_f32_16x16x32_bf16 a[148:151], v[20:23], a[68:71], a[148:151]
ds_read_b64_tr_b16 v[18:19], v4 offset:8192
v_max_f32 v0, v0, v2
ds_read_b32 v8, v8 offset:14336
v_cvt_pk_bf16_f32 v0, v0, v0
v_lshlrev_b32 v0, 16, v0
v_mul_f32 v0, 0xbdb8aa3b, v0
v_mov_b32 v2, v0
v_mfma_f32_16x16x32_bf16 a[208:211], v[24:27], a[64:67], a[208:211]
ds_read_b64_tr_b16 v[20:21], v4 offset:256
v_xor_b32 v5, 16544, v1
v_mfma_f32_16x16x32_bf16 a[212:215], v[24:27], a[68:71], a[212:215]
ds_read_b64_tr_b16 v[22:23], v4 offset:8448
v_permlane32_swap_b32 v0, v2
v_lshlrev_b32 v6, 16, v128
v_and_b32 v7, s50, v128
v_fma_f32 v6, v6, s48, v0
v_fma_f32 v7, v7, s48, v0
v_exp_f32 v6, v6
s_waitcnt lgkmcnt(5)
v_mfma_f32_16x16x32_bf16 a[152:155], v[28:31], a[64:67], a[152:155]
ds_read_b64_tr_b16 v[24:25], v5
v_exp_f32 v7, v7
v_mfma_f32_16x16x32_bf16 a[156:159], v[28:31], a[68:71], a[156:159]
ds_read_b64_tr_b16 v[26:27], v5 offset:8192
v_lshlrev_b32 v10, 16, v132
v_and_b32 v11, s50, v132
v_cvt_pk_bf16_f32 v128, v6, v7
v_fma_f32 v10, v10, s48, v2
v_fma_f32 v11, v11, s48, v2
v_exp_f32 v10, v10
v_mfma_f32_16x16x32_bf16 a[216:219], v[12:15], a[64:67], a[216:219]
ds_read_b64_tr_b16 v[28:29], v5 offset:256
v_xor_b32 v4, 16576, v1
v_mfma_f32_16x16x32_bf16 a[220:223], v[12:15], a[68:71], a[220:223]
ds_read_b64_tr_b16 v[30:31], v5 offset:8448
v_exp_f32 v11, v11
v_lshlrev_b32 v6, 16, v129
v_and_b32 v7, s50, v129
v_cvt_pk_bf16_f32 v132, v10, v11
v_fma_f32 v6, v6, s48, v0
s_waitcnt lgkmcnt(4)
v_mfma_f32_16x16x32_bf16 a[160:163], v[16:19], a[64:67], a[160:163]
ds_read_b64_tr_b16 v[12:13], v4
v_cmp_le_u32 vcc, 47, v8
v_mfma_f32_16x16x32_bf16 a[164:167], v[16:19], a[68:71], a[164:167]
ds_read_b64_tr_b16 v[14:15], v4 offset:8192
v_fma_f32 v7, v7, s48, v0
v_exp_f32 v6, v6
v_exp_f32 v7, v7
v_lshlrev_b32 v10, 16, v133
v_and_b32 v11, s50, v133
v_cvt_pk_bf16_f32 v129, v6, v7
v_fma_f32 v10, v10, s48, v2
v_mfma_f32_16x16x32_bf16 a[224:227], v[20:23], a[64:67], a[224:227]
ds_read_b64_tr_b16 v[16:17], v4 offset:256
v_xor_b32 v5, 16608, v1
v_mfma_f32_16x16x32_bf16 a[228:231], v[20:23], a[68:71], a[228:231]
ds_read_b64_tr_b16 v[18:19], v4 offset:8448
v_fma_f32 v11, v11, s48, v2
v_exp_f32 v10, v10
v_exp_f32 v11, v11
v_lshlrev_b32 v6, 16, v130
v_and_b32 v7, s50, v130
s_waitcnt lgkmcnt(4)
v_mfma_f32_16x16x32_bf16 a[168:171], v[24:27], a[64:67], a[168:171]
ds_read_b64_tr_b16 v[20:21], v5
v_cvt_pk_bf16_f32 v133, v10, v11
v_mfma_f32_16x16x32_bf16 a[172:175], v[24:27], a[68:71], a[172:175]
ds_read_b64_tr_b16 v[22:23], v5 offset:8192
s_cbranch_vccz L_sp39
L_ok39:
v_fma_f32 v6, v6, s48, v0
v_fma_f32 v7, v7, s48, v0
v_exp_f32 v6, v6
v_exp_f32 v7, v7
v_mfma_f32_16x16x32_bf16 a[232:235], v[28:31], a[64:67], a[232:235]
ds_read_b64_tr_b16 v[24:25], v5 offset:256
v_xor_b32 v4, 32768, v1
v_mfma_f32_16x16x32_bf16 a[236:239], v[28:31], a[68:71], a[236:239]
ds_read_b64_tr_b16 v[26:27], v5 offset:8448
v_lshlrev_b32 v10, 16, v134
v_and_b32 v11, s50, v134
v_cvt_pk_bf16_f32 v130, v6, v7
v_fma_f32 v10, v10, s48, v2
v_fma_f32 v11, v11, s48, v2
v_exp_f32 v10, v10
s_waitcnt lgkmcnt(4)
v_mfma_f32_16x16x32_bf16 a[176:179], v[12:15], a[64:67], a[176:179]
ds_read_b64_tr_b16 v[28:29], v4
v_exp_f32 v11, v11
v_mfma_f32_16x16x32_bf16 a[180:183], v[12:15], a[68:71], a[180:183]
ds_read_b64_tr_b16 v[30:31], v4 offset:8192
v_lshlrev_b32 v6, 16, v131
v_and_b32 v7, s50, v131
v_cvt_pk_bf16_f32 v134, v10, v11
v_fma_f32 v6, v6, s48, v0
v_fma_f32 v7, v7, s48, v0
v_exp_f32 v6, v6
v_mfma_f32_16x16x32_bf16 a[240:243], v[16:19], a[64:67], a[240:243]
ds_read_b64_tr_b16 v[12:13], v4 offset:256
v_xor_b32 v5, 32800, v1
v_mfma_f32_16x16x32_bf16 a[244:247], v[16:19], a[68:71], a[244:247]
ds_read_b64_tr_b16 v[14:15], v4 offset:8448
v_exp_f32 v7, v7
v_lshlrev_b32 v10, 16, v135
v_and_b32 v11, s50, v135
v_cvt_pk_bf16_f32 v131, v6, v7
v_fma_f32 v10, v10, s48, v2
v_fma_f32 v11, v11, s48, v2
s_waitcnt lgkmcnt(4)
v_mfma_f32_16x16x32_bf16 a[184:187], v[20:23], a[64:67], a[184:187]
ds_read_b64_tr_b16 v[16:17], v5
v_exp_f32 v10, v10
v_mfma_f32_16x16x32_bf16 a[188:191], v[20:23], a[68:71], a[188:191]
ds_read_b64_tr_b16 v[18:19], v5 offset:8192
v_exp_f32 v11, v11
s_nop 0
v_cvt_pk_bf16_f32 v135, v10, v11
v_lshlrev_b32 v6, 16, v136
v_and_b32 v7, s50, v136
v_fma_f32 v6, v6, s48, v0
v_fma_f32 v7, v7, s48, v0
v_mfma_f32_16x16x32_bf16 a[248:251], v[24:27], a[64:67], a[248:251]
ds_read_b64_tr_b16 v[20:21], v5 offset:256
v_xor_b32 v4, 32832, v1
v_mfma_f32_16x16x32_bf16 a[252:255], v[24:27], a[68:71], a[252:255]
ds_read_b64_tr_b16 v[22:23], v5 offset:8448
s_waitcnt lgkmcnt(4)
v_mfma_f32_16x16x32_bf16 v[32:35], v[28:31], v[128:131], 0
ds_read_b64_tr_b16 v[24:25], v4
ds_read_b64_tr_b16 v[26:27], v4 offset:8192
v_mfma_f32_16x16x32_bf16 v[36:39], v[28:31], v[132:135], 0
v_exp_f32 v6, v6
v_exp_f32 v7, v7
v_lshlrev_b32 v10, 16, v140
v_and_b32 v11, s50, v140
v_pk_fma_f32 v[10:11], v[10:11], s[48:49], v[2:3] op_sel_hi:[1,0,0]
v_mfma_f32_16x16x32_bf16 v[96:99], v[12:15], v[128:131], 0
ds_read_b64_tr_b16 v[28:29], v4 offset:256
ds_read_b64_tr_b16 v[30:31], v4 offset:8448
v_mfma_f32_16x16x32_bf16 v[100:103], v[12:15], v[132:135], 0
v_xor_b32 v5, 32864, v1
v_cvt_pk_bf16_f32 v136, v6, v7
v_mfma_f32_16x16x32_bf16 a[36:39], a[32:35], v[128:131], 0
s_waitcnt lgkmcnt(4)
v_mfma_f32_16x16x32_bf16 v[40:43], v[16:19], v[128:131], 0
ds_read_b64_tr_b16 v[12:13], v5
ds_read_b64_tr_b16 v[14:15], v5 offset:8192
v_mfma_f32_16x16x32_bf16 v[44:47], v[16:19], v[132:135], 0
v_mov_b32 v8, 0
v_exp_f32 v10, v10
v_exp_f32 v11, v11
v_lshlrev_b32 v6, 16, v137
v_and_b32 v7, s50, v137
v_pk_fma_f32 v[6:7], v[6:7], s[48:49], v[0:1] op_sel_hi:[1,0,0]
v_mfma_f32_16x16x32_bf16 v[104:107], v[20:23], v[128:131], 0
ds_read_b64_tr_b16 v[16:17], v5 offset:256
ds_read_b64_tr_b16 v[18:19], v5 offset:8448
v_mfma_f32_16x16x32_bf16 v[108:111], v[20:23], v[132:135], 0
v_xor_b32 v4, 32896, v1
v_cvt_pk_bf16_f32 v140, v10, v11
v_mfma_f32_16x16x32_bf16 a[40:43], a[32:35], v[132:135], 0
s_waitcnt lgkmcnt(4)
v_mfma_f32_16x16x32_bf16 v[48:51], v[24:27], v[128:131], 0
ds_read_b64_tr_b16 v[20:21], v4
ds_read_b64_tr_b16 v[22:23], v4 offset:8192
v_mfma_f32_16x16x32_bf16 v[52:55], v[24:27], v[132:135], 0
ds_read_b32 v8, v8 offset:14336
v_exp_f32 v6, v6
v_exp_f32 v7, v7
v_lshlrev_b32 v10, 16, v141
v_and_b32 v11, s50, v141
v_pk_fma_f32 v[10:11], v[10:11], s[48:49], v[2:3] op_sel_hi:[1,0,0]
v_mfma_f32_16x16x32_bf16 v[112:115], v[28:31], v[128:131], 0
ds_read_b64_tr_b16 v[24:25], v4 offset:256
ds_read_b64_tr_b16 v[26:27], v4 offset:8448
v_mfma_f32_16x16x32_bf16 v[116:119], v[28:31], v[132:135], 0
v_xor_b32 v5, 32928, v1
v_cvt_pk_bf16_f32 v137, v6, v7
s_waitcnt lgkmcnt(5)
v_mfma_f32_16x16x32_bf16 v[56:59], v[12:15], v[128:131], 0
ds_read_b64_tr_b16 v[28:29], v5
ds_read_b64_tr_b16 v[30:31], v5 offset:8192
v_mfma_f32_16x16x32_bf16 v[60:63], v[12:15], v[132:135], 0
v_exp_f32 v10, v10
v_exp_f32 v11, v11
v_lshlrev_b32 v6, 16, v138
v_and_b32 v7, s50, v138
v_pk_fma_f32 v[6:7], v[6:7], s[48:49], v[0:1] op_sel_hi:[1,0,0]
v_mfma_f32_16x16x32_bf16 v[120:123], v[16:19], v[128:131], 0
ds_read_b64_tr_b16 v[12:13], v5 offset:256
ds_read_b64_tr_b16 v[14:15], v5 offset:8448
v_mfma_f32_16x16x32_bf16 v[124:127], v[16:19], v[132:135], 0
v_xor_b32 v4, 32960, v1
v_cvt_pk_bf16_f32 v141, v10, v11
s_waitcnt lgkmcnt(4)
v_mfma_f32_16x16x32_bf16 v[64:67], v[20:23], v[128:131], 0
ds_read_b64_tr_b16 v[16:17], v4
ds_read_b64_tr_b16 v[18:19], v4 offset:8192
v_mfma_f32_16x16x32_bf16 v[68:71], v[20:23], v[132:135], 0
v_cmp_le_u32 vcc, 49, v8
v_exp_f32 v6, v6
v_exp_f32 v7, v7
v_lshlrev_b32 v10, 16, v142
v_and_b32 v11, s50, v142
v_pk_fma_f32 v[10:11], v[10:11], s[48:49], v[2:3] op_sel_hi:[1,0,0]
v_mfma_f32_16x16x32_bf16 a[0:3], v[24:27], v[128:131], 0
ds_read_b64_tr_b16 v[20:21], v4 offset:256
ds_read_b64_tr_b16 v[22:23], v4 offset:8448
v_mfma_f32_16x16x32_bf16 a[4:7], v[24:27], v[132:135], 0
v_xor_b32 v5, 32992, v1
v_cvt_pk_bf16_f32 v138, v6, v7
s_waitcnt lgkmcnt(4)
v_mfma_f32_16x16x32_bf16 v[72:75], v[28:31], v[128:131], 0
ds_read_b64_tr_b16 v[24:25], v5
ds_read_b64_tr_b16 v[26:27], v5 offset:8192
v_mfma_f32_16x16x32_bf16 v[76:79], v[28:31], v[132:135], 0
s_cbranch_vccz L_sp40
L_ok40:
v_exp_f32 v10, v10
v_exp_f32 v11, v11
v_lshlrev_b32 v6, 16, v139
v_and_b32 v7, s50, v139
v_pk_fma_f32 v[6:7], v[6:7], s[48:49], v[0:1] op_sel_hi:[1,0,0]
v_mfma_f32_16x16x32_bf16 a[8:11], v[12:15], v[128:131], 0
ds_read_b64_tr_b16 v[28:29], v5 offset:256
ds_read_b64_tr_b16 v[30:31], v5 offset:8448
v_mfma_f32_16x16x32_bf16 a[12:15], v[12:15], v[132:135], 0
v_xor_b32 v4, 65536, v1
v_cvt_pk_bf16_f32 v142, v10, v11
s_waitcnt lgkmcnt(4)
v_mfma_f32_16x16x32_bf16 v[80:83], v[16:19], v[128:131], 0
ds_read_b64_tr_b16 v[12:13], v4
ds_read_b64_tr_b16 v[14:15], v4 offset:8192
v_mfma_f32_16x16x32_bf16 v[84:87], v[16:19], v[132:135], 0
v_exp_f32 v6, v6
v_exp_f32 v7, v7
v_lshlrev_b32 v10, 16, v143
v_and_b32 v11, s50, v143
v_pk_fma_f32 v[10:11], v[10:11], s[48:49], v[2:3] op_sel_hi:[1,0,0]
v_mfma_f32_16x16x32_bf16 a[16:19], v[20:23], v[128:131], 0
ds_read_b64_tr_b16 v[16:17], v4 offset:256
ds_read_b64_tr_b16 v[18:19], v4 offset:8448
v_mfma_f32_16x16x32_bf16 a[20:23], v[20:23], v[132:135], 0
v_xor_b32 v5, 65568, v1
v_cvt_pk_bf16_f32 v139, v6, v7
s_waitcnt lgkmcnt(4)
v_mfma_f32_16x16x32_bf16 v[88:91], v[24:27], v[128:131], 0
ds_read_b64_tr_b16 v[20:21], v5
ds_read_b64_tr_b16 v[22:23], v5 offset:8192
v_mfma_f32_16x16x32_bf16 v[92:95], v[24:27], v[132:135], 0
s_movk_i32 s12, 160
v_exp_f32 v10, v10
v_exp_f32 v11, v11
v_lshlrev_b32 v6, 16, v144
v_and_b32 v7, s50, v144
v_pk_fma_f32 v[6:7], v[6:7], s[48:49], v[0:1] op_sel_hi:[1,0,0]
v_mfma_f32_16x16x32_bf16 a[24:27], v[28:31], v[128:131], 0
s_branch L_pg7
L_sp42:
v_mov_b32 v8, 0
ds_read_b32 v8, v8 offset:14336
s_waitcnt lgkmcnt(0)
v_cmp_le_u32 vcc, 50, v8
s_cbranch_vccz L_sp42
s_branch L_ok42
L_sp43:
v_mov_b32 v8, 0
ds_read_b32 v8, v8 offset:14336
s_waitcnt lgkmcnt(0)
v_cmp_le_u32 vcc, 51, v8
s_cbranch_vccz L_sp43
s_branch L_ok43
L_sp44:
v_mov_b32 v8, 0
ds_read_b32 v8, v8 offset:14336
s_waitcnt lgkmcnt(0)
v_cmp_le_u32 vcc, 53, v8
s_cbranch_vccz L_sp44
s_branch L_ok44
.p2align 12
L_stub7:
s_setpc_b64 s[94:95]
L_pg7:
ds_read_b64_tr_b16 v[24:25], v5 offset:256
ds_read_b64_tr_b16 v[26:27], v5 offset:8448
v_mfma_f32_16x16x32_bf16 a[28:31], v[28:31], v[132:135], 0
v_xor_b32 v4, 65600, v1
v_cvt_pk_bf16_f32 v143, v10, v11
s_waitcnt lgkmcnt(4)
v_mfma_f32_16x16x32_bf16 v[32:35], v[12:15], v[136:139], v[32:35]
ds_read_b64_tr_b16 v[28:29], v4
ds_read_b64_tr_b16 v[30:31], v4 offset:8192
v_mfma_f32_16x16x32_bf16 v[36:39], v[12:15], v[140:143], v[36:39]
buffer_load_dword off, s[8:11], s12 lds
v_exp_f32 v6, v6
v_exp_f32 v7, v7
v_lshlrev_b32 v10, 16, v148
v_and_b32 v11, s50, v148
v_pk_fma_f32 v[10:11], v[10:11], s[48:49], v[2:3] op_sel_hi:[1,0,0]
v_mfma_f32_16x16x32_bf16 v[96:99], v[16:19], v[136:139], v[96:99]
ds_read_b64_tr_b16 v[12:13], v4 offset:256
ds_read_b64_tr_b16 v[14:15], v4 offset:8448
v_mfma_f32_16x16x32_bf16 v[100:103], v[16:19], v[140:143], v[100:103]
v_xor_b32 v5, 65632, v1
v_cvt_pk_bf16_f32 v144, v6, v7
v_mfma_f32_16x16x32_bf16 a[36:39], a[32:35], v[136:139], a[36:39]
s_waitcnt lgkmcnt(4)
v_mfma_f32_16x16x32_bf16 v[40:43], v[20:23], v[136:139], v[40:43]
ds_read_b64_tr_b16 v[16:17], v5
ds_read_b64_tr_b16 v[18:19], v5 offset:8192
v_mfma_f32_16x16x32_bf16 v[44:47], v[20:23], v[140:143], v[44:47]
v_exp_f32 v10, v10
v_exp_f32 v11, v11
v_lshlrev_b32 v6, 16, v145
v_and_b32 v7, s50, v145
v_pk_fma_f32 v[6:7], v[6:7], s[48:49], v[0:1] op_sel_hi:[1,0,0]
v_mfma_f32_16x16x32_bf16 v[104:107], v[24:27], v[136:139], v[104:107]
ds_read_b64_tr_b16 v[20:21], v5 offset:256
ds_read_b64_tr_b16 v[22:23], v5 offset:8448
v_mfma_f32_16x16x32_bf16 v[108:111], v[24:27], v[140:143], v[108:111]
v_xor_b32 v4, 65664, v1
v_cvt_pk_bf16_f32 v148, v10, v11
v_mfma_f32_16x16x32_bf16 a[40:43], a[32:35], v[140:143], a[40:43]
s_waitcnt lgkmcnt(4)
v_mfma_f32_16x16x32_bf16 v[48:51], v[28:31], v[136:139], v[48:51]
ds_read_b64_tr_b16 v[24:25], v4
ds_read_b64_tr_b16 v[26:27], v4 offset:8192
v_mfma_f32_16x16x32_bf16 v[52:55], v[28:31], v[140:143], v[52:55]
v_exp_f32 v6, v6
v_exp_f32 v7, v7
v_lshlrev_b32 v10, 16, v149
v_and_b32 v11, s50, v149
v_pk_fma_f32 v[10:11], v[10:11], s[48:49], v[2:3] op_sel_hi:[1,0,0]
v_xor_b32 v128, 0, v1
v_mfma_f32_16x16x32_bf16 v[112:115], v[12:15], v[136:139], v[112:115]
ds_read_b64_tr_b16 v[28:29], v4 offset:256
ds_read_b64_tr_b16 v[30:31], v4 offset:8448
v_mfma_f32_16x16x32_bf16 v[116:119], v[12:15], v[140:143], v[116:119]
v_xor_b32 v5, 65696, v1
v_cvt_pk_bf16_f32 v145, v6, v7
s_waitcnt lgkmcnt(4)
v_mfma_f32_16x16x32_bf16 v[56:59], v[16:19], v[136:139], v[56:59]
ds_read_b64_tr_b16 v[12:13], v5
ds_read_b64_tr_b16 v[14:15], v5 offset:8192
v_mfma_f32_16x16x32_bf16 v[60:63], v[16:19], v[140:143], v[60:63]
v_exp_f32 v10, v10
v_exp_f32 v11, v11
v_lshlrev_b32 v6, 16, v146
v_and_b32 v7, s50, v146
v_pk_fma_f32 v[6:7], v[6:7], s[48:49], v[0:1] op_sel_hi:[1,0,0]
v_mfma_f32_16x16x32_bf16 v[120:123], v[20:23], v[136:139], v[120:123]
ds_read_b64_tr_b16 v[16:17], v5 offset:256
ds_read_b64_tr_b16 v[18:19], v5 offset:8448
v_mfma_f32_16x16x32_bf16 v[124:127], v[20:23], v[140:143], v[124:127]
v_xor_b32 v4, 65728, v1
v_cvt_pk_bf16_f32 v149, v10, v11
s_waitcnt lgkmcnt(4)
v_mfma_f32_16x16x32_bf16 v[64:67], v[24:27], v[136:139], v[64:67]
ds_read_b64_tr_b16 v[20:21], v4
ds_read_b64_tr_b16 v[22:23], v4 offset:8192
v_mfma_f32_16x16x32_bf16 v[68:71], v[24:27], v[140:143], v[68:71]
v_exp_f32 v6, v6
v_exp_f32 v7, v7
v_lshlrev_b32 v10, 16, v150
v_and_b32 v11, s50, v150
v_pk_fma_f32 v[10:11], v[10:11], s[48:49], v[2:3] op_sel_hi:[1,0,0]
v_mfma_f32_16x16x32_bf16 a[0:3], v[28:31], v[136:139], a[0:3]
ds_read_b64_tr_b16 v[24:25], v4 offset:256
ds_read_b64_tr_b16 v[26:27], v4 offset:8448
v_mfma_f32_16x16x32_bf16 a[4:7], v[28:31], v[140:143], a[4:7]
v_xor_b32 v5, 65760, v1
v_cvt_pk_bf16_f32 v146, v6, v7
s_waitcnt lgkmcnt(4)
v_mfma_f32_16x16x32_bf16 v[72:75], v[12:15], v[136:139], v[72:75]
ds_read_b64_tr_b16 v[28:29], v5
ds_read_b64_tr_b16 v[30:31], v5 offset:8192
v_mfma_f32_16x16x32_bf16 v[76:79], v[12:15], v[140:143], v[76:79]
v_exp_f32 v10, v10
v_exp_f32 v11, v11
v_lshlrev_b32 v6, 16, v147
v_and_b32 v7, s50, v147
v_pk_fma_f32 v[6:7], v[6:7], s[48:49], v[0:1] op_sel_hi:[1,0,0]
v_mfma_f32_16x16x32_bf16 a[8:11], v[16:19], v[136:139], a[8:11]
ds_read_b64_tr_b16 v[12:13], v5 offset:256
ds_read_b64_tr_b16 v[14:15], v5 offset:8448
v_mfma_f32_16x16x32_bf16 a[12:15], v[16:19], v[140:143], a[12:15]
v_xor_b32 v4, 49152, v1
v_cvt_pk_bf16_f32 v150, v10, v11
v_xor_b32 v129, 32, v1
s_waitcnt lgkmcnt(4)
v_mfma_f32_16x16x32_bf16 v[80:83], v[20:23], v[136:139], v[80:83]
ds_read_b64_tr_b16 v[16:17], v4
ds_read_b64_tr_b16 v[18:19], v4 offset:8192
v_mfma_f32_16x16x32_bf16 v[84:87], v[20:23], v[140:143], v[84:87]
v_exp_f32 v6, v6
v_mfma_f32_16x16x32_bf16 a[16:19], v[24:27], v[136:139], a[16:19]
ds_read_b64_tr_b16 v[20:21], v4 offset:256
ds_read_b64_tr_b16 v[22:23], v4 offset:8448
v_mfma_f32_16x16x32_bf16 a[20:23], v[24:27], v[140:143], a[20:23]
v_xor_b32 v5, 49184, v1
s_waitcnt lgkmcnt(4)
v_mfma_f32_16x16x32_bf16 v[88:91], v[28:31], v[136:139], v[88:91]
ds_read_b64_tr_b16 v[24:25], v5
ds_read_b64_tr_b16 v[26:27], v5 offset:8192
v_mfma_f32_16x16x32_bf16 v[92:95], v[28:31], v[140:143], v[92:95]
s_movk_i32 s12, 164
v_exp_f32 v7, v7
v_mfma_f32_16x16x32_bf16 a[24:27], v[12:15], v[136:139], a[24:27]
ds_read_b64_tr_b16 v[28:29], v5 offset:256
ds_read_b64_tr_b16 v[30:31], v5 offset:8448
v_mfma_f32_16x16x32_bf16 a[28:31], v[12:15], v[140:143], a[28:31]
v_xor_b32 v4, 49216, v1
s_waitcnt lgkmcnt(4)
v_mfma_f32_16x16x32_bf16 a[128:131], v[16:19], a[72:75], a[128:131]
ds_read_b64_tr_b16 v[12:13], v4
v_lshlrev_b32 v10, 16, v151
v_mfma_f32_16x16x32_bf16 a[132:135], v[16:19], a[76:79], a[132:135]
ds_read_b64_tr_b16 v[14:15], v4 offset:8192
buffer_load_dword off, s[8:11], s12 lds
v_mfma_f32_16x16x32_bf16 a[192:195], v[20:23], a[72:75], a[192:195]
ds_read_b64_tr_b16 v[16:17], v4 offset:256
v_xor_b32 v5, 49248, v1
v_mfma_f32_16x16x32_bf16 a[196:199], v[20:23], a[76:79], a[196:199]
ds_read_b64_tr_b16 v[18:19], v4 offset:8448
s_waitcnt lgkmcnt(4)
v_mfma_f32_16x16x32_bf16 a[136:139], v[24:27], a[72:75], a[136:139]
ds_read_b64_tr_b16 v[20:21], v5
v_mov_b32 v8, 0
v_mfma_f32_16x16x32_bf16 a[140:143], v[24:27], a[76:79], a[140:143]
ds_read_b64_tr_b16 v[22:23], v5 offset:8192
v_and_b32 v11, s50, v151
v_xor_b32 v130, 64, v1
v_mfma_f32_16x16x32_bf16 a[200:203], v[28:31], a[72:75], a[200:203]
ds_read_b64_tr_b16 v[24:25], v5 offset:256
v_xor_b32 v4, 49280, v1
v_mfma_f32_16x16x32_bf16 a[204:207], v[28:31], a[76:79], a[204:207]
ds_read_b64_tr_b16 v[26:27], v5 offset:8448
v_cvt_pk_bf16_f32 v147, v6, v7
v_xor_b32 v136, 65536, v1
s_waitcnt lgkmcnt(4)
v_mfma_f32_16x16x32_bf16 a[144:147], v[12:15], a[72:75], a[144:147]
ds_read_b64_tr_b16 v[28:29], v4
v_fma_f32 v10, v10, s48, v2
v_mfma_f32_16x16x32_bf16 a[148:151], v[12:15], a[76:79], a[148:151]
ds_read_b64_tr_b16 v[30:31], v4 offset:8192
ds_read_b32 v8, v8 offset:14336
v_mfma_f32_16x16x32_bf16 a[208:211], v[16:19], a[72:75], a[208:211]
ds_read_b64_tr_b16 v[12:13], v4 offset:256
v_xor_b32 v5, 49312, v1
v_mfma_f32_16x16x32_bf16 a[212:215], v[16:19], a[76:79], a[212:215]
ds_read_b64_tr_b16 v[14:15], v4 offset:8448
s_waitcnt lgkmcnt(5)
v_mfma_f32_16x16x32_bf16 a[152:155], v[20:23], a[72:75], a[152:155]
ds_read_b64_tr_b16 v[16:17], v5
v_fma_f32 v11, v11, s48, v2
v_mfma_f32_16x16x32_bf16 a[156:159], v[20:23], a[76:79], a[156:159]
ds_read_b64_tr_b16 v[18:19], v5 offset:8192
v_exp_f32 v10, v10
v_mfma_f32_16x16x32_bf16 a[216:219], v[24:27], a[72:75], a[216:219]
ds_read_b64_tr_b16 v[20:21], v5 offset:256
v_xor_b32 v4, 49344, v1
v_mfma_f32_16x16x32_bf16 a[220:223], v[24:27], a[76:79], a[220:223]
ds_read_b64_tr_b16 v[22:23], v5 offset:8448
s_waitcnt lgkmcnt(4)
v_mfma_f32_16x16x32_bf16 a[160:163], v[28:31], a[72:75], a[160:163]
ds_read_b64_tr_b16 v[24:25], v4
v_cmp_le_u32 vcc, 50, v8
v_mfma_f32_16x16x32_bf16 a[164:167], v[28:31], a[76:79], a[164:167]
ds_read_b64_tr_b16 v[26:27], v4 offset:8192
v_exp_f32 v11, v11
v_xor_b32 v137, 65568, v1
v_mfma_f32_16x16x32_bf16 a[224:227], v[12:15], a[72:75], a[224:227]
ds_read_b64_tr_b16 v[28:29], v4 offset:256
v_xor_b32 v5, 49376, v1
v_mfma_f32_16x16x32_bf16 a[228:231], v[12:15], a[76:79], a[228:231]
ds_read_b64_tr_b16 v[30:31], v4 offset:8448
v_xor_b32 v131, 96, v1
s_waitcnt lgkmcnt(4)
v_mfma_f32_16x16x32_bf16 a[168:171], v[16:19], a[72:75], a[168:171]
ds_read_b64_tr_b16 v[12:13], v5
ds_read_b64_tr_b16 v[14:15], v5 offset:8192
v_mfma_f32_16x16x32_bf16 a[172:175], v[16:19], a[76:79], a[172:175]
s_cbranch_vccz L_sp42
L_ok42:
v_mfma_f32_16x16x32_bf16 a[232:235], v[20:23], a[72:75], a[232:235]
ds_read_b64_tr_b16 v[16:17], v5 offset:256
v_xor_b32 v4, 114688, v1
v_mfma_f32_16x16x32_bf16 a[236:239], v[20:23], a[76:79], a[236:239]
ds_read_b64_tr_b16 v[18:19], v5 offset:8448
s_waitcnt lgkmcnt(4)
v_mfma_f32_16x16x32_bf16 a[176:179], v[24:27], a[72:75], a[176:179]
ds_read_b64_tr_b16 v[20:21], v4
v_lshlrev_b32 v6, 16, v152
v_mfma_f32_16x16x32_bf16 a[180:183], v[24:27], a[76:79], a[180:183]
ds_read_b64_tr_b16 v[22:23], v4 offset:8192
v_and_b32 v7, s50, v152
v_mfma_f32_16x16x32_bf16 a[240:243], v[28:31], a[72:75], a[240:243]
ds_read_b64_tr_b16 v[24:25], v4 offset:256
v_xor_b32 v5, 114720, v1
v_mfma_f32_16x16x32_bf16 a[244:247], v[28:31], a[76:79], a[244:247]
ds_read_b64_tr_b16 v[26:27], v4 offset:8448
v_cvt_pk_bf16_f32 v151, v10, v11
v_xor_b32 v138, 65600, v1
s_waitcnt lgkmcnt(4)
v_mfma_f32_16x16x32_bf16 a[184:187], v[12:15], a[72:75], a[184:187]
ds_read_b64_tr_b16 v[28:29], v5
v_fma_f32 v6, v6, s48, v0
v_mfma_f32_16x16x32_bf16 a[188:191], v[12:15], a[76:79], a[188:191]
ds_read_b64_tr_b16 v[30:31], v5 offset:8192
v_fma_f32 v7, v7, s48, v0
v_mfma_f32_16x16x32_bf16 a[248:251], v[16:19], a[72:75], a[248:251]
ds_read_b64_tr_b16 v[12:13], v5 offset:256
v_xor_b32 v4, 114752, v1
v_mfma_f32_16x16x32_bf16 a[252:255], v[16:19], a[76:79], a[252:255]
ds_read_b64_tr_b16 v[14:15], v5 offset:8448
s_waitcnt lgkmcnt(4)
v_mfma_f32_16x16x32_bf16 v[32:35], v[20:23], v[144:147], v[32:35]
ds_read_b64_tr_b16 v[16:17], v4
ds_read_b64_tr_b16 v[18:19], v4 offset:8192
v_mfma_f32_16x16x32_bf16 v[36:39], v[20:23], v[148:151], v[36:39]
v_exp_f32 v6, v6
v_exp_f32 v7, v7
v_lshlrev_b32 v10, 16, v156
v_and_b32 v11, s50, v156
v_pk_fma_f32 v[10:11], v[10:11], s[48:49], v[2:3] op_sel_hi:[1,0,0]
v_mfma_f32_16x16x32_bf16 v[96:99], v[24:27], v[144:147], v[96:99]
ds_read_b64_tr_b16 v[20:21], v4 offset:256
ds_read_b64_tr_b16 v[22:23], v4 offset:8448
v_mfma_f32_16x16x32_bf16 v[100:103], v[24:27], v[148:151], v[100:103]
v_xor_b32 v5, 114784, v1
v_cvt_pk_bf16_f32 v152, v6, v7
v_mfma_f32_16x16x32_bf16 a[36:39], a[32:35], v[144:147], a[36:39]
v_xor_b32 v132, 128, v1
s_waitcnt lgkmcnt(4)
v_mfma_f32_16x16x32_bf16 v[40:43], v[28:31], v[144:147], v[40:43]
ds_read_b64_tr_b16 v[24:25], v5
ds_read_b64_tr_b16 v[26:27], v5 offset:8192
v_mfma_f32_16x16x32_bf16 v[44:47], v[28:31], v[148:151], v[44:47]
v_mov_b32 v8, 0
v_exp_f32 v10, v10
v_exp_f32 v11, v11
v_lshlrev_b32 v6, 16, v153
v_and_b32 v7, s50, v153
v_pk_fma_f32 v[6:7], v[6:7], s[48:49], v[0:1] op_sel_hi:[1,0,0]
v_xor_b32 v139, 65632, v1
v_mfma_f32_16x16x32_bf16 v[104:107], v[12:15], v[144:147], v[104:107]
ds_read_b64_tr_b16 v[28:29], v5 offset:256
ds_read_b64_tr_b16 v[30:31], v5 offset:8448
v_mfma_f32_16x16x32_bf16 v[108:111], v[12:15], v[148:151], v[108:111]
v_xor_b32 v4, 114816, v1
v_cvt_pk_bf16_f32 v156, v10, v11
v_mfma_f32_16x16x32_bf16 a[40:43], a[32:35], v[148:151], a[40:43]
s_waitcnt lgkmcnt(4)
v_mfma_f32_16x16x32_bf16 v[48:51], v[16:19], v[144:147], v[48:51]
ds_read_b64_tr_b16 v[12:13], v4
ds_read_b64_tr_b16 v[14:15], v4 offset:8192
v_mfma_f32_16x16x32_bf16 v[52:55], v[16:19], v[148:151], v[52:55]
ds_read_b32 v8, v8 offset:14336
v_exp_f32 v6, v6
v_exp_f32 v7, v7
v_lshlrev_b32 v10, 16, v157
v_and_b32 v11, s50, v157
v_pk_fma_f32 v[10:11], v[10:11], s[48:49], v[2:3] op_sel_hi:[1,0,0]
v_mfma_f32_16x16x32_bf16 v[112:115], v[20:23], v[144:147], v[112:115]
ds_read_b64_tr_b16 v[16:17], v4 offset:256
ds_read_b64_tr_b16 v[18:19], v4 offset:8448
v_mfma_f32_16x16x32_bf16 v[116:119], v[20:23], v[148:151], v[116:119]
v_xor_b32 v5, 114848, v1
v_cvt_pk_bf16_f32 v153, v6, v7
s_waitcnt lgkmcnt(5)
v_mfma_f32_16x16x32_bf16 v[56:59], v[24:27], v[144:147], v[56:59]
ds_read_b64_tr_b16 v[20:21], v5
ds_read_b64_tr_b16 v[22:23], v5 offset:8192
v_mfma_f32_16x16x32_bf16 v[60:63], v[24:27], v[148:151], v[60:63]
v_exp_f32 v10, v10
v_exp_f32 v11, v11
v_lshlrev_b32 v6, 16, v154
v_and_b32 v7, s50, v154
v_pk_fma_f32 v[6:7], v[6:7], s[48:49], v[0:1] op_sel_hi:[1,0,0]
v_mfma_f32_16x16x32_bf16 v[120:123], v[28:31], v[144:147], v[120:123]
ds_read_b64_tr_b16 v[24:25], v5 offset:256
ds_read_b64_tr_b16 v[26:27], v5 offset:8448
v_mfma_f32_16x16x32_bf16 v[124:127], v[28:31], v[148:151], v[124:127]
v_xor_b32 v4, 114880, v1
v_cvt_pk_bf16_f32 v157, v10, v11
s_waitcnt lgkmcnt(4)
v_mfma_f32_16x16x32_bf16 v[64:67], v[12:15], v[144:147], v[64:67]
ds_read_b64_tr_b16 v[28:29], v4
ds_read_b64_tr_b16 v[30:31], v4 offset:8192
v_mfma_f32_16x16x32_bf16 v[68:71], v[12:15], v[148:151], v[68:71]
v_cmp_le_u32 vcc, 51, v8
v_exp_f32 v6, v6
v_exp_f32 v7, v7
v_lshlrev_b32 v10, 16, v158
v_and_b32 v11, s50, v158
v_pk_fma_f32 v[10:11], v[10:11], s[48:49], v[2:3] op_sel_hi:[1,0,0]
v_xor_b32 v133, 160, v1
v_xor_b32 v140, 65664, v1
v_mfma_f32_16x16x32_bf16 a[0:3], v[16:19], v[144:147], a[0:3]
ds_read_b64_tr_b16 v[12:13], v4 offset:256
ds_read_b64_tr_b16 v[14:15], v4 offset:8448
v_mfma_f32_16x16x32_bf16 a[4:7], v[16:19], v[148:151], a[4:7]
v_xor_b32 v5, 114912, v1
v_cvt_pk_bf16_f32 v154, v6, v7
s_waitcnt lgkmcnt(4)
v_mfma_f32_16x16x32_bf16 v[72:75], v[20:23], v[144:147], v[72:75]
ds_read_b64_tr_b16 v[16:17], v5
ds_read_b64_tr_b16 v[18:19], v5 offset:8192
v_mfma_f32_16x16x32_bf16 v[76:79], v[20:23], v[148:151], v[76:79]
s_cbranch_vccz L_sp43
L_ok43:
v_exp_f32 v10, v10
v_exp_f32 v11, v11
v_lshlrev_b32 v6, 16, v155
v_and_b32 v7, s50, v155
v_pk_fma_f32 v[6:7], v[6:7], s[48:49], v[0:1] op_sel_hi:[1,0,0]
v_mfma_f32_16x16x32_bf16 a[8:11], v[24:27], v[144:147], a[8:11]
ds_read_b64_tr_b16 v[20:21], v5 offset:256
ds_read_b64_tr_b16 v[22:23], v5 offset:8448
v_mfma_f32_16x16x32_bf16 a[12:15], v[24:27], v[148:151], a[12:15]
v_xor_b32 v4, 131072, v1
v_cvt_pk_bf16_f32 v158, v10, v11
s_waitcnt lgkmcnt(4)
v_mfma_f32_16x16x32_bf16 v[80:83], v[28:31], v[144:147], v[80:83]
ds_read_b64_tr_b16 v[24:25], v4
ds_read_b64_tr_b16 v[26:27], v4 offset:8192
v_mfma_f32_16x16x32_bf16 v[84:87], v[28:31], v[148:151], v[84:87]
v_exp_f32 v6, v6
v_exp_f32 v7, v7
v_lshlrev_b32 v10, 16, v159
v_and_b32 v11, s50, v159
v_pk_fma_f32 v[10:11], v[10:11], s[48:49], v[2:3] op_sel_hi:[1,0,0]
v_mfma_f32_16x16x32_bf16 a[16:19], v[12:15], v[144:147], a[16:19]
ds_read_b64_tr_b16 v[28:29], v4 offset:256
ds_read_b64_tr_b16 v[30:31], v4 offset:8448
v_mfma_f32_16x16x32_bf16 a[20:23], v[12:15], v[148:151], a[20:23]
v_xor_b32 v5, 131104, v1
v_cvt_pk_bf16_f32 v155, v6, v7
v_xor_b32 v141, 65696, v1
s_waitcnt lgkmcnt(4)
v_mfma_f32_16x16x32_bf16 v[88:91], v[16:19], v[144:147], v[88:91]
ds_read_b64_tr_b16 v[12:13], v5
ds_read_b64_tr_b16 v[14:15], v5 offset:8192
v_mfma_f32_16x16x32_bf16 v[92:95], v[16:19], v[148:151], v[92:95]
s_movk_i32 s12, 172
v_exp_f32 v10, v10
v_exp_f32 v11, v11
v_lshlrev_b32 v6, 16, v160
v_and_b32 v7, s50, v160
v_pk_fma_f32 v[6:7], v[6:7], s[48:49], v[0:1] op_sel_hi:[1,0,0]
v_mfma_f32_16x16x32_bf16 a[24:27], v[20:23], v[144:147], a[24:27]
ds_read_b64_tr_b16 v[16:17], v5 offset:256
ds_read_b64_tr_b16 v[18:19], v5 offset:8448
v_mfma_f32_16x16x32_bf16 a[28:31], v[20:23], v[148:151], a[28:31]
v_xor_b32 v4, 131136, v1
v_cvt_pk_bf16_f32 v159, v10, v11
v_xor_b32 v134, 192, v1
s_waitcnt lgkmcnt(4)
v_mfma_f32_16x16x32_bf16 v[32:35], v[24:27], v[152:155], v[32:35]
ds_read_b64_tr_b16 v[20:21], v4
ds_read_b64_tr_b16 v[22:23], v4 offset:8192
v_mfma_f32_16x16x32_bf16 v[36:39], v[24:27], v[156:159], v[36:39]
buffer_load_dword off, s[8:11], s12 lds
v_exp_f32 v6, v6
v_exp_f32 v7, v7
v_lshlrev_b32 v10, 16, v164
v_and_b32 v11, s50, v164
v_pk_fma_f32 v[10:11], v[10:11], s[48:49], v[2:3] op_sel_hi:[1,0,0]
v_mfma_f32_16x16x32_bf16 v[96:99], v[28:31], v[152:155], v[96:99]
ds_read_b64_tr_b16 v[24:25], v4 offset:256
ds_read_b64_tr_b16 v[26:27], v4 offset:8448
v_mfma_f32_16x16x32_bf16 v[100:103], v[28:31], v[156:159], v[100:103]
v_xor_b32 v5, 131168, v1
v_cvt_pk_bf16_f32 v160, v6, v7
v_mfma_f32_16x16x32_bf16 a[36:39], a[32:35], v[152:155], a[36:39]
v_xor_b32 v144, 131072, v1
s_waitcnt lgkmcnt(4)
v_mfma_f32_16x16x32_bf16 v[40:43], v[12:15], v[152:155], v[40:43]
ds_read_b64_tr_b16 v[28:29], v5
ds_read_b64_tr_b16 v[30:31], v5 offset:8192
v_mfma_f32_16x16x32_bf16 v[44:47], v[12:15], v[156:159], v[44:47]
v_mov_b32 v8, 0
v_exp_f32 v10, v10
v_exp_f32 v11, v11
v_lshlrev_b32 v6, 16, v161
v_and_b32 v7, s50, v161
v_pk_fma_f32 v[6:7], v[6:7], s[48:49], v[0:1] op_sel_hi:[1,0,0]
v_xor_b32 v142, 65728, v1
v_xor_b32 v145, 131104, v1
v_mfma_f32_16x16x32_bf16 v[104:107], v[16:19], v[152:155], v[104:107]
ds_read_b64_tr_b16 v[12:13], v5 offset:256
ds_read_b64_tr_b16 v[14:15], v5 offset:8448
v_mfma_f32_16x16x32_bf16 v[108:111], v[16:19], v[156:159], v[108:111]
v_xor_b32 v4, 131200, v1
v_cvt_pk_bf16_f32 v164, v10, v11
v_mfma_f32_16x16x32_bf16 a[40:43], a[32:35], v[156:159], a[40:43]
v_xor_b32 v146, 131136, v1
s_waitcnt lgkmcnt(4)
v_mfma_f32_16x16x32_bf16 v[48:51], v[20:23], v[152:155], v[48:51]
ds_read_b64_tr_b16 v[16:17], v4
ds_read_b64_tr_b16 v[18:19], v4 offset:8192
v_mfma_f32_16x16x32_bf16 v[52:55], v[20:23], v[156:159], v[52:55]
ds_read_b32 v8, v8 offset:14336
v_exp_f32 v6, v6
v_exp_f32 v7, v7
v_lshlrev_b32 v10, 16, v165
v_and_b32 v11, s50, v165
v_pk_fma_f32 v[10:11], v[10:11], s[48:49], v[2:3] op_sel_hi:[1,0,0]
v_xor_b32 v147, 131168, v1
v_mfma_f32_16x16x32_bf16 v[112:115], v[24:27], v[152:155], v[112:115]
ds_read_b64_tr_b16 v[20:21], v4 offset:256
ds_read_b64_tr_b16 v[22:23], v4 offset:8448
v_mfma_f32_16x16x32_bf16 v[116:119], v[24:27], v[156:159], v[116:119]
v_xor_b32 v5, 131232, v1
v_cvt_pk_bf16_f32 v161, v6, v7
s_waitcnt lgkmcnt(5)
v_mfma_f32_16x16x32_bf16 v[56:59], v[28:31], v[152:155], v[56:59]
ds_read_b64_tr_b16 v[24:25], v5
ds_read_b64_tr_b16 v[26:27], v5 offset:8192
v_mfma_f32_16x16x32_bf16 v[60:63], v[28:31], v[156:159], v[60:63]
v_exp_f32 v10, v10
v_exp_f32 v11, v11
v_lshlrev_b32 v6, 16, v162
v_and_b32 v7, s50, v162
v_pk_fma_f32 v[6:7], v[6:7], s[48:49], v[0:1] op_sel_hi:[1,0,0]
v_xor_b32 v135, 224, v1
v_xor_b32 v148, 131200, v1
v_mfma_f32_16x16x32_bf16 v[120:123], v[12:15], v[152:155], v[120:123]
ds_read_b64_tr_b16 v[28:29], v5 offset:256
ds_read_b64_tr_b16 v[30:31], v5 offset:8448
v_mfma_f32_16x16x32_bf16 v[124:127], v[12:15], v[156:159], v[124:127]
v_xor_b32 v4, 131264, v1
v_cvt_pk_bf16_f32 v165, v10, v11
v_xor_b32 v143, 65760, v1
v_xor_b32 v149, 131232, v1
s_waitcnt lgkmcnt(4)
v_mfma_f32_16x16x32_bf16 v[64:67], v[16:19], v[152:155], v[64:67]
ds_read_b64_tr_b16 v[12:13], v4
ds_read_b64_tr_b16 v[14:15], v4 offset:8192
v_mfma_f32_16x16x32_bf16 v[68:71], v[16:19], v[156:159], v[68:71]
v_cmp_le_u32 vcc, 53, v8
v_exp_f32 v6, v6
v_exp_f32 v7, v7
v_lshlrev_b32 v10, 16, v166
v_and_b32 v11, s50, v166
v_pk_fma_f32 v[10:11], v[10:11], s[48:49], v[2:3] op_sel_hi:[1,0,0]
v_xor_b32 v150, 131264, v1
v_mfma_f32_16x16x32_bf16 a[0:3], v[20:23], v[152:155], a[0:3]
ds_read_b64_tr_b16 v[16:17], v4 offset:256
ds_read_b64_tr_b16 v[18:19], v4 offset:8448
v_mfma_f32_16x16x32_bf16 a[4:7], v[20:23], v[156:159], a[4:7]
v_xor_b32 v5, 131296, v1
v_cvt_pk_bf16_f32 v162, v6, v7
v_xor_b32 v151, 131296, v1
s_waitcnt lgkmcnt(4)
v_mfma_f32_16x16x32_bf16 v[72:75], v[24:27], v[152:155], v[72:75]
ds_read_b64_tr_b16 v[20:21], v5
ds_read_b64_tr_b16 v[22:23], v5 offset:8192
v_mfma_f32_16x16x32_bf16 v[76:79], v[24:27], v[156:159], v[76:79]
s_cbranch_vccz L_sp44
L_ok44:
v_exp_f32 v10, v10
v_exp_f32 v11, v11
v_lshlrev_b32 v6, 16, v163
v_and_b32 v7, s50, v163
v_pk_fma_f32 v[6:7], v[6:7], s[48:49], v[0:1] op_sel_hi:[1,0,0]
v_mfma_f32_16x16x32_bf16 a[8:11], v[28:31], v[152:155], a[8:11]
ds_read_b64_tr_b16 v[24:25], v5 offset:256
ds_read_b64_tr_b16 v[26:27], v5 offset:8448
v_mfma_f32_16x16x32_bf16 a[12:15], v[28:31], v[156:159], a[12:15]
v_cvt_pk_bf16_f32 v166, v10, v11
s_waitcnt lgkmcnt(4)
v_mfma_f32_16x16x32_bf16 v[80:83], v[12:15], v[152:155], v[80:83]
ds_read_b64_tr_b16 v[28:29], v136 offset:32768
ds_read_b64_tr_b16 v[30:31], v136 offset:40960
v_mfma_f32_16x16x32_bf16 v[84:87], v[12:15], v[156:159], v[84:87]
v_exp_f32 v6, v6
v_exp_f32 v7, v7
v_lshlrev_b32 v10, 16, v167
v_and_b32 v11, s50, v167
v_pk_fma_f32 v[10:11], v[10:11], s[48:49], v[2:3] op_sel_hi:[1,0,0]
v_mfma_f32_16x16x32_bf16 a[16:19], v[16:19], v[152:155], a[16:19]
ds_read_b64_tr_b16 v[12:13], v136 offset:33024
ds_read_b64_tr_b16 v[14:15], v136 offset:41216
v_mfma_f32_16x16x32_bf16 a[20:23], v[16:19], v[156:159], a[20:23]
v_cvt_pk_bf16_f32 v163, v6, v7
s_waitcnt lgkmcnt(4)
v_mfma_f32_16x16x32_bf16 v[88:91], v[20:23], v[152:155], v[88:91]
ds_read_b64_tr_b16 v[16:17], v137 offset:32768
ds_read_b64_tr_b16 v[18:19], v137 offset:40960
v_mfma_f32_16x16x32_bf16 v[92:95], v[20:23], v[156:159], v[92:95]
v_exp_f32 v10, v10
v_exp_f32 v11, v11
v_lshlrev_b32 v6, 16, v168
v_and_b32 v7, s50, v168
v_pk_fma_f32 v[6:7], v[6:7], s[48:49], v[0:1] op_sel_hi:[1,0,0]
v_mfma_f32_16x16x32_bf16 a[24:27], v[24:27], v[152:155], a[24:27]
ds_read_b64_tr_b16 v[20:21], v137 offset:33024
ds_read_b64_tr_b16 v[22:23], v137 offset:41216
v_mfma_f32_16x16x32_bf16 a[28:31], v[24:27], v[156:159], a[28:31]
v_cvt_pk_bf16_f32 v167, v10, v11
s_waitcnt lgkmcnt(4)
v_mfma_f32_16x16x32_bf16 v[32:35], v[28:31], v[160:163], v[32:35]
ds_read_b64_tr_b16 v[24:25], v138 offset:32768
ds_read_b64_tr_b16 v[26:27], v138 offset:40960
v_mfma_f32_16x16x32_bf16 v[36:39], v[28:31], v[164:167], v[36:39]
v_exp_f32 v6, v6
v_exp_f32 v7, v7
v_lshlrev_b32 v10, 16, v172
v_and_b32 v11, s50, v172
v_pk_fma_f32 v[10:11], v[10:11], s[48:49], v[2:3] op_sel_hi:[1,0,0]
v_mfma_f32_16x16x32_bf16 v[96:99], v[12:15], v[160:163], v[96:99]
ds_read_b64_tr_b16 v[28:29], v138 offset:33024
ds_read_b64_tr_b16 v[30:31], v138 offset:41216
v_mfma_f32_16x16x32_bf16 v[100:103], v[12:15], v[164:167], v[100:103]
v_cvt_pk_bf16_f32 v168, v6, v7
v_mfma_f32_16x16x32_bf16 a[36:39], a[32:35], v[160:163], a[36:39]
s_waitcnt lgkmcnt(4)
v_mfma_f32_16x16x32_bf16 v[40:43], v[16:19], v[160:163], v[40:43]
ds_read_b64_tr_b16 v[12:13], v139 offset:32768
ds_read_b64_tr_b16 v[14:15], v139 offset:40960
v_mfma_f32_16x16x32_bf16 v[44:47], v[16:19], v[164:167], v[44:47]
v_exp_f32 v10, v10
v_exp_f32 v11, v11
v_lshlrev_b32 v6, 16, v169
v_and_b32 v7, s50, v169
v_pk_fma_f32 v[6:7], v[6:7], s[48:49], v[0:1] op_sel_hi:[1,0,0]
v_mfma_f32_16x16x32_bf16 v[104:107], v[20:23], v[160:163], v[104:107]
ds_read_b64_tr_b16 v[16:17], v139 offset:33024
ds_read_b64_tr_b16 v[18:19], v139 offset:41216
v_mfma_f32_16x16x32_bf16 v[108:111], v[20:23], v[164:167], v[108:111]
v_cvt_pk_bf16_f32 v172, v10, v11
v_mfma_f32_16x16x32_bf16 a[40:43], a[32:35], v[164:167], a[40:43]
s_waitcnt lgkmcnt(4)
v_mfma_f32_16x16x32_bf16 v[48:51], v[24:27], v[160:163], v[48:51]
ds_read_b64_tr_b16 v[20:21], v140 offset:32768
ds_read_b64_tr_b16 v[22:23], v140 offset:40960
v_mfma_f32_16x16x32_bf16 v[52:55], v[24:27], v[164:167], v[52:55]
s_branch L_pg8
L_sp46:
v_mov_b32 v8, 0
ds_read_b32 v8, v8 offset:14336
s_waitcnt lgkmcnt(0)
v_cmp_le_u32 vcc, 54, v8
s_cbranch_vccz L_sp46
s_branch L_ok46
L_sp47:
v_mov_b32 v8, 0
ds_read_b32 v8, v8 offset:14336
s_waitcnt lgkmcnt(0)
v_cmp_le_u32 vcc, 56, v8
s_cbranch_vccz L_sp47
s_branch L_ok47
L_sp49:
v_mov_b32 v8, 0
ds_read_b32 v8, v8 offset:14336
s_waitcnt lgkmcnt(0)
v_cmp_le_u32 vcc, 57, v8
s_cbranch_vccz L_sp49
s_branch L_ok49
.p2align 12
L_stub8:
s_setpc_b64 s[94:95]
L_pg8:
v_exp_f32 v6, v6
v_exp_f32 v7, v7
v_lshlrev_b32 v10, 16, v173
v_and_b32 v11, s50, v173
v_pk_fma_f32 v[10:11], v[10:11], s[48:49], v[2:3] op_sel_hi:[1,0,0]
v_mfma_f32_16x16x32_bf16 v[112:115], v[28:31], v[160:163], v[112:115]
ds_read_b64_tr_b16 v[24:25], v140 offset:33024
ds_read_b64_tr_b16 v[26:27], v140 offset:41216
v_mfma_f32_16x16x32_bf16 v[116:119], v[28:31], v[164:167], v[116:119]
v_cvt_pk_bf16_f32 v169, v6, v7
s_waitcnt lgkmcnt(4)
v_mfma_f32_16x16x32_bf16 v[56:59], v[12:15], v[160:163], v[56:59]
ds_read_b64_tr_b16 v[28:29], v141 offset:32768
ds_read_b64_tr_b16 v[30:31], v141 offset:40960
v_mfma_f32_16x16x32_bf16 v[60:63], v[12:15], v[164:167], v[60:63]
v_exp_f32 v10, v10
v_exp_f32 v11, v11
v_lshlrev_b32 v6, 16, v170
v_and_b32 v7, s50, v170
v_pk_fma_f32 v[6:7], v[6:7], s[48:49], v[0:1] op_sel_hi:[1,0,0]
v_mfma_f32_16x16x32_bf16 v[120:123], v[16:19], v[160:163], v[120:123]
ds_read_b64_tr_b16 v[12:13], v141 offset:33024
ds_read_b64_tr_b16 v[14:15], v141 offset:41216
v_mfma_f32_16x16x32_bf16 v[124:127], v[16:19], v[164:167], v[124:127]
v_cvt_pk_bf16_f32 v173, v10, v11
s_waitcnt lgkmcnt(4)
v_mfma_f32_16x16x32_bf16 v[64:67], v[20:23], v[160:163], v[64:67]
ds_read_b64_tr_b16 v[16:17], v142 offset:32768
ds_read_b64_tr_b16 v[18:19], v142 offset:40960
v_mfma_f32_16x16x32_bf16 v[68:71], v[20:23], v[164:167], v[68:71]
v_exp_f32 v6, v6
v_exp_f32 v7, v7
v_lshlrev_b32 v10, 16, v174
v_and_b32 v11, s50, v174
v_pk_fma_f32 v[10:11], v[10:11], s[48:49], v[2:3] op_sel_hi:[1,0,0]
v_mfma_f32_16x16x32_bf16 a[0:3], v[24:27], v[160:163], a[0:3]
ds_read_b64_tr_b16 v[20:21], v142 offset:33024
ds_read_b64_tr_b16 v[22:23], v142 offset:41216
v_mfma_f32_16x16x32_bf16 a[4:7], v[24:27], v[164:167], a[4:7]
v_cvt_pk_bf16_f32 v170, v6, v7
s_waitcnt lgkmcnt(4)
v_mfma_f32_16x16x32_bf16 v[72:75], v[28:31], v[160:163], v[72:75]
ds_read_b64_tr_b16 v[24:25], v143 offset:32768
ds_read_b64_tr_b16 v[26:27], v143 offset:40960
v_mfma_f32_16x16x32_bf16 v[76:79], v[28:31], v[164:167], v[76:79]
v_exp_f32 v10, v10
v_exp_f32 v11, v11
v_lshlrev_b32 v6, 16, v171
v_and_b32 v7, s50, v171
v_pk_fma_f32 v[6:7], v[6:7], s[48:49], v[0:1] op_sel_hi:[1,0,0]
v_mfma_f32_16x16x32_bf16 a[8:11], v[12:15], v[160:163], a[8:11]
ds_read_b64_tr_b16 v[28:29], v143 offset:33024
ds_read_b64_tr_b16 v[30:31], v143 offset:41216
v_mfma_f32_16x16x32_bf16 a[12:15], v[12:15], v[164:167], a[12:15]
v_cvt_pk_bf16_f32 v174, v10, v11
s_waitcnt lgkmcnt(4)
v_mfma_f32_16x16x32_bf16 v[80:83], v[16:19], v[160:163], v[80:83]
ds_read_b64_tr_b16 v[12:13], v136 offset:16384
ds_read_b64_tr_b16 v[14:15], v136 offset:24576
v_mfma_f32_16x16x32_bf16 v[84:87], v[16:19], v[164:167], v[84:87]
v_exp_f32 v6, v6
v_mfma_f32_16x16x32_bf16 a[16:19], v[20:23], v[160:163], a[16:19]
ds_read_b64_tr_b16 v[16:17], v136 offset:16640
ds_read_b64_tr_b16 v[18:19], v136 offset:24832
v_mfma_f32_16x16x32_bf16 a[20:23], v[20:23], v[164:167], a[20:23]
v_exp_f32 v7, v7
s_waitcnt lgkmcnt(4)
v_mfma_f32_16x16x32_bf16 v[88:91], v[24:27], v[160:163], v[88:91]
ds_read_b64_tr_b16 v[20:21], v137 offset:16384
ds_read_b64_tr_b16 v[22:23], v137 offset:24576
v_mfma_f32_16x16x32_bf16 v[92:95], v[24:27], v[164:167], v[92:95]
s_movk_i32 s12, 180
v_lshlrev_b32 v10, 16, v175
v_mfma_f32_16x16x32_bf16 a[24:27], v[28:31], v[160:163], a[24:27]
ds_read_b64_tr_b16 v[24:25], v137 offset:16640
ds_read_b64_tr_b16 v[26:27], v137 offset:24832
v_mfma_f32_16x16x32_bf16 a[28:31], v[28:31], v[164:167], a[28:31]
v_and_b32 v11, s50, v175
s_waitcnt lgkmcnt(4)
v_mfma_f32_16x16x32_bf16 a[128:131], v[12:15], a[80:83], a[128:131]
ds_read_b64_tr_b16 v[28:29], v138 offset:16384
ds_read_b64_tr_b16 v[30:31], v138 offset:24576
v_mfma_f32_16x16x32_bf16 a[132:135], v[12:15], a[84:87], a[132:135]
buffer_load_dword off, s[8:11], s12 lds
v_mfma_f32_16x16x32_bf16 a[192:195], v[16:19], a[80:83], a[192:195]
ds_read_b64_tr_b16 v[12:13], v138 offset:16640
v_cvt_pk_bf16_f32 v171, v6, v7
v_mfma_f32_16x16x32_bf16 a[196:199], v[16:19], a[84:87], a[196:199]
ds_read_b64_tr_b16 v[14:15], v138 offset:24832
s_waitcnt lgkmcnt(4)
v_mfma_f32_16x16x32_bf16 a[136:139], v[20:23], a[80:83], a[136:139]
ds_read_b64_tr_b16 v[16:17], v139 offset:16384
v_mov_b32 v8, 0
v_mfma_f32_16x16x32_bf16 a[140:143], v[20:23], a[84:87], a[140:143]
ds_read_b64_tr_b16 v[18:19], v139 offset:24576
v_fma_f32 v10, v10, s48, v2
v_mfma_f32_16x16x32_bf16 a[200:203], v[24:27], a[80:83], a[200:203]
ds_read_b64_tr_b16 v[20:21], v139 offset:16640
v_fma_f32 v11, v11, s48, v2
v_mfma_f32_16x16x32_bf16 a[204:207], v[24:27], a[84:87], a[204:207]
ds_read_b64_tr_b16 v[22:23], v139 offset:24832
s_waitcnt lgkmcnt(4)
v_mfma_f32_16x16x32_bf16 a[144:147], v[28:31], a[80:83], a[144:147]
ds_read_b64_tr_b16 v[24:25], v140 offset:16384
v_exp_f32 v10, v10
v_mfma_f32_16x16x32_bf16 a[148:151], v[28:31], a[84:87], a[148:151]
ds_read_b64_tr_b16 v[26:27], v140 offset:24576
ds_read_b32 v8, v8 offset:14336
v_mfma_f32_16x16x32_bf16 a[208:211], v[12:15], a[80:83], a[208:211]
ds_read_b64_tr_b16 v[28:29], v140 offset:16640
v_exp_f32 v11, v11
v_mfma_f32_16x16x32_bf16 a[212:215], v[12:15], a[84:87], a[212:215]
ds_read_b64_tr_b16 v[30:31], v140 offset:24832
s_waitcnt lgkmcnt(5)
v_mfma_f32_16x16x32_bf16 a[152:155], v[16:19], a[80:83], a[152:155]
ds_read_b64_tr_b16 v[12:13], v141 offset:16384
v_lshlrev_b32 v6, 16, v176
v_mfma_f32_16x16x32_bf16 a[156:159], v[16:19], a[84:87], a[156:159]
ds_read_b64_tr_b16 v[14:15], v141 offset:24576
v_and_b32 v7, s50, v176
v_mfma_f32_16x16x32_bf16 a[216:219], v[20:23], a[80:83], a[216:219]
ds_read_b64_tr_b16 v[16:17], v141 offset:16640
v_cvt_pk_bf16_f32 v175, v10, v11
v_mfma_f32_16x16x32_bf16 a[220:223], v[20:23], a[84:87], a[220:223]
ds_read_b64_tr_b16 v[18:19], v141 offset:24832
s_waitcnt lgkmcnt(4)
v_mfma_f32_16x16x32_bf16 a[160:163], v[24:27], a[80:83], a[160:163]
ds_read_b64_tr_b16 v[20:21], v142 offset:16384
v_cmp_le_u32 vcc, 54, v8
v_mfma_f32_16x16x32_bf16 a[164:167], v[24:27], a[84:87], a[164:167]
ds_read_b64_tr_b16 v[22:23], v142 offset:24576
v_fma_f32 v6, v6, s48, v0
v_mfma_f32_16x16x32_bf16 a[224:227], v[28:31], a[80:83], a[224:227]
ds_read_b64_tr_b16 v[24:25], v142 offset:16640
v_fma_f32 v7, v7, s48, v0
v_mfma_f32_16x16x32_bf16 a[228:231], v[28:31], a[84:87], a[228:231]
ds_read_b64_tr_b16 v[26:27], v142 offset:24832
s_waitcnt lgkmcnt(4)
v_mfma_f32_16x16x32_bf16 a[168:171], v[12:15], a[80:83], a[168:171]
ds_read_b64_tr_b16 v[28:29], v143 offset:16384
ds_read_b64_tr_b16 v[30:31], v143 offset:24576
v_mfma_f32_16x16x32_bf16 a[172:175], v[12:15], a[84:87], a[172:175]
s_cbranch_vccz L_sp46
L_ok46:
v_mfma_f32_16x16x32_bf16 a[232:235], v[16:19], a[80:83], a[232:235]
ds_read_b64_tr_b16 v[12:13], v143 offset:16640
v_mfma_f32_16x16x32_bf16 a[236:239], v[16:19], a[84:87], a[236:239]
ds_read_b64_tr_b16 v[14:15], v143 offset:24832
s_waitcnt lgkmcnt(4)
v_mfma_f32_16x16x32_bf16 a[176:179], v[20:23], a[80:83], a[176:179]
ds_read_b64_tr_b16 v[16:17], v144 offset:16384
v_mfma_f32_16x16x32_bf16 a[180:183], v[20:23], a[84:87], a[180:183]
ds_read_b64_tr_b16 v[18:19], v144 offset:24576
v_mfma_f32_16x16x32_bf16 a[240:243], v[24:27], a[80:83], a[240:243]
ds_read_b64_tr_b16 v[20:21], v144 offset:16640
v_mfma_f32_16x16x32_bf16 a[244:247], v[24:27], a[84:87], a[244:247]
ds_read_b64_tr_b16 v[22:23], v144 offset:24832
s_waitcnt lgkmcnt(4)
v_mfma_f32_16x16x32_bf16 a[184:187], v[28:31], a[80:83], a[184:187]
ds_read_b64_tr_b16 v[24:25], v145 offset:16384
v_mfma_f32_16x16x32_bf16 a[188:191], v[28:31], a[84:87], a[188:191]
ds_read_b64_tr_b16 v[26:27], v145 offset:24576
v_mfma_f32_16x16x32_bf16 a[248:251], v[12:15], a[80:83], a[248:251]
ds_read_b64_tr_b16 v[28:29], v145 offset:16640
v_mfma_f32_16x16x32_bf16 a[252:255], v[12:15], a[84:87], a[252:255]
ds_read_b64_tr_b16 v[30:31], v145 offset:24832
s_waitcnt lgkmcnt(4)
v_mfma_f32_16x16x32_bf16 v[32:35], v[16:19], v[168:171], v[32:35]
ds_read_b64_tr_b16 v[12:13], v146 offset:16384
ds_read_b64_tr_b16 v[14:15], v146 offset:24576
v_mfma_f32_16x16x32_bf16 v[36:39], v[16:19], v[172:175], v[36:39]
v_exp_f32 v6, v6
v_exp_f32 v7, v7
v_lshlrev_b32 v10, 16, v180
v_and_b32 v11, s50, v180
v_pk_fma_f32 v[10:11], v[10:11], s[48:49], v[2:3] op_sel_hi:[1,0,0]
v_mfma_f32_16x16x32_bf16 v[96:99], v[20:23], v[168:171], v[96:99]
ds_read_b64_tr_b16 v[16:17], v146 offset:16640
ds_read_b64_tr_b16 v[18:19], v146 offset:24832
v_mfma_f32_16x16x32_bf16 v[100:103], v[20:23], v[172:175], v[100:103]
v_cvt_pk_bf16_f32 v176, v6, v7
v_mfma_f32_16x16x32_bf16 a[36:39], a[32:35], v[168:171], a[36:39]
s_waitcnt lgkmcnt(4)
v_mfma_f32_16x16x32_bf16 v[40:43], v[24:27], v[168:171], v[40:43]
ds_read_b64_tr_b16 v[20:21], v147 offset:16384
ds_read_b64_tr_b16 v[22:23], v147 offset:24576
v_mfma_f32_16x16x32_bf16 v[44:47], v[24:27], v[172:175], v[44:47]
v_mov_b32 v8, 0
v_exp_f32 v10, v10
v_exp_f32 v11, v11
v_lshlrev_b32 v6, 16, v177
v_and_b32 v7, s50, v177
v_pk_fma_f32 v[6:7], v[6:7], s[48:49], v[0:1] op_sel_hi:[1,0,0]
v_mfma_f32_16x16x32_bf16 v[104:107], v[28:31], v[168:171], v[104:107]
ds_read_b64_tr_b16 v[24:25], v147 offset:16640
ds_read_b64_tr_b16 v[26:27], v147 offset:24832
v_mfma_f32_16x16x32_bf16 v[108:111], v[28:31], v[172:175], v[108:111]
v_cvt_pk_bf16_f32 v180, v10, v11
v_mfma_f32_16x16x32_bf16 a[40:43], a[32:35], v[172:175], a[40:43]
s_waitcnt lgkmcnt(4)
v_mfma_f32_16x16x32_bf16 v[48:51], v[12:15], v[168:171], v[48:51]
ds_read_b64_tr_b16 v[28:29], v148 offset:16384
ds_read_b64_tr_b16 v[30:31], v148 offset:24576
v_mfma_f32_16x16x32_bf16 v[52:55], v[12:15], v[172:175], v[52:55]
ds_read_b32 v8, v8 offset:14336
v_exp_f32 v6, v6
v_exp_f32 v7, v7
v_lshlrev_b32 v10, 16, v181
v_and_b32 v11, s50, v181
v_pk_fma_f32 v[10:11], v[10:11], s[48:49], v[2:3] op_sel_hi:[1,0,0]
v_mfma_f32_16x16x32_bf16 v[112:115], v[16:19], v[168:171], v[112:115]
ds_read_b64_tr_b16 v[12:13], v148 offset:16640
ds_read_b64_tr_b16 v[14:15], v148 offset:24832
v_mfma_f32_16x16x32_bf16 v[116:119], v[16:19], v[172:175], v[116:119]
v_cvt_pk_bf16_f32 v177, v6, v7
s_waitcnt lgkmcnt(5)
v_mfma_f32_16x16x32_bf16 v[56:59], v[20:23], v[168:171], v[56:59]
ds_read_b64_tr_b16 v[16:17], v149 offset:16384
ds_read_b64_tr_b16 v[18:19], v149 offset:24576
v_mfma_f32_16x16x32_bf16 v[60:63], v[20:23], v[172:175], v[60:63]
v_exp_f32 v10, v10
v_exp_f32 v11, v11
v_lshlrev_b32 v6, 16, v178
v_and_b32 v7, s50, v178
v_pk_fma_f32 v[6:7], v[6:7], s[48:49], v[0:1] op_sel_hi:[1,0,0]
v_mfma_f32_16x16x32_bf16 v[120:123], v[24:27], v[168:171], v[120:123]
ds_read_b64_tr_b16 v[20:21], v149 offset:16640
ds_read_b64_tr_b16 v[22:23], v149 offset:24832
v_mfma_f32_16x16x32_bf16 v[124:127], v[24:27], v[172:175], v[124:127]
v_cvt_pk_bf16_f32 v181, v10, v11
s_waitcnt lgkmcnt(4)
v_mfma_f32_16x16x32_bf16 v[64:67], v[28:31], v[168:171], v[64:67]
ds_read_b64_tr_b16 v[24:25], v150 offset:16384
ds_read_b64_tr_b16 v[26:27], v150 offset:24576
v_mfma_f32_16x16x32_bf16 v[68:71], v[28:31], v[172:175], v[68:71]
v_cmp_le_u32 vcc, 56, v8
v_exp_f32 v6, v6
v_exp_f32 v7, v7
v_lshlrev_b32 v10, 16, v182
v_and_b32 v11, s50, v182
v_pk_fma_f32 v[10:11], v[10:11], s[48:49], v[2:3] op_sel_hi:[1,0,0]
v_mfma_f32_16x16x32_bf16 a[0:3], v[12:15], v[168:171], a[0:3]
ds_read_b64_tr_b16 v[28:29], v150 offset:16640
ds_read_b64_tr_b16 v[30:31], v150 offset:24832
v_mfma_f32_16x16x32_bf16 a[4:7], v[12:15], v[172:175], a[4:7]
v_cvt_pk_bf16_f32 v178, v6, v7
s_waitcnt lgkmcnt(4)
v_mfma_f32_16x16x32_bf16 v[72:75], v[16:19], v[168:171], v[72:75]
ds_read_b64_tr_b16 v[12:13], v151 offset:16384
ds_read_b64_tr_b16 v[14:15], v151 offset:24576
v_mfma_f32_16x16x32_bf16 v[76:79], v[16:19], v[172:175], v[76:79]
s_cbranch_vccz L_sp47
L_ok47:
v_exp_f32 v10, v10
v_exp_f32 v11, v11
v_lshlrev_b32 v6, 16, v179
v_and_b32 v7, s50, v179
v_pk_fma_f32 v[6:7], v[6:7], s[48:49], v[0:1] op_sel_hi:[1,0,0]
v_mfma_f32_16x16x32_bf16 a[8:11], v[20:23], v[168:171], a[8:11]
ds_read_b64_tr_b16 v[16:17], v151 offset:16640
ds_read_b64_tr_b16 v[18:19], v151 offset:24832
v_mfma_f32_16x16x32_bf16 a[12:15], v[20:23], v[172:175], a[12:15]
v_cvt_pk_bf16_f32 v182, v10, v11
s_waitcnt lgkmcnt(4)
v_mfma_f32_16x16x32_bf16 v[80:83], v[24:27], v[168:171], v[80:83]
ds_read_b64_tr_b16 v[20:21], v128 offset:32768
ds_read_b64_tr_b16 v[22:23], v128 offset:40960
v_mfma_f32_16x16x32_bf16 v[84:87], v[24:27], v[172:175], v[84:87]
v_exp_f32 v6, v6
v_exp_f32 v7, v7
v_lshlrev_b32 v10, 16, v183
v_and_b32 v11, s50, v183
v_pk_fma_f32 v[10:11], v[10:11], s[48:49], v[2:3] op_sel_hi:[1,0,0]
v_mfma_f32_16x16x32_bf16 a[16:19], v[28:31], v[168:171], a[16:19]
ds_read_b64_tr_b16 v[24:25], v128 offset:33024
ds_read_b64_tr_b16 v[26:27], v128 offset:41216
v_mfma_f32_16x16x32_bf16 a[20:23], v[28:31], v[172:175], a[20:23]
v_cvt_pk_bf16_f32 v179, v6, v7
s_waitcnt lgkmcnt(4)
v_mfma_f32_16x16x32_bf16 v[88:91], v[12:15], v[168:171], v[88:91]
ds_read_b64_tr_b16 v[28:29], v129 offset:32768
ds_read_b64_tr_b16 v[30:31], v129 offset:40960
v_mfma_f32_16x16x32_bf16 v[92:95], v[12:15], v[172:175], v[92:95]
s_movk_i32 s12, 188
v_exp_f32 v10, v10
v_exp_f32 v11, v11
v_lshlrev_b32 v6, 16, v184
v_and_b32 v7, s50, v184
v_pk_fma_f32 v[6:7], v[6:7], s[48:49], v[0:1] op_sel_hi:[1,0,0]
v_mfma_f32_16x16x32_bf16 a[24:27], v[16:19], v[168:171], a[24:27]
ds_read_b64_tr_b16 v[12:13], v129 offset:33024
ds_read_b64_tr_b16 v[14:15], v129 offset:41216
v_mfma_f32_16x16x32_bf16 a[28:31], v[16:19], v[172:175], a[28:31]
v_cvt_pk_bf16_f32 v183, v10, v11
s_waitcnt lgkmcnt(4)
v_mfma_f32_16x16x32_bf16 v[32:35], v[20:23], v[176:179], v[32:35]
ds_read_b64_tr_b16 v[16:17], v130 offset:32768
ds_read_b64_tr_b16 v[18:19], v130 offset:40960
v_mfma_f32_16x16x32_bf16 v[36:39], v[20:23], v[180:183], v[36:39]
buffer_load_dword off, s[8:11], s12 lds
v_exp_f32 v6, v6
v_exp_f32 v7, v7
v_lshlrev_b32 v10, 16, v188
v_and_b32 v11, s50, v188
v_pk_fma_f32 v[10:11], v[10:11], s[48:49], v[2:3] op_sel_hi:[1,0,0]
v_mfma_f32_16x16x32_bf16 v[96:99], v[24:27], v[176:179], v[96:99]
ds_read_b64_tr_b16 v[20:21], v130 offset:33024
ds_read_b64_tr_b16 v[22:23], v130 offset:41216
v_mfma_f32_16x16x32_bf16 v[100:103], v[24:27], v[180:183], v[100:103]
v_cvt_pk_bf16_f32 v184, v6, v7
v_mfma_f32_16x16x32_bf16 a[36:39], a[32:35], v[176:179], a[36:39]
s_waitcnt lgkmcnt(4)
v_mfma_f32_16x16x32_bf16 v[40:43], v[28:31], v[176:179], v[40:43]
ds_read_b64_tr_b16 v[24:25], v131 offset:32768
ds_read_b64_tr_b16 v[26:27], v131 offset:40960
v_mfma_f32_16x16x32_bf16 v[44:47], v[28:31], v[180:183], v[44:47]
v_exp_f32 v10, v10
v_exp_f32 v11, v11
v_lshlrev_b32 v6, 16, v185
v_and_b32 v7, s50, v185
v_pk_fma_f32 v[6:7], v[6:7], s[48:49], v[0:1] op_sel_hi:[1,0,0]
v_mfma_f32_16x16x32_bf16 v[104:107], v[12:15], v[176:179], v[104:107]
ds_read_b64_tr_b16 v[28:29], v131 offset:33024
ds_read_b64_tr_b16 v[30:31], v131 offset:41216
v_mfma_f32_16x16x32_bf16 v[108:111], v[12:15], v[180:183], v[108:111]
v_cvt_pk_bf16_f32 v188, v10, v11
v_mfma_f32_16x16x32_bf16 a[40:43], a[32:35], v[180:183], a[40:43]
s_waitcnt lgkmcnt(4)
v_mfma_f32_16x16x32_bf16 v[48:51], v[16:19], v[176:179], v[48:51]
ds_read_b64_tr_b16 v[12:13], v132 offset:32768
ds_read_b64_tr_b16 v[14:15], v132 offset:40960
v_mfma_f32_16x16x32_bf16 v[52:55], v[16:19], v[180:183], v[52:55]
v_exp_f32 v6, v6
v_exp_f32 v7, v7
v_lshlrev_b32 v10, 16, v189
v_and_b32 v11, s50, v189
v_pk_fma_f32 v[10:11], v[10:11], s[48:49], v[2:3] op_sel_hi:[1,0,0]
v_mfma_f32_16x16x32_bf16 v[112:115], v[20:23], v[176:179], v[112:115]
ds_read_b64_tr_b16 v[16:17], v132 offset:33024
ds_read_b64_tr_b16 v[18:19], v132 offset:41216
v_mfma_f32_16x16x32_bf16 v[116:119], v[20:23], v[180:183], v[116:119]
v_cvt_pk_bf16_f32 v185, v6, v7
s_waitcnt lgkmcnt(4)
v_mfma_f32_16x16x32_bf16 v[56:59], v[24:27], v[176:179], v[56:59]
ds_read_b64_tr_b16 v[20:21], v133 offset:32768
ds_read_b64_tr_b16 v[22:23], v133 offset:40960
v_mfma_f32_16x16x32_bf16 v[60:63], v[24:27], v[180:183], v[60:63]
v_exp_f32 v10, v10
v_exp_f32 v11, v11
v_lshlrev_b32 v6, 16, v186
v_and_b32 v7, s50, v186
v_pk_fma_f32 v[6:7], v[6:7], s[48:49], v[0:1] op_sel_hi:[1,0,0]
v_mfma_f32_16x16x32_bf16 v[120:123], v[28:31], v[176:179], v[120:123]
ds_read_b64_tr_b16 v[24:25], v133 offset:33024
ds_read_b64_tr_b16 v[26:27], v133 offset:41216
v_mfma_f32_16x16x32_bf16 v[124:127], v[28:31], v[180:183], v[124:127]
v_cvt_pk_bf16_f32 v189, v10, v11
s_waitcnt lgkmcnt(4)
v_mfma_f32_16x16x32_bf16 v[64:67], v[12:15], v[176:179], v[64:67]
ds_read_b64_tr_b16 v[28:29], v134 offset:32768
ds_read_b64_tr_b16 v[30:31], v134 offset:40960
v_mfma_f32_16x16x32_bf16 v[68:71], v[12:15], v[180:183], v[68:71]
v_exp_f32 v6, v6
v_exp_f32 v7, v7
v_lshlrev_b32 v10, 16, v190
v_and_b32 v11, s50, v190
v_pk_fma_f32 v[10:11], v[10:11], s[48:49], v[2:3] op_sel_hi:[1,0,0]
v_mfma_f32_16x16x32_bf16 a[0:3], v[16:19], v[176:179], a[0:3]
ds_read_b64_tr_b16 v[12:13], v134 offset:33024
ds_read_b64_tr_b16 v[14:15], v134 offset:41216
v_mfma_f32_16x16x32_bf16 a[4:7], v[16:19], v[180:183], a[4:7]
v_cvt_pk_bf16_f32 v186, v6, v7
s_waitcnt lgkmcnt(4)
v_mfma_f32_16x16x32_bf16 v[72:75], v[20:23], v[176:179], v[72:75]
ds_read_b64_tr_b16 v[16:17], v135 offset:32768
ds_read_b64_tr_b16 v[18:19], v135 offset:40960
v_mfma_f32_16x16x32_bf16 v[76:79], v[20:23], v[180:183], v[76:79]
v_exp_f32 v10, v10
v_exp_f32 v11, v11
v_lshlrev_b32 v6, 16, v187
v_and_b32 v7, s50, v187
v_pk_fma_f32 v[6:7], v[6:7], s[48:49], v[0:1] op_sel_hi:[1,0,0]
v_mfma_f32_16x16x32_bf16 a[8:11], v[24:27], v[176:179], a[8:11]
ds_read_b64_tr_b16 v[20:21], v135 offset:33024
ds_read_b64_tr_b16 v[22:23], v135 offset:41216
v_mfma_f32_16x16x32_bf16 a[12:15], v[24:27], v[180:183], a[12:15]
v_cvt_pk_bf16_f32 v190, v10, v11
s_waitcnt lgkmcnt(4)
v_mfma_f32_16x16x32_bf16 v[80:83], v[28:31], v[176:179], v[80:83]
ds_read_b64_tr_b16 v[24:25], v128 offset:16384
ds_read_b64_tr_b16 v[26:27], v128 offset:24576
v_mfma_f32_16x16x32_bf16 v[84:87], v[28:31], v[180:183], v[84:87]
v_exp_f32 v6, v6
v_mfma_f32_16x16x32_bf16 a[16:19], v[12:15], v[176:179], a[16:19]
ds_read_b64_tr_b16 v[28:29], v128 offset:16640
ds_read_b64_tr_b16 v[30:31], v128 offset:24832
v_mfma_f32_16x16x32_bf16 a[20:23], v[12:15], v[180:183], a[20:23]
v_exp_f32 v7, v7
s_waitcnt lgkmcnt(4)
v_mfma_f32_16x16x32_bf16 v[88:91], v[16:19], v[176:179], v[88:91]
ds_read_b64_tr_b16 v[12:13], v129 offset:16384
ds_read_b64_tr_b16 v[14:15], v129 offset:24576
v_mfma_f32_16x16x32_bf16 v[92:95], v[16:19], v[180:183], v[92:95]
s_movk_i32 s12, 192
v_lshlrev_b32 v10, 16, v191
v_mfma_f32_16x16x32_bf16 a[24:27], v[20:23], v[176:179], a[24:27]
ds_read_b64_tr_b16 v[16:17], v129 offset:16640
ds_read_b64_tr_b16 v[18:19], v129 offset:24832
v_mfma_f32_16x16x32_bf16 a[28:31], v[20:23], v[180:183], a[28:31]
v_and_b32 v11, s50, v191
s_waitcnt lgkmcnt(4)
v_mfma_f32_16x16x32_bf16 a[128:131], v[24:27], a[88:91], a[128:131]
ds_read_b64_tr_b16 v[20:21], v130 offset:16384
ds_read_b64_tr_b16 v[22:23], v130 offset:24576
v_mfma_f32_16x16x32_bf16 a[132:135], v[24:27], a[92:95], a[132:135]
buffer_load_dword off, s[8:11], s12 lds
v_mfma_f32_16x16x32_bf16 a[192:195], v[28:31], a[88:91], a[192:195]
ds_read_b64_tr_b16 v[24:25], v130 offset:16640
v_cvt_pk_bf16_f32 v187, v6, v7
v_mfma_f32_16x16x32_bf16 a[196:199], v[28:31], a[92:95], a[196:199]
ds_read_b64_tr_b16 v[26:27], v130 offset:24832
s_waitcnt lgkmcnt(4)
v_mfma_f32_16x16x32_bf16 a[136:139], v[12:15], a[88:91], a[136:139]
ds_read_b64_tr_b16 v[28:29], v131 offset:16384
v_mov_b32 v8, 0
v_mfma_f32_16x16x32_bf16 a[140:143], v[12:15], a[92:95], a[140:143]
ds_read_b64_tr_b16 v[30:31], v131 offset:24576
v_fma_f32 v10, v10, s48, v2
v_mfma_f32_16x16x32_bf16 a[200:203], v[16:19], a[88:91], a[200:203]
ds_read_b64_tr_b16 v[12:13], v131 offset:16640
v_fma_f32 v11, v11, s48, v2
v_mfma_f32_16x16x32_bf16 a[204:207], v[16:19], a[92:95], a[204:207]
ds_read_b64_tr_b16 v[14:15], v131 offset:24832
s_waitcnt lgkmcnt(4)
v_mfma_f32_16x16x32_bf16 a[144:147], v[20:23], a[88:91], a[144:147]
ds_read_b64_tr_b16 v[16:17], v132 offset:16384
v_exp_f32 v10, v10
v_mfma_f32_16x16x32_bf16 a[148:151], v[20:23], a[92:95], a[148:151]
ds_read_b64_tr_b16 v[18:19], v132 offset:24576
ds_read_b32 v8, v8 offset:14336
v_mfma_f32_16x16x32_bf16 a[208:211], v[24:27], a[88:91], a[208:211]
ds_read_b64_tr_b16 v[20:21], v132 offset:16640
v_exp_f32 v11, v11
v_mfma_f32_16x16x32_bf16 a[212:215], v[24:27], a[92:95], a[212:215]
ds_read_b64_tr_b16 v[22:23], v132 offset:24832
s_waitcnt lgkmcnt(5)
v_mfma_f32_16x16x32_bf16 a[152:155], v[28:31], a[88:91], a[152:155]
ds_read_b64_tr_b16 v[24:25], v133 offset:16384
v_lshlrev_b32 v6, 16, v192
v_mfma_f32_16x16x32_bf16 a[156:159], v[28:31], a[92:95], a[156:159]
ds_read_b64_tr_b16 v[26:27], v133 offset:24576
v_and_b32 v7, s50, v192
v_mfma_f32_16x16x32_bf16 a[216:219], v[12:15], a[88:91], a[216:219]
ds_read_b64_tr_b16 v[28:29], v133 offset:16640
v_cvt_pk_bf16_f32 v191, v10, v11
v_mfma_f32_16x16x32_bf16 a[220:223], v[12:15], a[92:95], a[220:223]
ds_read_b64_tr_b16 v[30:31], v133 offset:24832
s_waitcnt lgkmcnt(4)
v_mfma_f32_16x16x32_bf16 a[160:163], v[16:19], a[88:91], a[160:163]
ds_read_b64_tr_b16 v[12:13], v134 offset:16384
v_cmp_le_u32 vcc, 57, v8
v_mfma_f32_16x16x32_bf16 a[164:167], v[16:19], a[92:95], a[164:167]
ds_read_b64_tr_b16 v[14:15], v134 offset:24576
v_fma_f32 v6, v6, s48, v0
v_mfma_f32_16x16x32_bf16 a[224:227], v[20:23], a[88:91], a[224:227]
ds_read_b64_tr_b16 v[16:17], v134 offset:16640
v_fma_f32 v7, v7, s48, v0
v_mfma_f32_16x16x32_bf16 a[228:231], v[20:23], a[92:95], a[228:231]
ds_read_b64_tr_b16 v[18:19], v134 offset:24832
s_waitcnt lgkmcnt(4)
v_mfma_f32_16x16x32_bf16 a[168:171], v[24:27], a[88:91], a[168:171]
ds_read_b64_tr_b16 v[20:21], v135 offset:16384
ds_read_b64_tr_b16 v[22:23], v135 offset:24576
v_mfma_f32_16x16x32_bf16 a[172:175], v[24:27], a[92:95], a[172:175]
s_cbranch_vccz L_sp49
L_ok49:
v_mfma_f32_16x16x32_bf16 a[232:235], v[28:31], a[88:91], a[232:235]
ds_read_b64_tr_b16 v[24:25], v135 offset:16640
v_mfma_f32_16x16x32_bf16 a[236:239], v[28:31], a[92:95], a[236:239]
ds_read_b64_tr_b16 v[26:27], v135 offset:24832
s_waitcnt lgkmcnt(4)
v_mfma_f32_16x16x32_bf16 a[176:179], v[12:15], a[88:91], a[176:179]
ds_read_b64_tr_b16 v[28:29], v136
v_mfma_f32_16x16x32_bf16 a[180:183], v[12:15], a[92:95], a[180:183]
ds_read_b64_tr_b16 v[30:31], v136 offset:8192
v_mfma_f32_16x16x32_bf16 a[240:243], v[16:19], a[88:91], a[240:243]
ds_read_b64_tr_b16 v[12:13], v136 offset:256
v_mfma_f32_16x16x32_bf16 a[244:247], v[16:19], a[92:95], a[244:247]
ds_read_b64_tr_b16 v[14:15], v136 offset:8448
s_waitcnt lgkmcnt(4)
v_mfma_f32_16x16x32_bf16 a[184:187], v[20:23], a[88:91], a[184:187]
ds_read_b64_tr_b16 v[16:17], v137
v_mfma_f32_16x16x32_bf16 a[188:191], v[20:23], a[92:95], a[188:191]
ds_read_b64_tr_b16 v[18:19], v137 offset:8192
v_mfma_f32_16x16x32_bf16 a[248:251], v[24:27], a[88:91], a[248:251]
ds_read_b64_tr_b16 v[20:21], v137 offset:256
v_mfma_f32_16x16x32_bf16 a[252:255], v[24:27], a[92:95], a[252:255]
ds_read_b64_tr_b16 v[22:23], v137 offset:8448
s_waitcnt lgkmcnt(4)
v_mfma_f32_16x16x32_bf16 v[32:35], v[28:31], v[184:187], v[32:35]
ds_read_b64_tr_b16 v[24:25], v138
ds_read_b64_tr_b16 v[26:27], v138 offset:8192
v_mfma_f32_16x16x32_bf16 v[36:39], v[28:31], v[188:191], v[36:39]
v_exp_f32 v6, v6
v_exp_f32 v7, v7
v_lshlrev_b32 v10, 16, v196
v_and_b32 v11, s50, v196
v_pk_fma_f32 v[10:11], v[10:11], s[48:49], v[2:3] op_sel_hi:[1,0,0]
v_mfma_f32_16x16x32_bf16 v[96:99], v[12:15], v[184:187], v[96:99]
ds_read_b64_tr_b16 v[28:29], v138 offset:256
ds_read_b64_tr_b16 v[30:31], v138 offset:8448
v_mfma_f32_16x16x32_bf16 v[100:103], v[12:15], v[188:191], v[100:103]
v_cvt_pk_bf16_f32 v192, v6, v7
v_mfma_f32_16x16x32_bf16 a[36:39], a[32:35], v[184:187], a[36:39]
s_waitcnt lgkmcnt(4)
v_mfma_f32_16x16x32_bf16 v[40:43], v[16:19], v[184:187], v[40:43]
ds_read_b64_tr_b16 v[12:13], v139
ds_read_b64_tr_b16 v[14:15], v139 offset:8192
v_mfma_f32_16x16x32_bf16 v[44:47], v[16:19], v[188:191], v[44:47]
v_mov_b32 v8, 0
v_exp_f32 v10, v10
v_exp_f32 v11, v11
v_lshlrev_b32 v6, 16, v193
v_and_b32 v7, s50, v193
v_pk_fma_f32 v[6:7], v[6:7], s[48:49], v[0:1] op_sel_hi:[1,0,0]
v_mfma_f32_16x16x32_bf16 v[104:107], v[20:23], v[184:187], v[104:107]
ds_read_b64_tr_b16 v[16:17], v139 offset:256
ds_read_b64_tr_b16 v[18:19], v139 offset:8448
v_mfma_f32_16x16x32_bf16 v[108:111], v[20:23], v[188:191], v[108:111]
v_cvt_pk_bf16_f32 v196, v10, v11
v_mfma_f32_16x16x32_bf16 a[40:43], a[32:35], v[188:191], a[40:43]
s_waitcnt lgkmcnt(4)
v_mfma_f32_16x16x32_bf16 v[48:51], v[24:27], v[184:187], v[48:51]
ds_read_b64_tr_b16 v[20:21], v140
ds_read_b64_tr_b16 v[22:23], v140 offset:8192
v_mfma_f32_16x16x32_bf16 v[52:55], v[24:27], v[188:191], v[52:55]
ds_read_b32 v8, v8 offset:14336
v_exp_f32 v6, v6
v_exp_f32 v7, v7
v_lshlrev_b32 v10, 16, v197
v_and_b32 v11, s50, v197
v_pk_fma_f32 v[10:11], v[10:11], s[48:49], v[2:3] op_sel_hi:[1,0,0]
v_mfma_f32_16x16x32_bf16 v[112:115], v[28:31], v[184:187], v[112:115]
ds_read_b64_tr_b16 v[24:25], v140 offset:256
ds_read_b64_tr_b16 v[26:27], v140 offset:8448
v_mfma_f32_16x16x32_bf16 v[116:119], v[28:31], v[188:191], v[116:119]
v_cvt_pk_bf16_f32 v193, v6, v7
s_waitcnt lgkmcnt(5)
v_mfma_f32_16x16x32_bf16 v[56:59], v[12:15], v[184:187], v[56:59]
ds_read_b64_tr_b16 v[28:29], v141
ds_read_b64_tr_b16 v[30:31], v141 offset:8192
v_mfma_f32_16x16x32_bf16 v[60:63], v[12:15], v[188:191], v[60:63]
v_exp_f32 v10, v10
v_exp_f32 v11, v11
v_lshlrev_b32 v6, 16, v194
v_and_b32 v7, s50, v194
v_pk_fma_f32 v[6:7], v[6:7], s[48:49], v[0:1] op_sel_hi:[1,0,0]
v_mfma_f32_16x16x32_bf16 v[120:123], v[16:19], v[184:187], v[120:123]
s_branch L_pg9
L_sp50:
v_mov_b32 v8, 0
ds_read_b32 v8, v8 offset:14336
s_waitcnt lgkmcnt(0)
v_cmp_le_u32 vcc, 58, v8
s_cbranch_vccz L_sp50
s_branch L_ok50
L_sp51:
v_mov_b32 v8, 0
ds_read_b32 v8, v8 offset:14336
s_waitcnt lgkmcnt(0)
v_cmp_le_u32 vcc, 60, v8
s_cbranch_vccz L_sp51
s_branch L_ok51
L_sp53:
v_mov_b32 v8, 0
ds_read_b32 v8, v8 offset:14336
s_waitcnt lgkmcnt(0)
v_cmp_le_u32 vcc, 61, v8
s_cbranch_vccz L_sp53
s_branch L_ok53
L_sp54:
v_mov_b32 v8, 0
ds_read_b32 v8, v8 offset:14336
s_waitcnt lgkmcnt(0)
v_cmp_le_u32 vcc, 62, v8
s_cbranch_vccz L_sp54
s_branch L_ok54
.p2align 12
L_stub9:
s_setpc_b64 s[94:95]
L_pg9:
ds_read_b64_tr_b16 v[12:13], v141 offset:256
ds_read_b64_tr_b16 v[14:15], v141 offset:8448
v_mfma_f32_16x16x32_bf16 v[124:127], v[16:19], v[188:191], v[124:127]
v_cvt_pk_bf16_f32 v197, v10, v11
s_waitcnt lgkmcnt(4)
v_mfma_f32_16x16x32_bf16 v[64:67], v[20:23], v[184:187], v[64:67]
ds_read_b64_tr_b16 v[16:17], v142
ds_read_b64_tr_b16 v[18:19], v142 offset:8192
v_mfma_f32_16x16x32_bf16 v[68:71], v[20:23], v[188:191], v[68:71]
v_cmp_le_u32 vcc, 58, v8
v_exp_f32 v6, v6
v_exp_f32 v7, v7
v_lshlrev_b32 v10, 16, v198
v_and_b32 v11, s50, v198
v_pk_fma_f32 v[10:11], v[10:11], s[48:49], v[2:3] op_sel_hi:[1,0,0]
v_mfma_f32_16x16x32_bf16 a[0:3], v[24:27], v[184:187], a[0:3]
ds_read_b64_tr_b16 v[20:21], v142 offset:256
ds_read_b64_tr_b16 v[22:23], v142 offset:8448
v_mfma_f32_16x16x32_bf16 a[4:7], v[24:27], v[188:191], a[4:7]
v_cvt_pk_bf16_f32 v194, v6, v7
s_waitcnt lgkmcnt(4)
v_mfma_f32_16x16x32_bf16 v[72:75], v[28:31], v[184:187], v[72:75]
ds_read_b64_tr_b16 v[24:25], v143
ds_read_b64_tr_b16 v[26:27], v143 offset:8192
v_mfma_f32_16x16x32_bf16 v[76:79], v[28:31], v[188:191], v[76:79]
s_cbranch_vccz L_sp50
L_ok50:
v_exp_f32 v10, v10
v_exp_f32 v11, v11
v_lshlrev_b32 v6, 16, v195
v_and_b32 v7, s50, v195
v_pk_fma_f32 v[6:7], v[6:7], s[48:49], v[0:1] op_sel_hi:[1,0,0]
v_mfma_f32_16x16x32_bf16 a[8:11], v[12:15], v[184:187], a[8:11]
ds_read_b64_tr_b16 v[28:29], v143 offset:256
ds_read_b64_tr_b16 v[30:31], v143 offset:8448
v_mfma_f32_16x16x32_bf16 a[12:15], v[12:15], v[188:191], a[12:15]
v_cvt_pk_bf16_f32 v198, v10, v11
s_waitcnt lgkmcnt(4)
v_mfma_f32_16x16x32_bf16 v[80:83], v[16:19], v[184:187], v[80:83]
ds_read_b64_tr_b16 v[12:13], v128 offset:49152
ds_read_b64_tr_b16 v[14:15], v128 offset:57344
v_mfma_f32_16x16x32_bf16 v[84:87], v[16:19], v[188:191], v[84:87]
v_exp_f32 v6, v6
v_exp_f32 v7, v7
v_lshlrev_b32 v10, 16, v199
v_and_b32 v11, s50, v199
v_pk_fma_f32 v[10:11], v[10:11], s[48:49], v[2:3] op_sel_hi:[1,0,0]
v_mfma_f32_16x16x32_bf16 a[16:19], v[20:23], v[184:187], a[16:19]
ds_read_b64_tr_b16 v[16:17], v128 offset:49408
ds_read_b64_tr_b16 v[18:19], v128 offset:57600
v_mfma_f32_16x16x32_bf16 a[20:23], v[20:23], v[188:191], a[20:23]
v_cvt_pk_bf16_f32 v195, v6, v7
s_waitcnt lgkmcnt(4)
v_mfma_f32_16x16x32_bf16 v[88:91], v[24:27], v[184:187], v[88:91]
ds_read_b64_tr_b16 v[20:21], v129 offset:49152
ds_read_b64_tr_b16 v[22:23], v129 offset:57344
v_mfma_f32_16x16x32_bf16 v[92:95], v[24:27], v[188:191], v[92:95]
s_movk_i32 s12, 200
v_exp_f32 v10, v10
v_exp_f32 v11, v11
v_lshlrev_b32 v6, 16, v200
v_and_b32 v7, s50, v200
v_pk_fma_f32 v[6:7], v[6:7], s[48:49], v[0:1] op_sel_hi:[1,0,0]
v_mfma_f32_16x16x32_bf16 a[24:27], v[28:31], v[184:187], a[24:27]
ds_read_b64_tr_b16 v[24:25], v129 offset:49408
ds_read_b64_tr_b16 v[26:27], v129 offset:57600
v_mfma_f32_16x16x32_bf16 a[28:31], v[28:31], v[188:191], a[28:31]
v_cvt_pk_bf16_f32 v199, v10, v11
s_waitcnt lgkmcnt(4)
v_mfma_f32_16x16x32_bf16 v[32:35], v[12:15], v[192:195], v[32:35]
ds_read_b64_tr_b16 v[28:29], v130 offset:49152
ds_read_b64_tr_b16 v[30:31], v130 offset:57344
v_mfma_f32_16x16x32_bf16 v[36:39], v[12:15], v[196:199], v[36:39]
buffer_load_dword off, s[8:11], s12 lds
v_exp_f32 v6, v6
v_exp_f32 v7, v7
v_lshlrev_b32 v10, 16, v204
v_and_b32 v11, s50, v204
v_pk_fma_f32 v[10:11], v[10:11], s[48:49], v[2:3] op_sel_hi:[1,0,0]
v_mfma_f32_16x16x32_bf16 v[96:99], v[16:19], v[192:195], v[96:99]
ds_read_b64_tr_b16 v[12:13], v130 offset:49408
ds_read_b64_tr_b16 v[14:15], v130 offset:57600
v_mfma_f32_16x16x32_bf16 v[100:103], v[16:19], v[196:199], v[100:103]
v_cvt_pk_bf16_f32 v200, v6, v7
v_mfma_f32_16x16x32_bf16 a[36:39], a[32:35], v[192:195], a[36:39]
s_waitcnt lgkmcnt(4)
v_mfma_f32_16x16x32_bf16 v[40:43], v[20:23], v[192:195], v[40:43]
ds_read_b64_tr_b16 v[16:17], v131 offset:49152
ds_read_b64_tr_b16 v[18:19], v131 offset:57344
v_mfma_f32_16x16x32_bf16 v[44:47], v[20:23], v[196:199], v[44:47]
v_mov_b32 v8, 0
v_exp_f32 v10, v10
v_exp_f32 v11, v11
v_lshlrev_b32 v6, 16, v201
v_and_b32 v7, s50, v201
v_pk_fma_f32 v[6:7], v[6:7], s[48:49], v[0:1] op_sel_hi:[1,0,0]
v_mfma_f32_16x16x32_bf16 v[104:107], v[24:27], v[192:195], v[104:107]
ds_read_b64_tr_b16 v[20:21], v131 offset:49408
ds_read_b64_tr_b16 v[22:23], v131 offset:57600
v_mfma_f32_16x16x32_bf16 v[108:111], v[24:27], v[196:199], v[108:111]
v_cvt_pk_bf16_f32 v204, v10, v11
v_mfma_f32_16x16x32_bf16 a[40:43], a[32:35], v[196:199], a[40:43]
s_waitcnt lgkmcnt(4)
v_mfma_f32_16x16x32_bf16 v[48:51], v[28:31], v[192:195], v[48:51]
ds_read_b64_tr_b16 v[24:25], v132 offset:49152
ds_read_b64_tr_b16 v[26:27], v132 offset:57344
v_mfma_f32_16x16x32_bf16 v[52:55], v[28:31], v[196:199], v[52:55]
ds_read_b32 v8, v8 offset:14336
v_exp_f32 v6, v6
v_exp_f32 v7, v7
v_lshlrev_b32 v10, 16, v205
v_and_b32 v11, s50, v205
v_pk_fma_f32 v[10:11], v[10:11], s[48:49], v[2:3] op_sel_hi:[1,0,0]
v_mfma_f32_16x16x32_bf16 v[112:115], v[12:15], v[192:195], v[112:115]
ds_read_b64_tr_b16 v[28:29], v132 offset:49408
ds_read_b64_tr_b16 v[30:31], v132 offset:57600
v_mfma_f32_16x16x32_bf16 v[116:119], v[12:15], v[196:199], v[116:119]
v_cvt_pk_bf16_f32 v201, v6, v7
s_waitcnt lgkmcnt(5)
v_mfma_f32_16x16x32_bf16 v[56:59], v[16:19], v[192:195], v[56:59]
ds_read_b64_tr_b16 v[12:13], v133 offset:49152
ds_read_b64_tr_b16 v[14:15], v133 offset:57344
v_mfma_f32_16x16x32_bf16 v[60:63], v[16:19], v[196:199], v[60:63]
v_exp_f32 v10, v10
v_exp_f32 v11, v11
v_lshlrev_b32 v6, 16, v202
v_and_b32 v7, s50, v202
v_pk_fma_f32 v[6:7], v[6:7], s[48:49], v[0:1] op_sel_hi:[1,0,0]
v_mfma_f32_16x16x32_bf16 v[120:123], v[20:23], v[192:195], v[120:123]
ds_read_b64_tr_b16 v[16:17], v133 offset:49408
ds_read_b64_tr_b16 v[18:19], v133 offset:57600
v_mfma_f32_16x16x32_bf16 v[124:127], v[20:23], v[196:199], v[124:127]
v_cvt_pk_bf16_f32 v205, v10, v11
s_waitcnt lgkmcnt(4)
v_mfma_f32_16x16x32_bf16 v[64:67], v[24:27], v[192:195], v[64:67]
ds_read_b64_tr_b16 v[20:21], v134 offset:49152
ds_read_b64_tr_b16 v[22:23], v134 offset:57344
v_mfma_f32_16x16x32_bf16 v[68:71], v[24:27], v[196:199], v[68:71]
v_cmp_le_u32 vcc, 60, v8
v_exp_f32 v6, v6
v_exp_f32 v7, v7
v_lshlrev_b32 v10, 16, v206
v_and_b32 v11, s50, v206
v_pk_fma_f32 v[10:11], v[10:11], s[48:49], v[2:3] op_sel_hi:[1,0,0]
v_mfma_f32_16x16x32_bf16 a[0:3], v[28:31], v[192:195], a[0:3]
ds_read_b64_tr_b16 v[24:25], v134 offset:49408
ds_read_b64_tr_b16 v[26:27], v134 offset:57600
v_mfma_f32_16x16x32_bf16 a[4:7], v[28:31], v[196:199], a[4:7]
v_cvt_pk_bf16_f32 v202, v6, v7
s_waitcnt lgkmcnt(4)
v_mfma_f32_16x16x32_bf16 v[72:75], v[12:15], v[192:195], v[72:75]
ds_read_b64_tr_b16 v[28:29], v135 offset:49152
ds_read_b64_tr_b16 v[30:31], v135 offset:57344
v_mfma_f32_16x16x32_bf16 v[76:79], v[12:15], v[196:199], v[76:79]
s_cbranch_vccz L_sp51
L_ok51:
v_exp_f32 v10, v10
v_exp_f32 v11, v11
v_lshlrev_b32 v6, 16, v203
v_and_b32 v7, s50, v203
v_pk_fma_f32 v[6:7], v[6:7], s[48:49], v[0:1] op_sel_hi:[1,0,0]
v_mfma_f32_16x16x32_bf16 a[8:11], v[16:19], v[192:195], a[8:11]
ds_read_b64_tr_b16 v[12:13], v135 offset:49408
ds_read_b64_tr_b16 v[14:15], v135 offset:57600
v_mfma_f32_16x16x32_bf16 a[12:15], v[16:19], v[196:199], a[12:15]
v_cvt_pk_bf16_f32 v206, v10, v11
s_waitcnt lgkmcnt(4)
v_mfma_f32_16x16x32_bf16 v[80:83], v[20:23], v[192:195], v[80:83]
ds_read_b64_tr_b16 v[16:17], v144
ds_read_b64_tr_b16 v[18:19], v144 offset:8192
v_mfma_f32_16x16x32_bf16 v[84:87], v[20:23], v[196:199], v[84:87]
v_exp_f32 v6, v6
v_exp_f32 v7, v7
v_lshlrev_b32 v10, 16, v207
v_and_b32 v11, s50, v207
v_pk_fma_f32 v[10:11], v[10:11], s[48:49], v[2:3] op_sel_hi:[1,0,0]
v_mfma_f32_16x16x32_bf16 a[16:19], v[24:27], v[192:195], a[16:19]
ds_read_b64_tr_b16 v[20:21], v144 offset:256
ds_read_b64_tr_b16 v[22:23], v144 offset:8448
v_mfma_f32_16x16x32_bf16 a[20:23], v[24:27], v[196:199], a[20:23]
v_cvt_pk_bf16_f32 v203, v6, v7
s_waitcnt lgkmcnt(4)
v_mfma_f32_16x16x32_bf16 v[88:91], v[28:31], v[192:195], v[88:91]
ds_read_b64_tr_b16 v[24:25], v145
ds_read_b64_tr_b16 v[26:27], v145 offset:8192
v_mfma_f32_16x16x32_bf16 v[92:95], v[28:31], v[196:199], v[92:95]
v_exp_f32 v10, v10
v_exp_f32 v11, v11
v_lshlrev_b32 v6, 16, v208
v_and_b32 v7, s50, v208
v_pk_fma_f32 v[6:7], v[6:7], s[48:49], v[0:1] op_sel_hi:[1,0,0]
v_mfma_f32_16x16x32_bf16 a[24:27], v[12:15], v[192:195], a[24:27]
ds_read_b64_tr_b16 v[28:29], v145 offset:256
ds_read_b64_tr_b16 v[30:31], v145 offset:8448
v_mfma_f32_16x16x32_bf16 a[28:31], v[12:15], v[196:199], a[28:31]
v_cvt_pk_bf16_f32 v207, v10, v11
s_waitcnt lgkmcnt(4)
v_mfma_f32_16x16x32_bf16 v[32:35], v[16:19], v[200:203], v[32:35]
ds_read_b64_tr_b16 v[12:13], v146
ds_read_b64_tr_b16 v[14:15], v146 offset:8192
v_mfma_f32_16x16x32_bf16 v[36:39], v[16:19], v[204:207], v[36:39]
v_exp_f32 v6, v6
v_exp_f32 v7, v7
v_lshlrev_b32 v10, 16, v212
v_and_b32 v11, s50, v212
v_pk_fma_f32 v[10:11], v[10:11], s[48:49], v[2:3] op_sel_hi:[1,0,0]
v_mfma_f32_16x16x32_bf16 v[96:99], v[20:23], v[200:203], v[96:99]
ds_read_b64_tr_b16 v[16:17], v146 offset:256
ds_read_b64_tr_b16 v[18:19], v146 offset:8448
v_mfma_f32_16x16x32_bf16 v[100:103], v[20:23], v[204:207], v[100:103]
v_cvt_pk_bf16_f32 v208, v6, v7
v_mfma_f32_16x16x32_bf16 a[36:39], a[32:35], v[200:203], a[36:39]
s_waitcnt lgkmcnt(4)
v_mfma_f32_16x16x32_bf16 v[40:43], v[24:27], v[200:203], v[40:43]
ds_read_b64_tr_b16 v[20:21], v147
ds_read_b64_tr_b16 v[22:23], v147 offset:8192
v_mfma_f32_16x16x32_bf16 v[44:47], v[24:27], v[204:207], v[44:47]
v_exp_f32 v10, v10
v_exp_f32 v11, v11
v_lshlrev_b32 v6, 16, v209
v_and_b32 v7, s50, v209
v_pk_fma_f32 v[6:7], v[6:7], s[48:49], v[0:1] op_sel_hi:[1,0,0]
v_mfma_f32_16x16x32_bf16 v[104:107], v[28:31], v[200:203], v[104:107]
ds_read_b64_tr_b16 v[24:25], v147 offset:256
ds_read_b64_tr_b16 v[26:27], v147 offset:8448
v_mfma_f32_16x16x32_bf16 v[108:111], v[28:31], v[204:207], v[108:111]
v_cvt_pk_bf16_f32 v212, v10, v11
v_mfma_f32_16x16x32_bf16 a[40:43], a[32:35], v[204:207], a[40:43]
s_waitcnt lgkmcnt(4)
v_mfma_f32_16x16x32_bf16 v[48:51], v[12:15], v[200:203], v[48:51]
ds_read_b64_tr_b16 v[28:29], v148
ds_read_b64_tr_b16 v[30:31], v148 offset:8192
v_mfma_f32_16x16x32_bf16 v[52:55], v[12:15], v[204:207], v[52:55]
v_exp_f32 v6, v6
v_exp_f32 v7, v7
v_lshlrev_b32 v10, 16, v213
v_and_b32 v11, s50, v213
v_pk_fma_f32 v[10:11], v[10:11], s[48:49], v[2:3] op_sel_hi:[1,0,0]
v_mfma_f32_16x16x32_bf16 v[112:115], v[16:19], v[200:203], v[112:115]
ds_read_b64_tr_b16 v[12:13], v148 offset:256
ds_read_b64_tr_b16 v[14:15], v148 offset:8448
v_mfma_f32_16x16x32_bf16 v[116:119], v[16:19], v[204:207], v[116:119]
v_cvt_pk_bf16_f32 v209, v6, v7
s_waitcnt lgkmcnt(4)
v_mfma_f32_16x16x32_bf16 v[56:59], v[20:23], v[200:203], v[56:59]
ds_read_b64_tr_b16 v[16:17], v149
ds_read_b64_tr_b16 v[18:19], v149 offset:8192
v_mfma_f32_16x16x32_bf16 v[60:63], v[20:23], v[204:207], v[60:63]
v_exp_f32 v10, v10
v_exp_f32 v11, v11
v_lshlrev_b32 v6, 16, v210
v_and_b32 v7, s50, v210
v_pk_fma_f32 v[6:7], v[6:7], s[48:49], v[0:1] op_sel_hi:[1,0,0]
v_mfma_f32_16x16x32_bf16 v[120:123], v[24:27], v[200:203], v[120:123]
ds_read_b64_tr_b16 v[20:21], v149 offset:256
ds_read_b64_tr_b16 v[22:23], v149 offset:8448
v_mfma_f32_16x16x32_bf16 v[124:127], v[24:27], v[204:207], v[124:127]
v_cvt_pk_bf16_f32 v213, v10, v11
s_waitcnt lgkmcnt(4)
v_mfma_f32_16x16x32_bf16 v[64:67], v[28:31], v[200:203], v[64:67]
ds_read_b64_tr_b16 v[24:25], v150
ds_read_b64_tr_b16 v[26:27], v150 offset:8192
v_mfma_f32_16x16x32_bf16 v[68:71], v[28:31], v[204:207], v[68:71]
v_exp_f32 v6, v6
v_exp_f32 v7, v7
v_lshlrev_b32 v10, 16, v214
v_and_b32 v11, s50, v214
v_pk_fma_f32 v[10:11], v[10:11], s[48:49], v[2:3] op_sel_hi:[1,0,0]
v_mfma_f32_16x16x32_bf16 a[0:3], v[12:15], v[200:203], a[0:3]
ds_read_b64_tr_b16 v[28:29], v150 offset:256
ds_read_b64_tr_b16 v[30:31], v150 offset:8448
v_mfma_f32_16x16x32_bf16 a[4:7], v[12:15], v[204:207], a[4:7]
v_cvt_pk_bf16_f32 v210, v6, v7
s_waitcnt lgkmcnt(4)
v_mfma_f32_16x16x32_bf16 v[72:75], v[16:19], v[200:203], v[72:75]
ds_read_b64_tr_b16 v[12:13], v151
ds_read_b64_tr_b16 v[14:15], v151 offset:8192
v_mfma_f32_16x16x32_bf16 v[76:79], v[16:19], v[204:207], v[76:79]
v_exp_f32 v10, v10
v_exp_f32 v11, v11
v_lshlrev_b32 v6, 16, v211
v_and_b32 v7, s50, v211
v_pk_fma_f32 v[6:7], v[6:7], s[48:49], v[0:1] op_sel_hi:[1,0,0]
v_mfma_f32_16x16x32_bf16 a[8:11], v[20:23], v[200:203], a[8:11]
ds_read_b64_tr_b16 v[16:17], v151 offset:256
ds_read_b64_tr_b16 v[18:19], v151 offset:8448
v_mfma_f32_16x16x32_bf16 a[12:15], v[20:23], v[204:207], a[12:15]
v_cvt_pk_bf16_f32 v214, v10, v11
s_waitcnt lgkmcnt(4)
v_mfma_f32_16x16x32_bf16 v[80:83], v[24:27], v[200:203], v[80:83]
ds_read_b64_tr_b16 v[20:21], v136 offset:49152
ds_read_b64_tr_b16 v[22:23], v136 offset:57344
v_mfma_f32_16x16x32_bf16 v[84:87], v[24:27], v[204:207], v[84:87]
v_exp_f32 v6, v6
v_mfma_f32_16x16x32_bf16 a[16:19], v[28:31], v[200:203], a[16:19]
ds_read_b64_tr_b16 v[24:25], v136 offset:49408
ds_read_b64_tr_b16 v[26:27], v136 offset:57600
v_mfma_f32_16x16x32_bf16 a[20:23], v[28:31], v[204:207], a[20:23]
v_exp_f32 v7, v7
s_waitcnt lgkmcnt(4)
v_mfma_f32_16x16x32_bf16 v[88:91], v[12:15], v[200:203], v[88:91]
ds_read_b64_tr_b16 v[28:29], v137 offset:49152
ds_read_b64_tr_b16 v[30:31], v137 offset:57344
v_mfma_f32_16x16x32_bf16 v[92:95], v[12:15], v[204:207], v[92:95]
s_movk_i32 s12, 208
v_lshlrev_b32 v10, 16, v215
v_mfma_f32_16x16x32_bf16 a[24:27], v[16:19], v[200:203], a[24:27]
ds_read_b64_tr_b16 v[12:13], v137 offset:49408
ds_read_b64_tr_b16 v[14:15], v137 offset:57600
v_mfma_f32_16x16x32_bf16 a[28:31], v[16:19], v[204:207], a[28:31]
v_and_b32 v11, s50, v215
s_waitcnt lgkmcnt(4)
v_mfma_f32_16x16x32_bf16 a[128:131], v[20:23], a[96:99], a[128:131]
ds_read_b64_tr_b16 v[16:17], v138 offset:49152
ds_read_b64_tr_b16 v[18:19], v138 offset:57344
v_mfma_f32_16x16x32_bf16 a[132:135], v[20:23], a[100:103], a[132:135]
buffer_load_dword off, s[8:11], s12 lds
v_mfma_f32_16x16x32_bf16 a[192:195], v[24:27], a[96:99], a[192:195]
ds_read_b64_tr_b16 v[20:21], v138 offset:49408
v_cvt_pk_bf16_f32 v211, v6, v7
v_mfma_f32_16x16x32_bf16 a[196:199], v[24:27], a[100:103], a[196:199]
ds_read_b64_tr_b16 v[22:23], v138 offset:57600
s_waitcnt lgkmcnt(4)
v_mfma_f32_16x16x32_bf16 a[136:139], v[28:31], a[96:99], a[136:139]
ds_read_b64_tr_b16 v[24:25], v139 offset:49152
v_mov_b32 v8, 0
v_mfma_f32_16x16x32_bf16 a[140:143], v[28:31], a[100:103], a[140:143]
ds_read_b64_tr_b16 v[26:27], v139 offset:57344
v_fma_f32 v10, v10, s48, v2
v_mfma_f32_16x16x32_bf16 a[200:203], v[12:15], a[96:99], a[200:203]
ds_read_b64_tr_b16 v[28:29], v139 offset:49408
v_fma_f32 v11, v11, s48, v2
v_mfma_f32_16x16x32_bf16 a[204:207], v[12:15], a[100:103], a[204:207]
ds_read_b64_tr_b16 v[30:31], v139 offset:57600
s_waitcnt lgkmcnt(4)
v_mfma_f32_16x16x32_bf16 a[144:147], v[16:19], a[96:99], a[144:147]
ds_read_b64_tr_b16 v[12:13], v140 offset:49152
v_exp_f32 v10, v10
v_mfma_f32_16x16x32_bf16 a[148:151], v[16:19], a[100:103], a[148:151]
ds_read_b64_tr_b16 v[14:15], v140 offset:57344
ds_read_b32 v8, v8 offset:14336
v_mfma_f32_16x16x32_bf16 a[208:211], v[20:23], a[96:99], a[208:211]
ds_read_b64_tr_b16 v[16:17], v140 offset:49408
v_exp_f32 v11, v11
v_mfma_f32_16x16x32_bf16 a[212:215], v[20:23], a[100:103], a[212:215]
ds_read_b64_tr_b16 v[18:19], v140 offset:57600
s_waitcnt lgkmcnt(5)
v_mfma_f32_16x16x32_bf16 a[152:155], v[24:27], a[96:99], a[152:155]
ds_read_b64_tr_b16 v[20:21], v141 offset:49152
v_lshlrev_b32 v6, 16, v216
v_mfma_f32_16x16x32_bf16 a[156:159], v[24:27], a[100:103], a[156:159]
ds_read_b64_tr_b16 v[22:23], v141 offset:57344
v_and_b32 v7, s50, v216
v_mfma_f32_16x16x32_bf16 a[216:219], v[28:31], a[96:99], a[216:219]
ds_read_b64_tr_b16 v[24:25], v141 offset:49408
v_cvt_pk_bf16_f32 v215, v10, v11
v_mfma_f32_16x16x32_bf16 a[220:223], v[28:31], a[100:103], a[220:223]
ds_read_b64_tr_b16 v[26:27], v141 offset:57600
s_waitcnt lgkmcnt(4)
v_mfma_f32_16x16x32_bf16 a[160:163], v[12:15], a[96:99], a[160:163]
ds_read_b64_tr_b16 v[28:29], v142 offset:49152
v_cmp_le_u32 vcc, 61, v8
v_mfma_f32_16x16x32_bf16 a[164:167], v[12:15], a[100:103], a[164:167]
ds_read_b64_tr_b16 v[30:31], v142 offset:57344
v_fma_f32 v6, v6, s48, v0
v_mfma_f32_16x16x32_bf16 a[224:227], v[16:19], a[96:99], a[224:227]
ds_read_b64_tr_b16 v[12:13], v142 offset:49408
v_fma_f32 v7, v7, s48, v0
v_mfma_f32_16x16x32_bf16 a[228:231], v[16:19], a[100:103], a[228:231]
ds_read_b64_tr_b16 v[14:15], v142 offset:57600
s_waitcnt lgkmcnt(4)
v_mfma_f32_16x16x32_bf16 a[168:171], v[20:23], a[96:99], a[168:171]
ds_read_b64_tr_b16 v[16:17], v143 offset:49152
ds_read_b64_tr_b16 v[18:19], v143 offset:57344
v_mfma_f32_16x16x32_bf16 a[172:175], v[20:23], a[100:103], a[172:175]
s_cbranch_vccz L_sp53
L_ok53:
v_mfma_f32_16x16x32_bf16 a[232:235], v[24:27], a[96:99], a[232:235]
ds_read_b64_tr_b16 v[20:21], v143 offset:49408
v_mfma_f32_16x16x32_bf16 a[236:239], v[24:27], a[100:103], a[236:239]
ds_read_b64_tr_b16 v[22:23], v143 offset:57600
s_waitcnt lgkmcnt(4)
v_mfma_f32_16x16x32_bf16 a[176:179], v[28:31], a[96:99], a[176:179]
ds_read_b64_tr_b16 v[24:25], v136 offset:32768
v_mfma_f32_16x16x32_bf16 a[180:183], v[28:31], a[100:103], a[180:183]
ds_read_b64_tr_b16 v[26:27], v136 offset:40960
v_mfma_f32_16x16x32_bf16 a[240:243], v[12:15], a[96:99], a[240:243]
ds_read_b64_tr_b16 v[28:29], v136 offset:33024
v_mfma_f32_16x16x32_bf16 a[244:247], v[12:15], a[100:103], a[244:247]
ds_read_b64_tr_b16 v[30:31], v136 offset:41216
s_waitcnt lgkmcnt(4)
v_mfma_f32_16x16x32_bf16 a[184:187], v[16:19], a[96:99], a[184:187]
ds_read_b64_tr_b16 v[12:13], v137 offset:32768
v_mfma_f32_16x16x32_bf16 a[188:191], v[16:19], a[100:103], a[188:191]
ds_read_b64_tr_b16 v[14:15], v137 offset:40960
v_mfma_f32_16x16x32_bf16 a[248:251], v[20:23], a[96:99], a[248:251]
ds_read_b64_tr_b16 v[16:17], v137 offset:33024
v_mfma_f32_16x16x32_bf16 a[252:255], v[20:23], a[100:103], a[252:255]
ds_read_b64_tr_b16 v[18:19], v137 offset:41216
s_waitcnt lgkmcnt(4)
v_mfma_f32_16x16x32_bf16 v[32:35], v[24:27], v[208:211], v[32:35]
ds_read_b64_tr_b16 v[20:21], v138 offset:32768
ds_read_b64_tr_b16 v[22:23], v138 offset:40960
v_mfma_f32_16x16x32_bf16 v[36:39], v[24:27], v[212:215], v[36:39]
v_exp_f32 v6, v6
v_exp_f32 v7, v7
v_lshlrev_b32 v10, 16, v220
v_and_b32 v11, s50, v220
v_pk_fma_f32 v[10:11], v[10:11], s[48:49], v[2:3] op_sel_hi:[1,0,0]
v_mfma_f32_16x16x32_bf16 v[96:99], v[28:31], v[208:211], v[96:99]
ds_read_b64_tr_b16 v[24:25], v138 offset:33024
ds_read_b64_tr_b16 v[26:27], v138 offset:41216
v_mfma_f32_16x16x32_bf16 v[100:103], v[28:31], v[212:215], v[100:103]
v_cvt_pk_bf16_f32 v216, v6, v7
v_mfma_f32_16x16x32_bf16 a[36:39], a[32:35], v[208:211], a[36:39]
s_waitcnt lgkmcnt(4)
v_mfma_f32_16x16x32_bf16 v[40:43], v[12:15], v[208:211], v[40:43]
ds_read_b64_tr_b16 v[28:29], v139 offset:32768
ds_read_b64_tr_b16 v[30:31], v139 offset:40960
v_mfma_f32_16x16x32_bf16 v[44:47], v[12:15], v[212:215], v[44:47]
v_mov_b32 v8, 0
v_exp_f32 v10, v10
v_exp_f32 v11, v11
v_lshlrev_b32 v6, 16, v217
v_and_b32 v7, s50, v217
v_pk_fma_f32 v[6:7], v[6:7], s[48:49], v[0:1] op_sel_hi:[1,0,0]
v_mfma_f32_16x16x32_bf16 v[104:107], v[16:19], v[208:211], v[104:107]
ds_read_b64_tr_b16 v[12:13], v139 offset:33024
ds_read_b64_tr_b16 v[14:15], v139 offset:41216
v_mfma_f32_16x16x32_bf16 v[108:111], v[16:19], v[212:215], v[108:111]
v_cvt_pk_bf16_f32 v220, v10, v11
v_mfma_f32_16x16x32_bf16 a[40:43], a[32:35], v[212:215], a[40:43]
s_waitcnt lgkmcnt(4)
v_mfma_f32_16x16x32_bf16 v[48:51], v[20:23], v[208:211], v[48:51]
ds_read_b64_tr_b16 v[16:17], v140 offset:32768
ds_read_b64_tr_b16 v[18:19], v140 offset:40960
v_mfma_f32_16x16x32_bf16 v[52:55], v[20:23], v[212:215], v[52:55]
ds_read_b32 v8, v8 offset:14336
v_exp_f32 v6, v6
v_exp_f32 v7, v7
v_lshlrev_b32 v10, 16, v221
v_and_b32 v11, s50, v221
v_pk_fma_f32 v[10:11], v[10:11], s[48:49], v[2:3] op_sel_hi:[1,0,0]
v_mfma_f32_16x16x32_bf16 v[112:115], v[24:27], v[208:211], v[112:115]
ds_read_b64_tr_b16 v[20:21], v140 offset:33024
ds_read_b64_tr_b16 v[22:23], v140 offset:41216
v_mfma_f32_16x16x32_bf16 v[116:119], v[24:27], v[212:215], v[116:119]
v_cvt_pk_bf16_f32 v217, v6, v7
s_waitcnt lgkmcnt(5)
v_mfma_f32_16x16x32_bf16 v[56:59], v[28:31], v[208:211], v[56:59]
ds_read_b64_tr_b16 v[24:25], v141 offset:32768
ds_read_b64_tr_b16 v[26:27], v141 offset:40960
v_mfma_f32_16x16x32_bf16 v[60:63], v[28:31], v[212:215], v[60:63]
v_exp_f32 v10, v10
v_exp_f32 v11, v11
v_lshlrev_b32 v6, 16, v218
v_and_b32 v7, s50, v218
v_pk_fma_f32 v[6:7], v[6:7], s[48:49], v[0:1] op_sel_hi:[1,0,0]
v_mfma_f32_16x16x32_bf16 v[120:123], v[12:15], v[208:211], v[120:123]
ds_read_b64_tr_b16 v[28:29], v141 offset:33024
ds_read_b64_tr_b16 v[30:31], v141 offset:41216
v_mfma_f32_16x16x32_bf16 v[124:127], v[12:15], v[212:215], v[124:127]
v_cvt_pk_bf16_f32 v221, v10, v11
s_waitcnt lgkmcnt(4)
v_mfma_f32_16x16x32_bf16 v[64:67], v[16:19], v[208:211], v[64:67]
ds_read_b64_tr_b16 v[12:13], v142 offset:32768
ds_read_b64_tr_b16 v[14:15], v142 offset:40960
v_mfma_f32_16x16x32_bf16 v[68:71], v[16:19], v[212:215], v[68:71]
v_cmp_le_u32 vcc, 62, v8
v_exp_f32 v6, v6
v_exp_f32 v7, v7
v_lshlrev_b32 v10, 16, v222
v_and_b32 v11, s50, v222
v_pk_fma_f32 v[10:11], v[10:11], s[48:49], v[2:3] op_sel_hi:[1,0,0]
v_mfma_f32_16x16x32_bf16 a[0:3], v[20:23], v[208:211], a[0:3]
ds_read_b64_tr_b16 v[16:17], v142 offset:33024
ds_read_b64_tr_b16 v[18:19], v142 offset:41216
v_mfma_f32_16x16x32_bf16 a[4:7], v[20:23], v[212:215], a[4:7]
v_cvt_pk_bf16_f32 v218, v6, v7
s_waitcnt lgkmcnt(4)
v_mfma_f32_16x16x32_bf16 v[72:75], v[24:27], v[208:211], v[72:75]
ds_read_b64_tr_b16 v[20:21], v143 offset:32768
ds_read_b64_tr_b16 v[22:23], v143 offset:40960
v_mfma_f32_16x16x32_bf16 v[76:79], v[24:27], v[212:215], v[76:79]
s_cbranch_vccz L_sp54
L_ok54:
v_exp_f32 v10, v10
v_exp_f32 v11, v11
v_lshlrev_b32 v6, 16, v219
v_and_b32 v7, s50, v219
v_pk_fma_f32 v[6:7], v[6:7], s[48:49], v[0:1] op_sel_hi:[1,0,0]
v_mfma_f32_16x16x32_bf16 a[8:11], v[28:31], v[208:211], a[8:11]
ds_read_b64_tr_b16 v[24:25], v143 offset:33024
ds_read_b64_tr_b16 v[26:27], v143 offset:41216
v_mfma_f32_16x16x32_bf16 a[12:15], v[28:31], v[212:215], a[12:15]
v_cvt_pk_bf16_f32 v222, v10, v11
s_waitcnt lgkmcnt(4)
v_mfma_f32_16x16x32_bf16 v[80:83], v[12:15], v[208:211], v[80:83]
ds_read_b64_tr_b16 v[28:29], v136 offset:16384
ds_read_b64_tr_b16 v[30:31], v136 offset:24576
v_mfma_f32_16x16x32_bf16 v[84:87], v[12:15], v[212:215], v[84:87]
v_exp_f32 v6, v6
v_exp_f32 v7, v7
v_lshlrev_b32 v10, 16, v223
v_and_b32 v11, s50, v223
v_pk_fma_f32 v[10:11], v[10:11], s[48:49], v[2:3] op_sel_hi:[1,0,0]
v_mfma_f32_16x16x32_bf16 a[16:19], v[16:19], v[208:211], a[16:19]
ds_read_b64_tr_b16 v[12:13], v136 offset:16640
ds_read_b64_tr_b16 v[14:15], v136 offset:24832
v_mfma_f32_16x16x32_bf16 a[20:23], v[16:19], v[212:215], a[20:23]
v_cvt_pk_bf16_f32 v219, v6, v7
s_waitcnt lgkmcnt(4)
v_mfma_f32_16x16x32_bf16 v[88:91], v[20:23], v[208:211], v[88:91]
ds_read_b64_tr_b16 v[16:17], v137 offset:16384
ds_read_b64_tr_b16 v[18:19], v137 offset:24576
v_mfma_f32_16x16x32_bf16 v[92:95], v[20:23], v[212:215], v[92:95]
s_movk_i32 s12, 216
v_exp_f32 v10, v10
v_exp_f32 v11, v11
v_lshlrev_b32 v6, 16, v224
v_and_b32 v7, s50, v224
v_pk_fma_f32 v[6:7], v[6:7], s[48:49], v[0:1] op_sel_hi:[1,0,0]
v_mfma_f32_16x16x32_bf16 a[24:27], v[24:27], v[208:211], a[24:27]
ds_read_b64_tr_b16 v[20:21], v137 offset:16640
ds_read_b64_tr_b16 v[22:23], v137 offset:24832
v_mfma_f32_16x16x32_bf16 a[28:31], v[24:27], v[212:215], a[28:31]
v_cvt_pk_bf16_f32 v223, v10, v11
s_waitcnt lgkmcnt(4)
v_mfma_f32_16x16x32_bf16 v[32:35], v[28:31], v[216:219], v[32:35]
ds_read_b64_tr_b16 v[24:25], v138 offset:16384
ds_read_b64_tr_b16 v[26:27], v138 offset:24576
v_mfma_f32_16x16x32_bf16 v[36:39], v[28:31], v[220:223], v[36:39]
buffer_load_dword off, s[8:11], s12 lds
v_exp_f32 v6, v6
v_exp_f32 v7, v7
v_lshlrev_b32 v10, 16, v228
v_and_b32 v11, s50, v228
v_pk_fma_f32 v[10:11], v[10:11], s[48:49], v[2:3] op_sel_hi:[1,0,0]
v_mfma_f32_16x16x32_bf16 v[96:99], v[12:15], v[216:219], v[96:99]
ds_read_b64_tr_b16 v[28:29], v138 offset:16640
ds_read_b64_tr_b16 v[30:31], v138 offset:24832
v_mfma_f32_16x16x32_bf16 v[100:103], v[12:15], v[220:223], v[100:103]
v_cvt_pk_bf16_f32 v224, v6, v7
v_mfma_f32_16x16x32_bf16 a[36:39], a[32:35], v[216:219], a[36:39]
s_waitcnt lgkmcnt(4)
v_mfma_f32_16x16x32_bf16 v[40:43], v[16:19], v[216:219], v[40:43]
ds_read_b64_tr_b16 v[12:13], v139 offset:16384
ds_read_b64_tr_b16 v[14:15], v139 offset:24576
v_mfma_f32_16x16x32_bf16 v[44:47], v[16:19], v[220:223], v[44:47]
v_mov_b32 v8, 0
v_exp_f32 v10, v10
v_exp_f32 v11, v11
v_lshlrev_b32 v6, 16, v225
v_and_b32 v7, s50, v225
v_pk_fma_f32 v[6:7], v[6:7], s[48:49], v[0:1] op_sel_hi:[1,0,0]
v_mfma_f32_16x16x32_bf16 v[104:107], v[20:23], v[216:219], v[104:107]
ds_read_b64_tr_b16 v[16:17], v139 offset:16640
ds_read_b64_tr_b16 v[18:19], v139 offset:24832
v_mfma_f32_16x16x32_bf16 v[108:111], v[20:23], v[220:223], v[108:111]
v_cvt_pk_bf16_f32 v228, v10, v11
v_mfma_f32_16x16x32_bf16 a[40:43], a[32:35], v[220:223], a[40:43]
s_waitcnt lgkmcnt(4)
v_mfma_f32_16x16x32_bf16 v[48:51], v[24:27], v[216:219], v[48:51]
ds_read_b64_tr_b16 v[20:21], v140 offset:16384
ds_read_b64_tr_b16 v[22:23], v140 offset:24576
v_mfma_f32_16x16x32_bf16 v[52:55], v[24:27], v[220:223], v[52:55]
s_branch L_pg10
L_sp55:
v_mov_b32 v8, 0
ds_read_b32 v8, v8 offset:14336
s_waitcnt lgkmcnt(0)
v_cmp_le_u32 vcc, 64, v8
s_cbranch_vccz L_sp55
s_branch L_ok55
L_sp57:
v_mov_b32 v8, 0
ds_read_b32 v8, v8 offset:14336
s_waitcnt lgkmcnt(0)
v_cmp_le_u32 vcc, 65, v8
s_cbranch_vccz L_sp57
s_branch L_ok57
L_sp58:
v_mov_b32 v8, 0
ds_read_b32 v8, v8 offset:14336
s_waitcnt lgkmcnt(0)
v_cmp_le_u32 vcc, 66, v8
s_cbranch_vccz L_sp58
s_branch L_ok58
.p2align 12
L_stub10:
s_setpc_b64 s[94:95]
L_pg10:
ds_read_b32 v8, v8 offset:14336
v_exp_f32 v6, v6
v_exp_f32 v7, v7
v_lshlrev_b32 v10, 16, v229
v_and_b32 v11, s50, v229
v_pk_fma_f32 v[10:11], v[10:11], s[48:49], v[2:3] op_sel_hi:[1,0,0]
v_mfma_f32_16x16x32_bf16 v[112:115], v[28:31], v[216:219], v[112:115]
ds_read_b64_tr_b16 v[24:25], v140 offset:16640
ds_read_b64_tr_b16 v[26:27], v140 offset:24832
v_mfma_f32_16x16x32_bf16 v[116:119], v[28:31], v[220:223], v[116:119]
v_cvt_pk_bf16_f32 v225, v6, v7
s_waitcnt lgkmcnt(5)
v_mfma_f32_16x16x32_bf16 v[56:59], v[12:15], v[216:219], v[56:59]
ds_read_b64_tr_b16 v[28:29], v141 offset:16384
ds_read_b64_tr_b16 v[30:31], v141 offset:24576
v_mfma_f32_16x16x32_bf16 v[60:63], v[12:15], v[220:223], v[60:63]
v_exp_f32 v10, v10
v_exp_f32 v11, v11
v_lshlrev_b32 v6, 16, v226
v_and_b32 v7, s50, v226
v_pk_fma_f32 v[6:7], v[6:7], s[48:49], v[0:1] op_sel_hi:[1,0,0]
v_mfma_f32_16x16x32_bf16 v[120:123], v[16:19], v[216:219], v[120:123]
ds_read_b64_tr_b16 v[12:13], v141 offset:16640
ds_read_b64_tr_b16 v[14:15], v141 offset:24832
v_mfma_f32_16x16x32_bf16 v[124:127], v[16:19], v[220:223], v[124:127]
v_cvt_pk_bf16_f32 v229, v10, v11
s_waitcnt lgkmcnt(4)
v_mfma_f32_16x16x32_bf16 v[64:67], v[20:23], v[216:219], v[64:67]
ds_read_b64_tr_b16 v[16:17], v142 offset:16384
ds_read_b64_tr_b16 v[18:19], v142 offset:24576
v_mfma_f32_16x16x32_bf16 v[68:71], v[20:23], v[220:223], v[68:71]
v_cmp_le_u32 vcc, 64, v8
v_exp_f32 v6, v6
v_exp_f32 v7, v7
v_lshlrev_b32 v10, 16, v230
v_and_b32 v11, s50, v230
v_pk_fma_f32 v[10:11], v[10:11], s[48:49], v[2:3] op_sel_hi:[1,0,0]
v_mfma_f32_16x16x32_bf16 a[0:3], v[24:27], v[216:219], a[0:3]
ds_read_b64_tr_b16 v[20:21], v142 offset:16640
ds_read_b64_tr_b16 v[22:23], v142 offset:24832
v_mfma_f32_16x16x32_bf16 a[4:7], v[24:27], v[220:223], a[4:7]
v_cvt_pk_bf16_f32 v226, v6, v7
s_waitcnt lgkmcnt(4)
v_mfma_f32_16x16x32_bf16 v[72:75], v[28:31], v[216:219], v[72:75]
ds_read_b64_tr_b16 v[24:25], v143 offset:16384
ds_read_b64_tr_b16 v[26:27], v143 offset:24576
v_mfma_f32_16x16x32_bf16 v[76:79], v[28:31], v[220:223], v[76:79]
s_cbranch_vccz L_sp55
L_ok55:
v_exp_f32 v10, v10
v_exp_f32 v11, v11
v_lshlrev_b32 v6, 16, v227
v_and_b32 v7, s50, v227
v_pk_fma_f32 v[6:7], v[6:7], s[48:49], v[0:1] op_sel_hi:[1,0,0]
v_mfma_f32_16x16x32_bf16 a[8:11], v[12:15], v[216:219], a[8:11]
ds_read_b64_tr_b16 v[28:29], v143 offset:16640
ds_read_b64_tr_b16 v[30:31], v143 offset:24832
v_mfma_f32_16x16x32_bf16 a[12:15], v[12:15], v[220:223], a[12:15]
v_cvt_pk_bf16_f32 v230, v10, v11
s_waitcnt lgkmcnt(4)
v_mfma_f32_16x16x32_bf16 v[80:83], v[16:19], v[216:219], v[80:83]
ds_read_b64_tr_b16 v[12:13], v128 offset:32768
ds_read_b64_tr_b16 v[14:15], v128 offset:40960
v_mfma_f32_16x16x32_bf16 v[84:87], v[16:19], v[220:223], v[84:87]
v_exp_f32 v6, v6
v_exp_f32 v7, v7
v_lshlrev_b32 v10, 16, v231
v_and_b32 v11, s50, v231
v_pk_fma_f32 v[10:11], v[10:11], s[48:49], v[2:3] op_sel_hi:[1,0,0]
v_mfma_f32_16x16x32_bf16 a[16:19], v[20:23], v[216:219], a[16:19]
ds_read_b64_tr_b16 v[16:17], v128 offset:33024
ds_read_b64_tr_b16 v[18:19], v128 offset:41216
v_mfma_f32_16x16x32_bf16 a[20:23], v[20:23], v[220:223], a[20:23]
v_cvt_pk_bf16_f32 v227, v6, v7
s_waitcnt lgkmcnt(4)
v_mfma_f32_16x16x32_bf16 v[88:91], v[24:27], v[216:219], v[88:91]
ds_read_b64_tr_b16 v[20:21], v129 offset:32768
ds_read_b64_tr_b16 v[22:23], v129 offset:40960
v_mfma_f32_16x16x32_bf16 v[92:95], v[24:27], v[220:223], v[92:95]
v_exp_f32 v10, v10
v_exp_f32 v11, v11
v_lshlrev_b32 v6, 16, v232
v_and_b32 v7, s50, v232
v_pk_fma_f32 v[6:7], v[6:7], s[48:49], v[0:1] op_sel_hi:[1,0,0]
v_mfma_f32_16x16x32_bf16 a[24:27], v[28:31], v[216:219], a[24:27]
ds_read_b64_tr_b16 v[24:25], v129 offset:33024
ds_read_b64_tr_b16 v[26:27], v129 offset:41216
v_mfma_f32_16x16x32_bf16 a[28:31], v[28:31], v[220:223], a[28:31]
v_cvt_pk_bf16_f32 v231, v10, v11
s_waitcnt lgkmcnt(4)
v_mfma_f32_16x16x32_bf16 v[32:35], v[12:15], v[224:227], v[32:35]
ds_read_b64_tr_b16 v[28:29], v130 offset:32768
ds_read_b64_tr_b16 v[30:31], v130 offset:40960
v_mfma_f32_16x16x32_bf16 v[36:39], v[12:15], v[228:231], v[36:39]
v_exp_f32 v6, v6
v_exp_f32 v7, v7
v_lshlrev_b32 v10, 16, v236
v_and_b32 v11, s50, v236
v_pk_fma_f32 v[10:11], v[10:11], s[48:49], v[2:3] op_sel_hi:[1,0,0]
v_mfma_f32_16x16x32_bf16 v[96:99], v[16:19], v[224:227], v[96:99]
ds_read_b64_tr_b16 v[12:13], v130 offset:33024
ds_read_b64_tr_b16 v[14:15], v130 offset:41216
v_mfma_f32_16x16x32_bf16 v[100:103], v[16:19], v[228:231], v[100:103]
v_cvt_pk_bf16_f32 v232, v6, v7
v_mfma_f32_16x16x32_bf16 a[36:39], a[32:35], v[224:227], a[36:39]
s_waitcnt lgkmcnt(4)
v_mfma_f32_16x16x32_bf16 v[40:43], v[20:23], v[224:227], v[40:43]
ds_read_b64_tr_b16 v[16:17], v131 offset:32768
ds_read_b64_tr_b16 v[18:19], v131 offset:40960
v_mfma_f32_16x16x32_bf16 v[44:47], v[20:23], v[228:231], v[44:47]
v_exp_f32 v10, v10
v_exp_f32 v11, v11
v_lshlrev_b32 v6, 16, v233
v_and_b32 v7, s50, v233
v_pk_fma_f32 v[6:7], v[6:7], s[48:49], v[0:1] op_sel_hi:[1,0,0]
v_mfma_f32_16x16x32_bf16 v[104:107], v[24:27], v[224:227], v[104:107]
ds_read_b64_tr_b16 v[20:21], v131 offset:33024
ds_read_b64_tr_b16 v[22:23], v131 offset:41216
v_mfma_f32_16x16x32_bf16 v[108:111], v[24:27], v[228:231], v[108:111]
v_cvt_pk_bf16_f32 v236, v10, v11
v_mfma_f32_16x16x32_bf16 a[40:43], a[32:35], v[228:231], a[40:43]
s_waitcnt lgkmcnt(4)
v_mfma_f32_16x16x32_bf16 v[48:51], v[28:31], v[224:227], v[48:51]
ds_read_b64_tr_b16 v[24:25], v132 offset:32768
ds_read_b64_tr_b16 v[26:27], v132 offset:40960
v_mfma_f32_16x16x32_bf16 v[52:55], v[28:31], v[228:231], v[52:55]
v_exp_f32 v6, v6
v_exp_f32 v7, v7
v_lshlrev_b32 v10, 16, v237
v_and_b32 v11, s50, v237
v_pk_fma_f32 v[10:11], v[10:11], s[48:49], v[2:3] op_sel_hi:[1,0,0]
v_mfma_f32_16x16x32_bf16 v[112:115], v[12:15], v[224:227], v[112:115]
ds_read_b64_tr_b16 v[28:29], v132 offset:33024
ds_read_b64_tr_b16 v[30:31], v132 offset:41216
v_mfma_f32_16x16x32_bf16 v[116:119], v[12:15], v[228:231], v[116:119]
v_cvt_pk_bf16_f32 v233, v6, v7
s_waitcnt lgkmcnt(4)
v_mfma_f32_16x16x32_bf16 v[56:59], v[16:19], v[224:227], v[56:59]
ds_read_b64_tr_b16 v[12:13], v133 offset:32768
ds_read_b64_tr_b16 v[14:15], v133 offset:40960
v_mfma_f32_16x16x32_bf16 v[60:63], v[16:19], v[228:231], v[60:63]
v_exp_f32 v10, v10
v_exp_f32 v11, v11
v_lshlrev_b32 v6, 16, v234
v_and_b32 v7, s50, v234
v_pk_fma_f32 v[6:7], v[6:7], s[48:49], v[0:1] op_sel_hi:[1,0,0]
v_mfma_f32_16x16x32_bf16 v[120:123], v[20:23], v[224:227], v[120:123]
ds_read_b64_tr_b16 v[16:17], v133 offset:33024
ds_read_b64_tr_b16 v[18:19], v133 offset:41216
v_mfma_f32_16x16x32_bf16 v[124:127], v[20:23], v[228:231], v[124:127]
v_cvt_pk_bf16_f32 v237, v10, v11
s_waitcnt lgkmcnt(4)
v_mfma_f32_16x16x32_bf16 v[64:67], v[24:27], v[224:227], v[64:67]
ds_read_b64_tr_b16 v[20:21], v134 offset:32768
ds_read_b64_tr_b16 v[22:23], v134 offset:40960
v_mfma_f32_16x16x32_bf16 v[68:71], v[24:27], v[228:231], v[68:71]
v_exp_f32 v6, v6
v_exp_f32 v7, v7
v_lshlrev_b32 v10, 16, v238
v_and_b32 v11, s50, v238
v_pk_fma_f32 v[10:11], v[10:11], s[48:49], v[2:3] op_sel_hi:[1,0,0]
v_mfma_f32_16x16x32_bf16 a[0:3], v[28:31], v[224:227], a[0:3]
ds_read_b64_tr_b16 v[24:25], v134 offset:33024
ds_read_b64_tr_b16 v[26:27], v134 offset:41216
v_mfma_f32_16x16x32_bf16 a[4:7], v[28:31], v[228:231], a[4:7]
v_cvt_pk_bf16_f32 v234, v6, v7
s_waitcnt lgkmcnt(4)
v_mfma_f32_16x16x32_bf16 v[72:75], v[12:15], v[224:227], v[72:75]
ds_read_b64_tr_b16 v[28:29], v135 offset:32768
ds_read_b64_tr_b16 v[30:31], v135 offset:40960
v_mfma_f32_16x16x32_bf16 v[76:79], v[12:15], v[228:231], v[76:79]
v_exp_f32 v10, v10
v_exp_f32 v11, v11
v_lshlrev_b32 v6, 16, v235
v_and_b32 v7, s50, v235
v_pk_fma_f32 v[6:7], v[6:7], s[48:49], v[0:1] op_sel_hi:[1,0,0]
v_mfma_f32_16x16x32_bf16 a[8:11], v[16:19], v[224:227], a[8:11]
ds_read_b64_tr_b16 v[12:13], v135 offset:33024
ds_read_b64_tr_b16 v[14:15], v135 offset:41216
v_mfma_f32_16x16x32_bf16 a[12:15], v[16:19], v[228:231], a[12:15]
v_cvt_pk_bf16_f32 v238, v10, v11
s_waitcnt lgkmcnt(4)
v_mfma_f32_16x16x32_bf16 v[80:83], v[20:23], v[224:227], v[80:83]
ds_read_b64_tr_b16 v[16:17], v144 offset:16384
ds_read_b64_tr_b16 v[18:19], v144 offset:24576
v_mfma_f32_16x16x32_bf16 v[84:87], v[20:23], v[228:231], v[84:87]
v_exp_f32 v6, v6
v_mfma_f32_16x16x32_bf16 a[16:19], v[24:27], v[224:227], a[16:19]
ds_read_b64_tr_b16 v[20:21], v144 offset:16640
ds_read_b64_tr_b16 v[22:23], v144 offset:24832
v_mfma_f32_16x16x32_bf16 a[20:23], v[24:27], v[228:231], a[20:23]
v_exp_f32 v7, v7
s_waitcnt lgkmcnt(4)
v_mfma_f32_16x16x32_bf16 v[88:91], v[28:31], v[224:227], v[88:91]
ds_read_b64_tr_b16 v[24:25], v145 offset:16384
ds_read_b64_tr_b16 v[26:27], v145 offset:24576
v_mfma_f32_16x16x32_bf16 v[92:95], v[28:31], v[228:231], v[92:95]
s_movk_i32 s12, 224
v_lshlrev_b32 v10, 16, v239
v_mfma_f32_16x16x32_bf16 a[24:27], v[12:15], v[224:227], a[24:27]
ds_read_b64_tr_b16 v[28:29], v145 offset:16640
ds_read_b64_tr_b16 v[30:31], v145 offset:24832
v_mfma_f32_16x16x32_bf16 a[28:31], v[12:15], v[228:231], a[28:31]
v_and_b32 v11, s50, v239
s_waitcnt lgkmcnt(4)
v_mfma_f32_16x16x32_bf16 a[128:131], v[16:19], a[104:107], a[128:131]
ds_read_b64_tr_b16 v[12:13], v146 offset:16384
ds_read_b64_tr_b16 v[14:15], v146 offset:24576
v_mfma_f32_16x16x32_bf16 a[132:135], v[16:19], a[108:111], a[132:135]
buffer_load_dword off, s[8:11], s12 lds
v_mfma_f32_16x16x32_bf16 a[192:195], v[20:23], a[104:107], a[192:195]
ds_read_b64_tr_b16 v[16:17], v146 offset:16640
v_cvt_pk_bf16_f32 v235, v6, v7
v_mfma_f32_16x16x32_bf16 a[196:199], v[20:23], a[108:111], a[196:199]
ds_read_b64_tr_b16 v[18:19], v146 offset:24832
s_waitcnt lgkmcnt(4)
v_mfma_f32_16x16x32_bf16 a[136:139], v[24:27], a[104:107], a[136:139]
ds_read_b64_tr_b16 v[20:21], v147 offset:16384
v_mov_b32 v8, 0
v_mfma_f32_16x16x32_bf16 a[140:143], v[24:27], a[108:111], a[140:143]
ds_read_b64_tr_b16 v[22:23], v147 offset:24576
v_fma_f32 v10, v10, s48, v2
v_mfma_f32_16x16x32_bf16 a[200:203], v[28:31], a[104:107], a[200:203]
ds_read_b64_tr_b16 v[24:25], v147 offset:16640
v_fma_f32 v11, v11, s48, v2
v_mfma_f32_16x16x32_bf16 a[204:207], v[28:31], a[108:111], a[204:207]
ds_read_b64_tr_b16 v[26:27], v147 offset:24832
s_waitcnt lgkmcnt(4)
v_mfma_f32_16x16x32_bf16 a[144:147], v[12:15], a[104:107], a[144:147]
ds_read_b64_tr_b16 v[28:29], v148 offset:16384
v_exp_f32 v10, v10
v_mfma_f32_16x16x32_bf16 a[148:151], v[12:15], a[108:111], a[148:151]
ds_read_b64_tr_b16 v[30:31], v148 offset:24576
ds_read_b32 v8, v8 offset:14336
v_mfma_f32_16x16x32_bf16 a[208:211], v[16:19], a[104:107], a[208:211]
ds_read_b64_tr_b16 v[12:13], v148 offset:16640
v_exp_f32 v11, v11
v_mfma_f32_16x16x32_bf16 a[212:215], v[16:19], a[108:111], a[212:215]
ds_read_b64_tr_b16 v[14:15], v148 offset:24832
s_waitcnt lgkmcnt(5)
v_mfma_f32_16x16x32_bf16 a[152:155], v[20:23], a[104:107], a[152:155]
ds_read_b64_tr_b16 v[16:17], v149 offset:16384
v_lshlrev_b32 v6, 16, v240
v_mfma_f32_16x16x32_bf16 a[156:159], v[20:23], a[108:111], a[156:159]
ds_read_b64_tr_b16 v[18:19], v149 offset:24576
v_and_b32 v7, s50, v240
v_mfma_f32_16x16x32_bf16 a[216:219], v[24:27], a[104:107], a[216:219]
ds_read_b64_tr_b16 v[20:21], v149 offset:16640
v_cvt_pk_bf16_f32 v239, v10, v11
v_mfma_f32_16x16x32_bf16 a[220:223], v[24:27], a[108:111], a[220:223]
ds_read_b64_tr_b16 v[22:23], v149 offset:24832
s_waitcnt lgkmcnt(4)
v_mfma_f32_16x16x32_bf16 a[160:163], v[28:31], a[104:107], a[160:163]
ds_read_b64_tr_b16 v[24:25], v150 offset:16384
v_cmp_le_u32 vcc, 65, v8
v_mfma_f32_16x16x32_bf16 a[164:167], v[28:31], a[108:111], a[164:167]
ds_read_b64_tr_b16 v[26:27], v150 offset:24576
v_fma_f32 v6, v6, s48, v0
v_mfma_f32_16x16x32_bf16 a[224:227], v[12:15], a[104:107], a[224:227]
ds_read_b64_tr_b16 v[28:29], v150 offset:16640
v_fma_f32 v7, v7, s48, v0
v_mfma_f32_16x16x32_bf16 a[228:231], v[12:15], a[108:111], a[228:231]
ds_read_b64_tr_b16 v[30:31], v150 offset:24832
s_waitcnt lgkmcnt(4)
v_mfma_f32_16x16x32_bf16 a[168:171], v[16:19], a[104:107], a[168:171]
ds_read_b64_tr_b16 v[12:13], v151 offset:16384
ds_read_b64_tr_b16 v[14:15], v151 offset:24576
v_mfma_f32_16x16x32_bf16 a[172:175], v[16:19], a[108:111], a[172:175]
s_cbranch_vccz L_sp57
L_ok57:
v_mfma_f32_16x16x32_bf16 a[232:235], v[20:23], a[104:107], a[232:235]
ds_read_b64_tr_b16 v[16:17], v151 offset:16640
v_mfma_f32_16x16x32_bf16 a[236:239], v[20:23], a[108:111], a[236:239]
ds_read_b64_tr_b16 v[18:19], v151 offset:24832
s_waitcnt lgkmcnt(4)
v_mfma_f32_16x16x32_bf16 a[176:179], v[24:27], a[104:107], a[176:179]
ds_read_b64_tr_b16 v[20:21], v128 offset:16384
v_mfma_f32_16x16x32_bf16 a[180:183], v[24:27], a[108:111], a[180:183]
ds_read_b64_tr_b16 v[22:23], v128 offset:24576
v_mfma_f32_16x16x32_bf16 a[240:243], v[28:31], a[104:107], a[240:243]
ds_read_b64_tr_b16 v[24:25], v128 offset:16640
v_mfma_f32_16x16x32_bf16 a[244:247], v[28:31], a[108:111], a[244:247]
ds_read_b64_tr_b16 v[26:27], v128 offset:24832
s_waitcnt lgkmcnt(4)
v_mfma_f32_16x16x32_bf16 a[184:187], v[12:15], a[104:107], a[184:187]
ds_read_b64_tr_b16 v[28:29], v129 offset:16384
v_mfma_f32_16x16x32_bf16 a[188:191], v[12:15], a[108:111], a[188:191]
ds_read_b64_tr_b16 v[30:31], v129 offset:24576
v_mfma_f32_16x16x32_bf16 a[248:251], v[16:19], a[104:107], a[248:251]
ds_read_b64_tr_b16 v[12:13], v129 offset:16640
v_mfma_f32_16x16x32_bf16 a[252:255], v[16:19], a[108:111], a[252:255]
ds_read_b64_tr_b16 v[14:15], v129 offset:24832
s_waitcnt lgkmcnt(4)
v_mfma_f32_16x16x32_bf16 v[32:35], v[20:23], v[232:235], v[32:35]
ds_read_b64_tr_b16 v[16:17], v130 offset:16384
ds_read_b64_tr_b16 v[18:19], v130 offset:24576
v_mfma_f32_16x16x32_bf16 v[36:39], v[20:23], v[236:239], v[36:39]
v_exp_f32 v6, v6
v_exp_f32 v7, v7
v_lshlrev_b32 v10, 16, v244
v_and_b32 v11, s50, v244
v_pk_fma_f32 v[10:11], v[10:11], s[48:49], v[2:3] op_sel_hi:[1,0,0]
v_mfma_f32_16x16x32_bf16 v[96:99], v[24:27], v[232:235], v[96:99]
ds_read_b64_tr_b16 v[20:21], v130 offset:16640
ds_read_b64_tr_b16 v[22:23], v130 offset:24832
v_mfma_f32_16x16x32_bf16 v[100:103], v[24:27], v[236:239], v[100:103]
v_cvt_pk_bf16_f32 v240, v6, v7
v_accvgpr_read_b32 v192, a176
v_mfma_f32_16x16x32_bf16 a[36:39], a[32:35], v[232:235], a[36:39]
v_accvgpr_read_b32 v193, a177
v_cvt_pk_bf16_f32 v152, v192, v193
v_accvgpr_read_b32 v194, a178
s_waitcnt lgkmcnt(4)
v_mfma_f32_16x16x32_bf16 v[40:43], v[28:31], v[232:235], v[40:43]
ds_read_b64_tr_b16 v[24:25], v131 offset:16384
ds_read_b64_tr_b16 v[26:27], v131 offset:24576
v_mfma_f32_16x16x32_bf16 v[44:47], v[28:31], v[236:239], v[44:47]
v_mov_b32 v8, 0
v_exp_f32 v10, v10
v_exp_f32 v11, v11
v_lshlrev_b32 v6, 16, v241
v_and_b32 v7, s50, v241
v_pk_fma_f32 v[6:7], v[6:7], s[48:49], v[0:1] op_sel_hi:[1,0,0]
v_accvgpr_read_b32 v195, a179
v_cvt_pk_bf16_f32 v153, v194, v195
v_accvgpr_read_b32 v192, a184
v_accvgpr_read_b32 v193, a185
v_mfma_f32_16x16x32_bf16 v[104:107], v[12:15], v[232:235], v[104:107]
ds_read_b64_tr_b16 v[28:29], v131 offset:16640
ds_read_b64_tr_b16 v[30:31], v131 offset:24832
v_mfma_f32_16x16x32_bf16 v[108:111], v[12:15], v[236:239], v[108:111]
v_cvt_pk_bf16_f32 v244, v10, v11
v_cvt_pk_bf16_f32 v154, v192, v193
v_mfma_f32_16x16x32_bf16 a[40:43], a[32:35], v[236:239], a[40:43]
v_accvgpr_read_b32 v194, a186
v_accvgpr_read_b32 v195, a187
v_cvt_pk_bf16_f32 v155, v194, v195
s_waitcnt lgkmcnt(4)
v_mfma_f32_16x16x32_bf16 v[48:51], v[16:19], v[232:235], v[48:51]
ds_read_b64_tr_b16 v[12:13], v132 offset:16384
ds_read_b64_tr_b16 v[14:15], v132 offset:24576
v_mfma_f32_16x16x32_bf16 v[52:55], v[16:19], v[236:239], v[52:55]
ds_read_b32 v8, v8 offset:14336
v_exp_f32 v6, v6
v_exp_f32 v7, v7
v_lshlrev_b32 v10, 16, v245
v_and_b32 v11, s50, v245
v_pk_fma_f32 v[10:11], v[10:11], s[48:49], v[2:3] op_sel_hi:[1,0,0]
v_accvgpr_read_b32 v192, a180
v_accvgpr_read_b32 v193, a181
v_cvt_pk_bf16_f32 v156, v192, v193
v_accvgpr_read_b32 v194, a182
v_mfma_f32_16x16x32_bf16 v[112:115], v[20:23], v[232:235], v[112:115]
ds_read_b64_tr_b16 v[16:17], v132 offset:16640
ds_read_b64_tr_b16 v[18:19], v132 offset:24832
v_mfma_f32_16x16x32_bf16 v[116:119], v[20:23], v[236:239], v[116:119]
v_cvt_pk_bf16_f32 v241, v6, v7
v_accvgpr_read_b32 v195, a183
v_cvt_pk_bf16_f32 v157, v194, v195
v_accvgpr_read_b32 v192, a188
v_accvgpr_read_b32 v193, a189
s_waitcnt lgkmcnt(5)
v_mfma_f32_16x16x32_bf16 v[56:59], v[24:27], v[232:235], v[56:59]
ds_read_b64_tr_b16 v[20:21], v133 offset:16384
ds_read_b64_tr_b16 v[22:23], v133 offset:24576
v_mfma_f32_16x16x32_bf16 v[60:63], v[24:27], v[236:239], v[60:63]
v_exp_f32 v10, v10
v_exp_f32 v11, v11
v_lshlrev_b32 v6, 16, v242
v_and_b32 v7, s50, v242
v_pk_fma_f32 v[6:7], v[6:7], s[48:49], v[0:1] op_sel_hi:[1,0,0]
v_cvt_pk_bf16_f32 v158, v192, v193
v_accvgpr_read_b32 v194, a190
v_accvgpr_read_b32 v195, a191
v_cvt_pk_bf16_f32 v159, v194, v195
v_mfma_f32_16x16x32_bf16 v[120:123], v[28:31], v[232:235], v[120:123]
ds_read_b64_tr_b16 v[24:25], v133 offset:16640
ds_read_b64_tr_b16 v[26:27], v133 offset:24832
v_mfma_f32_16x16x32_bf16 v[124:127], v[28:31], v[236:239], v[124:127]
v_cvt_pk_bf16_f32 v245, v10, v11
v_permlane16_swap_b32 v152, v154
s_waitcnt lgkmcnt(4)
v_mfma_f32_16x16x32_bf16 v[64:67], v[12:15], v[232:235], v[64:67]
ds_read_b64_tr_b16 v[28:29], v134 offset:16384
ds_read_b64_tr_b16 v[30:31], v134 offset:24576
v_mfma_f32_16x16x32_bf16 v[68:71], v[12:15], v[236:239], v[68:71]
v_cmp_le_u32 vcc, 66, v8
v_exp_f32 v6, v6
v_exp_f32 v7, v7
v_lshlrev_b32 v10, 16, v246
v_and_b32 v11, s50, v246
v_pk_fma_f32 v[10:11], v[10:11], s[48:49], v[2:3] op_sel_hi:[1,0,0]
v_permlane16_swap_b32 v153, v155
v_permlane16_swap_b32 v156, v158
v_mfma_f32_16x16x32_bf16 a[0:3], v[16:19], v[232:235], a[0:3]
ds_read_b64_tr_b16 v[12:13], v134 offset:16640
ds_read_b64_tr_b16 v[14:15], v134 offset:24832
v_mfma_f32_16x16x32_bf16 a[4:7], v[16:19], v[236:239], a[4:7]
v_cvt_pk_bf16_f32 v242, v6, v7
v_permlane16_swap_b32 v157, v159
s_waitcnt lgkmcnt(4)
v_mfma_f32_16x16x32_bf16 v[72:75], v[20:23], v[232:235], v[72:75]
ds_read_b64_tr_b16 v[16:17], v135 offset:16384
ds_read_b64_tr_b16 v[18:19], v135 offset:24576
v_mfma_f32_16x16x32_bf16 v[76:79], v[20:23], v[236:239], v[76:79]
s_cbranch_vccz L_sp58
L_ok58:
v_exp_f32 v10, v10
v_exp_f32 v11, v11
v_lshlrev_b32 v6, 16, v243
v_and_b32 v7, s50, v243
v_pk_fma_f32 v[6:7], v[6:7], s[48:49], v[0:1] op_sel_hi:[1,0,0]
v_accvgpr_read_b32 v192, a192
v_accvgpr_read_b32 v193, a193
v_cvt_pk_bf16_f32 v160, v192, v193
v_accvgpr_read_b32 v194, a194
v_mfma_f32_16x16x32_bf16 a[8:11], v[24:27], v[232:235], a[8:11]
ds_read_b64_tr_b16 v[20:21], v135 offset:16640
ds_read_b64_tr_b16 v[22:23], v135 offset:24832
v_mfma_f32_16x16x32_bf16 a[12:15], v[24:27], v[236:239], a[12:15]
v_cvt_pk_bf16_f32 v246, v10, v11
v_accvgpr_read_b32 v195, a195
v_cvt_pk_bf16_f32 v161, v194, v195
v_accvgpr_read_b32 v192, a200
v_accvgpr_read_b32 v193, a201
v_cvt_pk_bf16_f32 v162, v192, v193
s_waitcnt lgkmcnt(4)
v_mfma_f32_16x16x32_bf16 v[80:83], v[28:31], v[232:235], v[80:83]
ds_read_b64_tr_b16 v[24:25], v136
ds_read_b64_tr_b16 v[26:27], v136 offset:8192
v_mfma_f32_16x16x32_bf16 v[84:87], v[28:31], v[236:239], v[84:87]
v_exp_f32 v6, v6
v_exp_f32 v7, v7
v_lshlrev_b32 v10, 16, v247
v_and_b32 v11, s50, v247
v_pk_fma_f32 v[10:11], v[10:11], s[48:49], v[2:3] op_sel_hi:[1,0,0]
v_accvgpr_read_b32 v194, a202
v_accvgpr_read_b32 v195, a203
v_cvt_pk_bf16_f32 v163, v194, v195
v_accvgpr_read_b32 v192, a196
v_mfma_f32_16x16x32_bf16 a[16:19], v[12:15], v[232:235], a[16:19]
ds_read_b64_tr_b16 v[28:29], v136 offset:256
ds_read_b64_tr_b16 v[30:31], v136 offset:8448
v_mfma_f32_16x16x32_bf16 a[20:23], v[12:15], v[236:239], a[20:23]
v_cvt_pk_bf16_f32 v243, v6, v7
v_accvgpr_read_b32 v193, a197
v_cvt_pk_bf16_f32 v164, v192, v193
v_accvgpr_read_b32 v194, a198
v_accvgpr_read_b32 v195, a199
s_waitcnt lgkmcnt(4)
v_mfma_f32_16x16x32_bf16 v[88:91], v[16:19], v[232:235], v[88:91]
ds_read_b64_tr_b16 v[12:13], v137
ds_read_b64_tr_b16 v[14:15], v137 offset:8192
v_mfma_f32_16x16x32_bf16 v[92:95], v[16:19], v[236:239], v[92:95]
s_movk_i32 s12, 232
v_exp_f32 v10, v10
v_exp_f32 v11, v11
v_lshlrev_b32 v6, 16, v248
v_and_b32 v7, s50, v248
v_pk_fma_f32 v[6:7], v[6:7], s[48:49], v[0:1] op_sel_hi:[1,0,0]
v_cvt_pk_bf16_f32 v165, v194, v195
v_accvgpr_read_b32 v192, a204
v_accvgpr_read_b32 v193, a205
v_cvt_pk_bf16_f32 v166, v192, v193
v_mfma_f32_16x16x32_bf16 a[24:27], v[20:23], v[232:235], a[24:27]
ds_read_b64_tr_b16 v[16:17], v137 offset:256
ds_read_b64_tr_b16 v[18:19], v137 offset:8448
v_mfma_f32_16x16x32_bf16 a[28:31], v[20:23], v[236:239], a[28:31]
v_cvt_pk_bf16_f32 v247, v10, v11
v_accvgpr_read_b32 v194, a206
v_accvgpr_read_b32 v195, a207
v_cvt_pk_bf16_f32 v167, v194, v195
s_waitcnt lgkmcnt(4)
v_mfma_f32_16x16x32_bf16 v[32:35], v[24:27], v[240:243], v[32:35]
ds_read_b64_tr_b16 v[20:21], v138
ds_read_b64_tr_b16 v[22:23], v138 offset:8192
v_mfma_f32_16x16x32_bf16 v[36:39], v[24:27], v[244:247], v[36:39]
buffer_load_dword off, s[8:11], s12 lds
v_exp_f32 v6, v6
v_exp_f32 v7, v7
v_lshlrev_b32 v10, 16, v252
v_and_b32 v11, s50, v252
v_pk_fma_f32 v[10:11], v[10:11], s[48:49], v[2:3] op_sel_hi:[1,0,0]
v_permlane16_swap_b32 v160, v162
v_permlane16_swap_b32 v161, v163
v_mfma_f32_16x16x32_bf16 v[96:99], v[28:31], v[240:243], v[96:99]
ds_read_b64_tr_b16 v[24:25], v138 offset:256
ds_read_b64_tr_b16 v[26:27], v138 offset:8448
v_mfma_f32_16x16x32_bf16 v[100:103], v[28:31], v[244:247], v[100:103]
v_cvt_pk_bf16_f32 v248, v6, v7
v_permlane16_swap_b32 v164, v166
v_mfma_f32_16x16x32_bf16 a[36:39], a[32:35], v[240:243], a[36:39]
s_waitcnt lgkmcnt(4)
v_mfma_f32_16x16x32_bf16 v[40:43], v[12:15], v[240:243], v[40:43]
ds_read_b64_tr_b16 v[28:29], v139
ds_read_b64_tr_b16 v[30:31], v139 offset:8192
v_mfma_f32_16x16x32_bf16 v[44:47], v[12:15], v[244:247], v[44:47]
v_mov_b32 v8, 0
v_exp_f32 v10, v10
v_exp_f32 v11, v11
v_lshlrev_b32 v6, 16, v249
v_and_b32 v7, s50, v249
v_pk_fma_f32 v[6:7], v[6:7], s[48:49], v[0:1] op_sel_hi:[1,0,0]
v_permlane16_swap_b32 v165, v167
v_accvgpr_read_b32 v192, a208
v_mfma_f32_16x16x32_bf16 v[104:107], v[16:19], v[240:243], v[104:107]
ds_read_b64_tr_b16 v[12:13], v139 offset:256
ds_read_b64_tr_b16 v[14:15], v139 offset:8448
v_mfma_f32_16x16x32_bf16 v[108:111], v[16:19], v[244:247], v[108:111]
v_cvt_pk_bf16_f32 v252, v10, v11
v_accvgpr_read_b32 v193, a209
v_mfma_f32_16x16x32_bf16 a[40:43], a[32:35], v[244:247], a[40:43]
v_cvt_pk_bf16_f32 v168, v192, v193
v_accvgpr_read_b32 v194, a210
v_accvgpr_read_b32 v195, a211
s_waitcnt lgkmcnt(4)
v_mfma_f32_16x16x32_bf16 v[48:51], v[20:23], v[240:243], v[48:51]
ds_read_b64_tr_b16 v[16:17], v140
ds_read_b64_tr_b16 v[18:19], v140 offset:8192
v_mfma_f32_16x16x32_bf16 v[52:55], v[20:23], v[244:247], v[52:55]
ds_read_b32 v8, v8 offset:14336
v_exp_f32 v6, v6
v_exp_f32 v7, v7
v_lshlrev_b32 v10, 16, v253
v_and_b32 v11, s50, v253
v_pk_fma_f32 v[10:11], v[10:11], s[48:49], v[2:3] op_sel_hi:[1,0,0]
v_cvt_pk_bf16_f32 v169, v194, v195
v_accvgpr_read_b32 v192, a216
v_accvgpr_read_b32 v193, a217
v_cvt_pk_bf16_f32 v170, v192, v193
v_mfma_f32_16x16x32_bf16 v[112:115], v[24:27], v[240:243], v[112:115]
ds_read_b64_tr_b16 v[20:21], v140 offset:256
ds_read_b64_tr_b16 v[22:23], v140 offset:8448
v_mfma_f32_16x16x32_bf16 v[116:119], v[24:27], v[244:247], v[116:119]
v_cvt_pk_bf16_f32 v249, v6, v7
v_accvgpr_read_b32 v194, a218
v_accvgpr_read_b32 v195, a219
v_cvt_pk_bf16_f32 v171, v194, v195
v_accvgpr_read_b32 v192, a212
s_waitcnt lgkmcnt(5)
v_mfma_f32_16x16x32_bf16 v[56:59], v[28:31], v[240:243], v[56:59]
ds_read_b64_tr_b16 v[24:25], v141
ds_read_b64_tr_b16 v[26:27], v141 offset:8192
v_mfma_f32_16x16x32_bf16 v[60:63], v[28:31], v[244:247], v[60:63]
v_exp_f32 v10, v10
v_exp_f32 v11, v11
v_lshlrev_b32 v6, 16, v250
v_and_b32 v7, s50, v250
v_pk_fma_f32 v[6:7], v[6:7], s[48:49], v[0:1] op_sel_hi:[1,0,0]
v_accvgpr_read_b32 v193, a213
v_cvt_pk_bf16_f32 v172, v192, v193
v_accvgpr_read_b32 v194, a214
v_accvgpr_read_b32 v195, a215
v_mfma_f32_16x16x32_bf16 v[120:123], v[12:15], v[240:243], v[120:123]
ds_read_b64_tr_b16 v[28:29], v141 offset:256
ds_read_b64_tr_b16 v[30:31], v141 offset:8448
v_mfma_f32_16x16x32_bf16 v[124:127], v[12:15], v[244:247], v[124:127]
s_branch L_pg11
L_sp59:
v_mov_b32 v8, 0
ds_read_b32 v8, v8 offset:14336
s_waitcnt lgkmcnt(0)
v_cmp_le_u32 vcc, 67, v8
s_cbranch_vccz L_sp59
s_branch L_ok59
L_sp60:
v_mov_b32 v8, 0
ds_read_b32 v8, v8 offset:14336
s_waitcnt lgkmcnt(0)
v_cmp_le_u32 vcc, 68, v8
s_cbranch_vccz L_sp60
s_branch L_ok60
L_sp61:
v_mov_b32 v8, 0
ds_read_b32 v8, v8 offset:14336
s_waitcnt lgkmcnt(0)
v_cmp_le_u32 vcc, 70, v8
s_cbranch_vccz L_sp61
s_branch L_ok61
.p2align 12
L_stub11:
s_setpc_b64 s[94:95]
L_pg11:
v_cvt_pk_bf16_f32 v253, v10, v11
v_cvt_pk_bf16_f32 v173, v194, v195
v_accvgpr_read_b32 v192, a220
v_accvgpr_read_b32 v193, a221
v_cvt_pk_bf16_f32 v174, v192, v193
s_waitcnt lgkmcnt(4)
v_mfma_f32_16x16x32_bf16 v[64:67], v[16:19], v[240:243], v[64:67]
ds_read_b64_tr_b16 v[12:13], v142
ds_read_b64_tr_b16 v[14:15], v142 offset:8192
v_mfma_f32_16x16x32_bf16 v[68:71], v[16:19], v[244:247], v[68:71]
v_cmp_le_u32 vcc, 67, v8
v_exp_f32 v6, v6
v_exp_f32 v7, v7
v_lshlrev_b32 v10, 16, v254
v_and_b32 v11, s50, v254
v_pk_fma_f32 v[10:11], v[10:11], s[48:49], v[2:3] op_sel_hi:[1,0,0]
v_accvgpr_read_b32 v194, a222
v_accvgpr_read_b32 v195, a223
v_cvt_pk_bf16_f32 v175, v194, v195
v_mfma_f32_16x16x32_bf16 a[0:3], v[20:23], v[240:243], a[0:3]
ds_read_b64_tr_b16 v[16:17], v142 offset:256
ds_read_b64_tr_b16 v[18:19], v142 offset:8448
v_mfma_f32_16x16x32_bf16 a[4:7], v[20:23], v[244:247], a[4:7]
v_cvt_pk_bf16_f32 v250, v6, v7
v_permlane16_swap_b32 v168, v170
v_permlane16_swap_b32 v169, v171
s_waitcnt lgkmcnt(4)
v_mfma_f32_16x16x32_bf16 v[72:75], v[24:27], v[240:243], v[72:75]
ds_read_b64_tr_b16 v[20:21], v143
ds_read_b64_tr_b16 v[22:23], v143 offset:8192
v_mfma_f32_16x16x32_bf16 v[76:79], v[24:27], v[244:247], v[76:79]
s_cbranch_vccz L_sp59
L_ok59:
v_exp_f32 v10, v10
v_exp_f32 v11, v11
v_lshlrev_b32 v6, 16, v251
v_and_b32 v7, s50, v251
v_pk_fma_f32 v[6:7], v[6:7], s[48:49], v[0:1] op_sel_hi:[1,0,0]
v_permlane16_swap_b32 v172, v174
v_mfma_f32_16x16x32_bf16 a[8:11], v[28:31], v[240:243], a[8:11]
ds_read_b64_tr_b16 v[24:25], v143 offset:256
ds_read_b64_tr_b16 v[26:27], v143 offset:8448
v_mfma_f32_16x16x32_bf16 a[12:15], v[28:31], v[244:247], a[12:15]
v_cvt_pk_bf16_f32 v254, v10, v11
v_permlane16_swap_b32 v173, v175
v_accvgpr_read_b32 v192, a224
s_waitcnt lgkmcnt(4)
v_mfma_f32_16x16x32_bf16 v[80:83], v[12:15], v[240:243], v[80:83]
ds_read_b64_tr_b16 v[28:29], v128 offset:49152
ds_read_b64_tr_b16 v[30:31], v128 offset:57344
v_mfma_f32_16x16x32_bf16 v[84:87], v[12:15], v[244:247], v[84:87]
v_exp_f32 v6, v6
v_exp_f32 v7, v7
v_lshlrev_b32 v10, 16, v255
v_and_b32 v11, s50, v255
v_pk_fma_f32 v[10:11], v[10:11], s[48:49], v[2:3] op_sel_hi:[1,0,0]
v_accvgpr_read_b32 v193, a225
v_cvt_pk_bf16_f32 v176, v192, v193
v_accvgpr_read_b32 v194, a226
v_accvgpr_read_b32 v195, a227
v_mfma_f32_16x16x32_bf16 a[16:19], v[16:19], v[240:243], a[16:19]
ds_read_b64_tr_b16 v[12:13], v128 offset:49408
ds_read_b64_tr_b16 v[14:15], v128 offset:57600
v_mfma_f32_16x16x32_bf16 a[20:23], v[16:19], v[244:247], a[20:23]
v_cvt_pk_bf16_f32 v251, v6, v7
v_cvt_pk_bf16_f32 v177, v194, v195
v_accvgpr_read_b32 v192, a232
v_accvgpr_read_b32 v193, a233
v_cvt_pk_bf16_f32 v178, v192, v193
s_waitcnt lgkmcnt(4)
v_mfma_f32_16x16x32_bf16 v[88:91], v[20:23], v[240:243], v[88:91]
ds_read_b64_tr_b16 v[16:17], v129 offset:49152
ds_read_b64_tr_b16 v[18:19], v129 offset:57344
v_mfma_f32_16x16x32_bf16 v[92:95], v[20:23], v[244:247], v[92:95]
v_exp_f32 v10, v10
v_exp_f32 v11, v11
v_accvgpr_read_b32 v194, a234
v_accvgpr_read_b32 v195, a235
v_cvt_pk_bf16_f32 v179, v194, v195
v_accvgpr_read_b32 v192, a228
v_mfma_f32_16x16x32_bf16 a[24:27], v[24:27], v[240:243], a[24:27]
ds_read_b64_tr_b16 v[20:21], v129 offset:49408
ds_read_b64_tr_b16 v[22:23], v129 offset:57600
v_mfma_f32_16x16x32_bf16 a[28:31], v[24:27], v[244:247], a[28:31]
v_cvt_pk_bf16_f32 v255, v10, v11
v_accvgpr_read_b32 v193, a229
v_cvt_pk_bf16_f32 v180, v192, v193
v_accvgpr_read_b32 v194, a230
v_accvgpr_read_b32 v195, a231
s_waitcnt lgkmcnt(4)
v_mfma_f32_16x16x32_bf16 v[32:35], v[28:31], v[248:251], v[32:35]
ds_read_b64_tr_b16 v[24:25], v130 offset:49152
ds_read_b64_tr_b16 v[26:27], v130 offset:57344
v_mfma_f32_16x16x32_bf16 v[36:39], v[28:31], v[252:255], v[36:39]
v_cvt_pk_bf16_f32 v181, v194, v195
v_accvgpr_read_b32 v192, a236
v_accvgpr_read_b32 v193, a237
v_cvt_pk_bf16_f32 v182, v192, v193
v_accvgpr_read_b32 v194, a238
v_accvgpr_read_b32 v195, a239
v_mfma_f32_16x16x32_bf16 v[96:99], v[12:15], v[248:251], v[96:99]
ds_read_b64_tr_b16 v[28:29], v130 offset:49408
ds_read_b64_tr_b16 v[30:31], v130 offset:57600
v_mfma_f32_16x16x32_bf16 v[100:103], v[12:15], v[252:255], v[100:103]
v_cvt_pk_bf16_f32 v183, v194, v195
v_permlane16_swap_b32 v176, v178
v_mfma_f32_16x16x32_bf16 a[36:39], a[32:35], v[248:251], a[36:39]
s_waitcnt lgkmcnt(4)
v_mfma_f32_16x16x32_bf16 v[40:43], v[16:19], v[248:251], v[40:43]
ds_read_b64_tr_b16 v[12:13], v131 offset:49152
ds_read_b64_tr_b16 v[14:15], v131 offset:57344
v_mfma_f32_16x16x32_bf16 v[44:47], v[16:19], v[252:255], v[44:47]
v_mov_b32 v8, 0
v_permlane16_swap_b32 v177, v179
v_permlane16_swap_b32 v180, v182
v_mfma_f32_16x16x32_bf16 v[104:107], v[20:23], v[248:251], v[104:107]
ds_read_b64_tr_b16 v[16:17], v131 offset:49408
ds_read_b64_tr_b16 v[18:19], v131 offset:57600
v_mfma_f32_16x16x32_bf16 v[108:111], v[20:23], v[252:255], v[108:111]
v_permlane16_swap_b32 v181, v183
v_accvgpr_read_b32 v192, a240
v_mfma_f32_16x16x32_bf16 a[40:43], a[32:35], v[252:255], a[40:43]
s_waitcnt lgkmcnt(4)
v_mfma_f32_16x16x32_bf16 v[48:51], v[24:27], v[248:251], v[48:51]
ds_read_b64_tr_b16 v[20:21], v132 offset:49152
ds_read_b64_tr_b16 v[22:23], v132 offset:57344
v_mfma_f32_16x16x32_bf16 v[52:55], v[24:27], v[252:255], v[52:55]
ds_read_b32 v8, v8 offset:14336
v_accvgpr_read_b32 v193, a241
v_cvt_pk_bf16_f32 v184, v192, v193
v_accvgpr_read_b32 v194, a242
v_accvgpr_read_b32 v195, a243
v_cvt_pk_bf16_f32 v185, v194, v195
v_mfma_f32_16x16x32_bf16 v[112:115], v[28:31], v[248:251], v[112:115]
ds_read_b64_tr_b16 v[24:25], v132 offset:49408
ds_read_b64_tr_b16 v[26:27], v132 offset:57600
v_mfma_f32_16x16x32_bf16 v[116:119], v[28:31], v[252:255], v[116:119]
v_accvgpr_read_b32 v192, a248
v_accvgpr_read_b32 v193, a249
v_cvt_pk_bf16_f32 v186, v192, v193
v_accvgpr_read_b32 v194, a250
v_accvgpr_read_b32 v195, a251
s_waitcnt lgkmcnt(5)
v_mfma_f32_16x16x32_bf16 v[56:59], v[12:15], v[248:251], v[56:59]
ds_read_b64_tr_b16 v[28:29], v133 offset:49152
ds_read_b64_tr_b16 v[30:31], v133 offset:57344
v_mfma_f32_16x16x32_bf16 v[60:63], v[12:15], v[252:255], v[60:63]
v_accvgpr_read_b32 v10, a36
v_accvgpr_read_b32 v11, a40
v_cvt_pk_bf16_f32 v187, v194, v195
v_accvgpr_read_b32 v192, a244
v_accvgpr_read_b32 v193, a245
v_cvt_pk_bf16_f32 v188, v192, v193
v_mfma_f32_16x16x32_bf16 v[120:123], v[16:19], v[248:251], v[120:123]
ds_read_b64_tr_b16 v[12:13], v133 offset:49408
ds_read_b64_tr_b16 v[14:15], v133 offset:57600
v_mfma_f32_16x16x32_bf16 v[124:127], v[16:19], v[252:255], v[124:127]
v_rcp_f32 v10, v10
v_accvgpr_read_b32 v194, a246
v_accvgpr_read_b32 v195, a247
v_cvt_pk_bf16_f32 v189, v194, v195
v_accvgpr_read_b32 v192, a252
s_waitcnt lgkmcnt(4)
v_mfma_f32_16x16x32_bf16 v[64:67], v[20:23], v[248:251], v[64:67]
ds_read_b64_tr_b16 v[16:17], v134 offset:49152
ds_read_b64_tr_b16 v[18:19], v134 offset:57344
v_mfma_f32_16x16x32_bf16 v[68:71], v[20:23], v[252:255], v[68:71]
v_cmp_le_u32 vcc, 68, v8
v_accvgpr_read_b32 v193, a253
v_cvt_pk_bf16_f32 v190, v192, v193
v_accvgpr_read_b32 v194, a254
v_accvgpr_read_b32 v195, a255
v_cvt_pk_bf16_f32 v191, v194, v195
v_mfma_f32_16x16x32_bf16 a[0:3], v[24:27], v[248:251], a[0:3]
ds_read_b64_tr_b16 v[20:21], v134 offset:49408
ds_read_b64_tr_b16 v[22:23], v134 offset:57600
v_mfma_f32_16x16x32_bf16 a[4:7], v[24:27], v[252:255], a[4:7]
v_rcp_f32 v11, v11
v_permlane16_swap_b32 v184, v186
s_waitcnt lgkmcnt(4)
v_mfma_f32_16x16x32_bf16 v[72:75], v[28:31], v[248:251], v[72:75]
ds_read_b64_tr_b16 v[24:25], v135 offset:49152
ds_read_b64_tr_b16 v[26:27], v135 offset:57344
v_mfma_f32_16x16x32_bf16 v[76:79], v[28:31], v[252:255], v[76:79]
s_cbranch_vccz L_sp60
L_ok60:
v_permlane16_swap_b32 v185, v187
v_permlane16_swap_b32 v188, v190
v_mfma_f32_16x16x32_bf16 a[8:11], v[12:15], v[248:251], a[8:11]
ds_read_b64_tr_b16 v[28:29], v135 offset:49408
ds_read_b64_tr_b16 v[30:31], v135 offset:57600
v_mfma_f32_16x16x32_bf16 a[12:15], v[12:15], v[252:255], a[12:15]
v_xor_b32 v4, 131072, v9
v_permlane16_swap_b32 v189, v191
s_waitcnt lgkmcnt(4)
v_mfma_f32_16x16x32_bf16 v[80:83], v[16:19], v[248:251], v[80:83]
ds_read_b128 v[12:15], v4
v_accvgpr_read_b32 v192, a128
v_mfma_f32_16x16x32_bf16 v[84:87], v[16:19], v[252:255], v[84:87]
v_accvgpr_read_b32 v193, a129
v_cvt_pk_bf16_f32 v128, v192, v193
v_accvgpr_read_b32 v194, a130
v_accvgpr_read_b32 v195, a131
v_cvt_pk_bf16_f32 v129, v194, v195
v_accvgpr_read_b32 v192, a136
v_accvgpr_read_b32 v193, a137
v_cvt_pk_bf16_f32 v130, v192, v193
v_accvgpr_read_b32 v194, a138
v_accvgpr_read_b32 v195, a139
v_cvt_pk_bf16_f32 v131, v194, v195
v_accvgpr_read_b32 v192, a132
v_accvgpr_read_b32 v193, a133
v_cvt_pk_bf16_f32 v132, v192, v193
v_accvgpr_read_b32 v194, a134
v_accvgpr_read_b32 v195, a135
v_cvt_pk_bf16_f32 v133, v194, v195
v_accvgpr_read_b32 v192, a140
v_accvgpr_read_b32 v193, a141
v_cvt_pk_bf16_f32 v134, v192, v193
v_accvgpr_read_b32 v194, a142
v_accvgpr_read_b32 v195, a143
v_cvt_pk_bf16_f32 v135, v194, v195
v_permlane16_swap_b32 v128, v130
v_permlane16_swap_b32 v129, v131
v_permlane16_swap_b32 v132, v134
v_permlane16_swap_b32 v133, v135
v_accvgpr_read_b32 v192, a144
v_mfma_f32_16x16x32_bf16 a[16:19], v[20:23], v[248:251], a[16:19]
ds_read_b128 v[16:19], v4 offset:8192
v_accvgpr_read_b32 v193, a145
v_mfma_f32_16x16x32_bf16 a[20:23], v[20:23], v[252:255], a[20:23]
v_cvt_pk_bf16_f32 v136, v192, v193
v_accvgpr_read_b32 v194, a146
v_accvgpr_read_b32 v195, a147
v_cvt_pk_bf16_f32 v137, v194, v195
v_accvgpr_read_b32 v192, a152
v_accvgpr_read_b32 v193, a153
v_cvt_pk_bf16_f32 v138, v192, v193
v_accvgpr_read_b32 v194, a154
v_accvgpr_read_b32 v195, a155
v_cvt_pk_bf16_f32 v139, v194, v195
v_accvgpr_read_b32 v192, a148
v_accvgpr_read_b32 v193, a149
v_cvt_pk_bf16_f32 v140, v192, v193
v_accvgpr_read_b32 v194, a150
v_accvgpr_read_b32 v195, a151
v_cvt_pk_bf16_f32 v141, v194, v195
v_accvgpr_read_b32 v192, a156
v_accvgpr_read_b32 v193, a157
v_cvt_pk_bf16_f32 v142, v192, v193
v_accvgpr_read_b32 v194, a158
v_accvgpr_read_b32 v195, a159
v_cvt_pk_bf16_f32 v143, v194, v195
v_permlane16_swap_b32 v136, v138
v_permlane16_swap_b32 v137, v139
v_permlane16_swap_b32 v140, v142
v_permlane16_swap_b32 v141, v143
s_waitcnt lgkmcnt(2)
v_mfma_f32_16x16x32_bf16 v[88:91], v[24:27], v[248:251], v[88:91]
ds_read_b128 v[20:23], v4 offset:256
s_movk_i32 s12, 240
v_mfma_f32_16x16x32_bf16 v[92:95], v[24:27], v[252:255], v[92:95]
v_accvgpr_read_b32 v192, a160
v_accvgpr_read_b32 v193, a161
v_cvt_pk_bf16_f32 v144, v192, v193
v_accvgpr_read_b32 v194, a162
v_accvgpr_read_b32 v195, a163
v_cvt_pk_bf16_f32 v145, v194, v195
v_accvgpr_read_b32 v192, a168
v_accvgpr_read_b32 v193, a169
v_cvt_pk_bf16_f32 v146, v192, v193
v_accvgpr_read_b32 v194, a170
v_accvgpr_read_b32 v195, a171
v_cvt_pk_bf16_f32 v147, v194, v195
v_accvgpr_read_b32 v192, a164
v_accvgpr_read_b32 v193, a165
v_cvt_pk_bf16_f32 v148, v192, v193
v_accvgpr_read_b32 v194, a166
v_accvgpr_read_b32 v195, a167
v_cvt_pk_bf16_f32 v149, v194, v195
v_accvgpr_read_b32 v192, a172
v_accvgpr_read_b32 v193, a173
v_cvt_pk_bf16_f32 v150, v192, v193
v_accvgpr_read_b32 v194, a174
v_accvgpr_read_b32 v195, a175
v_cvt_pk_bf16_f32 v151, v194, v195
v_permlane16_swap_b32 v144, v146
v_permlane16_swap_b32 v145, v147
v_permlane16_swap_b32 v148, v150
v_permlane16_swap_b32 v149, v151
v_mfma_f32_16x16x32_bf16 a[24:27], v[28:31], v[248:251], a[24:27]
ds_read_b128 v[24:27], v4 offset:8448
v_xor_b32 v4, 131136, v9
v_mfma_f32_16x16x32_bf16 a[28:31], v[28:31], v[252:255], a[28:31]
s_waitcnt lgkmcnt(2)
v_mfma_f32_16x16x32_bf16 v[192:195], v[12:15], v[128:131], 0
ds_read_b128 v[28:31], v4
v_mfma_f32_16x16x32_bf16 v[200:203], v[12:15], v[132:135], 0
buffer_load_dword off, s[8:11], s12 lds
v_mfma_f32_16x16x32_bf16 v[196:199], v[16:19], v[128:131], 0
ds_read_b128 v[12:15], v4 offset:8192
v_mul_f32 v32, v10, v32
v_mfma_f32_16x16x32_bf16 v[204:207], v[16:19], v[132:135], 0
v_mul_f32 v33, v10, v33
v_cvt_pk_bf16_f32 v32, v32, v33
v_accvgpr_write_b32 a64, v32
s_waitcnt lgkmcnt(2)
v_mfma_f32_16x16x32_bf16 v[192:195], v[20:23], v[160:163], v[192:195]
ds_read_b128 v[16:19], v4 offset:256
v_mov_b32 v8, 0
v_mfma_f32_16x16x32_bf16 v[200:203], v[20:23], v[164:167], v[200:203]
v_mul_f32 v34, v10, v34
v_mul_f32 v35, v10, v35
v_cvt_pk_bf16_f32 v34, v34, v35
v_accvgpr_write_b32 a65, v34
v_mul_f32 v40, v10, v40
v_mfma_f32_16x16x32_bf16 v[196:199], v[24:27], v[160:163], v[196:199]
ds_read_b128 v[20:23], v4 offset:8448
v_xor_b32 v4, 131200, v9
v_mfma_f32_16x16x32_bf16 v[204:207], v[24:27], v[164:167], v[204:207]
v_mul_f32 v41, v10, v41
v_cvt_pk_bf16_f32 v40, v40, v41
v_accvgpr_write_b32 a66, v40
s_waitcnt lgkmcnt(2)
v_mfma_f32_16x16x32_bf16 v[192:195], v[28:31], v[136:139], v[192:195]
ds_read_b128 v[24:27], v4
v_mul_f32 v42, v10, v42
v_mfma_f32_16x16x32_bf16 v[200:203], v[28:31], v[140:143], v[200:203]
ds_read_b32 v8, v8 offset:14336
v_mul_f32 v43, v10, v43
v_cvt_pk_bf16_f32 v42, v42, v43
v_accvgpr_write_b32 a67, v42
v_mul_f32 v36, v11, v36
v_mfma_f32_16x16x32_bf16 v[196:199], v[12:15], v[136:139], v[196:199]
ds_read_b128 v[28:31], v4 offset:8192
v_mul_f32 v37, v11, v37
v_mfma_f32_16x16x32_bf16 v[204:207], v[12:15], v[140:143], v[204:207]
v_cvt_pk_bf16_f32 v36, v36, v37
v_accvgpr_write_b32 a68, v36
v_mul_f32 v38, v11, v38
s_waitcnt lgkmcnt(3)
v_mfma_f32_16x16x32_bf16 v[192:195], v[16:19], v[168:171], v[192:195]
ds_read_b128 v[12:15], v4 offset:256
v_mul_f32 v39, v11, v39
v_mfma_f32_16x16x32_bf16 v[200:203], v[16:19], v[172:175], v[200:203]
v_cvt_pk_bf16_f32 v38, v38, v39
v_accvgpr_write_b32 a69, v38
v_mul_f32 v44, v11, v44
v_mul_f32 v45, v11, v45
v_mfma_f32_16x16x32_bf16 v[196:199], v[20:23], v[168:171], v[196:199]
ds_read_b128 v[16:19], v4 offset:8448
v_xor_b32 v4, 131264, v9
v_mfma_f32_16x16x32_bf16 v[204:207], v[20:23], v[172:175], v[204:207]
v_cvt_pk_bf16_f32 v44, v44, v45
v_accvgpr_write_b32 a70, v44
v_mul_f32 v46, v11, v46
v_mul_f32 v47, v11, v47
s_waitcnt lgkmcnt(2)
v_mfma_f32_16x16x32_bf16 v[192:195], v[24:27], v[144:147], v[192:195]
ds_read_b128 v[20:23], v4
v_cmp_le_u32 vcc, 70, v8
v_mfma_f32_16x16x32_bf16 v[200:203], v[24:27], v[148:151], v[200:203]
v_cvt_pk_bf16_f32 v46, v46, v47
v_accvgpr_write_b32 a71, v46
v_mul_f32 v48, v10, v48
v_mul_f32 v49, v10, v49
v_mov_b32 v0, 0xff800000
v_mov_b32 v2, 0xff800000
v_mfma_f32_16x16x32_bf16 v[196:199], v[28:31], v[144:147], v[196:199]
ds_read_b128 v[24:27], v4 offset:8192
v_cvt_pk_bf16_f32 v48, v48, v49
v_mfma_f32_16x16x32_bf16 v[204:207], v[28:31], v[148:151], v[204:207]
v_accvgpr_write_b32 a72, v48
v_mul_f32 v50, v10, v50
v_mul_f32 v51, v10, v51
v_cvt_pk_bf16_f32 v50, v50, v51
s_waitcnt lgkmcnt(2)
v_mfma_f32_16x16x32_bf16 v[192:195], v[12:15], v[176:179], v[192:195]
ds_read_b128 v[28:31], v4 offset:256
v_accvgpr_write_b32 a73, v50
v_mfma_f32_16x16x32_bf16 v[200:203], v[12:15], v[180:183], v[200:203]
s_cbranch_vccz L_sp61
L_ok61:
v_mul_f32 v56, v10, v56
v_mul_f32 v57, v10, v57
v_mfma_f32_16x16x32_bf16 v[196:199], v[16:19], v[176:179], v[196:199]
ds_read_b128 v[12:15], v4 offset:8448
v_xor_b32 v4, 98304, v9
v_mfma_f32_16x16x32_bf16 v[204:207], v[16:19], v[180:183], v[204:207]
v_cvt_pk_bf16_f32 v56, v56, v57
v_accvgpr_write_b32 a74, v56
v_mul_f32 v58, v10, v58
s_waitcnt lgkmcnt(2)
v_mfma_f32_16x16x32_bf16 v[192:195], v[20:23], v[152:155], v[192:195]
ds_read_b128 v[16:19], v4
v_mul_f32 v59, v10, v59
v_mfma_f32_16x16x32_bf16 v[200:203], v[20:23], v[156:159], v[200:203]
v_cvt_pk_bf16_f32 v58, v58, v59
v_accvgpr_write_b32 a75, v58
v_mul_f32 v52, v11, v52
v_mul_f32 v53, v11, v53
v_cvt_pk_bf16_f32 v52, v52, v53
v_mfma_f32_16x16x32_bf16 v[196:199], v[24:27], v[152:155], v[196:199]
ds_read_b128 v[20:23], v4 offset:8192
v_accvgpr_write_b32 a76, v52
v_mfma_f32_16x16x32_bf16 v[204:207], v[24:27], v[156:159], v[204:207]
v_mul_f32 v54, v11, v54
v_mul_f32 v55, v11, v55
v_cvt_pk_bf16_f32 v54, v54, v55
s_waitcnt lgkmcnt(2)
v_mfma_f32_16x16x32_bf16 v[192:195], v[28:31], v[184:187], v[192:195]
ds_read_b128 v[24:27], v4 offset:256
s_movk_i32 s12, 244
v_mfma_f32_16x16x32_bf16 v[200:203], v[28:31], v[188:191], v[200:203]
v_accvgpr_write_b32 a77, v54
v_mul_f32 v60, v11, v60
v_mul_f32 v61, v11, v61
v_cvt_pk_bf16_f32 v60, v60, v61
v_accvgpr_write_b32 a78, v60
v_mfma_f32_16x16x32_bf16 v[196:199], v[12:15], v[184:187], v[196:199]
ds_read_b128 v[28:31], v4 offset:8448
v_xor_b32 v4, 98368, v9
v_mfma_f32_16x16x32_bf16 v[204:207], v[12:15], v[188:191], v[204:207]
v_mul_f32 v62, v11, v62
v_mul_f32 v63, v11, v63
v_cvt_pk_bf16_f32 v62, v62, v63
s_waitcnt lgkmcnt(2)
v_mfma_f32_16x16x32_bf16 v[208:211], v[16:19], v[128:131], 0
ds_read_b128 v[12:15], v4
v_accvgpr_write_b32 a79, v62
v_mfma_f32_16x16x32_bf16 v[216:219], v[16:19], v[132:135], 0
buffer_load_dword off, s[8:11], s12 lds
v_mul_f32 v64, v10, v64
v_mul_f32 v65, v10, v65
v_mfma_f32_16x16x32_bf16 v[212:215], v[20:23], v[128:131], 0
ds_read_b128 v[16:19], v4 offset:8192
v_cvt_pk_bf16_f32 v64, v64, v65
v_mfma_f32_16x16x32_bf16 v[220:223], v[20:23], v[132:135], 0
v_accvgpr_write_b32 a80, v64
v_mul_f32 v66, v10, v66
v_mul_f32 v67, v10, v67
v_cvt_pk_bf16_f32 v66, v66, v67
s_waitcnt lgkmcnt(2)
v_mfma_f32_16x16x32_bf16 v[208:211], v[24:27], v[160:163], v[208:211]
ds_read_b128 v[20:23], v4 offset:256
v_accvgpr_write_b32 a81, v66
v_mfma_f32_16x16x32_bf16 v[216:219], v[24:27], v[164:167], v[216:219]
v_mul_f32 v72, v10, v72
v_mul_f32 v73, v10, v73
v_cvt_pk_bf16_f32 v72, v72, v73
v_accvgpr_write_b32 a82, v72
v_mfma_f32_16x16x32_bf16 v[212:215], v[28:31], v[160:163], v[212:215]
ds_read_b128 v[24:27], v4 offset:8448
v_xor_b32 v4, 98432, v9
v_mfma_f32_16x16x32_bf16 v[220:223], v[28:31], v[164:167], v[220:223]
v_mul_f32 v74, v10, v74
v_mul_f32 v75, v10, v75
v_cvt_pk_bf16_f32 v74, v74, v75
v_accvgpr_write_b32 a83, v74
s_waitcnt lgkmcnt(2)
v_mfma_f32_16x16x32_bf16 v[208:211], v[12:15], v[136:139], v[208:211]
ds_read_b128 v[28:31], v4
v_mul_f32 v68, v11, v68
v_mfma_f32_16x16x32_bf16 v[216:219], v[12:15], v[140:143], v[216:219]
v_mul_f32 v69, v11, v69
v_cvt_pk_bf16_f32 v68, v68, v69
v_accvgpr_write_b32 a84, v68
v_mul_f32 v70, v11, v70
v_mfma_f32_16x16x32_bf16 v[212:215], v[16:19], v[136:139], v[212:215]
ds_read_b128 v[12:15], v4 offset:8192
v_mul_f32 v71, v11, v71
v_mfma_f32_16x16x32_bf16 v[220:223], v[16:19], v[140:143], v[220:223]
v_cvt_pk_bf16_f32 v70, v70, v71
v_accvgpr_write_b32 a85, v70
v_mul_f32 v76, v11, v76
s_waitcnt lgkmcnt(2)
v_mfma_f32_16x16x32_bf16 v[208:211], v[20:23], v[168:171], v[208:211]
ds_read_b128 v[16:19], v4 offset:256
v_mul_f32 v77, v11, v77
v_mfma_f32_16x16x32_bf16 v[216:219], v[20:23], v[172:175], v[216:219]
v_cvt_pk_bf16_f32 v76, v76, v77
v_accvgpr_write_b32 a86, v76
v_mul_f32 v78, v11, v78
v_mul_f32 v79, v11, v79
v_cvt_pk_bf16_f32 v78, v78, v79
v_mfma_f32_16x16x32_bf16 v[212:215], v[24:27], v[168:171], v[212:215]
ds_read_b128 v[20:23], v4 offset:8448
v_xor_b32 v4, 98496, v9
v_mfma_f32_16x16x32_bf16 v[220:223], v[24:27], v[172:175], v[220:223]
v_accvgpr_write_b32 a87, v78
v_mul_f32 v80, v10, v80
v_mul_f32 v81, v10, v81
s_waitcnt lgkmcnt(2)
v_mfma_f32_16x16x32_bf16 v[208:211], v[28:31], v[144:147], v[208:211]
ds_read_b128 v[24:27], v4
v_cvt_pk_bf16_f32 v80, v80, v81
v_mfma_f32_16x16x32_bf16 v[216:219], v[28:31], v[148:151], v[216:219]
v_accvgpr_write_b32 a88, v80
v_mul_f32 v82, v10, v82
v_mul_f32 v83, v10, v83
v_cvt_pk_bf16_f32 v82, v82, v83
v_accvgpr_write_b32 a89, v82
v_mfma_f32_16x16x32_bf16 v[212:215], v[12:15], v[144:147], v[212:215]
ds_read_b128 v[28:31], v4 offset:8192
v_mul_f32 v88, v10, v88
v_mfma_f32_16x16x32_bf16 v[220:223], v[12:15], v[148:151], v[220:223]
v_mul_f32 v89, v10, v89
v_cvt_pk_bf16_f32 v88, v88, v89
v_accvgpr_write_b32 a90, v88
s_waitcnt lgkmcnt(2)
v_mfma_f32_16x16x32_bf16 v[208:211], v[16:19], v[176:179], v[208:211]
ds_read_b128 v[12:15], v4 offset:256
v_mul_f32 v90, v10, v90
v_mfma_f32_16x16x32_bf16 v[216:219], v[16:19], v[180:183], v[216:219]
v_mul_f32 v91, v10, v91
v_cvt_pk_bf16_f32 v90, v90, v91
v_accvgpr_write_b32 a91, v90
v_mul_f32 v84, v11, v84
v_mfma_f32_16x16x32_bf16 v[212:215], v[20:23], v[176:179], v[212:215]
ds_read_b128 v[16:19], v4 offset:8448
v_xor_b32 v4, 114688, v3
v_mfma_f32_16x16x32_bf16 v[220:223], v[20:23], v[180:183], v[220:223]
v_mul_f32 v85, v11, v85
v_cvt_pk_bf16_f32 v84, v84, v85
v_accvgpr_write_b32 a92, v84
v_mul_f32 v86, v11, v86
s_waitcnt lgkmcnt(2)
v_mfma_f32_16x16x32_bf16 v[208:211], v[24:27], v[152:155], v[208:211]
ds_read_b64_tr_b16 v[20:21], v4
v_mul_f32 v87, v11, v87
v_mfma_f32_16x16x32_bf16 v[216:219], v[24:27], v[156:159], v[216:219]
ds_read_b64_tr_b16 v[22:23], v4 offset:2048
v_cvt_pk_bf16_f32 v86, v86, v87
v_accvgpr_write_b32 a93, v86
v_mul_f32 v92, v11, v92
v_mfma_f32_16x16x32_bf16 v[212:215], v[28:31], v[152:155], v[212:215]
ds_read_b64_tr_b16 v[24:25], v4 offset:4096
v_mul_f32 v93, v11, v93
v_mfma_f32_16x16x32_bf16 v[220:223], v[28:31], v[156:159], v[220:223]
ds_read_b64_tr_b16 v[26:27], v4 offset:6144
v_cvt_pk_bf16_f32 v92, v92, v93
v_accvgpr_write_b32 a94, v92
v_mul_f32 v94, v11, v94
s_waitcnt lgkmcnt(4)
v_mfma_f32_16x16x32_bf16 v[208:211], v[12:15], v[184:187], v[208:211]
ds_read_b64_tr_b16 v[28:29], v4 offset:8192
s_movk_i32 s12, 248
v_mfma_f32_16x16x32_bf16 v[216:219], v[12:15], v[188:191], v[216:219]
s_branch L_pg12
L_sp63:
v_mov_b32 v8, 0
ds_read_b32 v8, v8 offset:14336
s_waitcnt lgkmcnt(0)
v_cmp_le_u32 vcc, 71, v8
s_cbranch_vccz L_sp63
s_branch L_ok63
L_sp64:
v_mov_b32 v8, 0
ds_read_b32 v8, v8 offset:14336
s_waitcnt lgkmcnt(0)
v_cmp_le_u32 vcc, 73, v8
s_cbranch_vccz L_sp64
s_branch L_ok64
L_sp66:
v_mov_b32 v8, 0
ds_read_b32 v8, v8 offset:14336
s_waitcnt lgkmcnt(0)
v_cmp_le_u32 vcc, 74, v8
s_cbranch_vccz L_sp66
s_branch L_ok66
L_sp67:
v_mov_b32 v8, 0
ds_read_b32 v8, v8 offset:14336
s_waitcnt lgkmcnt(0)
v_cmp_le_u32 vcc, 75, v8
s_cbranch_vccz L_sp67
s_branch L_ok67
.p2align 12
L_stub12:
s_setpc_b64 s[94:95]
L_pg12:
ds_read_b64_tr_b16 v[30:31], v4 offset:10240
v_mul_f32 v95, v11, v95
v_cvt_pk_bf16_f32 v94, v94, v95
v_accvgpr_write_b32 a95, v94
v_mfma_f32_16x16x32_bf16 v[212:215], v[16:19], v[184:187], v[212:215]
ds_read_b64_tr_b16 v[12:13], v4 offset:12288
ds_read_b64_tr_b16 v[14:15], v4 offset:14336
v_mfma_f32_16x16x32_bf16 v[220:223], v[16:19], v[188:191], v[220:223]
v_xor_b32 v4, 114720, v3
s_waitcnt lgkmcnt(4)
v_mfma_f32_16x16x32_bf16 a[128:131], v[20:23], a[64:67], 0
ds_read_b64_tr_b16 v[16:17], v4
v_max3_f32 v0, v192, v193, v0
v_mfma_f32_16x16x32_bf16 a[132:135], v[20:23], a[68:71], 0
ds_read_b64_tr_b16 v[18:19], v4 offset:2048
buffer_load_dword off, s[8:11], s12 lds
v_mul_f32 v96, v10, v96
v_mfma_f32_16x16x32_bf16 a[132:135], v[24:27], a[76:79], a[132:135]
ds_read_b64_tr_b16 v[20:21], v4 offset:4096
v_cvt_pk_bf16_f32 v224, v192, v193
v_mfma_f32_16x16x32_bf16 a[128:131], v[24:27], a[72:75], a[128:131]
ds_read_b64_tr_b16 v[22:23], v4 offset:6144
s_waitcnt lgkmcnt(4)
v_mfma_f32_16x16x32_bf16 a[128:131], v[28:31], a[80:83], a[128:131]
ds_read_b64_tr_b16 v[24:25], v4 offset:8192
v_mov_b32 v8, 0
v_mfma_f32_16x16x32_bf16 a[132:135], v[28:31], a[84:87], a[132:135]
ds_read_b64_tr_b16 v[26:27], v4 offset:10240
v_max3_f32 v2, v200, v201, v2
v_mfma_f32_16x16x32_bf16 a[132:135], v[12:15], a[92:95], a[132:135]
ds_read_b64_tr_b16 v[28:29], v4 offset:12288
ds_read_b64_tr_b16 v[30:31], v4 offset:14336
v_mfma_f32_16x16x32_bf16 a[128:131], v[12:15], a[88:91], a[128:131]
v_xor_b32 v4, 114752, v3
s_waitcnt lgkmcnt(4)
v_mfma_f32_16x16x32_bf16 a[136:139], v[16:19], a[64:67], 0
ds_read_b64_tr_b16 v[12:13], v4
v_cvt_pk_bf16_f32 v228, v200, v201
v_mfma_f32_16x16x32_bf16 a[140:143], v[16:19], a[68:71], 0
ds_read_b64_tr_b16 v[14:15], v4 offset:2048
v_mul_f32 v97, v10, v97
ds_read_b32 v8, v8 offset:14336
v_mfma_f32_16x16x32_bf16 a[140:143], v[20:23], a[76:79], a[140:143]
ds_read_b64_tr_b16 v[16:17], v4 offset:4096
v_max3_f32 v0, v194, v195, v0
v_mfma_f32_16x16x32_bf16 a[136:139], v[20:23], a[72:75], a[136:139]
ds_read_b64_tr_b16 v[18:19], v4 offset:6144
s_waitcnt lgkmcnt(5)
v_mfma_f32_16x16x32_bf16 a[136:139], v[24:27], a[80:83], a[136:139]
ds_read_b64_tr_b16 v[20:21], v4 offset:8192
v_cvt_pk_bf16_f32 v225, v194, v195
v_mfma_f32_16x16x32_bf16 a[140:143], v[24:27], a[84:87], a[140:143]
ds_read_b64_tr_b16 v[22:23], v4 offset:10240
v_max3_f32 v2, v202, v203, v2
v_mfma_f32_16x16x32_bf16 a[140:143], v[28:31], a[92:95], a[140:143]
ds_read_b64_tr_b16 v[24:25], v4 offset:12288
ds_read_b64_tr_b16 v[26:27], v4 offset:14336
v_mfma_f32_16x16x32_bf16 a[136:139], v[28:31], a[88:91], a[136:139]
v_xor_b32 v4, 114784, v3
s_waitcnt lgkmcnt(4)
v_mfma_f32_16x16x32_bf16 a[144:147], v[12:15], a[64:67], 0
ds_read_b64_tr_b16 v[28:29], v4
v_cmp_le_u32 vcc, 71, v8
v_mfma_f32_16x16x32_bf16 a[148:151], v[12:15], a[68:71], 0
ds_read_b64_tr_b16 v[30:31], v4 offset:2048
v_cvt_pk_bf16_f32 v229, v202, v203
v_cvt_pk_bf16_f32 v96, v96, v97
v_mfma_f32_16x16x32_bf16 a[148:151], v[16:19], a[76:79], a[148:151]
ds_read_b64_tr_b16 v[12:13], v4 offset:4096
v_max3_f32 v0, v196, v197, v0
v_mfma_f32_16x16x32_bf16 a[144:147], v[16:19], a[72:75], a[144:147]
ds_read_b64_tr_b16 v[14:15], v4 offset:6144
s_waitcnt lgkmcnt(4)
v_mfma_f32_16x16x32_bf16 a[144:147], v[20:23], a[80:83], a[144:147]
ds_read_b64_tr_b16 v[16:17], v4 offset:8192
ds_read_b64_tr_b16 v[18:19], v4 offset:10240
v_mfma_f32_16x16x32_bf16 a[148:151], v[20:23], a[84:87], a[148:151]
s_cbranch_vccz L_sp63
L_ok63:
v_mfma_f32_16x16x32_bf16 a[148:151], v[24:27], a[92:95], a[148:151]
ds_read_b64_tr_b16 v[20:21], v4 offset:12288
ds_read_b64_tr_b16 v[22:23], v4 offset:14336
v_mfma_f32_16x16x32_bf16 a[144:147], v[24:27], a[88:91], a[144:147]
v_xor_b32 v4, 81920, v9
s_waitcnt lgkmcnt(4)
v_mfma_f32_16x16x32_bf16 a[152:155], v[28:31], a[64:67], 0
ds_read_b128 v[24:27], v4
v_cvt_pk_bf16_f32 v226, v196, v197
v_mfma_f32_16x16x32_bf16 a[156:159], v[28:31], a[68:71], 0
v_max3_f32 v2, v204, v205, v2
v_cvt_pk_bf16_f32 v230, v204, v205
v_accvgpr_write_b32 a96, v96
v_mfma_f32_16x16x32_bf16 a[156:159], v[12:15], a[76:79], a[156:159]
ds_read_b128 v[28:31], v4 offset:8192
v_max3_f32 v0, v198, v199, v0
v_mfma_f32_16x16x32_bf16 a[152:155], v[12:15], a[72:75], a[152:155]
v_cvt_pk_bf16_f32 v227, v198, v199
s_waitcnt lgkmcnt(2)
v_mfma_f32_16x16x32_bf16 a[152:155], v[16:19], a[80:83], a[152:155]
ds_read_b128 v[12:15], v4 offset:256
s_movk_i32 s12, 252
v_mfma_f32_16x16x32_bf16 a[156:159], v[16:19], a[84:87], a[156:159]
v_max3_f32 v2, v206, v207, v2
v_cvt_pk_bf16_f32 v231, v206, v207
v_mfma_f32_16x16x32_bf16 a[156:159], v[20:23], a[92:95], a[156:159]
ds_read_b128 v[16:19], v4 offset:8448
v_xor_b32 v4, 81984, v9
v_mfma_f32_16x16x32_bf16 a[152:155], v[20:23], a[88:91], a[152:155]
v_max3_f32 v0, v208, v209, v0
s_waitcnt lgkmcnt(2)
v_mfma_f32_16x16x32_bf16 v[192:195], v[24:27], v[128:131], 0
ds_read_b128 v[20:23], v4
v_cvt_pk_bf16_f32 v232, v208, v209
v_mfma_f32_16x16x32_bf16 v[200:203], v[24:27], v[132:135], 0
buffer_load_dword off, s[8:11], s12 lds
v_mul_f32 v98, v10, v98
v_mfma_f32_16x16x32_bf16 v[196:199], v[28:31], v[128:131], 0
ds_read_b128 v[24:27], v4 offset:8192
v_max3_f32 v2, v216, v217, v2
v_mfma_f32_16x16x32_bf16 v[204:207], v[28:31], v[132:135], 0
v_cvt_pk_bf16_f32 v236, v216, v217
s_waitcnt lgkmcnt(2)
v_mfma_f32_16x16x32_bf16 v[192:195], v[12:15], v[160:163], v[192:195]
ds_read_b128 v[28:31], v4 offset:256
v_mov_b32 v8, 0
v_mfma_f32_16x16x32_bf16 v[200:203], v[12:15], v[164:167], v[200:203]
v_max3_f32 v0, v210, v211, v0
v_cvt_pk_bf16_f32 v233, v210, v211
v_mfma_f32_16x16x32_bf16 v[196:199], v[16:19], v[160:163], v[196:199]
ds_read_b128 v[12:15], v4 offset:8448
v_xor_b32 v4, 82048, v9
v_mfma_f32_16x16x32_bf16 v[204:207], v[16:19], v[164:167], v[204:207]
v_max3_f32 v2, v218, v219, v2
s_waitcnt lgkmcnt(2)
v_mfma_f32_16x16x32_bf16 v[192:195], v[20:23], v[136:139], v[192:195]
ds_read_b128 v[16:19], v4
v_cvt_pk_bf16_f32 v237, v218, v219
v_mfma_f32_16x16x32_bf16 v[200:203], v[20:23], v[140:143], v[200:203]
ds_read_b32 v8, v8 offset:14336
v_max3_f32 v0, v212, v213, v0
v_mul_f32 v99, v10, v99
v_mfma_f32_16x16x32_bf16 v[196:199], v[24:27], v[136:139], v[196:199]
ds_read_b128 v[20:23], v4 offset:8192
v_cvt_pk_bf16_f32 v234, v212, v213
v_mfma_f32_16x16x32_bf16 v[204:207], v[24:27], v[140:143], v[204:207]
v_max3_f32 v2, v220, v221, v2
s_waitcnt lgkmcnt(3)
v_mfma_f32_16x16x32_bf16 v[192:195], v[28:31], v[168:171], v[192:195]
ds_read_b128 v[24:27], v4 offset:256
v_cvt_pk_bf16_f32 v238, v220, v221
v_mfma_f32_16x16x32_bf16 v[200:203], v[28:31], v[172:175], v[200:203]
v_max3_f32 v0, v214, v215, v0
v_cvt_pk_bf16_f32 v235, v214, v215
v_mfma_f32_16x16x32_bf16 v[196:199], v[12:15], v[168:171], v[196:199]
ds_read_b128 v[28:31], v4 offset:8448
v_xor_b32 v4, 82112, v9
v_mfma_f32_16x16x32_bf16 v[204:207], v[12:15], v[172:175], v[204:207]
v_max3_f32 v2, v222, v223, v2
s_waitcnt lgkmcnt(2)
v_mfma_f32_16x16x32_bf16 v[192:195], v[16:19], v[144:147], v[192:195]
ds_read_b128 v[12:15], v4
v_cmp_le_u32 vcc, 73, v8
v_mfma_f32_16x16x32_bf16 v[200:203], v[16:19], v[148:151], v[200:203]
v_cvt_pk_bf16_f32 v239, v222, v223
v_cvt_pk_bf16_f32 v98, v98, v99
v_accvgpr_write_b32 a97, v98
v_mfma_f32_16x16x32_bf16 v[196:199], v[20:23], v[144:147], v[196:199]
ds_read_b128 v[16:19], v4 offset:8192
v_mul_f32 v104, v10, v104
v_mfma_f32_16x16x32_bf16 v[204:207], v[20:23], v[148:151], v[204:207]
v_mul_f32 v105, v10, v105
s_waitcnt lgkmcnt(2)
v_mfma_f32_16x16x32_bf16 v[192:195], v[24:27], v[176:179], v[192:195]
ds_read_b128 v[20:23], v4 offset:256
v_cvt_pk_bf16_f32 v104, v104, v105
v_mfma_f32_16x16x32_bf16 v[200:203], v[24:27], v[180:183], v[200:203]
s_cbranch_vccz L_sp64
L_ok64:
v_mfma_f32_16x16x32_bf16 v[196:199], v[28:31], v[176:179], v[196:199]
ds_read_b128 v[24:27], v4 offset:8448
v_xor_b32 v4, 147456, v9
v_mfma_f32_16x16x32_bf16 v[204:207], v[28:31], v[180:183], v[204:207]
v_accvgpr_write_b32 a98, v104
s_waitcnt lgkmcnt(2)
v_mfma_f32_16x16x32_bf16 v[192:195], v[12:15], v[152:155], v[192:195]
ds_read_b128 v[28:31], v4
v_mul_f32 v106, v10, v106
v_mfma_f32_16x16x32_bf16 v[200:203], v[12:15], v[156:159], v[200:203]
v_mul_f32 v107, v10, v107
v_cvt_pk_bf16_f32 v106, v106, v107
v_accvgpr_write_b32 a99, v106
v_mfma_f32_16x16x32_bf16 v[196:199], v[16:19], v[152:155], v[196:199]
ds_read_b128 v[12:15], v4 offset:8192
v_mul_f32 v100, v11, v100
v_mfma_f32_16x16x32_bf16 v[204:207], v[16:19], v[156:159], v[204:207]
v_mul_f32 v101, v11, v101
s_waitcnt lgkmcnt(2)
v_mfma_f32_16x16x32_bf16 v[192:195], v[20:23], v[184:187], v[192:195]
ds_read_b128 v[16:19], v4 offset:256
s_movk_i32 s12, 256
v_mfma_f32_16x16x32_bf16 v[200:203], v[20:23], v[188:191], v[200:203]
v_cvt_pk_bf16_f32 v100, v100, v101
v_accvgpr_write_b32 a100, v100
v_mfma_f32_16x16x32_bf16 v[196:199], v[24:27], v[184:187], v[196:199]
ds_read_b128 v[20:23], v4 offset:8448
v_xor_b32 v4, 147520, v9
v_mfma_f32_16x16x32_bf16 v[204:207], v[24:27], v[188:191], v[204:207]
v_mul_f32 v102, v11, v102
s_waitcnt lgkmcnt(2)
v_mfma_f32_16x16x32_bf16 v[208:211], v[28:31], v[128:131], 0
ds_read_b128 v[24:27], v4
v_mul_f32 v103, v11, v103
v_mfma_f32_16x16x32_bf16 v[216:219], v[28:31], v[132:135], 0
buffer_load_dword off, s[8:11], s12 lds
v_cvt_pk_bf16_f32 v102, v102, v103
v_mfma_f32_16x16x32_bf16 v[212:215], v[12:15], v[128:131], 0
ds_read_b128 v[28:31], v4 offset:8192
v_max3_f32 v0, v192, v193, v0
v_mfma_f32_16x16x32_bf16 v[220:223], v[12:15], v[132:135], 0
v_cvt_pk_bf16_f32 v240, v192, v193
s_waitcnt lgkmcnt(2)
v_mfma_f32_16x16x32_bf16 v[208:211], v[16:19], v[160:163], v[208:211]
ds_read_b128 v[12:15], v4 offset:256
v_max3_f32 v2, v200, v201, v2
v_mfma_f32_16x16x32_bf16 v[216:219], v[16:19], v[164:167], v[216:219]
v_cvt_pk_bf16_f32 v244, v200, v201
v_max3_f32 v0, v194, v195, v0
v_mfma_f32_16x16x32_bf16 v[212:215], v[20:23], v[160:163], v[212:215]
ds_read_b128 v[16:19], v4 offset:8448
v_xor_b32 v4, 147584, v9
v_mfma_f32_16x16x32_bf16 v[220:223], v[20:23], v[164:167], v[220:223]
v_cvt_pk_bf16_f32 v241, v194, v195
s_waitcnt lgkmcnt(2)
v_mfma_f32_16x16x32_bf16 v[208:211], v[24:27], v[136:139], v[208:211]
ds_read_b128 v[20:23], v4
v_max3_f32 v2, v202, v203, v2
v_mfma_f32_16x16x32_bf16 v[216:219], v[24:27], v[140:143], v[216:219]
v_cvt_pk_bf16_f32 v245, v202, v203
v_max3_f32 v0, v196, v197, v0
v_accvgpr_write_b32 a101, v102
v_mfma_f32_16x16x32_bf16 v[212:215], v[28:31], v[136:139], v[212:215]
ds_read_b128 v[24:27], v4 offset:8192
v_cvt_pk_bf16_f32 v242, v196, v197
v_mfma_f32_16x16x32_bf16 v[220:223], v[28:31], v[140:143], v[220:223]
v_max3_f32 v2, v204, v205, v2
s_waitcnt lgkmcnt(2)
v_mfma_f32_16x16x32_bf16 v[208:211], v[12:15], v[168:171], v[208:211]
ds_read_b128 v[28:31], v4 offset:256
v_cvt_pk_bf16_f32 v246, v204, v205
v_mfma_f32_16x16x32_bf16 v[216:219], v[12:15], v[172:175], v[216:219]
v_max3_f32 v0, v198, v199, v0
v_cvt_pk_bf16_f32 v243, v198, v199
v_mfma_f32_16x16x32_bf16 v[212:215], v[16:19], v[168:171], v[212:215]
ds_read_b128 v[12:15], v4 offset:8448
v_xor_b32 v4, 147648, v9
v_mfma_f32_16x16x32_bf16 v[220:223], v[16:19], v[172:175], v[220:223]
v_max3_f32 v2, v206, v207, v2
s_waitcnt lgkmcnt(2)
v_mfma_f32_16x16x32_bf16 v[208:211], v[20:23], v[144:147], v[208:211]
ds_read_b128 v[16:19], v4
v_cvt_pk_bf16_f32 v247, v206, v207
v_mfma_f32_16x16x32_bf16 v[216:219], v[20:23], v[148:151], v[216:219]
v_mul_f32 v108, v11, v108
v_mul_f32 v109, v11, v109
v_cvt_pk_bf16_f32 v108, v108, v109
v_mfma_f32_16x16x32_bf16 v[212:215], v[24:27], v[144:147], v[212:215]
ds_read_b128 v[20:23], v4 offset:8192
v_accvgpr_write_b32 a102, v108
v_mfma_f32_16x16x32_bf16 v[220:223], v[24:27], v[148:151], v[220:223]
v_mul_f32 v110, v11, v110
s_waitcnt lgkmcnt(2)
v_mfma_f32_16x16x32_bf16 v[208:211], v[28:31], v[176:179], v[208:211]
ds_read_b128 v[24:27], v4 offset:256
v_mul_f32 v111, v11, v111
v_mfma_f32_16x16x32_bf16 v[216:219], v[28:31], v[180:183], v[216:219]
v_cvt_pk_bf16_f32 v110, v110, v111
v_accvgpr_write_b32 a103, v110
v_mfma_f32_16x16x32_bf16 v[212:215], v[12:15], v[176:179], v[212:215]
ds_read_b128 v[28:31], v4 offset:8448
v_xor_b32 v4, 32768, v3
v_mfma_f32_16x16x32_bf16 v[220:223], v[12:15], v[180:183], v[220:223]
v_mul_f32 v112, v10, v112
s_waitcnt lgkmcnt(2)
v_mfma_f32_16x16x32_bf16 v[208:211], v[16:19], v[152:155], v[208:211]
ds_read_b64_tr_b16 v[12:13], v4
v_mul_f32 v113, v10, v113
v_mfma_f32_16x16x32_bf16 v[216:219], v[16:19], v[156:159], v[216:219]
ds_read_b64_tr_b16 v[14:15], v4 offset:2048
v_cvt_pk_bf16_f32 v112, v112, v113
v_accvgpr_write_b32 a104, v112
v_mfma_f32_16x16x32_bf16 v[212:215], v[20:23], v[152:155], v[212:215]
ds_read_b64_tr_b16 v[16:17], v4 offset:4096
v_mul_f32 v114, v10, v114
v_mfma_f32_16x16x32_bf16 v[220:223], v[20:23], v[156:159], v[220:223]
ds_read_b64_tr_b16 v[18:19], v4 offset:6144
s_waitcnt lgkmcnt(4)
v_mfma_f32_16x16x32_bf16 v[208:211], v[24:27], v[184:187], v[208:211]
ds_read_b64_tr_b16 v[20:21], v4 offset:8192
s_movk_i32 s12, 260
v_mfma_f32_16x16x32_bf16 v[216:219], v[24:27], v[188:191], v[216:219]
ds_read_b64_tr_b16 v[22:23], v4 offset:10240
v_mul_f32 v115, v10, v115
v_mfma_f32_16x16x32_bf16 v[212:215], v[28:31], v[184:187], v[212:215]
ds_read_b64_tr_b16 v[24:25], v4 offset:12288
ds_read_b64_tr_b16 v[26:27], v4 offset:14336
v_mfma_f32_16x16x32_bf16 v[220:223], v[28:31], v[188:191], v[220:223]
v_xor_b32 v4, 32800, v3
s_waitcnt lgkmcnt(4)
v_mfma_f32_16x16x32_bf16 a[160:163], v[12:15], a[64:67], 0
ds_read_b64_tr_b16 v[28:29], v4
v_cvt_pk_bf16_f32 v114, v114, v115
v_mfma_f32_16x16x32_bf16 a[164:167], v[12:15], a[68:71], 0
ds_read_b64_tr_b16 v[30:31], v4 offset:2048
buffer_load_dword off, s[8:11], s12 lds
v_mfma_f32_16x16x32_bf16 a[164:167], v[16:19], a[76:79], a[164:167]
ds_read_b64_tr_b16 v[12:13], v4 offset:4096
v_max3_f32 v0, v208, v209, v0
v_mfma_f32_16x16x32_bf16 a[160:163], v[16:19], a[72:75], a[160:163]
ds_read_b64_tr_b16 v[14:15], v4 offset:6144
s_waitcnt lgkmcnt(4)
v_mfma_f32_16x16x32_bf16 a[160:163], v[20:23], a[80:83], a[160:163]
ds_read_b64_tr_b16 v[16:17], v4 offset:8192
v_mov_b32 v8, 0
v_mfma_f32_16x16x32_bf16 a[164:167], v[20:23], a[84:87], a[164:167]
ds_read_b64_tr_b16 v[18:19], v4 offset:10240
v_cvt_pk_bf16_f32 v248, v208, v209
v_mfma_f32_16x16x32_bf16 a[164:167], v[24:27], a[92:95], a[164:167]
ds_read_b64_tr_b16 v[20:21], v4 offset:12288
ds_read_b64_tr_b16 v[22:23], v4 offset:14336
v_mfma_f32_16x16x32_bf16 a[160:163], v[24:27], a[88:91], a[160:163]
v_xor_b32 v4, 32832, v3
s_waitcnt lgkmcnt(4)
v_mfma_f32_16x16x32_bf16 a[168:171], v[28:31], a[64:67], 0
ds_read_b64_tr_b16 v[24:25], v4
v_max3_f32 v2, v216, v217, v2
v_mfma_f32_16x16x32_bf16 a[172:175], v[28:31], a[68:71], 0
ds_read_b64_tr_b16 v[26:27], v4 offset:2048
v_accvgpr_write_b32 a105, v114
ds_read_b32 v8, v8 offset:14336
v_mfma_f32_16x16x32_bf16 a[172:175], v[12:15], a[76:79], a[172:175]
ds_read_b64_tr_b16 v[28:29], v4 offset:4096
v_cvt_pk_bf16_f32 v252, v216, v217
v_mfma_f32_16x16x32_bf16 a[168:171], v[12:15], a[72:75], a[168:171]
ds_read_b64_tr_b16 v[30:31], v4 offset:6144
s_waitcnt lgkmcnt(5)
v_mfma_f32_16x16x32_bf16 a[168:171], v[16:19], a[80:83], a[168:171]
ds_read_b64_tr_b16 v[12:13], v4 offset:8192
v_max3_f32 v0, v210, v211, v0
v_mfma_f32_16x16x32_bf16 a[172:175], v[16:19], a[84:87], a[172:175]
ds_read_b64_tr_b16 v[14:15], v4 offset:10240
v_cvt_pk_bf16_f32 v249, v210, v211
v_mfma_f32_16x16x32_bf16 a[172:175], v[20:23], a[92:95], a[172:175]
ds_read_b64_tr_b16 v[16:17], v4 offset:12288
ds_read_b64_tr_b16 v[18:19], v4 offset:14336
v_mfma_f32_16x16x32_bf16 a[168:171], v[20:23], a[88:91], a[168:171]
v_xor_b32 v4, 32864, v3
s_waitcnt lgkmcnt(4)
v_mfma_f32_16x16x32_bf16 a[176:179], v[24:27], a[64:67], 0
ds_read_b64_tr_b16 v[20:21], v4
v_cmp_le_u32 vcc, 74, v8
v_mfma_f32_16x16x32_bf16 a[180:183], v[24:27], a[68:71], 0
ds_read_b64_tr_b16 v[22:23], v4 offset:2048
v_max3_f32 v2, v218, v219, v2
v_mul_f32 v120, v10, v120
v_mfma_f32_16x16x32_bf16 a[180:183], v[28:31], a[76:79], a[180:183]
ds_read_b64_tr_b16 v[24:25], v4 offset:4096
v_cvt_pk_bf16_f32 v253, v218, v219
v_mfma_f32_16x16x32_bf16 a[176:179], v[28:31], a[72:75], a[176:179]
ds_read_b64_tr_b16 v[26:27], v4 offset:6144
s_waitcnt lgkmcnt(4)
v_mfma_f32_16x16x32_bf16 a[176:179], v[12:15], a[80:83], a[176:179]
ds_read_b64_tr_b16 v[28:29], v4 offset:8192
ds_read_b64_tr_b16 v[30:31], v4 offset:10240
v_mfma_f32_16x16x32_bf16 a[180:183], v[12:15], a[84:87], a[180:183]
s_cbranch_vccz L_sp66
L_ok66:
v_mfma_f32_16x16x32_bf16 a[180:183], v[16:19], a[92:95], a[180:183]
ds_read_b64_tr_b16 v[12:13], v4 offset:12288
ds_read_b64_tr_b16 v[14:15], v4 offset:14336
v_mfma_f32_16x16x32_bf16 a[176:179], v[16:19], a[88:91], a[176:179]
v_xor_b32 v4, 16384, v9
s_waitcnt lgkmcnt(4)
v_mfma_f32_16x16x32_bf16 a[184:187], v[20:23], a[64:67], 0
ds_read_b128 v[16:19], v4
v_max3_f32 v0, v212, v213, v0
v_mfma_f32_16x16x32_bf16 a[188:191], v[20:23], a[68:71], 0
v_cvt_pk_bf16_f32 v250, v212, v213
v_max3_f32 v2, v220, v221, v2
v_mul_f32 v121, v10, v121
v_mfma_f32_16x16x32_bf16 a[188:191], v[24:27], a[76:79], a[188:191]
ds_read_b128 v[20:23], v4 offset:8192
v_cvt_pk_bf16_f32 v254, v220, v221
v_mfma_f32_16x16x32_bf16 a[184:187], v[24:27], a[72:75], a[184:187]
v_max3_f32 v0, v214, v215, v0
s_waitcnt lgkmcnt(2)
v_mfma_f32_16x16x32_bf16 a[184:187], v[28:31], a[80:83], a[184:187]
ds_read_b128 v[24:27], v4 offset:256
s_movk_i32 s12, 264
v_mfma_f32_16x16x32_bf16 a[188:191], v[28:31], a[84:87], a[188:191]
v_cvt_pk_bf16_f32 v251, v214, v215
v_max3_f32 v2, v222, v223, v2
v_mfma_f32_16x16x32_bf16 a[188:191], v[12:15], a[92:95], a[188:191]
ds_read_b128 v[28:31], v4 offset:8448
v_xor_b32 v4, 16448, v9
v_mfma_f32_16x16x32_bf16 a[184:187], v[12:15], a[88:91], a[184:187]
v_cvt_pk_bf16_f32 v255, v222, v223
s_waitcnt lgkmcnt(2)
v_mfma_f32_16x16x32_bf16 v[192:195], v[16:19], v[128:131], 0
ds_read_b128 v[12:15], v4
v_cvt_pk_bf16_f32 v120, v120, v121
v_mfma_f32_16x16x32_bf16 v[200:203], v[16:19], v[132:135], 0
buffer_load_dword off, s[8:11], s12 lds
v_accvgpr_write_b32 a106, v120
v_mfma_f32_16x16x32_bf16 v[196:199], v[20:23], v[128:131], 0
ds_read_b128 v[16:19], v4 offset:8192
v_mul_f32 v122, v10, v122
v_mfma_f32_16x16x32_bf16 v[204:207], v[20:23], v[132:135], 0
v_mul_f32 v123, v10, v123
s_waitcnt lgkmcnt(2)
v_mfma_f32_16x16x32_bf16 v[192:195], v[24:27], v[160:163], v[192:195]
ds_read_b128 v[20:23], v4 offset:256
v_mov_b32 v8, 0
v_mfma_f32_16x16x32_bf16 v[200:203], v[24:27], v[164:167], v[200:203]
v_cvt_pk_bf16_f32 v122, v122, v123
v_accvgpr_write_b32 a107, v122
v_mfma_f32_16x16x32_bf16 v[196:199], v[28:31], v[160:163], v[196:199]
ds_read_b128 v[24:27], v4 offset:8448
v_xor_b32 v4, 16512, v9
v_mfma_f32_16x16x32_bf16 v[204:207], v[28:31], v[164:167], v[204:207]
v_mul_f32 v116, v11, v116
s_waitcnt lgkmcnt(2)
v_mfma_f32_16x16x32_bf16 v[192:195], v[12:15], v[136:139], v[192:195]
ds_read_b128 v[28:31], v4
v_mul_f32 v117, v11, v117
v_mfma_f32_16x16x32_bf16 v[200:203], v[12:15], v[140:143], v[200:203]
ds_read_b32 v8, v8 offset:14336
v_cvt_pk_bf16_f32 v116, v116, v117
v_accvgpr_write_b32 a108, v116
v_mfma_f32_16x16x32_bf16 v[196:199], v[16:19], v[136:139], v[196:199]
ds_read_b128 v[12:15], v4 offset:8192
v_mul_f32 v118, v11, v118
v_mfma_f32_16x16x32_bf16 v[204:207], v[16:19], v[140:143], v[204:207]
v_mul_f32 v119, v11, v119
s_waitcnt lgkmcnt(3)
v_mfma_f32_16x16x32_bf16 v[192:195], v[20:23], v[168:171], v[192:195]
ds_read_b128 v[16:19], v4 offset:256
v_cvt_pk_bf16_f32 v118, v118, v119
v_mfma_f32_16x16x32_bf16 v[200:203], v[20:23], v[172:175], v[200:203]
v_accvgpr_write_b32 a109, v118
v_mul_f32 v124, v11, v124
v_mfma_f32_16x16x32_bf16 v[196:199], v[24:27], v[168:171], v[196:199]
ds_read_b128 v[20:23], v4 offset:8448
v_xor_b32 v4, 16576, v9
v_mfma_f32_16x16x32_bf16 v[204:207], v[24:27], v[172:175], v[204:207]
v_mul_f32 v125, v11, v125
s_waitcnt lgkmcnt(2)
v_mfma_f32_16x16x32_bf16 v[192:195], v[28:31], v[144:147], v[192:195]
ds_read_b128 v[24:27], v4
v_cmp_le_u32 vcc, 75, v8
v_mfma_f32_16x16x32_bf16 v[200:203], v[28:31], v[148:151], v[200:203]
v_cvt_pk_bf16_f32 v124, v124, v125
v_accvgpr_write_b32 a110, v124
v_mul_f32 v126, v11, v126
v_mfma_f32_16x16x32_bf16 v[196:199], v[12:15], v[144:147], v[196:199]
ds_read_b128 v[28:31], v4 offset:8192
v_mul_f32 v127, v11, v127
v_mfma_f32_16x16x32_bf16 v[204:207], v[12:15], v[148:151], v[204:207]
v_cvt_pk_bf16_f32 v126, v126, v127
s_waitcnt lgkmcnt(2)
v_mfma_f32_16x16x32_bf16 v[192:195], v[16:19], v[176:179], v[192:195]
ds_read_b128 v[12:15], v4 offset:256
v_accvgpr_write_b32 a111, v126
v_mfma_f32_16x16x32_bf16 v[200:203], v[16:19], v[180:183], v[200:203]
s_cbranch_vccz L_sp67
L_ok67:
v_mfma_f32_16x16x32_bf16 v[196:199], v[20:23], v[176:179], v[196:199]
ds_read_b128 v[16:19], v4 offset:8448
v_xor_b32 v4, 65536, v9
v_mfma_f32_16x16x32_bf16 v[204:207], v[20:23], v[180:183], v[204:207]
v_accvgpr_read_b32 v6, a0
s_waitcnt lgkmcnt(2)
v_mfma_f32_16x16x32_bf16 v[192:195], v[24:27], v[152:155], v[192:195]
ds_read_b128 v[20:23], v4
v_accvgpr_read_b32 v7, a1
v_mfma_f32_16x16x32_bf16 v[200:203], v[24:27], v[156:159], v[200:203]
v_mul_f32 v6, v10, v6
v_mul_f32 v7, v10, v7
v_cvt_pk_bf16_f32 v6, v6, v7
v_mfma_f32_16x16x32_bf16 v[196:199], v[28:31], v[152:155], v[196:199]
ds_read_b128 v[24:27], v4 offset:8192
v_accvgpr_write_b32 a112, v6
v_mfma_f32_16x16x32_bf16 v[204:207], v[28:31], v[156:159], v[204:207]
v_accvgpr_read_b32 v6, a2
s_waitcnt lgkmcnt(2)
v_mfma_f32_16x16x32_bf16 v[192:195], v[12:15], v[184:187], v[192:195]
ds_read_b128 v[28:31], v4 offset:256
s_movk_i32 s12, 268
v_mfma_f32_16x16x32_bf16 v[200:203], v[12:15], v[188:191], v[200:203]
v_accvgpr_read_b32 v7, a3
v_mul_f32 v6, v10, v6
v_mfma_f32_16x16x32_bf16 v[196:199], v[16:19], v[184:187], v[196:199]
ds_read_b128 v[12:15], v4 offset:8448
v_xor_b32 v4, 65600, v9
v_mfma_f32_16x16x32_bf16 v[204:207], v[16:19], v[188:191], v[204:207]
v_mul_f32 v7, v10, v7
s_waitcnt lgkmcnt(2)
v_mfma_f32_16x16x32_bf16 v[208:211], v[20:23], v[128:131], 0
ds_read_b128 v[16:19], v4
v_cvt_pk_bf16_f32 v6, v6, v7
v_mfma_f32_16x16x32_bf16 v[216:219], v[20:23], v[132:135], 0
buffer_load_dword off, s[8:11], s12 lds
v_accvgpr_write_b32 a113, v6
v_mfma_f32_16x16x32_bf16 v[212:215], v[24:27], v[128:131], 0
ds_read_b128 v[20:23], v4 offset:8192
v_max3_f32 v0, v192, v193, v0
v_mfma_f32_16x16x32_bf16 v[220:223], v[24:27], v[132:135], 0
v_cvt_pk_bf16_f32 v32, v192, v193
s_waitcnt lgkmcnt(2)
v_mfma_f32_16x16x32_bf16 v[208:211], v[28:31], v[160:163], v[208:211]
ds_read_b128 v[24:27], v4 offset:256
v_mov_b32 v8, 0
v_mfma_f32_16x16x32_bf16 v[216:219], v[28:31], v[164:167], v[216:219]
v_max3_f32 v2, v200, v201, v2
v_cvt_pk_bf16_f32 v36, v200, v201
v_mfma_f32_16x16x32_bf16 v[212:215], v[12:15], v[160:163], v[212:215]
s_branch L_pg13
L_sp68:
v_mov_b32 v8, 0
ds_read_b32 v8, v8 offset:14336
s_waitcnt lgkmcnt(0)
v_cmp_le_u32 vcc, 77, v8
s_cbranch_vccz L_sp68
s_branch L_ok68
L_sp70:
v_mov_b32 v8, 0
ds_read_b32 v8, v8 offset:14336
s_waitcnt lgkmcnt(0)
v_cmp_le_u32 vcc, 78, v8
s_cbranch_vccz L_sp70
s_branch L_ok70
L_sp71:
v_mov_b32 v8, 0
ds_read_b32 v8, v8 offset:14336
s_waitcnt lgkmcnt(0)
v_cmp_le_u32 vcc, 80, v8
s_cbranch_vccz L_sp71
s_branch L_ok71
.p2align 12
L_stub13:
s_setpc_b64 s[94:95]
L_pg13:
ds_read_b128 v[28:31], v4 offset:8448
v_xor_b32 v4, 65664, v9
v_mfma_f32_16x16x32_bf16 v[220:223], v[12:15], v[164:167], v[220:223]
v_max3_f32 v0, v194, v195, v0
s_waitcnt lgkmcnt(2)
v_mfma_f32_16x16x32_bf16 v[208:211], v[16:19], v[136:139], v[208:211]
ds_read_b128 v[12:15], v4
v_cvt_pk_bf16_f32 v33, v194, v195
v_mfma_f32_16x16x32_bf16 v[216:219], v[16:19], v[140:143], v[216:219]
ds_read_b32 v8, v8 offset:14336
v_max3_f32 v2, v202, v203, v2
v_accvgpr_read_b32 v6, a8
v_mfma_f32_16x16x32_bf16 v[212:215], v[20:23], v[136:139], v[212:215]
ds_read_b128 v[16:19], v4 offset:8192
v_cvt_pk_bf16_f32 v37, v202, v203
v_mfma_f32_16x16x32_bf16 v[220:223], v[20:23], v[140:143], v[220:223]
v_max3_f32 v0, v196, v197, v0
s_waitcnt lgkmcnt(3)
v_mfma_f32_16x16x32_bf16 v[208:211], v[24:27], v[168:171], v[208:211]
ds_read_b128 v[20:23], v4 offset:256
v_cvt_pk_bf16_f32 v34, v196, v197
v_mfma_f32_16x16x32_bf16 v[216:219], v[24:27], v[172:175], v[216:219]
v_max3_f32 v2, v204, v205, v2
v_cvt_pk_bf16_f32 v38, v204, v205
v_mfma_f32_16x16x32_bf16 v[212:215], v[28:31], v[168:171], v[212:215]
ds_read_b128 v[24:27], v4 offset:8448
v_xor_b32 v4, 65728, v9
v_mfma_f32_16x16x32_bf16 v[220:223], v[28:31], v[172:175], v[220:223]
v_max3_f32 v0, v198, v199, v0
s_waitcnt lgkmcnt(2)
v_mfma_f32_16x16x32_bf16 v[208:211], v[12:15], v[144:147], v[208:211]
ds_read_b128 v[28:31], v4
v_cmp_le_u32 vcc, 77, v8
v_mfma_f32_16x16x32_bf16 v[216:219], v[12:15], v[148:151], v[216:219]
v_cvt_pk_bf16_f32 v35, v198, v199
v_max3_f32 v2, v206, v207, v2
v_accvgpr_read_b32 v7, a9
v_mfma_f32_16x16x32_bf16 v[212:215], v[16:19], v[144:147], v[212:215]
ds_read_b128 v[12:15], v4 offset:8192
v_cvt_pk_bf16_f32 v39, v206, v207
v_mfma_f32_16x16x32_bf16 v[220:223], v[16:19], v[148:151], v[220:223]
v_mul_f32 v6, v10, v6
s_waitcnt lgkmcnt(2)
v_mfma_f32_16x16x32_bf16 v[208:211], v[20:23], v[176:179], v[208:211]
ds_read_b128 v[16:19], v4 offset:256
v_mul_f32 v7, v10, v7
v_mfma_f32_16x16x32_bf16 v[216:219], v[20:23], v[180:183], v[216:219]
s_cbranch_vccz L_sp68
L_ok68:
v_mfma_f32_16x16x32_bf16 v[212:215], v[24:27], v[176:179], v[212:215]
ds_read_b128 v[20:23], v4 offset:8448
v_xor_b32 v4, 131072, v9
v_mfma_f32_16x16x32_bf16 v[220:223], v[24:27], v[180:183], v[220:223]
v_cvt_pk_bf16_f32 v6, v6, v7
s_waitcnt lgkmcnt(2)
v_mfma_f32_16x16x32_bf16 v[208:211], v[28:31], v[152:155], v[208:211]
ds_read_b128 v[24:27], v4
v_accvgpr_write_b32 a114, v6
v_mfma_f32_16x16x32_bf16 v[216:219], v[28:31], v[156:159], v[216:219]
v_accvgpr_read_b32 v6, a10
v_accvgpr_read_b32 v7, a11
v_mul_f32 v6, v10, v6
v_mfma_f32_16x16x32_bf16 v[212:215], v[12:15], v[152:155], v[212:215]
ds_read_b128 v[28:31], v4 offset:8192
v_mul_f32 v7, v10, v7
v_mfma_f32_16x16x32_bf16 v[220:223], v[12:15], v[156:159], v[220:223]
v_cvt_pk_bf16_f32 v6, v6, v7
s_waitcnt lgkmcnt(2)
v_mfma_f32_16x16x32_bf16 v[208:211], v[16:19], v[184:187], v[208:211]
ds_read_b128 v[12:15], v4 offset:256
s_movk_i32 s12, 272
v_mfma_f32_16x16x32_bf16 v[216:219], v[16:19], v[188:191], v[216:219]
v_accvgpr_write_b32 a115, v6
v_accvgpr_read_b32 v6, a4
v_mfma_f32_16x16x32_bf16 v[212:215], v[20:23], v[184:187], v[212:215]
ds_read_b128 v[16:19], v4 offset:8448
v_xor_b32 v4, 131136, v9
v_mfma_f32_16x16x32_bf16 v[220:223], v[20:23], v[188:191], v[220:223]
v_accvgpr_read_b32 v7, a5
s_waitcnt lgkmcnt(2)
v_mfma_f32_16x16x32_bf16 v[192:195], v[24:27], v[128:131], 0
ds_read_b128 v[20:23], v4
v_mul_f32 v6, v11, v6
v_mfma_f32_16x16x32_bf16 v[200:203], v[24:27], v[132:135], 0
buffer_load_dword off, s[8:11], s12 lds
v_mul_f32 v7, v11, v7
v_mfma_f32_16x16x32_bf16 v[196:199], v[28:31], v[128:131], 0
ds_read_b128 v[24:27], v4 offset:8192
v_max3_f32 v0, v208, v209, v0
v_mfma_f32_16x16x32_bf16 v[204:207], v[28:31], v[132:135], 0
v_cvt_pk_bf16_f32 v40, v208, v209
s_waitcnt lgkmcnt(2)
v_mfma_f32_16x16x32_bf16 v[192:195], v[12:15], v[160:163], v[192:195]
ds_read_b128 v[28:31], v4 offset:256
v_max3_f32 v2, v216, v217, v2
v_mfma_f32_16x16x32_bf16 v[200:203], v[12:15], v[164:167], v[200:203]
v_cvt_pk_bf16_f32 v44, v216, v217
v_max3_f32 v0, v210, v211, v0
v_mfma_f32_16x16x32_bf16 v[196:199], v[16:19], v[160:163], v[196:199]
ds_read_b128 v[12:15], v4 offset:8448
v_xor_b32 v4, 131200, v9
v_mfma_f32_16x16x32_bf16 v[204:207], v[16:19], v[164:167], v[204:207]
v_cvt_pk_bf16_f32 v41, v210, v211
s_waitcnt lgkmcnt(2)
v_mfma_f32_16x16x32_bf16 v[192:195], v[20:23], v[136:139], v[192:195]
ds_read_b128 v[16:19], v4
v_max3_f32 v2, v218, v219, v2
v_mfma_f32_16x16x32_bf16 v[200:203], v[20:23], v[140:143], v[200:203]
v_cvt_pk_bf16_f32 v45, v218, v219
v_max3_f32 v0, v212, v213, v0
v_cvt_pk_bf16_f32 v6, v6, v7
v_mfma_f32_16x16x32_bf16 v[196:199], v[24:27], v[136:139], v[196:199]
ds_read_b128 v[20:23], v4 offset:8192
v_cvt_pk_bf16_f32 v42, v212, v213
v_mfma_f32_16x16x32_bf16 v[204:207], v[24:27], v[140:143], v[204:207]
v_max3_f32 v2, v220, v221, v2
s_waitcnt lgkmcnt(2)
v_mfma_f32_16x16x32_bf16 v[192:195], v[28:31], v[168:171], v[192:195]
ds_read_b128 v[24:27], v4 offset:256
v_cvt_pk_bf16_f32 v46, v220, v221
v_mfma_f32_16x16x32_bf16 v[200:203], v[28:31], v[172:175], v[200:203]
v_max3_f32 v0, v214, v215, v0
v_cvt_pk_bf16_f32 v43, v214, v215
v_mfma_f32_16x16x32_bf16 v[196:199], v[12:15], v[168:171], v[196:199]
ds_read_b128 v[28:31], v4 offset:8448
v_xor_b32 v4, 131264, v9
v_mfma_f32_16x16x32_bf16 v[204:207], v[12:15], v[172:175], v[204:207]
v_max3_f32 v2, v222, v223, v2
s_waitcnt lgkmcnt(2)
v_mfma_f32_16x16x32_bf16 v[192:195], v[16:19], v[144:147], v[192:195]
ds_read_b128 v[12:15], v4
v_cvt_pk_bf16_f32 v47, v222, v223
v_mfma_f32_16x16x32_bf16 v[200:203], v[16:19], v[148:151], v[200:203]
v_accvgpr_write_b32 a116, v6
v_accvgpr_read_b32 v6, a6
v_accvgpr_read_b32 v7, a7
v_mfma_f32_16x16x32_bf16 v[196:199], v[20:23], v[144:147], v[196:199]
ds_read_b128 v[16:19], v4 offset:8192
v_mul_f32 v6, v11, v6
v_mfma_f32_16x16x32_bf16 v[204:207], v[20:23], v[148:151], v[204:207]
v_mul_f32 v7, v11, v7
s_waitcnt lgkmcnt(2)
v_mfma_f32_16x16x32_bf16 v[192:195], v[24:27], v[176:179], v[192:195]
ds_read_b128 v[20:23], v4 offset:256
v_cvt_pk_bf16_f32 v6, v6, v7
v_mfma_f32_16x16x32_bf16 v[200:203], v[24:27], v[180:183], v[200:203]
v_accvgpr_write_b32 a117, v6
v_accvgpr_read_b32 v6, a12
v_mfma_f32_16x16x32_bf16 v[196:199], v[28:31], v[176:179], v[196:199]
ds_read_b128 v[24:27], v4 offset:8448
v_xor_b32 v4, 49152, v3
v_mfma_f32_16x16x32_bf16 v[204:207], v[28:31], v[180:183], v[204:207]
v_accvgpr_read_b32 v7, a13
s_waitcnt lgkmcnt(2)
v_mfma_f32_16x16x32_bf16 v[192:195], v[12:15], v[152:155], v[192:195]
ds_read_b64_tr_b16 v[28:29], v4
v_mul_f32 v6, v11, v6
v_mfma_f32_16x16x32_bf16 v[200:203], v[12:15], v[156:159], v[200:203]
ds_read_b64_tr_b16 v[30:31], v4 offset:2048
v_mul_f32 v7, v11, v7
v_cvt_pk_bf16_f32 v6, v6, v7
v_mfma_f32_16x16x32_bf16 v[196:199], v[16:19], v[152:155], v[196:199]
ds_read_b64_tr_b16 v[12:13], v4 offset:4096
v_accvgpr_write_b32 a118, v6
v_mfma_f32_16x16x32_bf16 v[204:207], v[16:19], v[156:159], v[204:207]
ds_read_b64_tr_b16 v[14:15], v4 offset:6144
s_waitcnt lgkmcnt(4)
v_mfma_f32_16x16x32_bf16 v[192:195], v[20:23], v[184:187], v[192:195]
ds_read_b64_tr_b16 v[16:17], v4 offset:8192
s_movk_i32 s12, 276
v_mfma_f32_16x16x32_bf16 v[200:203], v[20:23], v[188:191], v[200:203]
ds_read_b64_tr_b16 v[18:19], v4 offset:10240
v_accvgpr_read_b32 v6, a14
v_mfma_f32_16x16x32_bf16 v[196:199], v[24:27], v[184:187], v[196:199]
ds_read_b64_tr_b16 v[20:21], v4 offset:12288
ds_read_b64_tr_b16 v[22:23], v4 offset:14336
v_mfma_f32_16x16x32_bf16 v[204:207], v[24:27], v[188:191], v[204:207]
v_xor_b32 v4, 49184, v3
s_waitcnt lgkmcnt(4)
v_mfma_f32_16x16x32_bf16 a[192:195], v[28:31], a[64:67], 0
ds_read_b64_tr_b16 v[24:25], v4
v_accvgpr_read_b32 v7, a15
v_mfma_f32_16x16x32_bf16 a[196:199], v[28:31], a[68:71], 0
ds_read_b64_tr_b16 v[26:27], v4 offset:2048
buffer_load_dword off, s[8:11], s12 lds
v_mfma_f32_16x16x32_bf16 a[196:199], v[12:15], a[76:79], a[196:199]
ds_read_b64_tr_b16 v[28:29], v4 offset:4096
v_max3_f32 v0, v192, v193, v0
v_mfma_f32_16x16x32_bf16 a[192:195], v[12:15], a[72:75], a[192:195]
ds_read_b64_tr_b16 v[30:31], v4 offset:6144
s_waitcnt lgkmcnt(4)
v_mfma_f32_16x16x32_bf16 a[192:195], v[16:19], a[80:83], a[192:195]
ds_read_b64_tr_b16 v[12:13], v4 offset:8192
v_mov_b32 v8, 0
v_mfma_f32_16x16x32_bf16 a[196:199], v[16:19], a[84:87], a[196:199]
ds_read_b64_tr_b16 v[14:15], v4 offset:10240
v_cvt_pk_bf16_f32 v48, v192, v193
v_mfma_f32_16x16x32_bf16 a[196:199], v[20:23], a[92:95], a[196:199]
ds_read_b64_tr_b16 v[16:17], v4 offset:12288
ds_read_b64_tr_b16 v[18:19], v4 offset:14336
v_mfma_f32_16x16x32_bf16 a[192:195], v[20:23], a[88:91], a[192:195]
v_xor_b32 v4, 49216, v3
s_waitcnt lgkmcnt(4)
v_mfma_f32_16x16x32_bf16 a[200:203], v[24:27], a[64:67], 0
ds_read_b64_tr_b16 v[20:21], v4
v_max3_f32 v2, v200, v201, v2
v_mfma_f32_16x16x32_bf16 a[204:207], v[24:27], a[68:71], 0
ds_read_b64_tr_b16 v[22:23], v4 offset:2048
v_mul_f32 v6, v11, v6
ds_read_b32 v8, v8 offset:14336
v_mfma_f32_16x16x32_bf16 a[204:207], v[28:31], a[76:79], a[204:207]
ds_read_b64_tr_b16 v[24:25], v4 offset:4096
v_cvt_pk_bf16_f32 v52, v200, v201
v_mfma_f32_16x16x32_bf16 a[200:203], v[28:31], a[72:75], a[200:203]
ds_read_b64_tr_b16 v[26:27], v4 offset:6144
s_waitcnt lgkmcnt(5)
v_mfma_f32_16x16x32_bf16 a[200:203], v[12:15], a[80:83], a[200:203]
ds_read_b64_tr_b16 v[28:29], v4 offset:8192
v_max3_f32 v0, v194, v195, v0
v_mfma_f32_16x16x32_bf16 a[204:207], v[12:15], a[84:87], a[204:207]
ds_read_b64_tr_b16 v[30:31], v4 offset:10240
v_cvt_pk_bf16_f32 v49, v194, v195
v_mfma_f32_16x16x32_bf16 a[204:207], v[16:19], a[92:95], a[204:207]
ds_read_b64_tr_b16 v[12:13], v4 offset:12288
ds_read_b64_tr_b16 v[14:15], v4 offset:14336
v_mfma_f32_16x16x32_bf16 a[200:203], v[16:19], a[88:91], a[200:203]
v_xor_b32 v4, 49248, v3
s_waitcnt lgkmcnt(4)
v_mfma_f32_16x16x32_bf16 a[208:211], v[20:23], a[64:67], 0
ds_read_b64_tr_b16 v[16:17], v4
v_cmp_le_u32 vcc, 78, v8
v_mfma_f32_16x16x32_bf16 a[212:215], v[20:23], a[68:71], 0
ds_read_b64_tr_b16 v[18:19], v4 offset:2048
v_max3_f32 v2, v202, v203, v2
v_mul_f32 v7, v11, v7
v_mfma_f32_16x16x32_bf16 a[212:215], v[24:27], a[76:79], a[212:215]
ds_read_b64_tr_b16 v[20:21], v4 offset:4096
v_cvt_pk_bf16_f32 v53, v202, v203
v_mfma_f32_16x16x32_bf16 a[208:211], v[24:27], a[72:75], a[208:211]
ds_read_b64_tr_b16 v[22:23], v4 offset:6144
s_waitcnt lgkmcnt(4)
v_mfma_f32_16x16x32_bf16 a[208:211], v[28:31], a[80:83], a[208:211]
ds_read_b64_tr_b16 v[24:25], v4 offset:8192
ds_read_b64_tr_b16 v[26:27], v4 offset:10240
v_mfma_f32_16x16x32_bf16 a[212:215], v[28:31], a[84:87], a[212:215]
s_cbranch_vccz L_sp70
L_ok70:
v_mfma_f32_16x16x32_bf16 a[212:215], v[12:15], a[92:95], a[212:215]
ds_read_b64_tr_b16 v[28:29], v4 offset:12288
ds_read_b64_tr_b16 v[30:31], v4 offset:14336
v_mfma_f32_16x16x32_bf16 a[208:211], v[12:15], a[88:91], a[208:211]
v_xor_b32 v4, 98304, v9
s_waitcnt lgkmcnt(4)
v_mfma_f32_16x16x32_bf16 a[216:219], v[16:19], a[64:67], 0
ds_read_b128 v[12:15], v4
v_max3_f32 v0, v196, v197, v0
v_mfma_f32_16x16x32_bf16 a[220:223], v[16:19], a[68:71], 0
v_cvt_pk_bf16_f32 v50, v196, v197
v_max3_f32 v2, v204, v205, v2
v_cvt_pk_bf16_f32 v6, v6, v7
v_mfma_f32_16x16x32_bf16 a[220:223], v[20:23], a[76:79], a[220:223]
ds_read_b128 v[16:19], v4 offset:8192
v_cvt_pk_bf16_f32 v54, v204, v205
v_mfma_f32_16x16x32_bf16 a[216:219], v[20:23], a[72:75], a[216:219]
v_max3_f32 v0, v198, v199, v0
s_waitcnt lgkmcnt(2)
v_mfma_f32_16x16x32_bf16 a[216:219], v[24:27], a[80:83], a[216:219]
ds_read_b128 v[20:23], v4 offset:256
s_movk_i32 s12, 280
v_mfma_f32_16x16x32_bf16 a[220:223], v[24:27], a[84:87], a[220:223]
v_cvt_pk_bf16_f32 v51, v198, v199
v_max3_f32 v2, v206, v207, v2
v_mfma_f32_16x16x32_bf16 a[220:223], v[28:31], a[92:95], a[220:223]
ds_read_b128 v[24:27], v4 offset:8448
v_xor_b32 v4, 98368, v9
v_mfma_f32_16x16x32_bf16 a[216:219], v[28:31], a[88:91], a[216:219]
v_cvt_pk_bf16_f32 v55, v206, v207
s_waitcnt lgkmcnt(2)
v_mfma_f32_16x16x32_bf16 v[208:211], v[12:15], v[128:131], 0
ds_read_b128 v[28:31], v4
v_accvgpr_write_b32 a119, v6
v_mfma_f32_16x16x32_bf16 v[216:219], v[12:15], v[132:135], 0
buffer_load_dword off, s[8:11], s12 lds
v_accvgpr_read_b32 v6, a16
v_mfma_f32_16x16x32_bf16 v[212:215], v[16:19], v[128:131], 0
ds_read_b128 v[12:15], v4 offset:8192
v_accvgpr_read_b32 v7, a17
v_mfma_f32_16x16x32_bf16 v[220:223], v[16:19], v[132:135], 0
v_mul_f32 v6, v10, v6
s_waitcnt lgkmcnt(2)
v_mfma_f32_16x16x32_bf16 v[208:211], v[20:23], v[160:163], v[208:211]
ds_read_b128 v[16:19], v4 offset:256
v_mov_b32 v8, 0
v_mfma_f32_16x16x32_bf16 v[216:219], v[20:23], v[164:167], v[216:219]
v_mul_f32 v7, v10, v7
v_cvt_pk_bf16_f32 v6, v6, v7
v_mfma_f32_16x16x32_bf16 v[212:215], v[24:27], v[160:163], v[212:215]
ds_read_b128 v[20:23], v4 offset:8448
v_xor_b32 v4, 98432, v9
v_mfma_f32_16x16x32_bf16 v[220:223], v[24:27], v[164:167], v[220:223]
v_accvgpr_write_b32 a120, v6
s_waitcnt lgkmcnt(2)
v_mfma_f32_16x16x32_bf16 v[208:211], v[28:31], v[136:139], v[208:211]
ds_read_b128 v[24:27], v4
v_accvgpr_read_b32 v6, a18
v_mfma_f32_16x16x32_bf16 v[216:219], v[28:31], v[140:143], v[216:219]
ds_read_b32 v8, v8 offset:14336
v_accvgpr_read_b32 v7, a19
v_mul_f32 v6, v10, v6
v_mfma_f32_16x16x32_bf16 v[212:215], v[12:15], v[136:139], v[212:215]
ds_read_b128 v[28:31], v4 offset:8192
v_mul_f32 v7, v10, v7
v_mfma_f32_16x16x32_bf16 v[220:223], v[12:15], v[140:143], v[220:223]
v_cvt_pk_bf16_f32 v6, v6, v7
s_waitcnt lgkmcnt(3)
v_mfma_f32_16x16x32_bf16 v[208:211], v[16:19], v[168:171], v[208:211]
ds_read_b128 v[12:15], v4 offset:256
v_accvgpr_write_b32 a121, v6
v_mfma_f32_16x16x32_bf16 v[216:219], v[16:19], v[172:175], v[216:219]
v_accvgpr_read_b32 v6, a24
v_accvgpr_read_b32 v7, a25
v_mfma_f32_16x16x32_bf16 v[212:215], v[20:23], v[168:171], v[212:215]
ds_read_b128 v[16:19], v4 offset:8448
v_xor_b32 v4, 98496, v9
v_mfma_f32_16x16x32_bf16 v[220:223], v[20:23], v[172:175], v[220:223]
v_mul_f32 v6, v10, v6
s_waitcnt lgkmcnt(2)
v_mfma_f32_16x16x32_bf16 v[208:211], v[24:27], v[144:147], v[208:211]
ds_read_b128 v[20:23], v4
v_cmp_le_u32 vcc, 80, v8
v_mfma_f32_16x16x32_bf16 v[216:219], v[24:27], v[148:151], v[216:219]
v_mul_f32 v7, v10, v7
v_cvt_pk_bf16_f32 v6, v6, v7
v_accvgpr_write_b32 a122, v6
v_mfma_f32_16x16x32_bf16 v[212:215], v[28:31], v[144:147], v[212:215]
ds_read_b128 v[24:27], v4 offset:8192
v_accvgpr_read_b32 v6, a26
v_mfma_f32_16x16x32_bf16 v[220:223], v[28:31], v[148:151], v[220:223]
v_accvgpr_read_b32 v7, a27
s_waitcnt lgkmcnt(2)
v_mfma_f32_16x16x32_bf16 v[208:211], v[12:15], v[176:179], v[208:211]
ds_read_b128 v[28:31], v4 offset:256
v_mul_f32 v6, v10, v6
v_mfma_f32_16x16x32_bf16 v[216:219], v[12:15], v[180:183], v[216:219]
s_cbranch_vccz L_sp71
L_ok71:
v_mfma_f32_16x16x32_bf16 v[212:215], v[16:19], v[176:179], v[212:215]
ds_read_b128 v[12:15], v4 offset:8448
v_xor_b32 v4, 81920, v9
v_mfma_f32_16x16x32_bf16 v[220:223], v[16:19], v[180:183], v[220:223]
v_mul_f32 v7, v10, v7
s_waitcnt lgkmcnt(2)
v_mfma_f32_16x16x32_bf16 v[208:211], v[20:23], v[152:155], v[208:211]
ds_read_b128 v[16:19], v4
v_cvt_pk_bf16_f32 v6, v6, v7
v_mfma_f32_16x16x32_bf16 v[216:219], v[20:23], v[156:159], v[216:219]
v_accvgpr_write_b32 a123, v6
v_accvgpr_read_b32 v6, a20
v_accvgpr_read_b32 v7, a21
v_mfma_f32_16x16x32_bf16 v[212:215], v[24:27], v[152:155], v[212:215]
ds_read_b128 v[20:23], v4 offset:8192
v_mul_f32 v6, v11, v6
v_mfma_f32_16x16x32_bf16 v[220:223], v[24:27], v[156:159], v[220:223]
v_mul_f32 v7, v11, v7
s_waitcnt lgkmcnt(2)
v_mfma_f32_16x16x32_bf16 v[208:211], v[28:31], v[184:187], v[208:211]
ds_read_b128 v[24:27], v4 offset:256
s_movk_i32 s12, 284
v_mfma_f32_16x16x32_bf16 v[216:219], v[28:31], v[188:191], v[216:219]
v_cvt_pk_bf16_f32 v6, v6, v7
v_accvgpr_write_b32 a124, v6
v_mfma_f32_16x16x32_bf16 v[212:215], v[12:15], v[184:187], v[212:215]
ds_read_b128 v[28:31], v4 offset:8448
v_xor_b32 v4, 81984, v9
v_mfma_f32_16x16x32_bf16 v[220:223], v[12:15], v[188:191], v[220:223]
v_accvgpr_read_b32 v6, a22
s_waitcnt lgkmcnt(2)
v_mfma_f32_16x16x32_bf16 v[192:195], v[16:19], v[128:131], 0
ds_read_b128 v[12:15], v4
v_accvgpr_read_b32 v7, a23
v_mfma_f32_16x16x32_bf16 v[200:203], v[16:19], v[132:135], 0
buffer_load_dword off, s[8:11], s12 lds
v_mul_f32 v6, v11, v6
v_mfma_f32_16x16x32_bf16 v[196:199], v[20:23], v[128:131], 0
ds_read_b128 v[16:19], v4 offset:8192
v_max3_f32 v0, v208, v209, v0
v_mfma_f32_16x16x32_bf16 v[204:207], v[20:23], v[132:135], 0
v_cvt_pk_bf16_f32 v56, v208, v209
s_waitcnt lgkmcnt(2)
v_mfma_f32_16x16x32_bf16 v[192:195], v[24:27], v[160:163], v[192:195]
ds_read_b128 v[20:23], v4 offset:256
v_max3_f32 v2, v216, v217, v2
v_mfma_f32_16x16x32_bf16 v[200:203], v[24:27], v[164:167], v[200:203]
v_cvt_pk_bf16_f32 v60, v216, v217
v_max3_f32 v0, v210, v211, v0
v_mfma_f32_16x16x32_bf16 v[196:199], v[28:31], v[160:163], v[196:199]
ds_read_b128 v[24:27], v4 offset:8448
v_xor_b32 v4, 82048, v9
v_mfma_f32_16x16x32_bf16 v[204:207], v[28:31], v[164:167], v[204:207]
v_cvt_pk_bf16_f32 v57, v210, v211
s_waitcnt lgkmcnt(2)
v_mfma_f32_16x16x32_bf16 v[192:195], v[12:15], v[136:139], v[192:195]
ds_read_b128 v[28:31], v4
v_max3_f32 v2, v218, v219, v2
v_mfma_f32_16x16x32_bf16 v[200:203], v[12:15], v[140:143], v[200:203]
v_cvt_pk_bf16_f32 v61, v218, v219
v_max3_f32 v0, v212, v213, v0
v_mul_f32 v7, v11, v7
v_mfma_f32_16x16x32_bf16 v[196:199], v[16:19], v[136:139], v[196:199]
ds_read_b128 v[12:15], v4 offset:8192
v_cvt_pk_bf16_f32 v58, v212, v213
v_mfma_f32_16x16x32_bf16 v[204:207], v[16:19], v[140:143], v[204:207]
v_max3_f32 v2, v220, v221, v2
s_waitcnt lgkmcnt(2)
v_mfma_f32_16x16x32_bf16 v[192:195], v[20:23], v[168:171], v[192:195]
ds_read_b128 v[16:19], v4 offset:256
v_cvt_pk_bf16_f32 v62, v220, v221
v_mfma_f32_16x16x32_bf16 v[200:203], v[20:23], v[172:175], v[200:203]
v_max3_f32 v0, v214, v215, v0
v_cvt_pk_bf16_f32 v59, v214, v215
v_mfma_f32_16x16x32_bf16 v[196:199], v[24:27], v[168:171], v[196:199]
ds_read_b128 v[20:23], v4 offset:8448
v_xor_b32 v4, 82112, v9
v_mfma_f32_16x16x32_bf16 v[204:207], v[24:27], v[172:175], v[204:207]
v_max3_f32 v2, v222, v223, v2
s_waitcnt lgkmcnt(2)
v_mfma_f32_16x16x32_bf16 v[192:195], v[28:31], v[144:147], v[192:195]
ds_read_b128 v[24:27], v4
v_cvt_pk_bf16_f32 v63, v222, v223
v_mfma_f32_16x16x32_bf16 v[200:203], v[28:31], v[148:151], v[200:203]
v_cvt_pk_bf16_f32 v6, v6, v7
v_accvgpr_write_b32 a125, v6
v_accvgpr_read_b32 v6, a28
v_mfma_f32_16x16x32_bf16 v[196:199], v[12:15], v[144:147], v[196:199]
ds_read_b128 v[28:31], v4 offset:8192
v_accvgpr_read_b32 v7, a29
v_mfma_f32_16x16x32_bf16 v[204:207], v[12:15], v[148:151], v[204:207]
v_mul_f32 v6, v11, v6
s_waitcnt lgkmcnt(2)
v_mfma_f32_16x16x32_bf16 v[192:195], v[16:19], v[176:179], v[192:195]
ds_read_b128 v[12:15], v4 offset:256
v_mul_f32 v7, v11, v7
v_mfma_f32_16x16x32_bf16 v[200:203], v[16:19], v[180:183], v[200:203]
v_cvt_pk_bf16_f32 v6, v6, v7
v_accvgpr_write_b32 a126, v6
v_mfma_f32_16x16x32_bf16 v[196:199], v[20:23], v[176:179], v[196:199]
ds_read_b128 v[16:19], v4 offset:8448
v_xor_b32 v4, 114688, v3
v_mfma_f32_16x16x32_bf16 v[204:207], v[20:23], v[180:183], v[204:207]
v_accvgpr_read_b32 v6, a30
s_waitcnt lgkmcnt(2)
v_mfma_f32_16x16x32_bf16 v[192:195], v[24:27], v[152:155], v[192:195]
ds_read_b64_tr_b16 v[20:21], v4
v_accvgpr_read_b32 v7, a31
v_mfma_f32_16x16x32_bf16 v[200:203], v[24:27], v[156:159], v[200:203]
ds_read_b64_tr_b16 v[22:23], v4 offset:2048
v_mul_f32 v6, v11, v6
v_mul_f32 v7, v11, v7
v_mfma_f32_16x16x32_bf16 v[196:199], v[28:31], v[152:155], v[196:199]
ds_read_b64_tr_b16 v[24:25], v4 offset:4096
v_cvt_pk_bf16_f32 v6, v6, v7
v_mfma_f32_16x16x32_bf16 v[204:207], v[28:31], v[156:159], v[204:207]
ds_read_b64_tr_b16 v[26:27], v4 offset:6144
s_waitcnt lgkmcnt(4)
v_mfma_f32_16x16x32_bf16 v[192:195], v[12:15], v[184:187], v[192:195]
ds_read_b64_tr_b16 v[28:29], v4 offset:8192
s_movk_i32 s12, 288
v_mfma_f32_16x16x32_bf16 v[200:203], v[12:15], v[188:191], v[200:203]
ds_read_b64_tr_b16 v[30:31], v4 offset:10240
v_accvgpr_write_b32 a127, v6
v_mfma_f32_16x16x32_bf16 v[196:199], v[16:19], v[184:187], v[196:199]
ds_read_b64_tr_b16 v[12:13], v4 offset:12288
ds_read_b64_tr_b16 v[14:15], v4 offset:14336
v_mfma_f32_16x16x32_bf16 v[204:207], v[16:19], v[188:191], v[204:207]
v_xor_b32 v4, 114720, v3
s_waitcnt lgkmcnt(4)
v_mfma_f32_16x16x32_bf16 a[128:131], v[20:23], a[96:99], a[128:131]
ds_read_b64_tr_b16 v[16:17], v4
ds_read_b64_tr_b16 v[18:19], v4 offset:2048
v_mfma_f32_16x16x32_bf16 a[132:135], v[20:23], a[100:103], a[132:135]
buffer_load_dword off, s[8:11], s12 lds
v_mfma_f32_16x16x32_bf16 a[132:135], v[24:27], a[108:111], a[132:135]
ds_read_b64_tr_b16 v[20:21], v4 offset:4096
v_max3_f32 v0, v192, v193, v0
v_mfma_f32_16x16x32_bf16 a[128:131], v[24:27], a[104:107], a[128:131]
ds_read_b64_tr_b16 v[22:23], v4 offset:6144
s_waitcnt lgkmcnt(4)
v_mfma_f32_16x16x32_bf16 a[128:131], v[28:31], a[112:115], a[128:131]
ds_read_b64_tr_b16 v[24:25], v4 offset:8192
v_mov_b32 v8, 0
v_mfma_f32_16x16x32_bf16 a[132:135], v[28:31], a[116:119], a[132:135]
ds_read_b64_tr_b16 v[26:27], v4 offset:10240
v_cvt_pk_bf16_f32 v64, v192, v193
v_mfma_f32_16x16x32_bf16 a[132:135], v[12:15], a[124:127], a[132:135]
ds_read_b64_tr_b16 v[28:29], v4 offset:12288
ds_read_b64_tr_b16 v[30:31], v4 offset:14336
v_mfma_f32_16x16x32_bf16 a[128:131], v[12:15], a[120:123], a[128:131]
v_xor_b32 v4, 114752, v3
s_waitcnt lgkmcnt(4)
v_mfma_f32_16x16x32_bf16 a[136:139], v[16:19], a[96:99], a[136:139]
ds_read_b64_tr_b16 v[12:13], v4
v_max3_f32 v2, v200, v201, v2
v_mfma_f32_16x16x32_bf16 a[140:143], v[16:19], a[100:103], a[140:143]
ds_read_b64_tr_b16 v[14:15], v4 offset:2048
ds_read_b32 v8, v8 offset:14336
v_mfma_f32_16x16x32_bf16 a[140:143], v[20:23], a[108:111], a[140:143]
ds_read_b64_tr_b16 v[16:17], v4 offset:4096
v_cvt_pk_bf16_f32 v68, v200, v201
v_mfma_f32_16x16x32_bf16 a[136:139], v[20:23], a[104:107], a[136:139]
ds_read_b64_tr_b16 v[18:19], v4 offset:6144
s_waitcnt lgkmcnt(5)
v_mfma_f32_16x16x32_bf16 a[136:139], v[24:27], a[112:115], a[136:139]
ds_read_b64_tr_b16 v[20:21], v4 offset:8192
v_max3_f32 v0, v194, v195, v0
v_mfma_f32_16x16x32_bf16 a[140:143], v[24:27], a[116:119], a[140:143]
ds_read_b64_tr_b16 v[22:23], v4 offset:10240
v_cvt_pk_bf16_f32 v65, v194, v195
v_mfma_f32_16x16x32_bf16 a[140:143], v[28:31], a[124:127], a[140:143]
s_branch L_pg14
L_sp73:
v_mov_b32 v8, 0
ds_read_b32 v8, v8 offset:14336
s_waitcnt lgkmcnt(0)
v_cmp_le_u32 vcc, 81, v8
s_cbranch_vccz L_sp73
s_branch L_ok73
L_sp74:
v_mov_b32 v8, 0
ds_read_b32 v8, v8 offset:14336
s_waitcnt lgkmcnt(0)
v_cmp_le_u32 vcc, 83, v8
s_cbranch_vccz L_sp74
s_branch L_ok74
L_sp76:
v_mov_b32 v8, 0
ds_read_b32 v8, v8 offset:14336
s_waitcnt lgkmcnt(0)
v_cmp_le_u32 vcc, 84, v8
s_cbranch_vccz L_sp76
s_branch L_ok76
L_sp77:
v_mov_b32 v8, 0
ds_read_b32 v8, v8 offset:14336
s_waitcnt lgkmcnt(0)
v_cmp_le_u32 vcc, 85, v8
s_cbranch_vccz L_sp77
s_branch L_ok77
L_sp78:
v_mov_b32 v8, 0
ds_read_b32 v8, v8 offset:14336
s_waitcnt lgkmcnt(0)
v_cmp_le_u32 vcc, 87, v8
s_cbranch_vccz L_sp78
s_branch L_ok78
.p2align 12
L_stub14:
s_setpc_b64 s[94:95]
L_pg14:
ds_read_b64_tr_b16 v[24:25], v4 offset:12288
ds_read_b64_tr_b16 v[26:27], v4 offset:14336
v_mfma_f32_16x16x32_bf16 a[136:139], v[28:31], a[120:123], a[136:139]
v_xor_b32 v4, 114784, v3
s_waitcnt lgkmcnt(4)
v_mfma_f32_16x16x32_bf16 a[144:147], v[12:15], a[96:99], a[144:147]
ds_read_b64_tr_b16 v[28:29], v4
v_cmp_le_u32 vcc, 81, v8
v_mfma_f32_16x16x32_bf16 a[148:151], v[12:15], a[100:103], a[148:151]
ds_read_b64_tr_b16 v[30:31], v4 offset:2048
v_max3_f32 v2, v202, v203, v2
v_mfma_f32_16x16x32_bf16 a[148:151], v[16:19], a[108:111], a[148:151]
ds_read_b64_tr_b16 v[12:13], v4 offset:4096
v_cvt_pk_bf16_f32 v69, v202, v203
v_mfma_f32_16x16x32_bf16 a[144:147], v[16:19], a[104:107], a[144:147]
ds_read_b64_tr_b16 v[14:15], v4 offset:6144
s_waitcnt lgkmcnt(4)
v_mfma_f32_16x16x32_bf16 a[144:147], v[20:23], a[112:115], a[144:147]
ds_read_b64_tr_b16 v[16:17], v4 offset:8192
ds_read_b64_tr_b16 v[18:19], v4 offset:10240
v_mfma_f32_16x16x32_bf16 a[148:151], v[20:23], a[116:119], a[148:151]
s_cbranch_vccz L_sp73
L_ok73:
v_mfma_f32_16x16x32_bf16 a[148:151], v[24:27], a[124:127], a[148:151]
ds_read_b64_tr_b16 v[20:21], v4 offset:12288
ds_read_b64_tr_b16 v[22:23], v4 offset:14336
v_mfma_f32_16x16x32_bf16 a[144:147], v[24:27], a[120:123], a[144:147]
v_xor_b32 v4, 147456, v9
s_waitcnt lgkmcnt(4)
v_mfma_f32_16x16x32_bf16 a[152:155], v[28:31], a[96:99], a[152:155]
ds_read_b128 v[24:27], v4
v_max3_f32 v0, v196, v197, v0
v_mfma_f32_16x16x32_bf16 a[156:159], v[28:31], a[100:103], a[156:159]
v_cvt_pk_bf16_f32 v66, v196, v197
v_max3_f32 v2, v204, v205, v2
v_mfma_f32_16x16x32_bf16 a[156:159], v[12:15], a[108:111], a[156:159]
ds_read_b128 v[28:31], v4 offset:8192
v_cvt_pk_bf16_f32 v70, v204, v205
v_mfma_f32_16x16x32_bf16 a[152:155], v[12:15], a[104:107], a[152:155]
v_max3_f32 v0, v198, v199, v0
s_waitcnt lgkmcnt(2)
v_mfma_f32_16x16x32_bf16 a[152:155], v[16:19], a[112:115], a[152:155]
ds_read_b128 v[12:15], v4 offset:256
s_movk_i32 s12, 292
v_mfma_f32_16x16x32_bf16 a[156:159], v[16:19], a[116:119], a[156:159]
v_cvt_pk_bf16_f32 v67, v198, v199
v_max3_f32 v2, v206, v207, v2
v_mfma_f32_16x16x32_bf16 a[156:159], v[20:23], a[124:127], a[156:159]
ds_read_b128 v[16:19], v4 offset:8448
v_xor_b32 v4, 147520, v9
v_mfma_f32_16x16x32_bf16 a[152:155], v[20:23], a[120:123], a[152:155]
v_cvt_pk_bf16_f32 v71, v206, v207
s_waitcnt lgkmcnt(2)
v_mfma_f32_16x16x32_bf16 v[208:211], v[24:27], v[128:131], 0
ds_read_b128 v[20:23], v4
v_mfma_f32_16x16x32_bf16 v[216:219], v[24:27], v[132:135], 0
buffer_load_dword off, s[8:11], s12 lds
v_mfma_f32_16x16x32_bf16 v[212:215], v[28:31], v[128:131], 0
ds_read_b128 v[24:27], v4 offset:8192
v_mfma_f32_16x16x32_bf16 v[220:223], v[28:31], v[132:135], 0
s_waitcnt lgkmcnt(2)
v_mfma_f32_16x16x32_bf16 v[208:211], v[12:15], v[160:163], v[208:211]
ds_read_b128 v[28:31], v4 offset:256
v_mov_b32 v8, 0
v_mfma_f32_16x16x32_bf16 v[216:219], v[12:15], v[164:167], v[216:219]
v_mfma_f32_16x16x32_bf16 v[212:215], v[16:19], v[160:163], v[212:215]
ds_read_b128 v[12:15], v4 offset:8448
v_xor_b32 v4, 147584, v9
v_mfma_f32_16x16x32_bf16 v[220:223], v[16:19], v[164:167], v[220:223]
s_waitcnt lgkmcnt(2)
v_mfma_f32_16x16x32_bf16 v[208:211], v[20:23], v[136:139], v[208:211]
ds_read_b128 v[16:19], v4
v_mfma_f32_16x16x32_bf16 v[216:219], v[20:23], v[140:143], v[216:219]
ds_read_b32 v8, v8 offset:14336
v_mfma_f32_16x16x32_bf16 v[212:215], v[24:27], v[136:139], v[212:215]
ds_read_b128 v[20:23], v4 offset:8192
v_mfma_f32_16x16x32_bf16 v[220:223], v[24:27], v[140:143], v[220:223]
s_waitcnt lgkmcnt(3)
v_mfma_f32_16x16x32_bf16 v[208:211], v[28:31], v[168:171], v[208:211]
ds_read_b128 v[24:27], v4 offset:256
v_mfma_f32_16x16x32_bf16 v[216:219], v[28:31], v[172:175], v[216:219]
v_mfma_f32_16x16x32_bf16 v[212:215], v[12:15], v[168:171], v[212:215]
ds_read_b128 v[28:31], v4 offset:8448
v_xor_b32 v4, 147648, v9
v_mfma_f32_16x16x32_bf16 v[220:223], v[12:15], v[172:175], v[220:223]
s_waitcnt lgkmcnt(2)
v_mfma_f32_16x16x32_bf16 v[208:211], v[16:19], v[144:147], v[208:211]
ds_read_b128 v[12:15], v4
v_cmp_le_u32 vcc, 83, v8
v_mfma_f32_16x16x32_bf16 v[216:219], v[16:19], v[148:151], v[216:219]
v_mfma_f32_16x16x32_bf16 v[212:215], v[20:23], v[144:147], v[212:215]
ds_read_b128 v[16:19], v4 offset:8192
v_mfma_f32_16x16x32_bf16 v[220:223], v[20:23], v[148:151], v[220:223]
s_waitcnt lgkmcnt(2)
v_mfma_f32_16x16x32_bf16 v[208:211], v[24:27], v[176:179], v[208:211]
ds_read_b128 v[20:23], v4 offset:256
v_mfma_f32_16x16x32_bf16 v[216:219], v[24:27], v[180:183], v[216:219]
s_cbranch_vccz L_sp74
L_ok74:
v_mfma_f32_16x16x32_bf16 v[212:215], v[28:31], v[176:179], v[212:215]
ds_read_b128 v[24:27], v4 offset:8448
v_xor_b32 v4, 16384, v9
v_mfma_f32_16x16x32_bf16 v[220:223], v[28:31], v[180:183], v[220:223]
s_waitcnt lgkmcnt(2)
v_mfma_f32_16x16x32_bf16 v[208:211], v[12:15], v[152:155], v[208:211]
ds_read_b128 v[28:31], v4
v_mfma_f32_16x16x32_bf16 v[216:219], v[12:15], v[156:159], v[216:219]
v_mfma_f32_16x16x32_bf16 v[212:215], v[16:19], v[152:155], v[212:215]
ds_read_b128 v[12:15], v4 offset:8192
v_mfma_f32_16x16x32_bf16 v[220:223], v[16:19], v[156:159], v[220:223]
s_waitcnt lgkmcnt(2)
v_mfma_f32_16x16x32_bf16 v[208:211], v[20:23], v[184:187], v[208:211]
ds_read_b128 v[16:19], v4 offset:256
s_movk_i32 s12, 296
v_mfma_f32_16x16x32_bf16 v[216:219], v[20:23], v[188:191], v[216:219]
v_mfma_f32_16x16x32_bf16 v[212:215], v[24:27], v[184:187], v[212:215]
ds_read_b128 v[20:23], v4 offset:8448
v_xor_b32 v4, 16448, v9
v_mfma_f32_16x16x32_bf16 v[220:223], v[24:27], v[188:191], v[220:223]
s_waitcnt lgkmcnt(2)
v_mfma_f32_16x16x32_bf16 v[192:195], v[28:31], v[128:131], 0
ds_read_b128 v[24:27], v4
v_mfma_f32_16x16x32_bf16 v[200:203], v[28:31], v[132:135], 0
buffer_load_dword off, s[8:11], s12 lds
v_mfma_f32_16x16x32_bf16 v[196:199], v[12:15], v[128:131], 0
ds_read_b128 v[28:31], v4 offset:8192
v_max3_f32 v0, v208, v209, v0
v_mfma_f32_16x16x32_bf16 v[204:207], v[12:15], v[132:135], 0
v_cvt_pk_bf16_f32 v72, v208, v209
s_waitcnt lgkmcnt(2)
v_mfma_f32_16x16x32_bf16 v[192:195], v[16:19], v[160:163], v[192:195]
ds_read_b128 v[12:15], v4 offset:256
v_max3_f32 v2, v216, v217, v2
v_mfma_f32_16x16x32_bf16 v[200:203], v[16:19], v[164:167], v[200:203]
v_cvt_pk_bf16_f32 v76, v216, v217
v_max3_f32 v0, v210, v211, v0
v_mfma_f32_16x16x32_bf16 v[196:199], v[20:23], v[160:163], v[196:199]
ds_read_b128 v[16:19], v4 offset:8448
v_xor_b32 v4, 16512, v9
v_mfma_f32_16x16x32_bf16 v[204:207], v[20:23], v[164:167], v[204:207]
v_cvt_pk_bf16_f32 v73, v210, v211
s_waitcnt lgkmcnt(2)
v_mfma_f32_16x16x32_bf16 v[192:195], v[24:27], v[136:139], v[192:195]
ds_read_b128 v[20:23], v4
v_max3_f32 v2, v218, v219, v2
v_mfma_f32_16x16x32_bf16 v[200:203], v[24:27], v[140:143], v[200:203]
v_cvt_pk_bf16_f32 v77, v218, v219
v_max3_f32 v0, v212, v213, v0
v_mfma_f32_16x16x32_bf16 v[196:199], v[28:31], v[136:139], v[196:199]
ds_read_b128 v[24:27], v4 offset:8192
v_cvt_pk_bf16_f32 v74, v212, v213
v_mfma_f32_16x16x32_bf16 v[204:207], v[28:31], v[140:143], v[204:207]
v_max3_f32 v2, v220, v221, v2
s_waitcnt lgkmcnt(2)
v_mfma_f32_16x16x32_bf16 v[192:195], v[12:15], v[168:171], v[192:195]
ds_read_b128 v[28:31], v4 offset:256
v_cvt_pk_bf16_f32 v78, v220, v221
v_mfma_f32_16x16x32_bf16 v[200:203], v[12:15], v[172:175], v[200:203]
v_max3_f32 v0, v214, v215, v0
v_cvt_pk_bf16_f32 v75, v214, v215
v_mfma_f32_16x16x32_bf16 v[196:199], v[16:19], v[168:171], v[196:199]
ds_read_b128 v[12:15], v4 offset:8448
v_xor_b32 v4, 16576, v9
v_mfma_f32_16x16x32_bf16 v[204:207], v[16:19], v[172:175], v[204:207]
v_max3_f32 v2, v222, v223, v2
s_waitcnt lgkmcnt(2)
v_mfma_f32_16x16x32_bf16 v[192:195], v[20:23], v[144:147], v[192:195]
ds_read_b128 v[16:19], v4
v_cvt_pk_bf16_f32 v79, v222, v223
v_mfma_f32_16x16x32_bf16 v[200:203], v[20:23], v[148:151], v[200:203]
v_mfma_f32_16x16x32_bf16 v[196:199], v[24:27], v[144:147], v[196:199]
ds_read_b128 v[20:23], v4 offset:8192
v_mfma_f32_16x16x32_bf16 v[204:207], v[24:27], v[148:151], v[204:207]
s_waitcnt lgkmcnt(2)
v_mfma_f32_16x16x32_bf16 v[192:195], v[28:31], v[176:179], v[192:195]
ds_read_b128 v[24:27], v4 offset:256
v_mfma_f32_16x16x32_bf16 v[200:203], v[28:31], v[180:183], v[200:203]
v_mfma_f32_16x16x32_bf16 v[196:199], v[12:15], v[176:179], v[196:199]
ds_read_b128 v[28:31], v4 offset:8448
v_xor_b32 v4, 32768, v3
v_mfma_f32_16x16x32_bf16 v[204:207], v[12:15], v[180:183], v[204:207]
s_waitcnt lgkmcnt(2)
v_mfma_f32_16x16x32_bf16 v[192:195], v[16:19], v[152:155], v[192:195]
ds_read_b64_tr_b16 v[12:13], v4
v_mfma_f32_16x16x32_bf16 v[200:203], v[16:19], v[156:159], v[200:203]
ds_read_b64_tr_b16 v[14:15], v4 offset:2048
v_mfma_f32_16x16x32_bf16 v[196:199], v[20:23], v[152:155], v[196:199]
ds_read_b64_tr_b16 v[16:17], v4 offset:4096
v_mfma_f32_16x16x32_bf16 v[204:207], v[20:23], v[156:159], v[204:207]
ds_read_b64_tr_b16 v[18:19], v4 offset:6144
s_waitcnt lgkmcnt(4)
v_mfma_f32_16x16x32_bf16 v[192:195], v[24:27], v[184:187], v[192:195]
ds_read_b64_tr_b16 v[20:21], v4 offset:8192
s_movk_i32 s12, 300
v_mfma_f32_16x16x32_bf16 v[200:203], v[24:27], v[188:191], v[200:203]
ds_read_b64_tr_b16 v[22:23], v4 offset:10240
v_mfma_f32_16x16x32_bf16 v[196:199], v[28:31], v[184:187], v[196:199]
ds_read_b64_tr_b16 v[24:25], v4 offset:12288
ds_read_b64_tr_b16 v[26:27], v4 offset:14336
v_mfma_f32_16x16x32_bf16 v[204:207], v[28:31], v[188:191], v[204:207]
v_xor_b32 v4, 32800, v3
s_waitcnt lgkmcnt(4)
v_mfma_f32_16x16x32_bf16 a[160:163], v[12:15], a[96:99], a[160:163]
ds_read_b64_tr_b16 v[28:29], v4
ds_read_b64_tr_b16 v[30:31], v4 offset:2048
v_mfma_f32_16x16x32_bf16 a[164:167], v[12:15], a[100:103], a[164:167]
buffer_load_dword off, s[8:11], s12 lds
v_mfma_f32_16x16x32_bf16 a[164:167], v[16:19], a[108:111], a[164:167]
ds_read_b64_tr_b16 v[12:13], v4 offset:4096
v_max3_f32 v0, v192, v193, v0
v_mfma_f32_16x16x32_bf16 a[160:163], v[16:19], a[104:107], a[160:163]
ds_read_b64_tr_b16 v[14:15], v4 offset:6144
s_waitcnt lgkmcnt(4)
v_mfma_f32_16x16x32_bf16 a[160:163], v[20:23], a[112:115], a[160:163]
ds_read_b64_tr_b16 v[16:17], v4 offset:8192
v_mov_b32 v8, 0
v_mfma_f32_16x16x32_bf16 a[164:167], v[20:23], a[116:119], a[164:167]
ds_read_b64_tr_b16 v[18:19], v4 offset:10240
v_cvt_pk_bf16_f32 v80, v192, v193
v_mfma_f32_16x16x32_bf16 a[164:167], v[24:27], a[124:127], a[164:167]
ds_read_b64_tr_b16 v[20:21], v4 offset:12288
ds_read_b64_tr_b16 v[22:23], v4 offset:14336
v_mfma_f32_16x16x32_bf16 a[160:163], v[24:27], a[120:123], a[160:163]
v_xor_b32 v4, 32832, v3
s_waitcnt lgkmcnt(4)
v_mfma_f32_16x16x32_bf16 a[168:171], v[28:31], a[96:99], a[168:171]
ds_read_b64_tr_b16 v[24:25], v4
v_max3_f32 v2, v200, v201, v2
v_mfma_f32_16x16x32_bf16 a[172:175], v[28:31], a[100:103], a[172:175]
ds_read_b64_tr_b16 v[26:27], v4 offset:2048
ds_read_b32 v8, v8 offset:14336
v_mfma_f32_16x16x32_bf16 a[172:175], v[12:15], a[108:111], a[172:175]
ds_read_b64_tr_b16 v[28:29], v4 offset:4096
v_cvt_pk_bf16_f32 v84, v200, v201
v_mfma_f32_16x16x32_bf16 a[168:171], v[12:15], a[104:107], a[168:171]
ds_read_b64_tr_b16 v[30:31], v4 offset:6144
s_waitcnt lgkmcnt(5)
v_mfma_f32_16x16x32_bf16 a[168:171], v[16:19], a[112:115], a[168:171]
ds_read_b64_tr_b16 v[12:13], v4 offset:8192
v_max3_f32 v0, v194, v195, v0
v_mfma_f32_16x16x32_bf16 a[172:175], v[16:19], a[116:119], a[172:175]
ds_read_b64_tr_b16 v[14:15], v4 offset:10240
v_cvt_pk_bf16_f32 v81, v194, v195
v_mfma_f32_16x16x32_bf16 a[172:175], v[20:23], a[124:127], a[172:175]
ds_read_b64_tr_b16 v[16:17], v4 offset:12288
ds_read_b64_tr_b16 v[18:19], v4 offset:14336
v_mfma_f32_16x16x32_bf16 a[168:171], v[20:23], a[120:123], a[168:171]
v_xor_b32 v4, 32864, v3
s_waitcnt lgkmcnt(4)
v_mfma_f32_16x16x32_bf16 a[176:179], v[24:27], a[96:99], a[176:179]
ds_read_b64_tr_b16 v[20:21], v4
v_cmp_le_u32 vcc, 84, v8
v_mfma_f32_16x16x32_bf16 a[180:183], v[24:27], a[100:103], a[180:183]
ds_read_b64_tr_b16 v[22:23], v4 offset:2048
v_max3_f32 v2, v202, v203, v2
v_mfma_f32_16x16x32_bf16 a[180:183], v[28:31], a[108:111], a[180:183]
ds_read_b64_tr_b16 v[24:25], v4 offset:4096
v_cvt_pk_bf16_f32 v85, v202, v203
v_mfma_f32_16x16x32_bf16 a[176:179], v[28:31], a[104:107], a[176:179]
ds_read_b64_tr_b16 v[26:27], v4 offset:6144
s_waitcnt lgkmcnt(4)
v_mfma_f32_16x16x32_bf16 a[176:179], v[12:15], a[112:115], a[176:179]
ds_read_b64_tr_b16 v[28:29], v4 offset:8192
ds_read_b64_tr_b16 v[30:31], v4 offset:10240
v_mfma_f32_16x16x32_bf16 a[180:183], v[12:15], a[116:119], a[180:183]
s_cbranch_vccz L_sp76
L_ok76:
v_mfma_f32_16x16x32_bf16 a[180:183], v[16:19], a[124:127], a[180:183]
ds_read_b64_tr_b16 v[12:13], v4 offset:12288
ds_read_b64_tr_b16 v[14:15], v4 offset:14336
v_mfma_f32_16x16x32_bf16 a[176:179], v[16:19], a[120:123], a[176:179]
v_xor_b32 v4, 65536, v9
s_waitcnt lgkmcnt(4)
v_mfma_f32_16x16x32_bf16 a[184:187], v[20:23], a[96:99], a[184:187]
ds_read_b128 v[16:19], v4
v_max3_f32 v0, v196, v197, v0
v_mfma_f32_16x16x32_bf16 a[188:191], v[20:23], a[100:103], a[188:191]
v_cvt_pk_bf16_f32 v82, v196, v197
v_max3_f32 v2, v204, v205, v2
v_mfma_f32_16x16x32_bf16 a[188:191], v[24:27], a[108:111], a[188:191]
ds_read_b128 v[20:23], v4 offset:8192
v_cvt_pk_bf16_f32 v86, v204, v205
v_mfma_f32_16x16x32_bf16 a[184:187], v[24:27], a[104:107], a[184:187]
v_max3_f32 v0, v198, v199, v0
s_waitcnt lgkmcnt(2)
v_mfma_f32_16x16x32_bf16 a[184:187], v[28:31], a[112:115], a[184:187]
ds_read_b128 v[24:27], v4 offset:256
s_movk_i32 s12, 304
v_mfma_f32_16x16x32_bf16 a[188:191], v[28:31], a[116:119], a[188:191]
v_cvt_pk_bf16_f32 v83, v198, v199
v_max3_f32 v2, v206, v207, v2
v_mfma_f32_16x16x32_bf16 a[188:191], v[12:15], a[124:127], a[188:191]
ds_read_b128 v[28:31], v4 offset:8448
v_xor_b32 v4, 65600, v9
v_mfma_f32_16x16x32_bf16 a[184:187], v[12:15], a[120:123], a[184:187]
v_cvt_pk_bf16_f32 v87, v206, v207
s_waitcnt lgkmcnt(2)
v_mfma_f32_16x16x32_bf16 v[208:211], v[16:19], v[128:131], 0
ds_read_b128 v[12:15], v4
v_mfma_f32_16x16x32_bf16 v[216:219], v[16:19], v[132:135], 0
buffer_load_dword off, s[8:11], s12 lds
v_mfma_f32_16x16x32_bf16 v[212:215], v[20:23], v[128:131], 0
ds_read_b128 v[16:19], v4 offset:8192
v_mfma_f32_16x16x32_bf16 v[220:223], v[20:23], v[132:135], 0
s_waitcnt lgkmcnt(2)
v_mfma_f32_16x16x32_bf16 v[208:211], v[24:27], v[160:163], v[208:211]
ds_read_b128 v[20:23], v4 offset:256
v_mov_b32 v8, 0
v_mfma_f32_16x16x32_bf16 v[216:219], v[24:27], v[164:167], v[216:219]
v_mfma_f32_16x16x32_bf16 v[212:215], v[28:31], v[160:163], v[212:215]
ds_read_b128 v[24:27], v4 offset:8448
v_xor_b32 v4, 65664, v9
v_mfma_f32_16x16x32_bf16 v[220:223], v[28:31], v[164:167], v[220:223]
s_waitcnt lgkmcnt(2)
v_mfma_f32_16x16x32_bf16 v[208:211], v[12:15], v[136:139], v[208:211]
ds_read_b128 v[28:31], v4
v_mfma_f32_16x16x32_bf16 v[216:219], v[12:15], v[140:143], v[216:219]
ds_read_b32 v8, v8 offset:14336
v_mfma_f32_16x16x32_bf16 v[212:215], v[16:19], v[136:139], v[212:215]
ds_read_b128 v[12:15], v4 offset:8192
v_mfma_f32_16x16x32_bf16 v[220:223], v[16:19], v[140:143], v[220:223]
s_waitcnt lgkmcnt(3)
v_mfma_f32_16x16x32_bf16 v[208:211], v[20:23], v[168:171], v[208:211]
ds_read_b128 v[16:19], v4 offset:256
v_mfma_f32_16x16x32_bf16 v[216:219], v[20:23], v[172:175], v[216:219]
v_mfma_f32_16x16x32_bf16 v[212:215], v[24:27], v[168:171], v[212:215]
ds_read_b128 v[20:23], v4 offset:8448
v_xor_b32 v4, 65728, v9
v_mfma_f32_16x16x32_bf16 v[220:223], v[24:27], v[172:175], v[220:223]
s_waitcnt lgkmcnt(2)
v_mfma_f32_16x16x32_bf16 v[208:211], v[28:31], v[144:147], v[208:211]
ds_read_b128 v[24:27], v4
v_cmp_le_u32 vcc, 85, v8
v_mfma_f32_16x16x32_bf16 v[216:219], v[28:31], v[148:151], v[216:219]
v_mfma_f32_16x16x32_bf16 v[212:215], v[12:15], v[144:147], v[212:215]
ds_read_b128 v[28:31], v4 offset:8192
v_mfma_f32_16x16x32_bf16 v[220:223], v[12:15], v[148:151], v[220:223]
s_waitcnt lgkmcnt(2)
v_mfma_f32_16x16x32_bf16 v[208:211], v[16:19], v[176:179], v[208:211]
ds_read_b128 v[12:15], v4 offset:256
v_mfma_f32_16x16x32_bf16 v[216:219], v[16:19], v[180:183], v[216:219]
s_cbranch_vccz L_sp77
L_ok77:
v_mfma_f32_16x16x32_bf16 v[212:215], v[20:23], v[176:179], v[212:215]
ds_read_b128 v[16:19], v4 offset:8448
v_xor_b32 v4, 131072, v9
v_mfma_f32_16x16x32_bf16 v[220:223], v[20:23], v[180:183], v[220:223]
s_waitcnt lgkmcnt(2)
v_mfma_f32_16x16x32_bf16 v[208:211], v[24:27], v[152:155], v[208:211]
ds_read_b128 v[20:23], v4
v_mfma_f32_16x16x32_bf16 v[216:219], v[24:27], v[156:159], v[216:219]
v_mfma_f32_16x16x32_bf16 v[212:215], v[28:31], v[152:155], v[212:215]
ds_read_b128 v[24:27], v4 offset:8192
v_mfma_f32_16x16x32_bf16 v[220:223], v[28:31], v[156:159], v[220:223]
s_waitcnt lgkmcnt(2)
v_mfma_f32_16x16x32_bf16 v[208:211], v[12:15], v[184:187], v[208:211]
ds_read_b128 v[28:31], v4 offset:256
s_movk_i32 s12, 308
v_mfma_f32_16x16x32_bf16 v[216:219], v[12:15], v[188:191], v[216:219]
v_mfma_f32_16x16x32_bf16 v[212:215], v[16:19], v[184:187], v[212:215]
ds_read_b128 v[12:15], v4 offset:8448
v_xor_b32 v4, 131136, v9
v_mfma_f32_16x16x32_bf16 v[220:223], v[16:19], v[188:191], v[220:223]
s_waitcnt lgkmcnt(2)
v_mfma_f32_16x16x32_bf16 v[192:195], v[20:23], v[128:131], 0
ds_read_b128 v[16:19], v4
v_mfma_f32_16x16x32_bf16 v[200:203], v[20:23], v[132:135], 0
buffer_load_dword off, s[8:11], s12 lds
v_mfma_f32_16x16x32_bf16 v[196:199], v[24:27], v[128:131], 0
ds_read_b128 v[20:23], v4 offset:8192
v_max3_f32 v0, v208, v209, v0
v_mfma_f32_16x16x32_bf16 v[204:207], v[24:27], v[132:135], 0
v_cvt_pk_bf16_f32 v88, v208, v209
s_waitcnt lgkmcnt(2)
v_mfma_f32_16x16x32_bf16 v[192:195], v[28:31], v[160:163], v[192:195]
ds_read_b128 v[24:27], v4 offset:256
v_mov_b32 v8, 0
v_mfma_f32_16x16x32_bf16 v[200:203], v[28:31], v[164:167], v[200:203]
v_max3_f32 v2, v216, v217, v2
v_cvt_pk_bf16_f32 v92, v216, v217
v_mfma_f32_16x16x32_bf16 v[196:199], v[12:15], v[160:163], v[196:199]
ds_read_b128 v[28:31], v4 offset:8448
v_xor_b32 v4, 131200, v9
v_mfma_f32_16x16x32_bf16 v[204:207], v[12:15], v[164:167], v[204:207]
v_max3_f32 v0, v210, v211, v0
s_waitcnt lgkmcnt(2)
v_mfma_f32_16x16x32_bf16 v[192:195], v[16:19], v[136:139], v[192:195]
ds_read_b128 v[12:15], v4
v_cvt_pk_bf16_f32 v89, v210, v211
v_mfma_f32_16x16x32_bf16 v[200:203], v[16:19], v[140:143], v[200:203]
ds_read_b32 v8, v8 offset:14336
v_max3_f32 v2, v218, v219, v2
v_mfma_f32_16x16x32_bf16 v[196:199], v[20:23], v[136:139], v[196:199]
ds_read_b128 v[16:19], v4 offset:8192
v_cvt_pk_bf16_f32 v93, v218, v219
v_mfma_f32_16x16x32_bf16 v[204:207], v[20:23], v[140:143], v[204:207]
v_max3_f32 v0, v212, v213, v0
s_waitcnt lgkmcnt(3)
v_mfma_f32_16x16x32_bf16 v[192:195], v[24:27], v[168:171], v[192:195]
ds_read_b128 v[20:23], v4 offset:256
v_cvt_pk_bf16_f32 v90, v212, v213
v_mfma_f32_16x16x32_bf16 v[200:203], v[24:27], v[172:175], v[200:203]
v_max3_f32 v2, v220, v221, v2
v_cvt_pk_bf16_f32 v94, v220, v221
v_mfma_f32_16x16x32_bf16 v[196:199], v[28:31], v[168:171], v[196:199]
ds_read_b128 v[24:27], v4 offset:8448
v_xor_b32 v4, 131264, v9
v_mfma_f32_16x16x32_bf16 v[204:207], v[28:31], v[172:175], v[204:207]
v_max3_f32 v0, v214, v215, v0
s_waitcnt lgkmcnt(2)
v_mfma_f32_16x16x32_bf16 v[192:195], v[12:15], v[144:147], v[192:195]
ds_read_b128 v[28:31], v4
v_cmp_le_u32 vcc, 87, v8
v_mfma_f32_16x16x32_bf16 v[200:203], v[12:15], v[148:151], v[200:203]
v_cvt_pk_bf16_f32 v91, v214, v215
v_max3_f32 v2, v222, v223, v2
v_mfma_f32_16x16x32_bf16 v[196:199], v[16:19], v[144:147], v[196:199]
ds_read_b128 v[12:15], v4 offset:8192
v_cvt_pk_bf16_f32 v95, v222, v223
v_mfma_f32_16x16x32_bf16 v[204:207], v[16:19], v[148:151], v[204:207]
s_waitcnt lgkmcnt(2)
v_mfma_f32_16x16x32_bf16 v[192:195], v[20:23], v[176:179], v[192:195]
ds_read_b128 v[16:19], v4 offset:256
v_mfma_f32_16x16x32_bf16 v[200:203], v[20:23], v[180:183], v[200:203]
s_cbranch_vccz L_sp78
L_ok78:
v_mfma_f32_16x16x32_bf16 v[196:199], v[24:27], v[176:179], v[196:199]
ds_read_b128 v[20:23], v4 offset:8448
v_xor_b32 v4, 98304, v9
v_mfma_f32_16x16x32_bf16 v[204:207], v[24:27], v[180:183], v[204:207]
s_waitcnt lgkmcnt(2)
v_mfma_f32_16x16x32_bf16 v[192:195], v[28:31], v[152:155], v[192:195]
ds_read_b128 v[24:27], v4
v_mfma_f32_16x16x32_bf16 v[200:203], v[28:31], v[156:159], v[200:203]
v_mfma_f32_16x16x32_bf16 v[196:199], v[12:15], v[152:155], v[196:199]
ds_read_b128 v[28:31], v4 offset:8192
v_mfma_f32_16x16x32_bf16 v[204:207], v[12:15], v[156:159], v[204:207]
s_waitcnt lgkmcnt(2)
v_mfma_f32_16x16x32_bf16 v[192:195], v[16:19], v[184:187], v[192:195]
ds_read_b128 v[12:15], v4 offset:256
s_movk_i32 s12, 312
v_mfma_f32_16x16x32_bf16 v[200:203], v[16:19], v[188:191], v[200:203]
v_mfma_f32_16x16x32_bf16 v[196:199], v[20:23], v[184:187], v[196:199]
ds_read_b128 v[16:19], v4 offset:8448
v_xor_b32 v4, 98368, v9
v_mfma_f32_16x16x32_bf16 v[204:207], v[20:23], v[188:191], v[204:207]
s_waitcnt lgkmcnt(2)
v_mfma_f32_16x16x32_bf16 v[208:211], v[24:27], v[128:131], 0
ds_read_b128 v[20:23], v4
v_mfma_f32_16x16x32_bf16 v[216:219], v[24:27], v[132:135], 0
buffer_load_dword off, s[8:11], s12 lds
v_mfma_f32_16x16x32_bf16 v[212:215], v[28:31], v[128:131], 0
ds_read_b128 v[24:27], v4 offset:8192
v_max3_f32 v0, v192, v193, v0
v_mfma_f32_16x16x32_bf16 v[220:223], v[28:31], v[132:135], 0
v_cvt_pk_bf16_f32 v96, v192, v193
s_waitcnt lgkmcnt(2)
v_mfma_f32_16x16x32_bf16 v[208:211], v[12:15], v[160:163], v[208:211]
ds_read_b128 v[28:31], v4 offset:256
v_max3_f32 v2, v200, v201, v2
v_mfma_f32_16x16x32_bf16 v[216:219], v[12:15], v[164:167], v[216:219]
v_cvt_pk_bf16_f32 v100, v200, v201
v_max3_f32 v0, v194, v195, v0
v_mfma_f32_16x16x32_bf16 v[212:215], v[16:19], v[160:163], v[212:215]
ds_read_b128 v[12:15], v4 offset:8448
v_xor_b32 v4, 98432, v9
v_mfma_f32_16x16x32_bf16 v[220:223], v[16:19], v[164:167], v[220:223]
v_cvt_pk_bf16_f32 v97, v194, v195
s_waitcnt lgkmcnt(2)
v_mfma_f32_16x16x32_bf16 v[208:211], v[20:23], v[136:139], v[208:211]
ds_read_b128 v[16:19], v4
v_max3_f32 v2, v202, v203, v2
v_mfma_f32_16x16x32_bf16 v[216:219], v[20:23], v[140:143], v[216:219]
v_cvt_pk_bf16_f32 v101, v202, v203
v_max3_f32 v0, v196, v197, v0
v_mfma_f32_16x16x32_bf16 v[212:215], v[24:27], v[136:139], v[212:215]
ds_read_b128 v[20:23], v4 offset:8192
v_cvt_pk_bf16_f32 v98, v196, v197
v_mfma_f32_16x16x32_bf16 v[220:223], v[24:27], v[140:143], v[220:223]
v_max3_f32 v2, v204, v205, v2
s_waitcnt lgkmcnt(2)
v_mfma_f32_16x16x32_bf16 v[208:211], v[28:31], v[168:171], v[208:211]
ds_read_b128 v[24:27], v4 offset:256
v_cvt_pk_bf16_f32 v102, v204, v205
v_mfma_f32_16x16x32_bf16 v[216:219], v[28:31], v[172:175], v[216:219]
v_max3_f32 v0, v198, v199, v0
v_cvt_pk_bf16_f32 v99, v198, v199
v_mfma_f32_16x16x32_bf16 v[212:215], v[12:15], v[168:171], v[212:215]
ds_read_b128 v[28:31], v4 offset:8448
v_xor_b32 v4, 98496, v9
v_mfma_f32_16x16x32_bf16 v[220:223], v[12:15], v[172:175], v[220:223]
v_max3_f32 v2, v206, v207, v2
s_waitcnt lgkmcnt(2)
v_mfma_f32_16x16x32_bf16 v[208:211], v[16:19], v[144:147], v[208:211]
ds_read_b128 v[12:15], v4
v_cvt_pk_bf16_f32 v103, v206, v207
v_mfma_f32_16x16x32_bf16 v[216:219], v[16:19], v[148:151], v[216:219]
v_mfma_f32_16x16x32_bf16 v[212:215], v[20:23], v[144:147], v[212:215]
ds_read_b128 v[16:19], v4 offset:8192
v_mfma_f32_16x16x32_bf16 v[220:223], v[20:23], v[148:151], v[220:223]
s_waitcnt lgkmcnt(2)
v_mfma_f32_16x16x32_bf16 v[208:211], v[24:27], v[176:179], v[208:211]
ds_read_b128 v[20:23], v4 offset:256
v_mfma_f32_16x16x32_bf16 v[216:219], v[24:27], v[180:183], v[216:219]
v_mfma_f32_16x16x32_bf16 v[212:215], v[28:31], v[176:179], v[212:215]
ds_read_b128 v[24:27], v4 offset:8448
v_xor_b32 v4, 49152, v3
v_mfma_f32_16x16x32_bf16 v[220:223], v[28:31], v[180:183], v[220:223]
s_waitcnt lgkmcnt(2)
v_mfma_f32_16x16x32_bf16 v[208:211], v[12:15], v[152:155], v[208:211]
ds_read_b64_tr_b16 v[28:29], v4
v_mfma_f32_16x16x32_bf16 v[216:219], v[12:15], v[156:159], v[216:219]
ds_read_b64_tr_b16 v[30:31], v4 offset:2048
v_mfma_f32_16x16x32_bf16 v[212:215], v[16:19], v[152:155], v[212:215]
s_branch L_pg15
L_sp80:
v_mov_b32 v8, 0
ds_read_b32 v8, v8 offset:14336
s_waitcnt lgkmcnt(0)
v_cmp_le_u32 vcc, 88, v8
s_cbranch_vccz L_sp80
s_branch L_ok80
L_sp81:
v_mov_b32 v8, 0
ds_read_b32 v8, v8 offset:14336
s_waitcnt lgkmcnt(0)
v_cmp_le_u32 vcc, 90, v8
s_cbranch_vccz L_sp81
s_branch L_ok81
L_sp83:
v_mov_b32 v8, 0
ds_read_b32 v8, v8 offset:14336
s_waitcnt lgkmcnt(0)
v_cmp_le_u32 vcc, 92, v8
s_cbranch_vccz L_sp83
s_branch L_ok83
.p2align 12
L_stub15:
s_setpc_b64 s[94:95]
L_pg15:
ds_read_b64_tr_b16 v[12:13], v4 offset:4096
v_mfma_f32_16x16x32_bf16 v[220:223], v[16:19], v[156:159], v[220:223]
ds_read_b64_tr_b16 v[14:15], v4 offset:6144
s_waitcnt lgkmcnt(4)
v_mfma_f32_16x16x32_bf16 v[208:211], v[20:23], v[184:187], v[208:211]
ds_read_b64_tr_b16 v[16:17], v4 offset:8192
s_movk_i32 s12, 316
v_mfma_f32_16x16x32_bf16 v[216:219], v[20:23], v[188:191], v[216:219]
ds_read_b64_tr_b16 v[18:19], v4 offset:10240
v_mfma_f32_16x16x32_bf16 v[212:215], v[24:27], v[184:187], v[212:215]
ds_read_b64_tr_b16 v[20:21], v4 offset:12288
ds_read_b64_tr_b16 v[22:23], v4 offset:14336
v_mfma_f32_16x16x32_bf16 v[220:223], v[24:27], v[188:191], v[220:223]
v_xor_b32 v4, 49184, v3
s_waitcnt lgkmcnt(4)
v_mfma_f32_16x16x32_bf16 a[192:195], v[28:31], a[96:99], a[192:195]
ds_read_b64_tr_b16 v[24:25], v4
ds_read_b64_tr_b16 v[26:27], v4 offset:2048
v_mfma_f32_16x16x32_bf16 a[196:199], v[28:31], a[100:103], a[196:199]
buffer_load_dword off, s[8:11], s12 lds
v_mfma_f32_16x16x32_bf16 a[196:199], v[12:15], a[108:111], a[196:199]
ds_read_b64_tr_b16 v[28:29], v4 offset:4096
v_max3_f32 v0, v208, v209, v0
v_mfma_f32_16x16x32_bf16 a[192:195], v[12:15], a[104:107], a[192:195]
ds_read_b64_tr_b16 v[30:31], v4 offset:6144
s_waitcnt lgkmcnt(4)
v_mfma_f32_16x16x32_bf16 a[192:195], v[16:19], a[112:115], a[192:195]
ds_read_b64_tr_b16 v[12:13], v4 offset:8192
v_mov_b32 v8, 0
v_mfma_f32_16x16x32_bf16 a[196:199], v[16:19], a[116:119], a[196:199]
ds_read_b64_tr_b16 v[14:15], v4 offset:10240
v_cvt_pk_bf16_f32 v104, v208, v209
v_mfma_f32_16x16x32_bf16 a[196:199], v[20:23], a[124:127], a[196:199]
ds_read_b64_tr_b16 v[16:17], v4 offset:12288
ds_read_b64_tr_b16 v[18:19], v4 offset:14336
v_mfma_f32_16x16x32_bf16 a[192:195], v[20:23], a[120:123], a[192:195]
v_xor_b32 v4, 49216, v3
s_waitcnt lgkmcnt(4)
v_mfma_f32_16x16x32_bf16 a[200:203], v[24:27], a[96:99], a[200:203]
ds_read_b64_tr_b16 v[20:21], v4
v_max3_f32 v2, v216, v217, v2
v_mfma_f32_16x16x32_bf16 a[204:207], v[24:27], a[100:103], a[204:207]
ds_read_b64_tr_b16 v[22:23], v4 offset:2048
ds_read_b32 v8, v8 offset:14336
v_mfma_f32_16x16x32_bf16 a[204:207], v[28:31], a[108:111], a[204:207]
ds_read_b64_tr_b16 v[24:25], v4 offset:4096
v_cvt_pk_bf16_f32 v108, v216, v217
v_mfma_f32_16x16x32_bf16 a[200:203], v[28:31], a[104:107], a[200:203]
ds_read_b64_tr_b16 v[26:27], v4 offset:6144
s_waitcnt lgkmcnt(5)
v_mfma_f32_16x16x32_bf16 a[200:203], v[12:15], a[112:115], a[200:203]
ds_read_b64_tr_b16 v[28:29], v4 offset:8192
v_max3_f32 v0, v210, v211, v0
v_mfma_f32_16x16x32_bf16 a[204:207], v[12:15], a[116:119], a[204:207]
ds_read_b64_tr_b16 v[30:31], v4 offset:10240
v_cvt_pk_bf16_f32 v105, v210, v211
v_mfma_f32_16x16x32_bf16 a[204:207], v[16:19], a[124:127], a[204:207]
ds_read_b64_tr_b16 v[12:13], v4 offset:12288
ds_read_b64_tr_b16 v[14:15], v4 offset:14336
v_mfma_f32_16x16x32_bf16 a[200:203], v[16:19], a[120:123], a[200:203]
v_xor_b32 v4, 49248, v3
s_waitcnt lgkmcnt(4)
v_mfma_f32_16x16x32_bf16 a[208:211], v[20:23], a[96:99], a[208:211]
ds_read_b64_tr_b16 v[16:17], v4
v_cmp_le_u32 vcc, 88, v8
v_mfma_f32_16x16x32_bf16 a[212:215], v[20:23], a[100:103], a[212:215]
ds_read_b64_tr_b16 v[18:19], v4 offset:2048
v_max3_f32 v2, v218, v219, v2
v_mfma_f32_16x16x32_bf16 a[212:215], v[24:27], a[108:111], a[212:215]
ds_read_b64_tr_b16 v[20:21], v4 offset:4096
v_cvt_pk_bf16_f32 v109, v218, v219
v_mfma_f32_16x16x32_bf16 a[208:211], v[24:27], a[104:107], a[208:211]
ds_read_b64_tr_b16 v[22:23], v4 offset:6144
s_waitcnt lgkmcnt(4)
v_mfma_f32_16x16x32_bf16 a[208:211], v[28:31], a[112:115], a[208:211]
ds_read_b64_tr_b16 v[24:25], v4 offset:8192
ds_read_b64_tr_b16 v[26:27], v4 offset:10240
v_mfma_f32_16x16x32_bf16 a[212:215], v[28:31], a[116:119], a[212:215]
s_cbranch_vccz L_sp80
L_ok80:
v_mfma_f32_16x16x32_bf16 a[212:215], v[12:15], a[124:127], a[212:215]
ds_read_b64_tr_b16 v[28:29], v4 offset:12288
ds_read_b64_tr_b16 v[30:31], v4 offset:14336
v_mfma_f32_16x16x32_bf16 a[208:211], v[12:15], a[120:123], a[208:211]
v_xor_b32 v4, 81920, v9
s_waitcnt lgkmcnt(4)
v_mfma_f32_16x16x32_bf16 a[216:219], v[16:19], a[96:99], a[216:219]
ds_read_b128 v[12:15], v4
v_max3_f32 v0, v212, v213, v0
v_mfma_f32_16x16x32_bf16 a[220:223], v[16:19], a[100:103], a[220:223]
v_cvt_pk_bf16_f32 v106, v212, v213
v_max3_f32 v2, v220, v221, v2
v_mfma_f32_16x16x32_bf16 a[220:223], v[20:23], a[108:111], a[220:223]
ds_read_b128 v[16:19], v4 offset:8192
v_cvt_pk_bf16_f32 v110, v220, v221
v_mfma_f32_16x16x32_bf16 a[216:219], v[20:23], a[104:107], a[216:219]
v_max3_f32 v0, v214, v215, v0
s_waitcnt lgkmcnt(2)
v_mfma_f32_16x16x32_bf16 a[216:219], v[24:27], a[112:115], a[216:219]
ds_read_b128 v[20:23], v4 offset:256
s_movk_i32 s12, 320
v_mfma_f32_16x16x32_bf16 a[220:223], v[24:27], a[116:119], a[220:223]
v_cvt_pk_bf16_f32 v107, v214, v215
v_max3_f32 v2, v222, v223, v2
v_mfma_f32_16x16x32_bf16 a[220:223], v[28:31], a[124:127], a[220:223]
ds_read_b128 v[24:27], v4 offset:8448
v_xor_b32 v4, 81984, v9
v_mfma_f32_16x16x32_bf16 a[216:219], v[28:31], a[120:123], a[216:219]
v_cvt_pk_bf16_f32 v111, v222, v223
s_waitcnt lgkmcnt(2)
v_mfma_f32_16x16x32_bf16 v[192:195], v[12:15], v[128:131], 0
ds_read_b128 v[28:31], v4
v_mfma_f32_16x16x32_bf16 v[200:203], v[12:15], v[132:135], 0
buffer_load_dword off, s[8:11], s12 lds
v_mfma_f32_16x16x32_bf16 v[196:199], v[16:19], v[128:131], 0
ds_read_b128 v[12:15], v4 offset:8192
v_mfma_f32_16x16x32_bf16 v[204:207], v[16:19], v[132:135], 0
s_waitcnt lgkmcnt(2)
v_mfma_f32_16x16x32_bf16 v[192:195], v[20:23], v[160:163], v[192:195]
ds_read_b128 v[16:19], v4 offset:256
v_mov_b32 v8, 0
v_mfma_f32_16x16x32_bf16 v[200:203], v[20:23], v[164:167], v[200:203]
v_mfma_f32_16x16x32_bf16 v[196:199], v[24:27], v[160:163], v[196:199]
ds_read_b128 v[20:23], v4 offset:8448
v_xor_b32 v4, 82048, v9
v_mfma_f32_16x16x32_bf16 v[204:207], v[24:27], v[164:167], v[204:207]
s_waitcnt lgkmcnt(2)
v_mfma_f32_16x16x32_bf16 v[192:195], v[28:31], v[136:139], v[192:195]
ds_read_b128 v[24:27], v4
v_mfma_f32_16x16x32_bf16 v[200:203], v[28:31], v[140:143], v[200:203]
ds_read_b32 v8, v8 offset:14336
v_mfma_f32_16x16x32_bf16 v[196:199], v[12:15], v[136:139], v[196:199]
ds_read_b128 v[28:31], v4 offset:8192
v_mfma_f32_16x16x32_bf16 v[204:207], v[12:15], v[140:143], v[204:207]
s_waitcnt lgkmcnt(3)
v_mfma_f32_16x16x32_bf16 v[192:195], v[16:19], v[168:171], v[192:195]
ds_read_b128 v[12:15], v4 offset:256
v_mfma_f32_16x16x32_bf16 v[200:203], v[16:19], v[172:175], v[200:203]
v_mfma_f32_16x16x32_bf16 v[196:199], v[20:23], v[168:171], v[196:199]
ds_read_b128 v[16:19], v4 offset:8448
v_xor_b32 v4, 82112, v9
v_mfma_f32_16x16x32_bf16 v[204:207], v[20:23], v[172:175], v[204:207]
s_waitcnt lgkmcnt(2)
v_mfma_f32_16x16x32_bf16 v[192:195], v[24:27], v[144:147], v[192:195]
ds_read_b128 v[20:23], v4
v_cmp_le_u32 vcc, 90, v8
v_mfma_f32_16x16x32_bf16 v[200:203], v[24:27], v[148:151], v[200:203]
v_mfma_f32_16x16x32_bf16 v[196:199], v[28:31], v[144:147], v[196:199]
ds_read_b128 v[24:27], v4 offset:8192
v_mfma_f32_16x16x32_bf16 v[204:207], v[28:31], v[148:151], v[204:207]
s_waitcnt lgkmcnt(2)
v_mfma_f32_16x16x32_bf16 v[192:195], v[12:15], v[176:179], v[192:195]
ds_read_b128 v[28:31], v4 offset:256
v_mfma_f32_16x16x32_bf16 v[200:203], v[12:15], v[180:183], v[200:203]
s_cbranch_vccz L_sp81
L_ok81:
v_mfma_f32_16x16x32_bf16 v[196:199], v[16:19], v[176:179], v[196:199]
ds_read_b128 v[12:15], v4 offset:8448
v_xor_b32 v4, 147456, v9
v_mfma_f32_16x16x32_bf16 v[204:207], v[16:19], v[180:183], v[204:207]
s_waitcnt lgkmcnt(2)
v_mfma_f32_16x16x32_bf16 v[192:195], v[20:23], v[152:155], v[192:195]
ds_read_b128 v[16:19], v4
v_mfma_f32_16x16x32_bf16 v[200:203], v[20:23], v[156:159], v[200:203]
v_mfma_f32_16x16x32_bf16 v[196:199], v[24:27], v[152:155], v[196:199]
ds_read_b128 v[20:23], v4 offset:8192
v_mfma_f32_16x16x32_bf16 v[204:207], v[24:27], v[156:159], v[204:207]
s_waitcnt lgkmcnt(2)
v_mfma_f32_16x16x32_bf16 v[192:195], v[28:31], v[184:187], v[192:195]
ds_read_b128 v[24:27], v4 offset:256
s_movk_i32 s12, 324
v_mfma_f32_16x16x32_bf16 v[200:203], v[28:31], v[188:191], v[200:203]
v_mfma_f32_16x16x32_bf16 v[196:199], v[12:15], v[184:187], v[196:199]
ds_read_b128 v[28:31], v4 offset:8448
v_xor_b32 v4, 147520, v9
v_mfma_f32_16x16x32_bf16 v[204:207], v[12:15], v[188:191], v[204:207]
s_waitcnt lgkmcnt(2)
v_mfma_f32_16x16x32_bf16 v[208:211], v[16:19], v[128:131], 0
ds_read_b128 v[12:15], v4
v_mfma_f32_16x16x32_bf16 v[216:219], v[16:19], v[132:135], 0
buffer_load_dword off, s[8:11], s12 lds
v_mfma_f32_16x16x32_bf16 v[212:215], v[20:23], v[128:131], 0
ds_read_b128 v[16:19], v4 offset:8192
v_max3_f32 v0, v192, v193, v0
v_mfma_f32_16x16x32_bf16 v[220:223], v[20:23], v[132:135], 0
v_cvt_pk_bf16_f32 v112, v192, v193
s_waitcnt lgkmcnt(2)
v_mfma_f32_16x16x32_bf16 v[208:211], v[24:27], v[160:163], v[208:211]
ds_read_b128 v[20:23], v4 offset:256
v_max3_f32 v2, v200, v201, v2
v_mfma_f32_16x16x32_bf16 v[216:219], v[24:27], v[164:167], v[216:219]
v_cvt_pk_bf16_f32 v116, v200, v201
v_max3_f32 v0, v194, v195, v0
v_mfma_f32_16x16x32_bf16 v[212:215], v[28:31], v[160:163], v[212:215]
ds_read_b128 v[24:27], v4 offset:8448
v_xor_b32 v4, 147584, v9
v_mfma_f32_16x16x32_bf16 v[220:223], v[28:31], v[164:167], v[220:223]
v_cvt_pk_bf16_f32 v113, v194, v195
s_waitcnt lgkmcnt(2)
v_mfma_f32_16x16x32_bf16 v[208:211], v[12:15], v[136:139], v[208:211]
ds_read_b128 v[28:31], v4
v_max3_f32 v2, v202, v203, v2
v_mfma_f32_16x16x32_bf16 v[216:219], v[12:15], v[140:143], v[216:219]
v_cvt_pk_bf16_f32 v117, v202, v203
v_max3_f32 v0, v196, v197, v0
v_mfma_f32_16x16x32_bf16 v[212:215], v[16:19], v[136:139], v[212:215]
ds_read_b128 v[12:15], v4 offset:8192
v_cvt_pk_bf16_f32 v114, v196, v197
v_mfma_f32_16x16x32_bf16 v[220:223], v[16:19], v[140:143], v[220:223]
v_max3_f32 v2, v204, v205, v2
s_waitcnt lgkmcnt(2)
v_mfma_f32_16x16x32_bf16 v[208:211], v[20:23], v[168:171], v[208:211]
ds_read_b128 v[16:19], v4 offset:256
v_cvt_pk_bf16_f32 v118, v204, v205
v_mfma_f32_16x16x32_bf16 v[216:219], v[20:23], v[172:175], v[216:219]
v_max3_f32 v0, v198, v199, v0
v_cvt_pk_bf16_f32 v115, v198, v199
v_mfma_f32_16x16x32_bf16 v[212:215], v[24:27], v[168:171], v[212:215]
ds_read_b128 v[20:23], v4 offset:8448
v_xor_b32 v4, 147648, v9
v_mfma_f32_16x16x32_bf16 v[220:223], v[24:27], v[172:175], v[220:223]
v_max3_f32 v2, v206, v207, v2
s_waitcnt lgkmcnt(2)
v_mfma_f32_16x16x32_bf16 v[208:211], v[28:31], v[144:147], v[208:211]
ds_read_b128 v[24:27], v4
v_cvt_pk_bf16_f32 v119, v206, v207
v_mfma_f32_16x16x32_bf16 v[216:219], v[28:31], v[148:151], v[216:219]
v_mfma_f32_16x16x32_bf16 v[212:215], v[12:15], v[144:147], v[212:215]
ds_read_b128 v[28:31], v4 offset:8192
v_mfma_f32_16x16x32_bf16 v[220:223], v[12:15], v[148:151], v[220:223]
s_waitcnt lgkmcnt(2)
v_mfma_f32_16x16x32_bf16 v[208:211], v[16:19], v[176:179], v[208:211]
ds_read_b128 v[12:15], v4 offset:256
v_mfma_f32_16x16x32_bf16 v[216:219], v[16:19], v[180:183], v[216:219]
v_mfma_f32_16x16x32_bf16 v[212:215], v[20:23], v[176:179], v[212:215]
ds_read_b128 v[16:19], v4 offset:8448
v_xor_b32 v4, 114688, v3
v_mfma_f32_16x16x32_bf16 v[220:223], v[20:23], v[180:183], v[220:223]
s_waitcnt lgkmcnt(2)
v_mfma_f32_16x16x32_bf16 v[208:211], v[24:27], v[152:155], v[208:211]
ds_read_b64_tr_b16 v[20:21], v4
v_mfma_f32_16x16x32_bf16 v[216:219], v[24:27], v[156:159], v[216:219]
ds_read_b64_tr_b16 v[22:23], v4 offset:2048
v_mfma_f32_16x16x32_bf16 v[212:215], v[28:31], v[152:155], v[212:215]
ds_read_b64_tr_b16 v[24:25], v4 offset:4096
v_mfma_f32_16x16x32_bf16 v[220:223], v[28:31], v[156:159], v[220:223]
ds_read_b64_tr_b16 v[26:27], v4 offset:6144
s_waitcnt lgkmcnt(4)
v_mfma_f32_16x16x32_bf16 v[208:211], v[12:15], v[184:187], v[208:211]
ds_read_b64_tr_b16 v[28:29], v4 offset:8192
s_movk_i32 s12, 328
v_mfma_f32_16x16x32_bf16 v[216:219], v[12:15], v[188:191], v[216:219]
ds_read_b64_tr_b16 v[30:31], v4 offset:10240
v_mfma_f32_16x16x32_bf16 v[212:215], v[16:19], v[184:187], v[212:215]
ds_read_b64_tr_b16 v[12:13], v4 offset:12288
ds_read_b64_tr_b16 v[14:15], v4 offset:14336
v_mfma_f32_16x16x32_bf16 v[220:223], v[16:19], v[188:191], v[220:223]
v_xor_b32 v4, 114720, v3
s_waitcnt lgkmcnt(4)
v_mfma_f32_16x16x32_bf16 a[224:227], v[20:23], a[64:67], 0
ds_read_b64_tr_b16 v[16:17], v4
ds_read_b64_tr_b16 v[18:19], v4 offset:2048
v_mfma_f32_16x16x32_bf16 a[228:231], v[20:23], a[68:71], 0
buffer_load_dword off, s[8:11], s12 lds
v_mfma_f32_16x16x32_bf16 a[228:231], v[24:27], a[76:79], a[228:231]
ds_read_b64_tr_b16 v[20:21], v4 offset:4096
v_max3_f32 v0, v208, v209, v0
v_mfma_f32_16x16x32_bf16 a[224:227], v[24:27], a[72:75], a[224:227]
ds_read_b64_tr_b16 v[22:23], v4 offset:6144
v_cvt_pk_bf16_f32 v120, v208, v209
v_max3_f32 v2, v216, v217, v2
v_cvt_pk_bf16_f32 v124, v216, v217
v_max3_f32 v0, v210, v211, v0
v_cvt_pk_bf16_f32 v121, v210, v211
v_max3_f32 v2, v218, v219, v2
v_cvt_pk_bf16_f32 v125, v218, v219
v_max3_f32 v0, v212, v213, v0
s_waitcnt lgkmcnt(4)
v_mfma_f32_16x16x32_bf16 a[224:227], v[28:31], a[80:83], a[224:227]
ds_read_b64_tr_b16 v[24:25], v4 offset:8192
v_mov_b32 v8, 0
v_mfma_f32_16x16x32_bf16 a[228:231], v[28:31], a[84:87], a[228:231]
ds_read_b64_tr_b16 v[26:27], v4 offset:10240
v_cvt_pk_bf16_f32 v122, v212, v213
v_max3_f32 v2, v220, v221, v2
v_cvt_pk_bf16_f32 v126, v220, v221
v_max3_f32 v0, v214, v215, v0
v_cvt_pk_bf16_f32 v123, v214, v215
v_max3_f32 v2, v222, v223, v2
v_cvt_pk_bf16_f32 v127, v222, v223
s_nop 0
v_permlane32_swap_b32 v0, v2
v_mfma_f32_16x16x32_bf16 a[228:231], v[12:15], a[92:95], a[228:231]
ds_read_b64_tr_b16 v[28:29], v4 offset:12288
v_max_f32 v0, v0, v2
v_mfma_f32_16x16x32_bf16 a[224:227], v[12:15], a[88:91], a[224:227]
ds_read_b64_tr_b16 v[30:31], v4 offset:14336
v_xor_b32 v4, 114752, v3
v_mov_b32 v2, v0
s_nop 1
v_permlane16_swap_b32 v0, v2
v_max_f32 v0, v0, v2
v_cvt_pk_bf16_f32 v0, v0, v0
s_waitcnt lgkmcnt(4)
v_mfma_f32_16x16x32_bf16 a[232:235], v[16:19], a[64:67], 0
ds_read_b64_tr_b16 v[12:13], v4
v_lshlrev_b32 v0, 16, v0
v_mfma_f32_16x16x32_bf16 a[236:239], v[16:19], a[68:71], 0
ds_read_b64_tr_b16 v[14:15], v4 offset:2048
v_mul_f32 v0, 0xbdb8aa3b, v0
ds_read_b32 v8, v8 offset:14336
v_mov_b32 v2, v0
s_nop 1
v_permlane32_swap_b32 v0, v2
v_lshlrev_b32 v6, 16, v224
v_and_b32 v7, s50, v224
v_mfma_f32_16x16x32_bf16 a[236:239], v[20:23], a[76:79], a[236:239]
ds_read_b64_tr_b16 v[16:17], v4 offset:4096
v_fma_f32 v6, v6, s48, v0
v_mfma_f32_16x16x32_bf16 a[232:235], v[20:23], a[72:75], a[232:235]
ds_read_b64_tr_b16 v[18:19], v4 offset:6144
v_fma_f32 v7, v7, s48, v0
v_exp_f32 v6, v6
v_exp_f32 v7, v7
v_lshlrev_b32 v10, 16, v228
v_and_b32 v11, s50, v228
v_cvt_pk_bf16_f32 v224, v6, v7
s_waitcnt lgkmcnt(5)
v_mfma_f32_16x16x32_bf16 a[232:235], v[24:27], a[80:83], a[232:235]
ds_read_b64_tr_b16 v[20:21], v4 offset:8192
v_add_f32 v9, v6, v7
v_mfma_f32_16x16x32_bf16 a[236:239], v[24:27], a[84:87], a[236:239]
ds_read_b64_tr_b16 v[22:23], v4 offset:10240
v_fma_f32 v10, v10, s48, v2
v_fma_f32 v11, v11, s48, v2
v_exp_f32 v10, v10
v_exp_f32 v11, v11
v_lshlrev_b32 v6, 16, v225
v_and_b32 v7, s50, v225
v_cvt_pk_bf16_f32 v228, v10, v11
v_mfma_f32_16x16x32_bf16 a[236:239], v[28:31], a[92:95], a[236:239]
ds_read_b64_tr_b16 v[24:25], v4 offset:12288
v_add_f32 v5, v10, v11
v_mfma_f32_16x16x32_bf16 a[232:235], v[28:31], a[88:91], a[232:235]
ds_read_b64_tr_b16 v[26:27], v4 offset:14336
v_xor_b32 v4, 114784, v3
v_fma_f32 v6, v6, s48, v0
v_fma_f32 v7, v7, s48, v0
v_exp_f32 v6, v6
v_exp_f32 v7, v7
v_lshlrev_b32 v10, 16, v229
s_waitcnt lgkmcnt(4)
v_mfma_f32_16x16x32_bf16 a[240:243], v[12:15], a[64:67], 0
ds_read_b64_tr_b16 v[28:29], v4
v_cmp_le_u32 vcc, 92, v8
v_mfma_f32_16x16x32_bf16 a[244:247], v[12:15], a[68:71], 0
ds_read_b64_tr_b16 v[30:31], v4 offset:2048
v_and_b32 v11, s50, v229
v_add_f32 v9, v9, v6
v_cvt_pk_bf16_f32 v225, v6, v7
v_add_f32 v9, v9, v7
v_fma_f32 v10, v10, s48, v2
v_fma_f32 v11, v11, s48, v2
v_exp_f32 v10, v10
v_mfma_f32_16x16x32_bf16 a[244:247], v[16:19], a[76:79], a[244:247]
ds_read_b64_tr_b16 v[12:13], v4 offset:4096
v_exp_f32 v11, v11
v_mfma_f32_16x16x32_bf16 a[240:243], v[16:19], a[72:75], a[240:243]
ds_read_b64_tr_b16 v[14:15], v4 offset:6144
v_lshlrev_b32 v6, 16, v226
v_and_b32 v7, s50, v226
v_add_f32 v5, v5, v10
v_cvt_pk_bf16_f32 v229, v10, v11
v_add_f32 v5, v5, v11
v_fma_f32 v6, v6, s48, v0
v_fma_f32 v7, v7, s48, v0
s_waitcnt lgkmcnt(4)
v_mfma_f32_16x16x32_bf16 a[240:243], v[20:23], a[80:83], a[240:243]
ds_read_b64_tr_b16 v[16:17], v4 offset:8192
v_exp_f32 v6, v6
v_mfma_f32_16x16x32_bf16 a[244:247], v[20:23], a[84:87], a[244:247]
ds_read_b64_tr_b16 v[18:19], v4 offset:10240
s_cbranch_vccz L_sp83
L_ok83:
v_exp_f32 v7, v7
v_lshlrev_b32 v10, 16, v230
v_and_b32 v11, s50, v230
v_add_f32 v9, v9, v6
v_cvt_pk_bf16_f32 v226, v6, v7
v_add_f32 v9, v9, v7
v_mfma_f32_16x16x32_bf16 a[244:247], v[24:27], a[92:95], a[244:247]
ds_read_b64_tr_b16 v[20:21], v4 offset:12288
v_fma_f32 v10, v10, s48, v2
v_mfma_f32_16x16x32_bf16 a[240:243], v[24:27], a[88:91], a[240:243]
ds_read_b64_tr_b16 v[22:23], v4 offset:14336
v_xor_b32 v4, 32768, v1
v_fma_f32 v11, v11, s48, v2
v_exp_f32 v10, v10
v_exp_f32 v11, v11
v_lshlrev_b32 v6, 16, v227
s_waitcnt lgkmcnt(4)
v_mfma_f32_16x16x32_bf16 a[248:251], v[28:31], a[64:67], 0
ds_read_b64_tr_b16 v[24:25], v4
v_and_b32 v7, s50, v227
v_mfma_f32_16x16x32_bf16 a[252:255], v[28:31], a[68:71], 0
ds_read_b64_tr_b16 v[26:27], v4 offset:8192
v_add_f32 v5, v5, v10
v_cvt_pk_bf16_f32 v230, v10, v11
v_add_f32 v5, v5, v11
v_fma_f32 v6, v6, s48, v0
v_fma_f32 v7, v7, s48, v0
v_exp_f32 v6, v6
v_exp_f32 v7, v7
v_mfma_f32_16x16x32_bf16 a[252:255], v[12:15], a[76:79], a[252:255]
ds_read_b64_tr_b16 v[28:29], v4 offset:256
v_lshlrev_b32 v10, 16, v231
v_mfma_f32_16x16x32_bf16 a[248:251], v[12:15], a[72:75], a[248:251]
ds_read_b64_tr_b16 v[30:31], v4 offset:8448
v_xor_b32 v4, 32800, v1
v_and_b32 v11, s50, v231
v_add_f32 v9, v9, v6
v_cvt_pk_bf16_f32 v227, v6, v7
v_add_f32 v9, v9, v7
v_fma_f32 v10, v10, s48, v2
v_fma_f32 v11, v11, s48, v2
v_exp_f32 v10, v10
s_waitcnt lgkmcnt(4)
v_mfma_f32_16x16x32_bf16 a[248:251], v[16:19], a[80:83], a[248:251]
ds_read_b64_tr_b16 v[12:13], v4
v_exp_f32 v11, v11
v_mfma_f32_16x16x32_bf16 a[252:255], v[16:19], a[84:87], a[252:255]
ds_read_b64_tr_b16 v[14:15], v4 offset:8192
v_add_f32 v5, v5, v10
v_cvt_pk_bf16_f32 v231, v10, v11
v_add_f32 v5, v5, v11
v_lshlrev_b32 v6, 16, v232
v_and_b32 v7, s50, v232
v_fma_f32 v6, v6, s48, v0
v_fma_f32 v7, v7, s48, v0
v_mfma_f32_16x16x32_bf16 a[252:255], v[20:23], a[92:95], a[252:255]
ds_read_b64_tr_b16 v[16:17], v4 offset:256
ds_read_b64_tr_b16 v[18:19], v4 offset:8448
v_mfma_f32_16x16x32_bf16 a[248:251], v[20:23], a[88:91], a[248:251]
v_xor_b32 v4, 32832, v1
s_waitcnt lgkmcnt(4)
v_mfma_f32_16x16x32_bf16 v[128:131], v[24:27], v[224:227], 0
ds_read_b64_tr_b16 v[20:21], v4
ds_read_b64_tr_b16 v[22:23], v4 offset:8192
v_mfma_f32_16x16x32_bf16 v[132:135], v[24:27], v[228:231], 0
v_exp_f32 v6, v6
v_exp_f32 v7, v7
v_lshlrev_b32 v10, 16, v236
v_and_b32 v11, s50, v236
v_pk_fma_f32 v[10:11], v[10:11], s[48:49], v[2:3] op_sel_hi:[1,0,0]
v_mfma_f32_16x16x32_bf16 v[192:195], v[28:31], v[224:227], 0
ds_read_b64_tr_b16 v[24:25], v4 offset:256
ds_read_b64_tr_b16 v[26:27], v4 offset:8448
v_mfma_f32_16x16x32_bf16 v[196:199], v[28:31], v[228:231], 0
v_xor_b32 v4, 32864, v1
v_cvt_pk_bf16_f32 v232, v6, v7
s_waitcnt lgkmcnt(4)
v_mfma_f32_16x16x32_bf16 v[136:139], v[12:15], v[224:227], 0
ds_read_b64_tr_b16 v[28:29], v4
ds_read_b64_tr_b16 v[30:31], v4 offset:8192
v_mfma_f32_16x16x32_bf16 v[140:143], v[12:15], v[228:231], 0
v_exp_f32 v10, v10
v_exp_f32 v11, v11
v_lshlrev_b32 v6, 16, v233
v_and_b32 v7, s50, v233
v_pk_fma_f32 v[6:7], v[6:7], s[48:49], v[0:1] op_sel_hi:[1,0,0]
v_dot2c_f32_bf16 v9, s21, v232
v_mfma_f32_16x16x32_bf16 v[200:203], v[16:19], v[224:227], 0
ds_read_b64_tr_b16 v[12:13], v4 offset:256
ds_read_b64_tr_b16 v[14:15], v4 offset:8448
v_mfma_f32_16x16x32_bf16 v[204:207], v[16:19], v[228:231], 0
v_xor_b32 v4, 32896, v1
v_cvt_pk_bf16_f32 v236, v10, v11
s_waitcnt lgkmcnt(4)
v_mfma_f32_16x16x32_bf16 v[144:147], v[20:23], v[224:227], 0
ds_read_b64_tr_b16 v[16:17], v4
ds_read_b64_tr_b16 v[18:19], v4 offset:8192
v_mfma_f32_16x16x32_bf16 v[148:151], v[20:23], v[228:231], 0
v_exp_f32 v6, v6
v_exp_f32 v7, v7
v_lshlrev_b32 v10, 16, v237
v_and_b32 v11, s50, v237
v_pk_fma_f32 v[10:11], v[10:11], s[48:49], v[2:3] op_sel_hi:[1,0,0]
v_dot2c_f32_bf16 v5, s21, v236
v_mfma_f32_16x16x32_bf16 v[208:211], v[24:27], v[224:227], 0
ds_read_b64_tr_b16 v[20:21], v4 offset:256
ds_read_b64_tr_b16 v[22:23], v4 offset:8448
v_mfma_f32_16x16x32_bf16 v[212:215], v[24:27], v[228:231], 0
v_xor_b32 v4, 32928, v1
v_cvt_pk_bf16_f32 v233, v6, v7
s_waitcnt lgkmcnt(4)
v_mfma_f32_16x16x32_bf16 v[152:155], v[28:31], v[224:227], 0
ds_read_b64_tr_b16 v[24:25], v4
ds_read_b64_tr_b16 v[26:27], v4 offset:8192
v_mfma_f32_16x16x32_bf16 v[156:159], v[28:31], v[228:231], 0
v_exp_f32 v10, v10
v_exp_f32 v11, v11
v_lshlrev_b32 v6, 16, v234
v_and_b32 v7, s50, v234
v_pk_fma_f32 v[6:7], v[6:7], s[48:49], v[0:1] op_sel_hi:[1,0,0]
v_dot2c_f32_bf16 v9, s21, v233
v_mfma_f32_16x16x32_bf16 v[216:219], v[12:15], v[224:227], 0
ds_read_b64_tr_b16 v[28:29], v4 offset:256
ds_read_b64_tr_b16 v[30:31], v4 offset:8448
v_mfma_f32_16x16x32_bf16 v[220:223], v[12:15], v[228:231], 0
v_xor_b32 v4, 32960, v1
v_cvt_pk_bf16_f32 v237, v10, v11
s_waitcnt lgkmcnt(4)
v_mfma_f32_16x16x32_bf16 v[160:163], v[16:19], v[224:227], 0
ds_read_b64_tr_b16 v[12:13], v4
ds_read_b64_tr_b16 v[14:15], v4 offset:8192
v_mfma_f32_16x16x32_bf16 v[164:167], v[16:19], v[228:231], 0
v_exp_f32 v6, v6
v_exp_f32 v7, v7
v_lshlrev_b32 v10, 16, v238
v_and_b32 v11, s50, v238
v_pk_fma_f32 v[10:11], v[10:11], s[48:49], v[2:3] op_sel_hi:[1,0,0]
v_dot2c_f32_bf16 v5, s21, v237
v_mfma_f32_16x16x32_bf16 a[0:3], v[20:23], v[224:227], 0
ds_read_b64_tr_b16 v[16:17], v4 offset:256
ds_read_b64_tr_b16 v[18:19], v4 offset:8448
v_mfma_f32_16x16x32_bf16 a[4:7], v[20:23], v[228:231], 0
v_xor_b32 v4, 32992, v1
v_cvt_pk_bf16_f32 v234, v6, v7
s_waitcnt lgkmcnt(4)
v_mfma_f32_16x16x32_bf16 v[168:171], v[24:27], v[224:227], 0
ds_read_b64_tr_b16 v[20:21], v4
ds_read_b64_tr_b16 v[22:23], v4 offset:8192
v_mfma_f32_16x16x32_bf16 v[172:175], v[24:27], v[228:231], 0
v_exp_f32 v10, v10
v_exp_f32 v11, v11
v_lshlrev_b32 v6, 16, v235
v_and_b32 v7, s50, v235
v_pk_fma_f32 v[6:7], v[6:7], s[48:49], v[0:1] op_sel_hi:[1,0,0]
v_dot2c_f32_bf16 v9, s21, v234
v_mfma_f32_16x16x32_bf16 a[8:11], v[28:31], v[224:227], 0
ds_read_b64_tr_b16 v[24:25], v4 offset:256
ds_read_b64_tr_b16 v[26:27], v4 offset:8448
v_mfma_f32_16x16x32_bf16 a[12:15], v[28:31], v[228:231], 0
v_xor_b32 v4, 16384, v3
v_cvt_pk_bf16_f32 v238, v10, v11
s_waitcnt lgkmcnt(4)
v_mfma_f32_16x16x32_bf16 v[176:179], v[12:15], v[224:227], 0
ds_read_b64_tr_b16 v[28:29], v4
ds_read_b64_tr_b16 v[30:31], v4 offset:2048
v_mfma_f32_16x16x32_bf16 v[180:183], v[12:15], v[228:231], 0
s_branch L_pg16
L_sp85:
v_mov_b32 v8, 0
ds_read_b32 v8, v8 offset:14336
s_waitcnt lgkmcnt(0)
v_cmp_le_u32 vcc, 93, v8
s_cbranch_vccz L_sp85
s_branch L_ok85
L_sp86:
v_mov_b32 v8, 0
ds_read_b32 v8, v8 offset:14336
s_waitcnt lgkmcnt(0)
v_cmp_le_u32 vcc, 95, v8
s_cbranch_vccz L_sp86
s_branch L_ok86
L_sp88:
v_mov_b32 v8, 0
ds_read_b32 v8, v8 offset:14336
s_waitcnt lgkmcnt(0)
v_cmp_le_u32 vcc, 96, v8
s_cbranch_vccz L_sp88
s_branch L_ok88
.p2align 12
L_stub16:
s_setpc_b64 s[94:95]
L_pg16:
v_exp_f32 v6, v6
v_mfma_f32_16x16x32_bf16 a[16:19], v[16:19], v[224:227], 0
ds_read_b64_tr_b16 v[12:13], v4 offset:4096
ds_read_b64_tr_b16 v[14:15], v4 offset:6144
v_mfma_f32_16x16x32_bf16 a[20:23], v[16:19], v[228:231], 0
v_exp_f32 v7, v7
s_waitcnt lgkmcnt(4)
v_mfma_f32_16x16x32_bf16 v[184:187], v[20:23], v[224:227], 0
ds_read_b64_tr_b16 v[16:17], v4 offset:8192
ds_read_b64_tr_b16 v[18:19], v4 offset:10240
v_mfma_f32_16x16x32_bf16 v[188:191], v[20:23], v[228:231], 0
s_movk_i32 s12, 336
v_mfma_f32_16x16x32_bf16 a[24:27], v[24:27], v[224:227], 0
ds_read_b64_tr_b16 v[20:21], v4 offset:12288
ds_read_b64_tr_b16 v[22:23], v4 offset:14336
v_mfma_f32_16x16x32_bf16 a[28:31], v[24:27], v[228:231], 0
v_xor_b32 v4, 16416, v3
s_waitcnt lgkmcnt(4)
v_mfma_f32_16x16x32_bf16 a[224:227], v[28:31], a[96:99], a[224:227]
ds_read_b64_tr_b16 v[24:25], v4
v_lshlrev_b32 v10, 16, v239
v_mfma_f32_16x16x32_bf16 a[228:231], v[28:31], a[100:103], a[228:231]
ds_read_b64_tr_b16 v[26:27], v4 offset:2048
buffer_load_dword off, s[8:11], s12 lds
v_mfma_f32_16x16x32_bf16 a[228:231], v[12:15], a[108:111], a[228:231]
ds_read_b64_tr_b16 v[28:29], v4 offset:4096
v_and_b32 v11, s50, v239
v_mfma_f32_16x16x32_bf16 a[224:227], v[12:15], a[104:107], a[224:227]
ds_read_b64_tr_b16 v[30:31], v4 offset:6144
s_waitcnt lgkmcnt(4)
v_mfma_f32_16x16x32_bf16 a[224:227], v[16:19], a[112:115], a[224:227]
ds_read_b64_tr_b16 v[12:13], v4 offset:8192
v_mov_b32 v8, 0
v_mfma_f32_16x16x32_bf16 a[228:231], v[16:19], a[116:119], a[228:231]
ds_read_b64_tr_b16 v[14:15], v4 offset:10240
v_cvt_pk_bf16_f32 v235, v6, v7
v_mfma_f32_16x16x32_bf16 a[228:231], v[20:23], a[124:127], a[228:231]
ds_read_b64_tr_b16 v[16:17], v4 offset:12288
ds_read_b64_tr_b16 v[18:19], v4 offset:14336
v_mfma_f32_16x16x32_bf16 a[224:227], v[20:23], a[120:123], a[224:227]
v_xor_b32 v4, 16448, v3
s_waitcnt lgkmcnt(4)
v_mfma_f32_16x16x32_bf16 a[232:235], v[24:27], a[96:99], a[232:235]
ds_read_b64_tr_b16 v[20:21], v4
v_fma_f32 v10, v10, s48, v2
v_mfma_f32_16x16x32_bf16 a[236:239], v[24:27], a[100:103], a[236:239]
ds_read_b64_tr_b16 v[22:23], v4 offset:2048
ds_read_b32 v8, v8 offset:14336
v_mfma_f32_16x16x32_bf16 a[236:239], v[28:31], a[108:111], a[236:239]
ds_read_b64_tr_b16 v[24:25], v4 offset:4096
v_fma_f32 v11, v11, s48, v2
v_mfma_f32_16x16x32_bf16 a[232:235], v[28:31], a[104:107], a[232:235]
ds_read_b64_tr_b16 v[26:27], v4 offset:6144
s_waitcnt lgkmcnt(5)
v_mfma_f32_16x16x32_bf16 a[232:235], v[12:15], a[112:115], a[232:235]
ds_read_b64_tr_b16 v[28:29], v4 offset:8192
v_exp_f32 v10, v10
v_mfma_f32_16x16x32_bf16 a[236:239], v[12:15], a[116:119], a[236:239]
ds_read_b64_tr_b16 v[30:31], v4 offset:10240
v_mfma_f32_16x16x32_bf16 a[236:239], v[16:19], a[124:127], a[236:239]
ds_read_b64_tr_b16 v[12:13], v4 offset:12288
ds_read_b64_tr_b16 v[14:15], v4 offset:14336
v_mfma_f32_16x16x32_bf16 a[232:235], v[16:19], a[120:123], a[232:235]
v_xor_b32 v4, 16480, v3
s_waitcnt lgkmcnt(4)
v_mfma_f32_16x16x32_bf16 a[240:243], v[20:23], a[96:99], a[240:243]
ds_read_b64_tr_b16 v[16:17], v4
v_cmp_le_u32 vcc, 93, v8
v_mfma_f32_16x16x32_bf16 a[244:247], v[20:23], a[100:103], a[244:247]
ds_read_b64_tr_b16 v[18:19], v4 offset:2048
v_exp_f32 v11, v11
v_xor_b32 v224, 0, v1
v_mfma_f32_16x16x32_bf16 a[244:247], v[24:27], a[108:111], a[244:247]
ds_read_b64_tr_b16 v[20:21], v4 offset:4096
v_xor_b32 v225, 32, v1
v_mfma_f32_16x16x32_bf16 a[240:243], v[24:27], a[104:107], a[240:243]
ds_read_b64_tr_b16 v[22:23], v4 offset:6144
s_waitcnt lgkmcnt(4)
v_mfma_f32_16x16x32_bf16 a[240:243], v[28:31], a[112:115], a[240:243]
ds_read_b64_tr_b16 v[24:25], v4 offset:8192
v_lshlrev_b32 v6, 16, v240
v_mfma_f32_16x16x32_bf16 a[244:247], v[28:31], a[116:119], a[244:247]
ds_read_b64_tr_b16 v[26:27], v4 offset:10240
s_cbranch_vccz L_sp85
L_ok85:
v_mfma_f32_16x16x32_bf16 a[244:247], v[12:15], a[124:127], a[244:247]
ds_read_b64_tr_b16 v[28:29], v4 offset:12288
ds_read_b64_tr_b16 v[30:31], v4 offset:14336
v_mfma_f32_16x16x32_bf16 a[240:243], v[12:15], a[120:123], a[240:243]
v_xor_b32 v4, 65536, v1
s_waitcnt lgkmcnt(4)
v_mfma_f32_16x16x32_bf16 a[248:251], v[16:19], a[96:99], a[248:251]
ds_read_b64_tr_b16 v[12:13], v4
v_and_b32 v7, s50, v240
v_mfma_f32_16x16x32_bf16 a[252:255], v[16:19], a[100:103], a[252:255]
ds_read_b64_tr_b16 v[14:15], v4 offset:8192
v_cvt_pk_bf16_f32 v239, v10, v11
v_mfma_f32_16x16x32_bf16 a[252:255], v[20:23], a[108:111], a[252:255]
ds_read_b64_tr_b16 v[16:17], v4 offset:256
ds_read_b64_tr_b16 v[18:19], v4 offset:8448
v_mfma_f32_16x16x32_bf16 a[248:251], v[20:23], a[104:107], a[248:251]
v_xor_b32 v4, 65568, v1
s_waitcnt lgkmcnt(4)
v_mfma_f32_16x16x32_bf16 a[248:251], v[24:27], a[112:115], a[248:251]
ds_read_b64_tr_b16 v[20:21], v4
v_fma_f32 v6, v6, s48, v0
v_mfma_f32_16x16x32_bf16 a[252:255], v[24:27], a[116:119], a[252:255]
ds_read_b64_tr_b16 v[22:23], v4 offset:8192
v_fma_f32 v7, v7, s48, v0
v_mfma_f32_16x16x32_bf16 a[252:255], v[28:31], a[124:127], a[252:255]
ds_read_b64_tr_b16 v[24:25], v4 offset:256
ds_read_b64_tr_b16 v[26:27], v4 offset:8448
v_mfma_f32_16x16x32_bf16 a[248:251], v[28:31], a[120:123], a[248:251]
v_xor_b32 v4, 65600, v1
s_waitcnt lgkmcnt(4)
v_mfma_f32_16x16x32_bf16 v[128:131], v[12:15], v[232:235], v[128:131]
ds_read_b64_tr_b16 v[28:29], v4
ds_read_b64_tr_b16 v[30:31], v4 offset:8192
v_mfma_f32_16x16x32_bf16 v[132:135], v[12:15], v[236:239], v[132:135]
v_exp_f32 v6, v6
v_exp_f32 v7, v7
v_lshlrev_b32 v10, 16, v244
v_and_b32 v11, s50, v244
v_pk_fma_f32 v[10:11], v[10:11], s[48:49], v[2:3] op_sel_hi:[1,0,0]
v_dot2c_f32_bf16 v5, s21, v238
v_dot2c_f32_bf16 v9, s21, v235
v_dot2c_f32_bf16 v5, s21, v239
v_mfma_f32_16x16x32_bf16 v[192:195], v[16:19], v[232:235], v[192:195]
ds_read_b64_tr_b16 v[12:13], v4 offset:256
ds_read_b64_tr_b16 v[14:15], v4 offset:8448
v_mfma_f32_16x16x32_bf16 v[196:199], v[16:19], v[236:239], v[196:199]
v_xor_b32 v4, 65632, v1
v_cvt_pk_bf16_f32 v240, v6, v7
s_waitcnt lgkmcnt(4)
v_mfma_f32_16x16x32_bf16 v[136:139], v[20:23], v[232:235], v[136:139]
ds_read_b64_tr_b16 v[16:17], v4
ds_read_b64_tr_b16 v[18:19], v4 offset:8192
v_mfma_f32_16x16x32_bf16 v[140:143], v[20:23], v[236:239], v[140:143]
v_mov_b32 v8, 0
v_exp_f32 v10, v10
v_exp_f32 v11, v11
v_lshlrev_b32 v6, 16, v241
v_and_b32 v7, s50, v241
v_pk_fma_f32 v[6:7], v[6:7], s[48:49], v[0:1] op_sel_hi:[1,0,0]
v_dot2c_f32_bf16 v9, s21, v240
v_mfma_f32_16x16x32_bf16 v[200:203], v[24:27], v[232:235], v[200:203]
ds_read_b64_tr_b16 v[20:21], v4 offset:256
ds_read_b64_tr_b16 v[22:23], v4 offset:8448
v_mfma_f32_16x16x32_bf16 v[204:207], v[24:27], v[236:239], v[204:207]
v_xor_b32 v4, 65664, v1
v_cvt_pk_bf16_f32 v244, v10, v11
s_waitcnt lgkmcnt(4)
v_mfma_f32_16x16x32_bf16 v[144:147], v[28:31], v[232:235], v[144:147]
ds_read_b64_tr_b16 v[24:25], v4
ds_read_b64_tr_b16 v[26:27], v4 offset:8192
v_mfma_f32_16x16x32_bf16 v[148:151], v[28:31], v[236:239], v[148:151]
ds_read_b32 v8, v8 offset:14336
v_exp_f32 v6, v6
v_exp_f32 v7, v7
v_lshlrev_b32 v10, 16, v245
v_and_b32 v11, s50, v245
v_pk_fma_f32 v[10:11], v[10:11], s[48:49], v[2:3] op_sel_hi:[1,0,0]
v_dot2c_f32_bf16 v5, s21, v244
v_mfma_f32_16x16x32_bf16 v[208:211], v[12:15], v[232:235], v[208:211]
ds_read_b64_tr_b16 v[28:29], v4 offset:256
ds_read_b64_tr_b16 v[30:31], v4 offset:8448
v_mfma_f32_16x16x32_bf16 v[212:215], v[12:15], v[236:239], v[212:215]
v_xor_b32 v4, 65696, v1
v_cvt_pk_bf16_f32 v241, v6, v7
s_waitcnt lgkmcnt(5)
v_mfma_f32_16x16x32_bf16 v[152:155], v[16:19], v[232:235], v[152:155]
ds_read_b64_tr_b16 v[12:13], v4
ds_read_b64_tr_b16 v[14:15], v4 offset:8192
v_mfma_f32_16x16x32_bf16 v[156:159], v[16:19], v[236:239], v[156:159]
v_exp_f32 v10, v10
v_exp_f32 v11, v11
v_lshlrev_b32 v6, 16, v242
v_and_b32 v7, s50, v242
v_pk_fma_f32 v[6:7], v[6:7], s[48:49], v[0:1] op_sel_hi:[1,0,0]
v_dot2c_f32_bf16 v9, s21, v241
v_xor_b32 v226, 64, v1
v_mfma_f32_16x16x32_bf16 v[216:219], v[20:23], v[232:235], v[216:219]
ds_read_b64_tr_b16 v[16:17], v4 offset:256
ds_read_b64_tr_b16 v[18:19], v4 offset:8448
v_mfma_f32_16x16x32_bf16 v[220:223], v[20:23], v[236:239], v[220:223]
v_xor_b32 v4, 65728, v1
v_cvt_pk_bf16_f32 v245, v10, v11
s_waitcnt lgkmcnt(4)
v_mfma_f32_16x16x32_bf16 v[160:163], v[24:27], v[232:235], v[160:163]
ds_read_b64_tr_b16 v[20:21], v4
ds_read_b64_tr_b16 v[22:23], v4 offset:8192
v_mfma_f32_16x16x32_bf16 v[164:167], v[24:27], v[236:239], v[164:167]
v_cmp_le_u32 vcc, 95, v8
v_exp_f32 v6, v6
v_exp_f32 v7, v7
v_lshlrev_b32 v10, 16, v246
v_and_b32 v11, s50, v246
v_pk_fma_f32 v[10:11], v[10:11], s[48:49], v[2:3] op_sel_hi:[1,0,0]
v_dot2c_f32_bf16 v5, s21, v245
v_mfma_f32_16x16x32_bf16 a[0:3], v[28:31], v[232:235], a[0:3]
ds_read_b64_tr_b16 v[24:25], v4 offset:256
ds_read_b64_tr_b16 v[26:27], v4 offset:8448
v_mfma_f32_16x16x32_bf16 a[4:7], v[28:31], v[236:239], a[4:7]
v_xor_b32 v4, 65760, v1
v_cvt_pk_bf16_f32 v242, v6, v7
s_waitcnt lgkmcnt(4)
v_mfma_f32_16x16x32_bf16 v[168:171], v[12:15], v[232:235], v[168:171]
ds_read_b64_tr_b16 v[28:29], v4
ds_read_b64_tr_b16 v[30:31], v4 offset:8192
v_mfma_f32_16x16x32_bf16 v[172:175], v[12:15], v[236:239], v[172:175]
s_cbranch_vccz L_sp86
L_ok86:
v_exp_f32 v10, v10
v_exp_f32 v11, v11
v_lshlrev_b32 v6, 16, v243
v_and_b32 v7, s50, v243
v_pk_fma_f32 v[6:7], v[6:7], s[48:49], v[0:1] op_sel_hi:[1,0,0]
v_dot2c_f32_bf16 v9, s21, v242
v_mfma_f32_16x16x32_bf16 a[8:11], v[16:19], v[232:235], a[8:11]
ds_read_b64_tr_b16 v[12:13], v4 offset:256
ds_read_b64_tr_b16 v[14:15], v4 offset:8448
v_mfma_f32_16x16x32_bf16 a[12:15], v[16:19], v[236:239], a[12:15]
v_xor_b32 v4, 98304, v1
v_cvt_pk_bf16_f32 v246, v10, v11
s_waitcnt lgkmcnt(4)
v_mfma_f32_16x16x32_bf16 v[176:179], v[20:23], v[232:235], v[176:179]
ds_read_b64_tr_b16 v[16:17], v4
ds_read_b64_tr_b16 v[18:19], v4 offset:8192
v_mfma_f32_16x16x32_bf16 v[180:183], v[20:23], v[236:239], v[180:183]
v_exp_f32 v6, v6
v_exp_f32 v7, v7
v_lshlrev_b32 v10, 16, v247
v_and_b32 v11, s50, v247
v_pk_fma_f32 v[10:11], v[10:11], s[48:49], v[2:3] op_sel_hi:[1,0,0]
v_dot2c_f32_bf16 v5, s21, v246
v_mfma_f32_16x16x32_bf16 a[16:19], v[24:27], v[232:235], a[16:19]
ds_read_b64_tr_b16 v[20:21], v4 offset:256
ds_read_b64_tr_b16 v[22:23], v4 offset:8448
v_mfma_f32_16x16x32_bf16 a[20:23], v[24:27], v[236:239], a[20:23]
v_xor_b32 v4, 98336, v1
v_cvt_pk_bf16_f32 v243, v6, v7
s_waitcnt lgkmcnt(4)
v_mfma_f32_16x16x32_bf16 v[184:187], v[28:31], v[232:235], v[184:187]
ds_read_b64_tr_b16 v[24:25], v4
ds_read_b64_tr_b16 v[26:27], v4 offset:8192
v_mfma_f32_16x16x32_bf16 v[188:191], v[28:31], v[236:239], v[188:191]
s_movk_i32 s12, 344
v_exp_f32 v10, v10
v_exp_f32 v11, v11
v_lshlrev_b32 v6, 16, v248
v_and_b32 v7, s50, v248
v_pk_fma_f32 v[6:7], v[6:7], s[48:49], v[0:1] op_sel_hi:[1,0,0]
v_dot2c_f32_bf16 v9, s21, v243
v_mfma_f32_16x16x32_bf16 a[24:27], v[12:15], v[232:235], a[24:27]
ds_read_b64_tr_b16 v[28:29], v4 offset:256
ds_read_b64_tr_b16 v[30:31], v4 offset:8448
v_mfma_f32_16x16x32_bf16 a[28:31], v[12:15], v[236:239], a[28:31]
v_xor_b32 v4, 98368, v1
v_cvt_pk_bf16_f32 v247, v10, v11
s_waitcnt lgkmcnt(4)
v_mfma_f32_16x16x32_bf16 v[128:131], v[16:19], v[240:243], v[128:131]
ds_read_b64_tr_b16 v[12:13], v4
ds_read_b64_tr_b16 v[14:15], v4 offset:8192
v_mfma_f32_16x16x32_bf16 v[132:135], v[16:19], v[244:247], v[132:135]
buffer_load_dword off, s[8:11], s12 lds
v_exp_f32 v6, v6
v_exp_f32 v7, v7
v_lshlrev_b32 v10, 16, v252
v_and_b32 v11, s50, v252
v_pk_fma_f32 v[10:11], v[10:11], s[48:49], v[2:3] op_sel_hi:[1,0,0]
v_dot2c_f32_bf16 v5, s21, v247
v_mfma_f32_16x16x32_bf16 v[192:195], v[20:23], v[240:243], v[192:195]
ds_read_b64_tr_b16 v[16:17], v4 offset:256
ds_read_b64_tr_b16 v[18:19], v4 offset:8448
v_mfma_f32_16x16x32_bf16 v[196:199], v[20:23], v[244:247], v[196:199]
v_xor_b32 v4, 98400, v1
v_cvt_pk_bf16_f32 v248, v6, v7
s_waitcnt lgkmcnt(4)
v_mfma_f32_16x16x32_bf16 v[136:139], v[24:27], v[240:243], v[136:139]
ds_read_b64_tr_b16 v[20:21], v4
ds_read_b64_tr_b16 v[22:23], v4 offset:8192
v_mfma_f32_16x16x32_bf16 v[140:143], v[24:27], v[244:247], v[140:143]
v_exp_f32 v10, v10
v_exp_f32 v11, v11
v_lshlrev_b32 v6, 16, v249
v_and_b32 v7, s50, v249
v_pk_fma_f32 v[6:7], v[6:7], s[48:49], v[0:1] op_sel_hi:[1,0,0]
v_dot2c_f32_bf16 v9, s21, v248
v_mfma_f32_16x16x32_bf16 v[200:203], v[28:31], v[240:243], v[200:203]
ds_read_b64_tr_b16 v[24:25], v4 offset:256
ds_read_b64_tr_b16 v[26:27], v4 offset:8448
v_mfma_f32_16x16x32_bf16 v[204:207], v[28:31], v[244:247], v[204:207]
v_xor_b32 v4, 98432, v1
v_cvt_pk_bf16_f32 v252, v10, v11
v_xor_b32 v232, 65536, v1
s_waitcnt lgkmcnt(4)
v_mfma_f32_16x16x32_bf16 v[144:147], v[12:15], v[240:243], v[144:147]
ds_read_b64_tr_b16 v[28:29], v4
ds_read_b64_tr_b16 v[30:31], v4 offset:8192
v_mfma_f32_16x16x32_bf16 v[148:151], v[12:15], v[244:247], v[148:151]
v_exp_f32 v6, v6
v_exp_f32 v7, v7
v_lshlrev_b32 v10, 16, v253
v_and_b32 v11, s50, v253
v_pk_fma_f32 v[10:11], v[10:11], s[48:49], v[2:3] op_sel_hi:[1,0,0]
v_dot2c_f32_bf16 v5, s21, v252
v_mfma_f32_16x16x32_bf16 v[208:211], v[16:19], v[240:243], v[208:211]
ds_read_b64_tr_b16 v[12:13], v4 offset:256
ds_read_b64_tr_b16 v[14:15], v4 offset:8448
v_mfma_f32_16x16x32_bf16 v[212:215], v[16:19], v[244:247], v[212:215]
v_xor_b32 v4, 98464, v1
v_cvt_pk_bf16_f32 v249, v6, v7
v_xor_b32 v227, 96, v1
s_waitcnt lgkmcnt(4)
v_mfma_f32_16x16x32_bf16 v[152:155], v[20:23], v[240:243], v[152:155]
ds_read_b64_tr_b16 v[16:17], v4
ds_read_b64_tr_b16 v[18:19], v4 offset:8192
v_mfma_f32_16x16x32_bf16 v[156:159], v[20:23], v[244:247], v[156:159]
v_exp_f32 v10, v10
v_exp_f32 v11, v11
v_lshlrev_b32 v6, 16, v250
v_and_b32 v7, s50, v250
v_pk_fma_f32 v[6:7], v[6:7], s[48:49], v[0:1] op_sel_hi:[1,0,0]
v_dot2c_f32_bf16 v9, s21, v249
v_mfma_f32_16x16x32_bf16 v[216:219], v[24:27], v[240:243], v[216:219]
ds_read_b64_tr_b16 v[20:21], v4 offset:256
ds_read_b64_tr_b16 v[22:23], v4 offset:8448
v_mfma_f32_16x16x32_bf16 v[220:223], v[24:27], v[244:247], v[220:223]
v_xor_b32 v4, 98496, v1
v_cvt_pk_bf16_f32 v253, v10, v11
s_waitcnt lgkmcnt(4)
v_mfma_f32_16x16x32_bf16 v[160:163], v[28:31], v[240:243], v[160:163]
ds_read_b64_tr_b16 v[24:25], v4
ds_read_b64_tr_b16 v[26:27], v4 offset:8192
v_mfma_f32_16x16x32_bf16 v[164:167], v[28:31], v[244:247], v[164:167]
v_exp_f32 v6, v6
v_exp_f32 v7, v7
v_lshlrev_b32 v10, 16, v254
v_and_b32 v11, s50, v254
v_pk_fma_f32 v[10:11], v[10:11], s[48:49], v[2:3] op_sel_hi:[1,0,0]
v_dot2c_f32_bf16 v5, s21, v253
v_xor_b32 v233, 65568, v1
v_mfma_f32_16x16x32_bf16 a[0:3], v[12:15], v[240:243], a[0:3]
ds_read_b64_tr_b16 v[28:29], v4 offset:256
ds_read_b64_tr_b16 v[30:31], v4 offset:8448
v_mfma_f32_16x16x32_bf16 a[4:7], v[12:15], v[244:247], a[4:7]
v_xor_b32 v4, 98528, v1
v_cvt_pk_bf16_f32 v250, v6, v7
s_waitcnt lgkmcnt(4)
v_mfma_f32_16x16x32_bf16 v[168:171], v[16:19], v[240:243], v[168:171]
ds_read_b64_tr_b16 v[12:13], v4
ds_read_b64_tr_b16 v[14:15], v4 offset:8192
v_mfma_f32_16x16x32_bf16 v[172:175], v[16:19], v[244:247], v[172:175]
v_exp_f32 v10, v10
v_exp_f32 v11, v11
v_lshlrev_b32 v6, 16, v251
v_and_b32 v7, s50, v251
v_pk_fma_f32 v[6:7], v[6:7], s[48:49], v[0:1] op_sel_hi:[1,0,0]
v_dot2c_f32_bf16 v9, s21, v250
v_mfma_f32_16x16x32_bf16 a[8:11], v[20:23], v[240:243], a[8:11]
ds_read_b64_tr_b16 v[16:17], v4 offset:256
ds_read_b64_tr_b16 v[18:19], v4 offset:8448
v_mfma_f32_16x16x32_bf16 a[12:15], v[20:23], v[244:247], a[12:15]
v_xor_b32 v4, 131072, v3
v_cvt_pk_bf16_f32 v254, v10, v11
s_waitcnt lgkmcnt(4)
v_mfma_f32_16x16x32_bf16 v[176:179], v[24:27], v[240:243], v[176:179]
ds_read_b64_tr_b16 v[20:21], v4
ds_read_b64_tr_b16 v[22:23], v4 offset:2048
v_mfma_f32_16x16x32_bf16 v[180:183], v[24:27], v[244:247], v[180:183]
v_exp_f32 v6, v6
v_mfma_f32_16x16x32_bf16 a[16:19], v[28:31], v[240:243], a[16:19]
ds_read_b64_tr_b16 v[24:25], v4 offset:4096
ds_read_b64_tr_b16 v[26:27], v4 offset:6144
v_mfma_f32_16x16x32_bf16 a[20:23], v[28:31], v[244:247], a[20:23]
v_exp_f32 v7, v7
v_xor_b32 v234, 65600, v1
s_waitcnt lgkmcnt(4)
v_mfma_f32_16x16x32_bf16 v[184:187], v[12:15], v[240:243], v[184:187]
ds_read_b64_tr_b16 v[28:29], v4 offset:8192
ds_read_b64_tr_b16 v[30:31], v4 offset:10240
v_mfma_f32_16x16x32_bf16 v[188:191], v[12:15], v[244:247], v[188:191]
s_movk_i32 s12, 348
v_xor_b32 v228, 128, v1
v_mfma_f32_16x16x32_bf16 a[24:27], v[16:19], v[240:243], a[24:27]
ds_read_b64_tr_b16 v[12:13], v4 offset:12288
ds_read_b64_tr_b16 v[14:15], v4 offset:14336
v_mfma_f32_16x16x32_bf16 a[28:31], v[16:19], v[244:247], a[28:31]
v_xor_b32 v4, 131104, v3
s_waitcnt lgkmcnt(4)
v_mfma_f32_16x16x32_bf16 a[32:35], v[20:23], a[64:67], 0
ds_read_b64_tr_b16 v[16:17], v4
v_lshlrev_b32 v10, 16, v255
v_mfma_f32_16x16x32_bf16 a[36:39], v[20:23], a[68:71], 0
ds_read_b64_tr_b16 v[18:19], v4 offset:2048
buffer_load_dword off, s[8:11], s12 lds
v_mfma_f32_16x16x32_bf16 a[36:39], v[24:27], a[76:79], a[36:39]
ds_read_b64_tr_b16 v[20:21], v4 offset:4096
v_and_b32 v11, s50, v255
v_mfma_f32_16x16x32_bf16 a[32:35], v[24:27], a[72:75], a[32:35]
ds_read_b64_tr_b16 v[22:23], v4 offset:6144
s_waitcnt lgkmcnt(4)
v_mfma_f32_16x16x32_bf16 a[32:35], v[28:31], a[80:83], a[32:35]
ds_read_b64_tr_b16 v[24:25], v4 offset:8192
v_mov_b32 v8, 0
v_mfma_f32_16x16x32_bf16 a[36:39], v[28:31], a[84:87], a[36:39]
ds_read_b64_tr_b16 v[26:27], v4 offset:10240
v_cvt_pk_bf16_f32 v251, v6, v7
v_xor_b32 v235, 65632, v1
v_xor_b32 v240, 131072, v1
v_mfma_f32_16x16x32_bf16 a[36:39], v[12:15], a[92:95], a[36:39]
ds_read_b64_tr_b16 v[28:29], v4 offset:12288
ds_read_b64_tr_b16 v[30:31], v4 offset:14336
v_mfma_f32_16x16x32_bf16 a[32:35], v[12:15], a[88:91], a[32:35]
v_xor_b32 v4, 131136, v3
s_waitcnt lgkmcnt(4)
v_mfma_f32_16x16x32_bf16 a[40:43], v[16:19], a[64:67], 0
ds_read_b64_tr_b16 v[12:13], v4
v_fma_f32 v10, v10, s48, v2
v_mfma_f32_16x16x32_bf16 a[44:47], v[16:19], a[68:71], 0
ds_read_b64_tr_b16 v[14:15], v4 offset:2048
v_xor_b32 v229, 160, v1
ds_read_b32 v8, v8 offset:14336
v_mfma_f32_16x16x32_bf16 a[44:47], v[20:23], a[76:79], a[44:47]
ds_read_b64_tr_b16 v[16:17], v4 offset:4096
v_fma_f32 v11, v11, s48, v2
v_mfma_f32_16x16x32_bf16 a[40:43], v[20:23], a[72:75], a[40:43]
ds_read_b64_tr_b16 v[18:19], v4 offset:6144
v_xor_b32 v241, 131104, v1
s_waitcnt lgkmcnt(5)
v_mfma_f32_16x16x32_bf16 a[40:43], v[24:27], a[80:83], a[40:43]
ds_read_b64_tr_b16 v[20:21], v4 offset:8192
v_exp_f32 v10, v10
v_mfma_f32_16x16x32_bf16 a[44:47], v[24:27], a[84:87], a[44:47]
ds_read_b64_tr_b16 v[22:23], v4 offset:10240
v_mfma_f32_16x16x32_bf16 a[44:47], v[28:31], a[92:95], a[44:47]
ds_read_b64_tr_b16 v[24:25], v4 offset:12288
ds_read_b64_tr_b16 v[26:27], v4 offset:14336
v_mfma_f32_16x16x32_bf16 a[40:43], v[28:31], a[88:91], a[40:43]
v_xor_b32 v4, 131168, v3
s_waitcnt lgkmcnt(4)
v_mfma_f32_16x16x32_bf16 a[48:51], v[12:15], a[64:67], 0
ds_read_b64_tr_b16 v[28:29], v4
v_cmp_le_u32 vcc, 96, v8
v_mfma_f32_16x16x32_bf16 a[52:55], v[12:15], a[68:71], 0
ds_read_b64_tr_b16 v[30:31], v4 offset:2048
v_exp_f32 v11, v11
v_xor_b32 v236, 65664, v1
v_xor_b32 v242, 131136, v1
v_mfma_f32_16x16x32_bf16 a[52:55], v[16:19], a[76:79], a[52:55]
ds_read_b64_tr_b16 v[12:13], v4 offset:4096
v_xor_b32 v230, 192, v1
v_mfma_f32_16x16x32_bf16 a[48:51], v[16:19], a[72:75], a[48:51]
ds_read_b64_tr_b16 v[14:15], v4 offset:6144
s_waitcnt lgkmcnt(4)
v_mfma_f32_16x16x32_bf16 a[48:51], v[20:23], a[80:83], a[48:51]
ds_read_b64_tr_b16 v[16:17], v4 offset:8192
v_lshlrev_b32 v6, 16, v32
v_mfma_f32_16x16x32_bf16 a[52:55], v[20:23], a[84:87], a[52:55]
ds_read_b64_tr_b16 v[18:19], v4 offset:10240
s_cbranch_vccz L_sp88
L_ok88:
v_mfma_f32_16x16x32_bf16 a[52:55], v[24:27], a[92:95], a[52:55]
ds_read_b64_tr_b16 v[20:21], v4 offset:12288
v_xor_b32 v243, 131168, v1
v_mfma_f32_16x16x32_bf16 a[48:51], v[24:27], a[88:91], a[48:51]
ds_read_b64_tr_b16 v[22:23], v4 offset:14336
v_xor_b32 v4, 49152, v1
s_waitcnt lgkmcnt(4)
v_mfma_f32_16x16x32_bf16 a[56:59], v[28:31], a[64:67], 0
ds_read_b64_tr_b16 v[24:25], v4
v_and_b32 v7, s50, v32
v_mfma_f32_16x16x32_bf16 a[60:63], v[28:31], a[68:71], 0
ds_read_b64_tr_b16 v[26:27], v4 offset:8192
v_cvt_pk_bf16_f32 v255, v10, v11
v_mfma_f32_16x16x32_bf16 a[60:63], v[12:15], a[76:79], a[60:63]
ds_read_b64_tr_b16 v[28:29], v4 offset:256
v_xor_b32 v237, 65696, v1
v_mfma_f32_16x16x32_bf16 a[56:59], v[12:15], a[72:75], a[56:59]
ds_read_b64_tr_b16 v[30:31], v4 offset:8448
v_xor_b32 v4, 49184, v1
s_waitcnt lgkmcnt(4)
v_mfma_f32_16x16x32_bf16 a[56:59], v[16:19], a[80:83], a[56:59]
ds_read_b64_tr_b16 v[12:13], v4
v_fma_f32 v6, v6, s48, v0
v_mfma_f32_16x16x32_bf16 a[60:63], v[16:19], a[84:87], a[60:63]
ds_read_b64_tr_b16 v[14:15], v4 offset:8192
v_fma_f32 v7, v7, s48, v0
v_mfma_f32_16x16x32_bf16 a[60:63], v[20:23], a[92:95], a[60:63]
ds_read_b64_tr_b16 v[16:17], v4 offset:256
v_xor_b32 v244, 131200, v1
v_mfma_f32_16x16x32_bf16 a[56:59], v[20:23], a[88:91], a[56:59]
ds_read_b64_tr_b16 v[18:19], v4 offset:8448
v_xor_b32 v4, 49216, v1
s_waitcnt lgkmcnt(4)
v_mfma_f32_16x16x32_bf16 v[128:131], v[24:27], v[248:251], v[128:131]
ds_read_b64_tr_b16 v[20:21], v4
ds_read_b64_tr_b16 v[22:23], v4 offset:8192
v_mfma_f32_16x16x32_bf16 v[132:135], v[24:27], v[252:255], v[132:135]
v_exp_f32 v6, v6
v_exp_f32 v7, v7
v_lshlrev_b32 v10, 16, v36
v_and_b32 v11, s50, v36
v_pk_fma_f32 v[10:11], v[10:11], s[48:49], v[2:3] op_sel_hi:[1,0,0]
v_dot2c_f32_bf16 v5, s21, v254
v_dot2c_f32_bf16 v9, s21, v251
v_dot2c_f32_bf16 v5, s21, v255
v_mfma_f32_16x16x32_bf16 v[192:195], v[28:31], v[248:251], v[192:195]
ds_read_b64_tr_b16 v[24:25], v4 offset:256
ds_read_b64_tr_b16 v[26:27], v4 offset:8448
v_mfma_f32_16x16x32_bf16 v[196:199], v[28:31], v[252:255], v[196:199]
v_xor_b32 v4, 49248, v1
v_cvt_pk_bf16_f32 v32, v6, v7
s_waitcnt lgkmcnt(4)
v_mfma_f32_16x16x32_bf16 v[136:139], v[12:15], v[248:251], v[136:139]
ds_read_b64_tr_b16 v[28:29], v4
ds_read_b64_tr_b16 v[30:31], v4 offset:8192
v_mfma_f32_16x16x32_bf16 v[140:143], v[12:15], v[252:255], v[140:143]
v_mov_b32 v8, 0
v_exp_f32 v10, v10
v_exp_f32 v11, v11
v_lshlrev_b32 v6, 16, v33
v_and_b32 v7, s50, v33
v_pk_fma_f32 v[6:7], v[6:7], s[48:49], v[0:1] op_sel_hi:[1,0,0]
v_dot2c_f32_bf16 v9, s21, v32
v_xor_b32 v231, 224, v1
v_xor_b32 v238, 65728, v1
v_xor_b32 v245, 131232, v1
v_mfma_f32_16x16x32_bf16 v[200:203], v[16:19], v[248:251], v[200:203]
ds_read_b64_tr_b16 v[12:13], v4 offset:256
ds_read_b64_tr_b16 v[14:15], v4 offset:8448
v_mfma_f32_16x16x32_bf16 v[204:207], v[16:19], v[252:255], v[204:207]
v_xor_b32 v4, 49280, v1
v_cvt_pk_bf16_f32 v36, v10, v11
s_waitcnt lgkmcnt(4)
v_mfma_f32_16x16x32_bf16 v[144:147], v[20:23], v[248:251], v[144:147]
ds_read_b64_tr_b16 v[16:17], v4
ds_read_b64_tr_b16 v[18:19], v4 offset:8192
v_mfma_f32_16x16x32_bf16 v[148:151], v[20:23], v[252:255], v[148:151]
ds_read_b32 v8, v8 offset:14336
v_exp_f32 v6, v6
v_exp_f32 v7, v7
v_lshlrev_b32 v10, 16, v37
v_and_b32 v11, s50, v37
v_pk_fma_f32 v[10:11], v[10:11], s[48:49], v[2:3] op_sel_hi:[1,0,0]
v_dot2c_f32_bf16 v5, s21, v36
v_mfma_f32_16x16x32_bf16 v[208:211], v[24:27], v[248:251], v[208:211]
ds_read_b64_tr_b16 v[20:21], v4 offset:256
ds_read_b64_tr_b16 v[22:23], v4 offset:8448
v_mfma_f32_16x16x32_bf16 v[212:215], v[24:27], v[252:255], v[212:215]
v_xor_b32 v4, 49312, v1
v_cvt_pk_bf16_f32 v33, v6, v7
v_xor_b32 v246, 131264, v1
s_waitcnt lgkmcnt(5)
v_mfma_f32_16x16x32_bf16 v[152:155], v[28:31], v[248:251], v[152:155]
s_branch L_pg17
L_sp89:
v_mov_b32 v8, 0
ds_read_b32 v8, v8 offset:14336
s_waitcnt lgkmcnt(0)
v_cmp_le_u32 vcc, 98, v8
s_cbranch_vccz L_sp89
s_branch L_ok89
L_sp91:
v_mov_b32 v8, 0
ds_read_b32 v8, v8 offset:14336
s_waitcnt lgkmcnt(0)
v_cmp_le_u32 vcc, 99, v8
s_cbranch_vccz L_sp91
s_branch L_ok91
L_sp92:
v_mov_b32 v8, 0
ds_read_b32 v8, v8 offset:14336
s_waitcnt lgkmcnt(0)
v_cmp_le_u32 vcc, 100, v8
s_cbranch_vccz L_sp92
s_branch L_ok92
L_sp93:
v_mov_b32 v8, 0
ds_read_b32 v8, v8 offset:14336
s_waitcnt lgkmcnt(0)
v_cmp_le_u32 vcc, 102, v8
s_cbranch_vccz L_sp93
s_branch L_ok93
.p2align 12
L_stub17:
s_setpc_b64 s[94:95]
L_pg17:
ds_read_b64_tr_b16 v[24:25], v4
ds_read_b64_tr_b16 v[26:27], v4 offset:8192
v_mfma_f32_16x16x32_bf16 v[156:159], v[28:31], v[252:255], v[156:159]
v_exp_f32 v10, v10
v_exp_f32 v11, v11
v_lshlrev_b32 v6, 16, v34
v_and_b32 v7, s50, v34
v_pk_fma_f32 v[6:7], v[6:7], s[48:49], v[0:1] op_sel_hi:[1,0,0]
v_dot2c_f32_bf16 v9, s21, v33
v_mfma_f32_16x16x32_bf16 v[216:219], v[12:15], v[248:251], v[216:219]
ds_read_b64_tr_b16 v[28:29], v4 offset:256
ds_read_b64_tr_b16 v[30:31], v4 offset:8448
v_mfma_f32_16x16x32_bf16 v[220:223], v[12:15], v[252:255], v[220:223]
v_xor_b32 v4, 49344, v1
v_cvt_pk_bf16_f32 v37, v10, v11
v_xor_b32 v239, 65760, v1
s_waitcnt lgkmcnt(4)
v_mfma_f32_16x16x32_bf16 v[160:163], v[16:19], v[248:251], v[160:163]
ds_read_b64_tr_b16 v[12:13], v4
ds_read_b64_tr_b16 v[14:15], v4 offset:8192
v_mfma_f32_16x16x32_bf16 v[164:167], v[16:19], v[252:255], v[164:167]
v_cmp_le_u32 vcc, 98, v8
v_exp_f32 v6, v6
v_exp_f32 v7, v7
v_lshlrev_b32 v10, 16, v38
v_and_b32 v11, s50, v38
v_pk_fma_f32 v[10:11], v[10:11], s[48:49], v[2:3] op_sel_hi:[1,0,0]
v_dot2c_f32_bf16 v5, s21, v37
v_xor_b32 v247, 131296, v1
v_mfma_f32_16x16x32_bf16 a[0:3], v[20:23], v[248:251], a[0:3]
ds_read_b64_tr_b16 v[16:17], v4 offset:256
ds_read_b64_tr_b16 v[18:19], v4 offset:8448
v_mfma_f32_16x16x32_bf16 a[4:7], v[20:23], v[252:255], a[4:7]
v_xor_b32 v4, 49376, v1
v_cvt_pk_bf16_f32 v34, v6, v7
s_waitcnt lgkmcnt(4)
v_mfma_f32_16x16x32_bf16 v[168:171], v[24:27], v[248:251], v[168:171]
ds_read_b64_tr_b16 v[20:21], v4
ds_read_b64_tr_b16 v[22:23], v4 offset:8192
v_mfma_f32_16x16x32_bf16 v[172:175], v[24:27], v[252:255], v[172:175]
s_cbranch_vccz L_sp89
L_ok89:
v_exp_f32 v10, v10
v_exp_f32 v11, v11
v_lshlrev_b32 v6, 16, v35
v_and_b32 v7, s50, v35
v_pk_fma_f32 v[6:7], v[6:7], s[48:49], v[0:1] op_sel_hi:[1,0,0]
v_dot2c_f32_bf16 v9, s21, v34
v_mfma_f32_16x16x32_bf16 a[8:11], v[28:31], v[248:251], a[8:11]
ds_read_b64_tr_b16 v[24:25], v4 offset:256
ds_read_b64_tr_b16 v[26:27], v4 offset:8448
v_mfma_f32_16x16x32_bf16 a[12:15], v[28:31], v[252:255], a[12:15]
v_cvt_pk_bf16_f32 v38, v10, v11
s_waitcnt lgkmcnt(4)
v_mfma_f32_16x16x32_bf16 v[176:179], v[12:15], v[248:251], v[176:179]
ds_read_b64_tr_b16 v[28:29], v240 offset:16384
ds_read_b64_tr_b16 v[30:31], v240 offset:24576
v_mfma_f32_16x16x32_bf16 v[180:183], v[12:15], v[252:255], v[180:183]
v_exp_f32 v6, v6
v_exp_f32 v7, v7
v_lshlrev_b32 v10, 16, v39
v_and_b32 v11, s50, v39
v_pk_fma_f32 v[10:11], v[10:11], s[48:49], v[2:3] op_sel_hi:[1,0,0]
v_dot2c_f32_bf16 v5, s21, v38
v_mfma_f32_16x16x32_bf16 a[16:19], v[16:19], v[248:251], a[16:19]
ds_read_b64_tr_b16 v[12:13], v240 offset:16640
ds_read_b64_tr_b16 v[14:15], v240 offset:24832
v_mfma_f32_16x16x32_bf16 a[20:23], v[16:19], v[252:255], a[20:23]
v_cvt_pk_bf16_f32 v35, v6, v7
s_waitcnt lgkmcnt(4)
v_mfma_f32_16x16x32_bf16 v[184:187], v[20:23], v[248:251], v[184:187]
ds_read_b64_tr_b16 v[16:17], v241 offset:16384
ds_read_b64_tr_b16 v[18:19], v241 offset:24576
v_mfma_f32_16x16x32_bf16 v[188:191], v[20:23], v[252:255], v[188:191]
s_movk_i32 s12, 356
v_exp_f32 v10, v10
v_exp_f32 v11, v11
v_lshlrev_b32 v6, 16, v40
v_and_b32 v7, s50, v40
v_pk_fma_f32 v[6:7], v[6:7], s[48:49], v[0:1] op_sel_hi:[1,0,0]
v_dot2c_f32_bf16 v9, s21, v35
v_mfma_f32_16x16x32_bf16 a[24:27], v[24:27], v[248:251], a[24:27]
ds_read_b64_tr_b16 v[20:21], v241 offset:16640
ds_read_b64_tr_b16 v[22:23], v241 offset:24832
v_mfma_f32_16x16x32_bf16 a[28:31], v[24:27], v[252:255], a[28:31]
v_cvt_pk_bf16_f32 v39, v10, v11
s_waitcnt lgkmcnt(4)
v_mfma_f32_16x16x32_bf16 v[128:131], v[28:31], v[32:35], v[128:131]
ds_read_b64_tr_b16 v[24:25], v242 offset:16384
ds_read_b64_tr_b16 v[26:27], v242 offset:24576
v_mfma_f32_16x16x32_bf16 v[132:135], v[28:31], v[36:39], v[132:135]
buffer_load_dword off, s[8:11], s12 lds
v_exp_f32 v6, v6
v_exp_f32 v7, v7
v_lshlrev_b32 v10, 16, v44
v_and_b32 v11, s50, v44
v_pk_fma_f32 v[10:11], v[10:11], s[48:49], v[2:3] op_sel_hi:[1,0,0]
v_dot2c_f32_bf16 v5, s21, v39
v_mfma_f32_16x16x32_bf16 v[192:195], v[12:15], v[32:35], v[192:195]
ds_read_b64_tr_b16 v[28:29], v242 offset:16640
ds_read_b64_tr_b16 v[30:31], v242 offset:24832
v_mfma_f32_16x16x32_bf16 v[196:199], v[12:15], v[36:39], v[196:199]
v_cvt_pk_bf16_f32 v40, v6, v7
s_waitcnt lgkmcnt(4)
v_mfma_f32_16x16x32_bf16 v[136:139], v[16:19], v[32:35], v[136:139]
ds_read_b64_tr_b16 v[12:13], v243 offset:16384
ds_read_b64_tr_b16 v[14:15], v243 offset:24576
v_mfma_f32_16x16x32_bf16 v[140:143], v[16:19], v[36:39], v[140:143]
v_exp_f32 v10, v10
v_exp_f32 v11, v11
v_lshlrev_b32 v6, 16, v41
v_and_b32 v7, s50, v41
v_pk_fma_f32 v[6:7], v[6:7], s[48:49], v[0:1] op_sel_hi:[1,0,0]
v_dot2c_f32_bf16 v9, s21, v40
v_mfma_f32_16x16x32_bf16 v[200:203], v[20:23], v[32:35], v[200:203]
ds_read_b64_tr_b16 v[16:17], v243 offset:16640
ds_read_b64_tr_b16 v[18:19], v243 offset:24832
v_mfma_f32_16x16x32_bf16 v[204:207], v[20:23], v[36:39], v[204:207]
v_cvt_pk_bf16_f32 v44, v10, v11
s_waitcnt lgkmcnt(4)
v_mfma_f32_16x16x32_bf16 v[144:147], v[24:27], v[32:35], v[144:147]
ds_read_b64_tr_b16 v[20:21], v244 offset:16384
ds_read_b64_tr_b16 v[22:23], v244 offset:24576
v_mfma_f32_16x16x32_bf16 v[148:151], v[24:27], v[36:39], v[148:151]
v_exp_f32 v6, v6
v_exp_f32 v7, v7
v_lshlrev_b32 v10, 16, v45
v_and_b32 v11, s50, v45
v_pk_fma_f32 v[10:11], v[10:11], s[48:49], v[2:3] op_sel_hi:[1,0,0]
v_dot2c_f32_bf16 v5, s21, v44
v_mfma_f32_16x16x32_bf16 v[208:211], v[28:31], v[32:35], v[208:211]
ds_read_b64_tr_b16 v[24:25], v244 offset:16640
ds_read_b64_tr_b16 v[26:27], v244 offset:24832
v_mfma_f32_16x16x32_bf16 v[212:215], v[28:31], v[36:39], v[212:215]
v_cvt_pk_bf16_f32 v41, v6, v7
s_waitcnt lgkmcnt(4)
v_mfma_f32_16x16x32_bf16 v[152:155], v[12:15], v[32:35], v[152:155]
ds_read_b64_tr_b16 v[28:29], v245 offset:16384
ds_read_b64_tr_b16 v[30:31], v245 offset:24576
v_mfma_f32_16x16x32_bf16 v[156:159], v[12:15], v[36:39], v[156:159]
v_exp_f32 v10, v10
v_exp_f32 v11, v11
v_lshlrev_b32 v6, 16, v42
v_and_b32 v7, s50, v42
v_pk_fma_f32 v[6:7], v[6:7], s[48:49], v[0:1] op_sel_hi:[1,0,0]
v_dot2c_f32_bf16 v9, s21, v41
v_mfma_f32_16x16x32_bf16 v[216:219], v[16:19], v[32:35], v[216:219]
ds_read_b64_tr_b16 v[12:13], v245 offset:16640
ds_read_b64_tr_b16 v[14:15], v245 offset:24832
v_mfma_f32_16x16x32_bf16 v[220:223], v[16:19], v[36:39], v[220:223]
v_cvt_pk_bf16_f32 v45, v10, v11
s_waitcnt lgkmcnt(4)
v_mfma_f32_16x16x32_bf16 v[160:163], v[20:23], v[32:35], v[160:163]
ds_read_b64_tr_b16 v[16:17], v246 offset:16384
ds_read_b64_tr_b16 v[18:19], v246 offset:24576
v_mfma_f32_16x16x32_bf16 v[164:167], v[20:23], v[36:39], v[164:167]
v_exp_f32 v6, v6
v_exp_f32 v7, v7
v_lshlrev_b32 v10, 16, v46
v_and_b32 v11, s50, v46
v_pk_fma_f32 v[10:11], v[10:11], s[48:49], v[2:3] op_sel_hi:[1,0,0]
v_dot2c_f32_bf16 v5, s21, v45
v_mfma_f32_16x16x32_bf16 a[0:3], v[24:27], v[32:35], a[0:3]
ds_read_b64_tr_b16 v[20:21], v246 offset:16640
ds_read_b64_tr_b16 v[22:23], v246 offset:24832
v_mfma_f32_16x16x32_bf16 a[4:7], v[24:27], v[36:39], a[4:7]
v_cvt_pk_bf16_f32 v42, v6, v7
s_waitcnt lgkmcnt(4)
v_mfma_f32_16x16x32_bf16 v[168:171], v[28:31], v[32:35], v[168:171]
ds_read_b64_tr_b16 v[24:25], v247 offset:16384
ds_read_b64_tr_b16 v[26:27], v247 offset:24576
v_mfma_f32_16x16x32_bf16 v[172:175], v[28:31], v[36:39], v[172:175]
v_exp_f32 v10, v10
v_exp_f32 v11, v11
v_lshlrev_b32 v6, 16, v43
v_and_b32 v7, s50, v43
v_pk_fma_f32 v[6:7], v[6:7], s[48:49], v[0:1] op_sel_hi:[1,0,0]
v_dot2c_f32_bf16 v9, s21, v42
v_mfma_f32_16x16x32_bf16 a[8:11], v[12:15], v[32:35], a[8:11]
ds_read_b64_tr_b16 v[28:29], v247 offset:16640
ds_read_b64_tr_b16 v[30:31], v247 offset:24832
v_mfma_f32_16x16x32_bf16 a[12:15], v[12:15], v[36:39], a[12:15]
v_xor_b32 v4, 81920, v3
v_cvt_pk_bf16_f32 v46, v10, v11
s_waitcnt lgkmcnt(4)
v_mfma_f32_16x16x32_bf16 v[176:179], v[16:19], v[32:35], v[176:179]
ds_read_b64_tr_b16 v[12:13], v4
ds_read_b64_tr_b16 v[14:15], v4 offset:2048
v_mfma_f32_16x16x32_bf16 v[180:183], v[16:19], v[36:39], v[180:183]
v_exp_f32 v6, v6
v_mfma_f32_16x16x32_bf16 a[16:19], v[20:23], v[32:35], a[16:19]
ds_read_b64_tr_b16 v[16:17], v4 offset:4096
ds_read_b64_tr_b16 v[18:19], v4 offset:6144
v_mfma_f32_16x16x32_bf16 a[20:23], v[20:23], v[36:39], a[20:23]
v_exp_f32 v7, v7
s_waitcnt lgkmcnt(4)
v_mfma_f32_16x16x32_bf16 v[184:187], v[24:27], v[32:35], v[184:187]
ds_read_b64_tr_b16 v[20:21], v4 offset:8192
ds_read_b64_tr_b16 v[22:23], v4 offset:10240
v_mfma_f32_16x16x32_bf16 v[188:191], v[24:27], v[36:39], v[188:191]
s_movk_i32 s12, 360
v_lshlrev_b32 v10, 16, v47
v_mfma_f32_16x16x32_bf16 a[24:27], v[28:31], v[32:35], a[24:27]
ds_read_b64_tr_b16 v[24:25], v4 offset:12288
ds_read_b64_tr_b16 v[26:27], v4 offset:14336
v_mfma_f32_16x16x32_bf16 a[28:31], v[28:31], v[36:39], a[28:31]
v_xor_b32 v4, 81952, v3
s_waitcnt lgkmcnt(4)
v_mfma_f32_16x16x32_bf16 a[32:35], v[12:15], a[96:99], a[32:35]
ds_read_b64_tr_b16 v[28:29], v4
ds_read_b64_tr_b16 v[30:31], v4 offset:2048
v_mfma_f32_16x16x32_bf16 a[36:39], v[12:15], a[100:103], a[36:39]
buffer_load_dword off, s[8:11], s12 lds
v_mfma_f32_16x16x32_bf16 a[36:39], v[16:19], a[108:111], a[36:39]
ds_read_b64_tr_b16 v[12:13], v4 offset:4096
v_and_b32 v11, s50, v47
v_mfma_f32_16x16x32_bf16 a[32:35], v[16:19], a[104:107], a[32:35]
ds_read_b64_tr_b16 v[14:15], v4 offset:6144
s_waitcnt lgkmcnt(4)
v_mfma_f32_16x16x32_bf16 a[32:35], v[20:23], a[112:115], a[32:35]
ds_read_b64_tr_b16 v[16:17], v4 offset:8192
v_mov_b32 v8, 0
v_mfma_f32_16x16x32_bf16 a[36:39], v[20:23], a[116:119], a[36:39]
ds_read_b64_tr_b16 v[18:19], v4 offset:10240
v_cvt_pk_bf16_f32 v43, v6, v7
v_mfma_f32_16x16x32_bf16 a[36:39], v[24:27], a[124:127], a[36:39]
ds_read_b64_tr_b16 v[20:21], v4 offset:12288
ds_read_b64_tr_b16 v[22:23], v4 offset:14336
v_mfma_f32_16x16x32_bf16 a[32:35], v[24:27], a[120:123], a[32:35]
v_xor_b32 v4, 81984, v3
s_waitcnt lgkmcnt(4)
v_mfma_f32_16x16x32_bf16 a[40:43], v[28:31], a[96:99], a[40:43]
ds_read_b64_tr_b16 v[24:25], v4
v_fma_f32 v10, v10, s48, v2
v_mfma_f32_16x16x32_bf16 a[44:47], v[28:31], a[100:103], a[44:47]
ds_read_b64_tr_b16 v[26:27], v4 offset:2048
ds_read_b32 v8, v8 offset:14336
v_mfma_f32_16x16x32_bf16 a[44:47], v[12:15], a[108:111], a[44:47]
ds_read_b64_tr_b16 v[28:29], v4 offset:4096
v_fma_f32 v11, v11, s48, v2
v_mfma_f32_16x16x32_bf16 a[40:43], v[12:15], a[104:107], a[40:43]
ds_read_b64_tr_b16 v[30:31], v4 offset:6144
s_waitcnt lgkmcnt(5)
v_mfma_f32_16x16x32_bf16 a[40:43], v[16:19], a[112:115], a[40:43]
ds_read_b64_tr_b16 v[12:13], v4 offset:8192
v_exp_f32 v10, v10
v_mfma_f32_16x16x32_bf16 a[44:47], v[16:19], a[116:119], a[44:47]
ds_read_b64_tr_b16 v[14:15], v4 offset:10240
v_mfma_f32_16x16x32_bf16 a[44:47], v[20:23], a[124:127], a[44:47]
ds_read_b64_tr_b16 v[16:17], v4 offset:12288
ds_read_b64_tr_b16 v[18:19], v4 offset:14336
v_mfma_f32_16x16x32_bf16 a[40:43], v[20:23], a[120:123], a[40:43]
v_xor_b32 v4, 82016, v3
s_waitcnt lgkmcnt(4)
v_mfma_f32_16x16x32_bf16 a[48:51], v[24:27], a[96:99], a[48:51]
ds_read_b64_tr_b16 v[20:21], v4
v_cmp_le_u32 vcc, 99, v8
v_mfma_f32_16x16x32_bf16 a[52:55], v[24:27], a[100:103], a[52:55]
ds_read_b64_tr_b16 v[22:23], v4 offset:2048
v_exp_f32 v11, v11
v_mfma_f32_16x16x32_bf16 a[52:55], v[28:31], a[108:111], a[52:55]
ds_read_b64_tr_b16 v[24:25], v4 offset:4096
v_lshlrev_b32 v6, 16, v48
v_mfma_f32_16x16x32_bf16 a[48:51], v[28:31], a[104:107], a[48:51]
ds_read_b64_tr_b16 v[26:27], v4 offset:6144
s_waitcnt lgkmcnt(4)
v_mfma_f32_16x16x32_bf16 a[48:51], v[12:15], a[112:115], a[48:51]
ds_read_b64_tr_b16 v[28:29], v4 offset:8192
ds_read_b64_tr_b16 v[30:31], v4 offset:10240
v_mfma_f32_16x16x32_bf16 a[52:55], v[12:15], a[116:119], a[52:55]
s_cbranch_vccz L_sp91
L_ok91:
v_mfma_f32_16x16x32_bf16 a[52:55], v[16:19], a[124:127], a[52:55]
ds_read_b64_tr_b16 v[12:13], v4 offset:12288
v_and_b32 v7, s50, v48
v_mfma_f32_16x16x32_bf16 a[48:51], v[16:19], a[120:123], a[48:51]
ds_read_b64_tr_b16 v[14:15], v4 offset:14336
s_waitcnt lgkmcnt(4)
v_mfma_f32_16x16x32_bf16 a[56:59], v[20:23], a[96:99], a[56:59]
ds_read_b64_tr_b16 v[16:17], v232 offset:49152
v_cvt_pk_bf16_f32 v47, v10, v11
v_mfma_f32_16x16x32_bf16 a[60:63], v[20:23], a[100:103], a[60:63]
ds_read_b64_tr_b16 v[18:19], v232 offset:57344
v_fma_f32 v6, v6, s48, v0
v_mfma_f32_16x16x32_bf16 a[60:63], v[24:27], a[108:111], a[60:63]
ds_read_b64_tr_b16 v[20:21], v232 offset:49408
v_fma_f32 v7, v7, s48, v0
v_mfma_f32_16x16x32_bf16 a[56:59], v[24:27], a[104:107], a[56:59]
ds_read_b64_tr_b16 v[22:23], v232 offset:57600
s_waitcnt lgkmcnt(4)
v_mfma_f32_16x16x32_bf16 a[56:59], v[28:31], a[112:115], a[56:59]
ds_read_b64_tr_b16 v[24:25], v233 offset:49152
v_mfma_f32_16x16x32_bf16 a[60:63], v[28:31], a[116:119], a[60:63]
ds_read_b64_tr_b16 v[26:27], v233 offset:57344
v_mfma_f32_16x16x32_bf16 a[60:63], v[12:15], a[124:127], a[60:63]
ds_read_b64_tr_b16 v[28:29], v233 offset:49408
v_mfma_f32_16x16x32_bf16 a[56:59], v[12:15], a[120:123], a[56:59]
ds_read_b64_tr_b16 v[30:31], v233 offset:57600
s_waitcnt lgkmcnt(4)
v_mfma_f32_16x16x32_bf16 v[128:131], v[16:19], v[40:43], v[128:131]
ds_read_b64_tr_b16 v[12:13], v234 offset:49152
ds_read_b64_tr_b16 v[14:15], v234 offset:57344
v_mfma_f32_16x16x32_bf16 v[132:135], v[16:19], v[44:47], v[132:135]
v_exp_f32 v6, v6
v_exp_f32 v7, v7
v_lshlrev_b32 v10, 16, v52
v_and_b32 v11, s50, v52
v_pk_fma_f32 v[10:11], v[10:11], s[48:49], v[2:3] op_sel_hi:[1,0,0]
v_dot2c_f32_bf16 v5, s21, v46
v_dot2c_f32_bf16 v9, s21, v43
v_dot2c_f32_bf16 v5, s21, v47
v_mfma_f32_16x16x32_bf16 v[192:195], v[20:23], v[40:43], v[192:195]
ds_read_b64_tr_b16 v[16:17], v234 offset:49408
ds_read_b64_tr_b16 v[18:19], v234 offset:57600
v_mfma_f32_16x16x32_bf16 v[196:199], v[20:23], v[44:47], v[196:199]
v_cvt_pk_bf16_f32 v48, v6, v7
s_waitcnt lgkmcnt(4)
v_mfma_f32_16x16x32_bf16 v[136:139], v[24:27], v[40:43], v[136:139]
ds_read_b64_tr_b16 v[20:21], v235 offset:49152
ds_read_b64_tr_b16 v[22:23], v235 offset:57344
v_mfma_f32_16x16x32_bf16 v[140:143], v[24:27], v[44:47], v[140:143]
v_mov_b32 v8, 0
v_exp_f32 v10, v10
v_exp_f32 v11, v11
v_lshlrev_b32 v6, 16, v49
v_and_b32 v7, s50, v49
v_pk_fma_f32 v[6:7], v[6:7], s[48:49], v[0:1] op_sel_hi:[1,0,0]
v_dot2c_f32_bf16 v9, s21, v48
v_mfma_f32_16x16x32_bf16 v[200:203], v[28:31], v[40:43], v[200:203]
ds_read_b64_tr_b16 v[24:25], v235 offset:49408
ds_read_b64_tr_b16 v[26:27], v235 offset:57600
v_mfma_f32_16x16x32_bf16 v[204:207], v[28:31], v[44:47], v[204:207]
v_cvt_pk_bf16_f32 v52, v10, v11
s_waitcnt lgkmcnt(4)
v_mfma_f32_16x16x32_bf16 v[144:147], v[12:15], v[40:43], v[144:147]
ds_read_b64_tr_b16 v[28:29], v236 offset:49152
ds_read_b64_tr_b16 v[30:31], v236 offset:57344
v_mfma_f32_16x16x32_bf16 v[148:151], v[12:15], v[44:47], v[148:151]
ds_read_b32 v8, v8 offset:14336
v_exp_f32 v6, v6
v_exp_f32 v7, v7
v_lshlrev_b32 v10, 16, v53
v_and_b32 v11, s50, v53
v_pk_fma_f32 v[10:11], v[10:11], s[48:49], v[2:3] op_sel_hi:[1,0,0]
v_dot2c_f32_bf16 v5, s21, v52
v_mfma_f32_16x16x32_bf16 v[208:211], v[16:19], v[40:43], v[208:211]
ds_read_b64_tr_b16 v[12:13], v236 offset:49408
ds_read_b64_tr_b16 v[14:15], v236 offset:57600
v_mfma_f32_16x16x32_bf16 v[212:215], v[16:19], v[44:47], v[212:215]
v_cvt_pk_bf16_f32 v49, v6, v7
s_waitcnt lgkmcnt(5)
v_mfma_f32_16x16x32_bf16 v[152:155], v[20:23], v[40:43], v[152:155]
ds_read_b64_tr_b16 v[16:17], v237 offset:49152
ds_read_b64_tr_b16 v[18:19], v237 offset:57344
v_mfma_f32_16x16x32_bf16 v[156:159], v[20:23], v[44:47], v[156:159]
v_exp_f32 v10, v10
v_exp_f32 v11, v11
v_lshlrev_b32 v6, 16, v50
v_and_b32 v7, s50, v50
v_pk_fma_f32 v[6:7], v[6:7], s[48:49], v[0:1] op_sel_hi:[1,0,0]
v_dot2c_f32_bf16 v9, s21, v49
v_mfma_f32_16x16x32_bf16 v[216:219], v[24:27], v[40:43], v[216:219]
ds_read_b64_tr_b16 v[20:21], v237 offset:49408
ds_read_b64_tr_b16 v[22:23], v237 offset:57600
v_mfma_f32_16x16x32_bf16 v[220:223], v[24:27], v[44:47], v[220:223]
v_cvt_pk_bf16_f32 v53, v10, v11
s_waitcnt lgkmcnt(4)
v_mfma_f32_16x16x32_bf16 v[160:163], v[28:31], v[40:43], v[160:163]
ds_read_b64_tr_b16 v[24:25], v238 offset:49152
ds_read_b64_tr_b16 v[26:27], v238 offset:57344
v_mfma_f32_16x16x32_bf16 v[164:167], v[28:31], v[44:47], v[164:167]
v_cmp_le_u32 vcc, 100, v8
v_exp_f32 v6, v6
v_exp_f32 v7, v7
v_lshlrev_b32 v10, 16, v54
v_and_b32 v11, s50, v54
v_pk_fma_f32 v[10:11], v[10:11], s[48:49], v[2:3] op_sel_hi:[1,0,0]
v_dot2c_f32_bf16 v5, s21, v53
v_mfma_f32_16x16x32_bf16 a[0:3], v[12:15], v[40:43], a[0:3]
ds_read_b64_tr_b16 v[28:29], v238 offset:49408
ds_read_b64_tr_b16 v[30:31], v238 offset:57600
v_mfma_f32_16x16x32_bf16 a[4:7], v[12:15], v[44:47], a[4:7]
v_cvt_pk_bf16_f32 v50, v6, v7
s_waitcnt lgkmcnt(4)
v_mfma_f32_16x16x32_bf16 v[168:171], v[16:19], v[40:43], v[168:171]
ds_read_b64_tr_b16 v[12:13], v239 offset:49152
ds_read_b64_tr_b16 v[14:15], v239 offset:57344
v_mfma_f32_16x16x32_bf16 v[172:175], v[16:19], v[44:47], v[172:175]
s_cbranch_vccz L_sp92
L_ok92:
v_exp_f32 v10, v10
v_exp_f32 v11, v11
v_lshlrev_b32 v6, 16, v51
v_and_b32 v7, s50, v51
v_pk_fma_f32 v[6:7], v[6:7], s[48:49], v[0:1] op_sel_hi:[1,0,0]
v_dot2c_f32_bf16 v9, s21, v50
v_mfma_f32_16x16x32_bf16 a[8:11], v[20:23], v[40:43], a[8:11]
ds_read_b64_tr_b16 v[16:17], v239 offset:49408
ds_read_b64_tr_b16 v[18:19], v239 offset:57600
v_mfma_f32_16x16x32_bf16 a[12:15], v[20:23], v[44:47], a[12:15]
v_cvt_pk_bf16_f32 v54, v10, v11
s_waitcnt lgkmcnt(4)
v_mfma_f32_16x16x32_bf16 v[176:179], v[24:27], v[40:43], v[176:179]
ds_read_b64_tr_b16 v[20:21], v224 offset:32768
ds_read_b64_tr_b16 v[22:23], v224 offset:40960
v_mfma_f32_16x16x32_bf16 v[180:183], v[24:27], v[44:47], v[180:183]
v_exp_f32 v6, v6
v_exp_f32 v7, v7
v_lshlrev_b32 v10, 16, v55
v_and_b32 v11, s50, v55
v_pk_fma_f32 v[10:11], v[10:11], s[48:49], v[2:3] op_sel_hi:[1,0,0]
v_dot2c_f32_bf16 v5, s21, v54
v_mfma_f32_16x16x32_bf16 a[16:19], v[28:31], v[40:43], a[16:19]
ds_read_b64_tr_b16 v[24:25], v224 offset:33024
ds_read_b64_tr_b16 v[26:27], v224 offset:41216
v_mfma_f32_16x16x32_bf16 a[20:23], v[28:31], v[44:47], a[20:23]
v_cvt_pk_bf16_f32 v51, v6, v7
s_waitcnt lgkmcnt(4)
v_mfma_f32_16x16x32_bf16 v[184:187], v[12:15], v[40:43], v[184:187]
ds_read_b64_tr_b16 v[28:29], v225 offset:32768
ds_read_b64_tr_b16 v[30:31], v225 offset:40960
v_mfma_f32_16x16x32_bf16 v[188:191], v[12:15], v[44:47], v[188:191]
s_movk_i32 s12, 368
v_exp_f32 v10, v10
v_exp_f32 v11, v11
v_lshlrev_b32 v6, 16, v56
v_and_b32 v7, s50, v56
v_pk_fma_f32 v[6:7], v[6:7], s[48:49], v[0:1] op_sel_hi:[1,0,0]
v_dot2c_f32_bf16 v9, s21, v51
v_mfma_f32_16x16x32_bf16 a[24:27], v[16:19], v[40:43], a[24:27]
ds_read_b64_tr_b16 v[12:13], v225 offset:33024
ds_read_b64_tr_b16 v[14:15], v225 offset:41216
v_mfma_f32_16x16x32_bf16 a[28:31], v[16:19], v[44:47], a[28:31]
v_cvt_pk_bf16_f32 v55, v10, v11
s_waitcnt lgkmcnt(4)
v_mfma_f32_16x16x32_bf16 v[128:131], v[20:23], v[48:51], v[128:131]
ds_read_b64_tr_b16 v[16:17], v226 offset:32768
ds_read_b64_tr_b16 v[18:19], v226 offset:40960
v_mfma_f32_16x16x32_bf16 v[132:135], v[20:23], v[52:55], v[132:135]
buffer_load_dword off, s[8:11], s12 lds
v_exp_f32 v6, v6
v_exp_f32 v7, v7
v_lshlrev_b32 v10, 16, v60
v_and_b32 v11, s50, v60
v_pk_fma_f32 v[10:11], v[10:11], s[48:49], v[2:3] op_sel_hi:[1,0,0]
v_dot2c_f32_bf16 v5, s21, v55
v_mfma_f32_16x16x32_bf16 v[192:195], v[24:27], v[48:51], v[192:195]
ds_read_b64_tr_b16 v[20:21], v226 offset:33024
ds_read_b64_tr_b16 v[22:23], v226 offset:41216
v_mfma_f32_16x16x32_bf16 v[196:199], v[24:27], v[52:55], v[196:199]
v_cvt_pk_bf16_f32 v56, v6, v7
s_waitcnt lgkmcnt(4)
v_mfma_f32_16x16x32_bf16 v[136:139], v[28:31], v[48:51], v[136:139]
ds_read_b64_tr_b16 v[24:25], v227 offset:32768
ds_read_b64_tr_b16 v[26:27], v227 offset:40960
v_mfma_f32_16x16x32_bf16 v[140:143], v[28:31], v[52:55], v[140:143]
v_mov_b32 v8, 0
v_exp_f32 v10, v10
v_exp_f32 v11, v11
v_lshlrev_b32 v6, 16, v57
v_and_b32 v7, s50, v57
v_pk_fma_f32 v[6:7], v[6:7], s[48:49], v[0:1] op_sel_hi:[1,0,0]
v_dot2c_f32_bf16 v9, s21, v56
v_mfma_f32_16x16x32_bf16 v[200:203], v[12:15], v[48:51], v[200:203]
ds_read_b64_tr_b16 v[28:29], v227 offset:33024
ds_read_b64_tr_b16 v[30:31], v227 offset:41216
v_mfma_f32_16x16x32_bf16 v[204:207], v[12:15], v[52:55], v[204:207]
v_cvt_pk_bf16_f32 v60, v10, v11
s_waitcnt lgkmcnt(4)
v_mfma_f32_16x16x32_bf16 v[144:147], v[16:19], v[48:51], v[144:147]
ds_read_b64_tr_b16 v[12:13], v228 offset:32768
ds_read_b64_tr_b16 v[14:15], v228 offset:40960
v_mfma_f32_16x16x32_bf16 v[148:151], v[16:19], v[52:55], v[148:151]
ds_read_b32 v8, v8 offset:14336
v_exp_f32 v6, v6
v_exp_f32 v7, v7
v_lshlrev_b32 v10, 16, v61
v_and_b32 v11, s50, v61
v_pk_fma_f32 v[10:11], v[10:11], s[48:49], v[2:3] op_sel_hi:[1,0,0]
v_dot2c_f32_bf16 v5, s21, v60
v_mfma_f32_16x16x32_bf16 v[208:211], v[20:23], v[48:51], v[208:211]
ds_read_b64_tr_b16 v[16:17], v228 offset:33024
ds_read_b64_tr_b16 v[18:19], v228 offset:41216
v_mfma_f32_16x16x32_bf16 v[212:215], v[20:23], v[52:55], v[212:215]
v_cvt_pk_bf16_f32 v57, v6, v7
s_waitcnt lgkmcnt(5)
v_mfma_f32_16x16x32_bf16 v[152:155], v[24:27], v[48:51], v[152:155]
ds_read_b64_tr_b16 v[20:21], v229 offset:32768
ds_read_b64_tr_b16 v[22:23], v229 offset:40960
v_mfma_f32_16x16x32_bf16 v[156:159], v[24:27], v[52:55], v[156:159]
v_exp_f32 v10, v10
v_exp_f32 v11, v11
v_lshlrev_b32 v6, 16, v58
v_and_b32 v7, s50, v58
v_pk_fma_f32 v[6:7], v[6:7], s[48:49], v[0:1] op_sel_hi:[1,0,0]
v_dot2c_f32_bf16 v9, s21, v57
v_mfma_f32_16x16x32_bf16 v[216:219], v[28:31], v[48:51], v[216:219]
ds_read_b64_tr_b16 v[24:25], v229 offset:33024
ds_read_b64_tr_b16 v[26:27], v229 offset:41216
v_mfma_f32_16x16x32_bf16 v[220:223], v[28:31], v[52:55], v[220:223]
v_cvt_pk_bf16_f32 v61, v10, v11
s_waitcnt lgkmcnt(4)
v_mfma_f32_16x16x32_bf16 v[160:163], v[12:15], v[48:51], v[160:163]
ds_read_b64_tr_b16 v[28:29], v230 offset:32768
ds_read_b64_tr_b16 v[30:31], v230 offset:40960
v_mfma_f32_16x16x32_bf16 v[164:167], v[12:15], v[52:55], v[164:167]
v_cmp_le_u32 vcc, 102, v8
v_exp_f32 v6, v6
v_exp_f32 v7, v7
v_lshlrev_b32 v10, 16, v62
v_and_b32 v11, s50, v62
v_pk_fma_f32 v[10:11], v[10:11], s[48:49], v[2:3] op_sel_hi:[1,0,0]
v_dot2c_f32_bf16 v5, s21, v61
v_mfma_f32_16x16x32_bf16 a[0:3], v[16:19], v[48:51], a[0:3]
ds_read_b64_tr_b16 v[12:13], v230 offset:33024
ds_read_b64_tr_b16 v[14:15], v230 offset:41216
v_mfma_f32_16x16x32_bf16 a[4:7], v[16:19], v[52:55], a[4:7]
v_cvt_pk_bf16_f32 v58, v6, v7
s_waitcnt lgkmcnt(4)
v_mfma_f32_16x16x32_bf16 v[168:171], v[20:23], v[48:51], v[168:171]
ds_read_b64_tr_b16 v[16:17], v231 offset:32768
ds_read_b64_tr_b16 v[18:19], v231 offset:40960
v_mfma_f32_16x16x32_bf16 v[172:175], v[20:23], v[52:55], v[172:175]
s_cbranch_vccz L_sp93
L_ok93:
v_exp_f32 v10, v10
v_exp_f32 v11, v11
v_lshlrev_b32 v6, 16, v59
v_and_b32 v7, s50, v59
v_pk_fma_f32 v[6:7], v[6:7], s[48:49], v[0:1] op_sel_hi:[1,0,0]
v_dot2c_f32_bf16 v9, s21, v58
v_mfma_f32_16x16x32_bf16 a[8:11], v[24:27], v[48:51], a[8:11]
ds_read_b64_tr_b16 v[20:21], v231 offset:33024
ds_read_b64_tr_b16 v[22:23], v231 offset:41216
v_mfma_f32_16x16x32_bf16 a[12:15], v[24:27], v[52:55], a[12:15]
v_cvt_pk_bf16_f32 v62, v10, v11
s_waitcnt lgkmcnt(4)
v_mfma_f32_16x16x32_bf16 v[176:179], v[28:31], v[48:51], v[176:179]
ds_read_b64_tr_b16 v[24:25], v232
ds_read_b64_tr_b16 v[26:27], v232 offset:8192
v_mfma_f32_16x16x32_bf16 v[180:183], v[28:31], v[52:55], v[180:183]
v_exp_f32 v6, v6
v_exp_f32 v7, v7
v_lshlrev_b32 v10, 16, v63
v_and_b32 v11, s50, v63
v_pk_fma_f32 v[10:11], v[10:11], s[48:49], v[2:3] op_sel_hi:[1,0,0]
v_dot2c_f32_bf16 v5, s21, v62
v_mfma_f32_16x16x32_bf16 a[16:19], v[12:15], v[48:51], a[16:19]
ds_read_b64_tr_b16 v[28:29], v232 offset:256
ds_read_b64_tr_b16 v[30:31], v232 offset:8448
v_mfma_f32_16x16x32_bf16 a[20:23], v[12:15], v[52:55], a[20:23]
v_cvt_pk_bf16_f32 v59, v6, v7
s_waitcnt lgkmcnt(4)
v_mfma_f32_16x16x32_bf16 v[184:187], v[16:19], v[48:51], v[184:187]
ds_read_b64_tr_b16 v[12:13], v233
ds_read_b64_tr_b16 v[14:15], v233 offset:8192
v_mfma_f32_16x16x32_bf16 v[188:191], v[16:19], v[52:55], v[188:191]
v_exp_f32 v10, v10
v_exp_f32 v11, v11
v_lshlrev_b32 v6, 16, v64
v_and_b32 v7, s50, v64
v_pk_fma_f32 v[6:7], v[6:7], s[48:49], v[0:1] op_sel_hi:[1,0,0]
v_dot2c_f32_bf16 v9, s21, v59
v_mfma_f32_16x16x32_bf16 a[24:27], v[20:23], v[48:51], a[24:27]
ds_read_b64_tr_b16 v[16:17], v233 offset:256
ds_read_b64_tr_b16 v[18:19], v233 offset:8448
v_mfma_f32_16x16x32_bf16 a[28:31], v[20:23], v[52:55], a[28:31]
v_cvt_pk_bf16_f32 v63, v10, v11
s_waitcnt lgkmcnt(4)
v_mfma_f32_16x16x32_bf16 v[128:131], v[24:27], v[56:59], v[128:131]
ds_read_b64_tr_b16 v[20:21], v234
ds_read_b64_tr_b16 v[22:23], v234 offset:8192
v_mfma_f32_16x16x32_bf16 v[132:135], v[24:27], v[60:63], v[132:135]
v_exp_f32 v6, v6
v_exp_f32 v7, v7
v_lshlrev_b32 v10, 16, v68
v_and_b32 v11, s50, v68
v_pk_fma_f32 v[10:11], v[10:11], s[48:49], v[2:3] op_sel_hi:[1,0,0]
v_dot2c_f32_bf16 v5, s21, v63
v_mfma_f32_16x16x32_bf16 v[192:195], v[28:31], v[56:59], v[192:195]
s_branch L_pg18
L_sp95:
v_mov_b32 v8, 0
ds_read_b32 v8, v8 offset:14336
s_waitcnt lgkmcnt(0)
v_cmp_le_u32 vcc, 103, v8
s_cbranch_vccz L_sp95
s_branch L_ok95
L_sp96:
v_mov_b32 v8, 0
ds_read_b32 v8, v8 offset:14336
s_waitcnt lgkmcnt(0)
v_cmp_le_u32 vcc, 105, v8
s_cbranch_vccz L_sp96
s_branch L_ok96
L_sp98:
v_mov_b32 v8, 0
ds_read_b32 v8, v8 offset:14336
s_waitcnt lgkmcnt(0)
v_cmp_le_u32 vcc, 106, v8
s_cbranch_vccz L_sp98
s_branch L_ok98
.p2align 12
L_stub18:
s_setpc_b64 s[94:95]
L_pg18:
ds_read_b64_tr_b16 v[24:25], v234 offset:256
ds_read_b64_tr_b16 v[26:27], v234 offset:8448
v_mfma_f32_16x16x32_bf16 v[196:199], v[28:31], v[60:63], v[196:199]
v_cvt_pk_bf16_f32 v64, v6, v7
s_waitcnt lgkmcnt(4)
v_mfma_f32_16x16x32_bf16 v[136:139], v[12:15], v[56:59], v[136:139]
ds_read_b64_tr_b16 v[28:29], v235
ds_read_b64_tr_b16 v[30:31], v235 offset:8192
v_mfma_f32_16x16x32_bf16 v[140:143], v[12:15], v[60:63], v[140:143]
v_exp_f32 v10, v10
v_exp_f32 v11, v11
v_lshlrev_b32 v6, 16, v65
v_and_b32 v7, s50, v65
v_pk_fma_f32 v[6:7], v[6:7], s[48:49], v[0:1] op_sel_hi:[1,0,0]
v_dot2c_f32_bf16 v9, s21, v64
v_mfma_f32_16x16x32_bf16 v[200:203], v[16:19], v[56:59], v[200:203]
ds_read_b64_tr_b16 v[12:13], v235 offset:256
ds_read_b64_tr_b16 v[14:15], v235 offset:8448
v_mfma_f32_16x16x32_bf16 v[204:207], v[16:19], v[60:63], v[204:207]
v_cvt_pk_bf16_f32 v68, v10, v11
s_waitcnt lgkmcnt(4)
v_mfma_f32_16x16x32_bf16 v[144:147], v[20:23], v[56:59], v[144:147]
ds_read_b64_tr_b16 v[16:17], v236
ds_read_b64_tr_b16 v[18:19], v236 offset:8192
v_mfma_f32_16x16x32_bf16 v[148:151], v[20:23], v[60:63], v[148:151]
v_exp_f32 v6, v6
v_exp_f32 v7, v7
v_lshlrev_b32 v10, 16, v69
v_and_b32 v11, s50, v69
v_pk_fma_f32 v[10:11], v[10:11], s[48:49], v[2:3] op_sel_hi:[1,0,0]
v_dot2c_f32_bf16 v5, s21, v68
v_mfma_f32_16x16x32_bf16 v[208:211], v[24:27], v[56:59], v[208:211]
ds_read_b64_tr_b16 v[20:21], v236 offset:256
ds_read_b64_tr_b16 v[22:23], v236 offset:8448
v_mfma_f32_16x16x32_bf16 v[212:215], v[24:27], v[60:63], v[212:215]
v_cvt_pk_bf16_f32 v65, v6, v7
s_waitcnt lgkmcnt(4)
v_mfma_f32_16x16x32_bf16 v[152:155], v[28:31], v[56:59], v[152:155]
ds_read_b64_tr_b16 v[24:25], v237
ds_read_b64_tr_b16 v[26:27], v237 offset:8192
v_mfma_f32_16x16x32_bf16 v[156:159], v[28:31], v[60:63], v[156:159]
v_exp_f32 v10, v10
v_exp_f32 v11, v11
v_lshlrev_b32 v6, 16, v66
v_and_b32 v7, s50, v66
v_pk_fma_f32 v[6:7], v[6:7], s[48:49], v[0:1] op_sel_hi:[1,0,0]
v_dot2c_f32_bf16 v9, s21, v65
v_mfma_f32_16x16x32_bf16 v[216:219], v[12:15], v[56:59], v[216:219]
ds_read_b64_tr_b16 v[28:29], v237 offset:256
ds_read_b64_tr_b16 v[30:31], v237 offset:8448
v_mfma_f32_16x16x32_bf16 v[220:223], v[12:15], v[60:63], v[220:223]
v_cvt_pk_bf16_f32 v69, v10, v11
s_waitcnt lgkmcnt(4)
v_mfma_f32_16x16x32_bf16 v[160:163], v[16:19], v[56:59], v[160:163]
ds_read_b64_tr_b16 v[12:13], v238
ds_read_b64_tr_b16 v[14:15], v238 offset:8192
v_mfma_f32_16x16x32_bf16 v[164:167], v[16:19], v[60:63], v[164:167]
v_exp_f32 v6, v6
v_exp_f32 v7, v7
v_lshlrev_b32 v10, 16, v70
v_and_b32 v11, s50, v70
v_pk_fma_f32 v[10:11], v[10:11], s[48:49], v[2:3] op_sel_hi:[1,0,0]
v_dot2c_f32_bf16 v5, s21, v69
v_mfma_f32_16x16x32_bf16 a[0:3], v[20:23], v[56:59], a[0:3]
ds_read_b64_tr_b16 v[16:17], v238 offset:256
ds_read_b64_tr_b16 v[18:19], v238 offset:8448
v_mfma_f32_16x16x32_bf16 a[4:7], v[20:23], v[60:63], a[4:7]
v_cvt_pk_bf16_f32 v66, v6, v7
s_waitcnt lgkmcnt(4)
v_mfma_f32_16x16x32_bf16 v[168:171], v[24:27], v[56:59], v[168:171]
ds_read_b64_tr_b16 v[20:21], v239
ds_read_b64_tr_b16 v[22:23], v239 offset:8192
v_mfma_f32_16x16x32_bf16 v[172:175], v[24:27], v[60:63], v[172:175]
v_exp_f32 v10, v10
v_exp_f32 v11, v11
v_lshlrev_b32 v6, 16, v67
v_and_b32 v7, s50, v67
v_pk_fma_f32 v[6:7], v[6:7], s[48:49], v[0:1] op_sel_hi:[1,0,0]
v_dot2c_f32_bf16 v9, s21, v66
v_mfma_f32_16x16x32_bf16 a[8:11], v[28:31], v[56:59], a[8:11]
ds_read_b64_tr_b16 v[24:25], v239 offset:256
ds_read_b64_tr_b16 v[26:27], v239 offset:8448
v_mfma_f32_16x16x32_bf16 a[12:15], v[28:31], v[60:63], a[12:15]
v_xor_b32 v4, 16384, v3
v_cvt_pk_bf16_f32 v70, v10, v11
s_waitcnt lgkmcnt(4)
v_mfma_f32_16x16x32_bf16 v[176:179], v[12:15], v[56:59], v[176:179]
ds_read_b64_tr_b16 v[28:29], v4
ds_read_b64_tr_b16 v[30:31], v4 offset:2048
v_mfma_f32_16x16x32_bf16 v[180:183], v[12:15], v[60:63], v[180:183]
v_exp_f32 v6, v6
v_mfma_f32_16x16x32_bf16 a[16:19], v[16:19], v[56:59], a[16:19]
ds_read_b64_tr_b16 v[12:13], v4 offset:4096
ds_read_b64_tr_b16 v[14:15], v4 offset:6144
v_mfma_f32_16x16x32_bf16 a[20:23], v[16:19], v[60:63], a[20:23]
v_exp_f32 v7, v7
s_waitcnt lgkmcnt(4)
v_mfma_f32_16x16x32_bf16 v[184:187], v[20:23], v[56:59], v[184:187]
ds_read_b64_tr_b16 v[16:17], v4 offset:8192
ds_read_b64_tr_b16 v[18:19], v4 offset:10240
v_mfma_f32_16x16x32_bf16 v[188:191], v[20:23], v[60:63], v[188:191]
s_movk_i32 s12, 376
v_lshlrev_b32 v10, 16, v71
v_mfma_f32_16x16x32_bf16 a[24:27], v[24:27], v[56:59], a[24:27]
ds_read_b64_tr_b16 v[20:21], v4 offset:12288
ds_read_b64_tr_b16 v[22:23], v4 offset:14336
v_mfma_f32_16x16x32_bf16 a[28:31], v[24:27], v[60:63], a[28:31]
v_xor_b32 v4, 16416, v3
s_waitcnt lgkmcnt(4)
v_mfma_f32_16x16x32_bf16 v[248:251], v[28:31], a[64:67], 0
ds_read_b64_tr_b16 v[24:25], v4
ds_read_b64_tr_b16 v[26:27], v4 offset:2048
v_mfma_f32_16x16x32_bf16 v[252:255], v[28:31], a[68:71], 0
buffer_load_dword off, s[8:11], s12 lds
v_mfma_f32_16x16x32_bf16 v[252:255], v[12:15], a[76:79], v[252:255]
ds_read_b64_tr_b16 v[28:29], v4 offset:4096
v_and_b32 v11, s50, v71
v_mfma_f32_16x16x32_bf16 v[248:251], v[12:15], a[72:75], v[248:251]
ds_read_b64_tr_b16 v[30:31], v4 offset:6144
s_waitcnt lgkmcnt(4)
v_mfma_f32_16x16x32_bf16 v[248:251], v[16:19], a[80:83], v[248:251]
ds_read_b64_tr_b16 v[12:13], v4 offset:8192
v_mov_b32 v8, 0
v_mfma_f32_16x16x32_bf16 v[252:255], v[16:19], a[84:87], v[252:255]
ds_read_b64_tr_b16 v[14:15], v4 offset:10240
v_cvt_pk_bf16_f32 v67, v6, v7
v_mfma_f32_16x16x32_bf16 v[252:255], v[20:23], a[92:95], v[252:255]
ds_read_b64_tr_b16 v[16:17], v4 offset:12288
ds_read_b64_tr_b16 v[18:19], v4 offset:14336
v_mfma_f32_16x16x32_bf16 v[248:251], v[20:23], a[88:91], v[248:251]
v_xor_b32 v4, 16448, v3
s_waitcnt lgkmcnt(4)
v_mfma_f32_16x16x32_bf16 v[32:35], v[24:27], a[64:67], 0
ds_read_b64_tr_b16 v[20:21], v4
v_fma_f32 v10, v10, s48, v2
v_mfma_f32_16x16x32_bf16 v[36:39], v[24:27], a[68:71], 0
ds_read_b64_tr_b16 v[22:23], v4 offset:2048
ds_read_b32 v8, v8 offset:14336
v_mfma_f32_16x16x32_bf16 v[36:39], v[28:31], a[76:79], v[36:39]
ds_read_b64_tr_b16 v[24:25], v4 offset:4096
v_fma_f32 v11, v11, s48, v2
v_mfma_f32_16x16x32_bf16 v[32:35], v[28:31], a[72:75], v[32:35]
ds_read_b64_tr_b16 v[26:27], v4 offset:6144
s_waitcnt lgkmcnt(5)
v_mfma_f32_16x16x32_bf16 v[32:35], v[12:15], a[80:83], v[32:35]
ds_read_b64_tr_b16 v[28:29], v4 offset:8192
v_exp_f32 v10, v10
v_mfma_f32_16x16x32_bf16 v[36:39], v[12:15], a[84:87], v[36:39]
ds_read_b64_tr_b16 v[30:31], v4 offset:10240
v_mfma_f32_16x16x32_bf16 v[36:39], v[16:19], a[92:95], v[36:39]
ds_read_b64_tr_b16 v[12:13], v4 offset:12288
ds_read_b64_tr_b16 v[14:15], v4 offset:14336
v_mfma_f32_16x16x32_bf16 v[32:35], v[16:19], a[88:91], v[32:35]
v_xor_b32 v4, 16480, v3
s_waitcnt lgkmcnt(4)
v_mfma_f32_16x16x32_bf16 v[40:43], v[20:23], a[64:67], 0
ds_read_b64_tr_b16 v[16:17], v4
v_cmp_le_u32 vcc, 103, v8
v_mfma_f32_16x16x32_bf16 v[44:47], v[20:23], a[68:71], 0
ds_read_b64_tr_b16 v[18:19], v4 offset:2048
v_exp_f32 v11, v11
v_mfma_f32_16x16x32_bf16 v[44:47], v[24:27], a[76:79], v[44:47]
ds_read_b64_tr_b16 v[20:21], v4 offset:4096
v_lshlrev_b32 v6, 16, v72
v_mfma_f32_16x16x32_bf16 v[40:43], v[24:27], a[72:75], v[40:43]
ds_read_b64_tr_b16 v[22:23], v4 offset:6144
s_waitcnt lgkmcnt(4)
v_mfma_f32_16x16x32_bf16 v[40:43], v[28:31], a[80:83], v[40:43]
ds_read_b64_tr_b16 v[24:25], v4 offset:8192
ds_read_b64_tr_b16 v[26:27], v4 offset:10240
v_mfma_f32_16x16x32_bf16 v[44:47], v[28:31], a[84:87], v[44:47]
s_cbranch_vccz L_sp95
L_ok95:
v_mfma_f32_16x16x32_bf16 v[44:47], v[12:15], a[92:95], v[44:47]
ds_read_b64_tr_b16 v[28:29], v4 offset:12288
v_and_b32 v7, s50, v72
v_mfma_f32_16x16x32_bf16 v[40:43], v[12:15], a[88:91], v[40:43]
ds_read_b64_tr_b16 v[30:31], v4 offset:14336
s_waitcnt lgkmcnt(4)
v_mfma_f32_16x16x32_bf16 v[48:51], v[16:19], a[64:67], 0
ds_read_b64_tr_b16 v[12:13], v232 offset:32768
v_cvt_pk_bf16_f32 v71, v10, v11
v_mfma_f32_16x16x32_bf16 v[52:55], v[16:19], a[68:71], 0
ds_read_b64_tr_b16 v[14:15], v232 offset:40960
v_fma_f32 v6, v6, s48, v0
v_mfma_f32_16x16x32_bf16 v[52:55], v[20:23], a[76:79], v[52:55]
ds_read_b64_tr_b16 v[16:17], v232 offset:33024
v_fma_f32 v7, v7, s48, v0
v_mfma_f32_16x16x32_bf16 v[48:51], v[20:23], a[72:75], v[48:51]
ds_read_b64_tr_b16 v[18:19], v232 offset:41216
s_waitcnt lgkmcnt(4)
v_mfma_f32_16x16x32_bf16 v[48:51], v[24:27], a[80:83], v[48:51]
ds_read_b64_tr_b16 v[20:21], v233 offset:32768
v_mfma_f32_16x16x32_bf16 v[52:55], v[24:27], a[84:87], v[52:55]
ds_read_b64_tr_b16 v[22:23], v233 offset:40960
v_mfma_f32_16x16x32_bf16 v[52:55], v[28:31], a[92:95], v[52:55]
ds_read_b64_tr_b16 v[24:25], v233 offset:33024
v_mfma_f32_16x16x32_bf16 v[48:51], v[28:31], a[88:91], v[48:51]
ds_read_b64_tr_b16 v[26:27], v233 offset:41216
s_waitcnt lgkmcnt(4)
v_mfma_f32_16x16x32_bf16 v[128:131], v[12:15], v[64:67], v[128:131]
ds_read_b64_tr_b16 v[28:29], v234 offset:32768
ds_read_b64_tr_b16 v[30:31], v234 offset:40960
v_mfma_f32_16x16x32_bf16 v[132:135], v[12:15], v[68:71], v[132:135]
v_exp_f32 v6, v6
v_exp_f32 v7, v7
v_lshlrev_b32 v10, 16, v76
v_and_b32 v11, s50, v76
v_pk_fma_f32 v[10:11], v[10:11], s[48:49], v[2:3] op_sel_hi:[1,0,0]
v_dot2c_f32_bf16 v5, s21, v70
v_dot2c_f32_bf16 v9, s21, v67
v_dot2c_f32_bf16 v5, s21, v71
v_mfma_f32_16x16x32_bf16 v[192:195], v[16:19], v[64:67], v[192:195]
ds_read_b64_tr_b16 v[12:13], v234 offset:33024
ds_read_b64_tr_b16 v[14:15], v234 offset:41216
v_mfma_f32_16x16x32_bf16 v[196:199], v[16:19], v[68:71], v[196:199]
v_cvt_pk_bf16_f32 v72, v6, v7
s_waitcnt lgkmcnt(4)
v_mfma_f32_16x16x32_bf16 v[136:139], v[20:23], v[64:67], v[136:139]
ds_read_b64_tr_b16 v[16:17], v235 offset:32768
ds_read_b64_tr_b16 v[18:19], v235 offset:40960
v_mfma_f32_16x16x32_bf16 v[140:143], v[20:23], v[68:71], v[140:143]
v_mov_b32 v8, 0
v_exp_f32 v10, v10
v_exp_f32 v11, v11
v_lshlrev_b32 v6, 16, v73
v_and_b32 v7, s50, v73
v_pk_fma_f32 v[6:7], v[6:7], s[48:49], v[0:1] op_sel_hi:[1,0,0]
v_dot2c_f32_bf16 v9, s21, v72
v_mfma_f32_16x16x32_bf16 v[200:203], v[24:27], v[64:67], v[200:203]
ds_read_b64_tr_b16 v[20:21], v235 offset:33024
ds_read_b64_tr_b16 v[22:23], v235 offset:41216
v_mfma_f32_16x16x32_bf16 v[204:207], v[24:27], v[68:71], v[204:207]
v_cvt_pk_bf16_f32 v76, v10, v11
s_waitcnt lgkmcnt(4)
v_mfma_f32_16x16x32_bf16 v[144:147], v[28:31], v[64:67], v[144:147]
ds_read_b64_tr_b16 v[24:25], v236 offset:32768
ds_read_b64_tr_b16 v[26:27], v236 offset:40960
v_mfma_f32_16x16x32_bf16 v[148:151], v[28:31], v[68:71], v[148:151]
ds_read_b32 v8, v8 offset:14336
v_exp_f32 v6, v6
v_exp_f32 v7, v7
v_lshlrev_b32 v10, 16, v77
v_and_b32 v11, s50, v77
v_pk_fma_f32 v[10:11], v[10:11], s[48:49], v[2:3] op_sel_hi:[1,0,0]
v_dot2c_f32_bf16 v5, s21, v76
v_mfma_f32_16x16x32_bf16 v[208:211], v[12:15], v[64:67], v[208:211]
ds_read_b64_tr_b16 v[28:29], v236 offset:33024
ds_read_b64_tr_b16 v[30:31], v236 offset:41216
v_mfma_f32_16x16x32_bf16 v[212:215], v[12:15], v[68:71], v[212:215]
v_cvt_pk_bf16_f32 v73, v6, v7
s_waitcnt lgkmcnt(5)
v_mfma_f32_16x16x32_bf16 v[152:155], v[16:19], v[64:67], v[152:155]
ds_read_b64_tr_b16 v[12:13], v237 offset:32768
ds_read_b64_tr_b16 v[14:15], v237 offset:40960
v_mfma_f32_16x16x32_bf16 v[156:159], v[16:19], v[68:71], v[156:159]
v_exp_f32 v10, v10
v_exp_f32 v11, v11
v_lshlrev_b32 v6, 16, v74
v_and_b32 v7, s50, v74
v_pk_fma_f32 v[6:7], v[6:7], s[48:49], v[0:1] op_sel_hi:[1,0,0]
v_dot2c_f32_bf16 v9, s21, v73
v_mfma_f32_16x16x32_bf16 v[216:219], v[20:23], v[64:67], v[216:219]
ds_read_b64_tr_b16 v[16:17], v237 offset:33024
ds_read_b64_tr_b16 v[18:19], v237 offset:41216
v_mfma_f32_16x16x32_bf16 v[220:223], v[20:23], v[68:71], v[220:223]
v_cvt_pk_bf16_f32 v77, v10, v11
s_waitcnt lgkmcnt(4)
v_mfma_f32_16x16x32_bf16 v[160:163], v[24:27], v[64:67], v[160:163]
ds_read_b64_tr_b16 v[20:21], v238 offset:32768
ds_read_b64_tr_b16 v[22:23], v238 offset:40960
v_mfma_f32_16x16x32_bf16 v[164:167], v[24:27], v[68:71], v[164:167]
v_cmp_le_u32 vcc, 105, v8
v_exp_f32 v6, v6
v_exp_f32 v7, v7
v_lshlrev_b32 v10, 16, v78
v_and_b32 v11, s50, v78
v_pk_fma_f32 v[10:11], v[10:11], s[48:49], v[2:3] op_sel_hi:[1,0,0]
v_dot2c_f32_bf16 v5, s21, v77
v_mfma_f32_16x16x32_bf16 a[0:3], v[28:31], v[64:67], a[0:3]
ds_read_b64_tr_b16 v[24:25], v238 offset:33024
ds_read_b64_tr_b16 v[26:27], v238 offset:41216
v_mfma_f32_16x16x32_bf16 a[4:7], v[28:31], v[68:71], a[4:7]
v_cvt_pk_bf16_f32 v74, v6, v7
s_waitcnt lgkmcnt(4)
v_mfma_f32_16x16x32_bf16 v[168:171], v[12:15], v[64:67], v[168:171]
ds_read_b64_tr_b16 v[28:29], v239 offset:32768
ds_read_b64_tr_b16 v[30:31], v239 offset:40960
v_mfma_f32_16x16x32_bf16 v[172:175], v[12:15], v[68:71], v[172:175]
s_cbranch_vccz L_sp96
L_ok96:
v_exp_f32 v10, v10
v_exp_f32 v11, v11
v_lshlrev_b32 v6, 16, v75
v_and_b32 v7, s50, v75
v_pk_fma_f32 v[6:7], v[6:7], s[48:49], v[0:1] op_sel_hi:[1,0,0]
v_dot2c_f32_bf16 v9, s21, v74
v_mfma_f32_16x16x32_bf16 a[8:11], v[16:19], v[64:67], a[8:11]
ds_read_b64_tr_b16 v[12:13], v239 offset:33024
ds_read_b64_tr_b16 v[14:15], v239 offset:41216
v_mfma_f32_16x16x32_bf16 a[12:15], v[16:19], v[68:71], a[12:15]
v_cvt_pk_bf16_f32 v78, v10, v11
s_waitcnt lgkmcnt(4)
v_mfma_f32_16x16x32_bf16 v[176:179], v[20:23], v[64:67], v[176:179]
ds_read_b64_tr_b16 v[16:17], v224 offset:49152
ds_read_b64_tr_b16 v[18:19], v224 offset:57344
v_mfma_f32_16x16x32_bf16 v[180:183], v[20:23], v[68:71], v[180:183]
v_exp_f32 v6, v6
v_exp_f32 v7, v7
v_lshlrev_b32 v10, 16, v79
v_and_b32 v11, s50, v79
v_pk_fma_f32 v[10:11], v[10:11], s[48:49], v[2:3] op_sel_hi:[1,0,0]
v_dot2c_f32_bf16 v5, s21, v78
v_mfma_f32_16x16x32_bf16 a[16:19], v[24:27], v[64:67], a[16:19]
ds_read_b64_tr_b16 v[20:21], v224 offset:49408
ds_read_b64_tr_b16 v[22:23], v224 offset:57600
v_mfma_f32_16x16x32_bf16 a[20:23], v[24:27], v[68:71], a[20:23]
v_cvt_pk_bf16_f32 v75, v6, v7
s_waitcnt lgkmcnt(4)
v_mfma_f32_16x16x32_bf16 v[184:187], v[28:31], v[64:67], v[184:187]
ds_read_b64_tr_b16 v[24:25], v225 offset:49152
ds_read_b64_tr_b16 v[26:27], v225 offset:57344
v_mfma_f32_16x16x32_bf16 v[188:191], v[28:31], v[68:71], v[188:191]
s_movk_i32 s12, 384
v_exp_f32 v10, v10
v_exp_f32 v11, v11
v_lshlrev_b32 v6, 16, v80
v_and_b32 v7, s50, v80
v_pk_fma_f32 v[6:7], v[6:7], s[48:49], v[0:1] op_sel_hi:[1,0,0]
v_dot2c_f32_bf16 v9, s21, v75
v_mfma_f32_16x16x32_bf16 a[24:27], v[12:15], v[64:67], a[24:27]
ds_read_b64_tr_b16 v[28:29], v225 offset:49408
ds_read_b64_tr_b16 v[30:31], v225 offset:57600
v_mfma_f32_16x16x32_bf16 a[28:31], v[12:15], v[68:71], a[28:31]
v_cvt_pk_bf16_f32 v79, v10, v11
s_waitcnt lgkmcnt(4)
v_mfma_f32_16x16x32_bf16 v[128:131], v[16:19], v[72:75], v[128:131]
ds_read_b64_tr_b16 v[12:13], v226 offset:49152
ds_read_b64_tr_b16 v[14:15], v226 offset:57344
v_mfma_f32_16x16x32_bf16 v[132:135], v[16:19], v[76:79], v[132:135]
buffer_load_dword off, s[8:11], s12 lds
v_exp_f32 v6, v6
v_exp_f32 v7, v7
v_lshlrev_b32 v10, 16, v84
v_and_b32 v11, s50, v84
v_pk_fma_f32 v[10:11], v[10:11], s[48:49], v[2:3] op_sel_hi:[1,0,0]
v_dot2c_f32_bf16 v5, s21, v79
v_mfma_f32_16x16x32_bf16 v[192:195], v[20:23], v[72:75], v[192:195]
ds_read_b64_tr_b16 v[16:17], v226 offset:49408
ds_read_b64_tr_b16 v[18:19], v226 offset:57600
v_mfma_f32_16x16x32_bf16 v[196:199], v[20:23], v[76:79], v[196:199]
v_cvt_pk_bf16_f32 v80, v6, v7
s_waitcnt lgkmcnt(4)
v_mfma_f32_16x16x32_bf16 v[136:139], v[24:27], v[72:75], v[136:139]
ds_read_b64_tr_b16 v[20:21], v227 offset:49152
ds_read_b64_tr_b16 v[22:23], v227 offset:57344
v_mfma_f32_16x16x32_bf16 v[140:143], v[24:27], v[76:79], v[140:143]
v_exp_f32 v10, v10
v_exp_f32 v11, v11
v_lshlrev_b32 v6, 16, v81
v_and_b32 v7, s50, v81
v_pk_fma_f32 v[6:7], v[6:7], s[48:49], v[0:1] op_sel_hi:[1,0,0]
v_dot2c_f32_bf16 v9, s21, v80
v_mfma_f32_16x16x32_bf16 v[200:203], v[28:31], v[72:75], v[200:203]
ds_read_b64_tr_b16 v[24:25], v227 offset:49408
ds_read_b64_tr_b16 v[26:27], v227 offset:57600
v_mfma_f32_16x16x32_bf16 v[204:207], v[28:31], v[76:79], v[204:207]
v_cvt_pk_bf16_f32 v84, v10, v11
s_waitcnt lgkmcnt(4)
v_mfma_f32_16x16x32_bf16 v[144:147], v[12:15], v[72:75], v[144:147]
ds_read_b64_tr_b16 v[28:29], v228 offset:49152
ds_read_b64_tr_b16 v[30:31], v228 offset:57344
v_mfma_f32_16x16x32_bf16 v[148:151], v[12:15], v[76:79], v[148:151]
v_exp_f32 v6, v6
v_exp_f32 v7, v7
v_lshlrev_b32 v10, 16, v85
v_and_b32 v11, s50, v85
v_pk_fma_f32 v[10:11], v[10:11], s[48:49], v[2:3] op_sel_hi:[1,0,0]
v_dot2c_f32_bf16 v5, s21, v84
v_mfma_f32_16x16x32_bf16 v[208:211], v[16:19], v[72:75], v[208:211]
ds_read_b64_tr_b16 v[12:13], v228 offset:49408
ds_read_b64_tr_b16 v[14:15], v228 offset:57600
v_mfma_f32_16x16x32_bf16 v[212:215], v[16:19], v[76:79], v[212:215]
v_cvt_pk_bf16_f32 v81, v6, v7
s_waitcnt lgkmcnt(4)
v_mfma_f32_16x16x32_bf16 v[152:155], v[20:23], v[72:75], v[152:155]
ds_read_b64_tr_b16 v[16:17], v229 offset:49152
ds_read_b64_tr_b16 v[18:19], v229 offset:57344
v_mfma_f32_16x16x32_bf16 v[156:159], v[20:23], v[76:79], v[156:159]
v_exp_f32 v10, v10
v_exp_f32 v11, v11
v_lshlrev_b32 v6, 16, v82
v_and_b32 v7, s50, v82
v_pk_fma_f32 v[6:7], v[6:7], s[48:49], v[0:1] op_sel_hi:[1,0,0]
v_dot2c_f32_bf16 v9, s21, v81
v_mfma_f32_16x16x32_bf16 v[216:219], v[24:27], v[72:75], v[216:219]
ds_read_b64_tr_b16 v[20:21], v229 offset:49408
ds_read_b64_tr_b16 v[22:23], v229 offset:57600
v_mfma_f32_16x16x32_bf16 v[220:223], v[24:27], v[76:79], v[220:223]
v_cvt_pk_bf16_f32 v85, v10, v11
s_waitcnt lgkmcnt(4)
v_mfma_f32_16x16x32_bf16 v[160:163], v[28:31], v[72:75], v[160:163]
ds_read_b64_tr_b16 v[24:25], v230 offset:49152
ds_read_b64_tr_b16 v[26:27], v230 offset:57344
v_mfma_f32_16x16x32_bf16 v[164:167], v[28:31], v[76:79], v[164:167]
v_exp_f32 v6, v6
v_exp_f32 v7, v7
v_lshlrev_b32 v10, 16, v86
v_and_b32 v11, s50, v86
v_pk_fma_f32 v[10:11], v[10:11], s[48:49], v[2:3] op_sel_hi:[1,0,0]
v_dot2c_f32_bf16 v5, s21, v85
v_mfma_f32_16x16x32_bf16 a[0:3], v[12:15], v[72:75], a[0:3]
ds_read_b64_tr_b16 v[28:29], v230 offset:49408
ds_read_b64_tr_b16 v[30:31], v230 offset:57600
v_mfma_f32_16x16x32_bf16 a[4:7], v[12:15], v[76:79], a[4:7]
v_cvt_pk_bf16_f32 v82, v6, v7
s_waitcnt lgkmcnt(4)
v_mfma_f32_16x16x32_bf16 v[168:171], v[16:19], v[72:75], v[168:171]
ds_read_b64_tr_b16 v[12:13], v231 offset:49152
ds_read_b64_tr_b16 v[14:15], v231 offset:57344
v_mfma_f32_16x16x32_bf16 v[172:175], v[16:19], v[76:79], v[172:175]
v_exp_f32 v10, v10
v_exp_f32 v11, v11
v_lshlrev_b32 v6, 16, v83
v_and_b32 v7, s50, v83
v_pk_fma_f32 v[6:7], v[6:7], s[48:49], v[0:1] op_sel_hi:[1,0,0]
v_dot2c_f32_bf16 v9, s21, v82
v_mfma_f32_16x16x32_bf16 a[8:11], v[20:23], v[72:75], a[8:11]
ds_read_b64_tr_b16 v[16:17], v231 offset:49408
ds_read_b64_tr_b16 v[18:19], v231 offset:57600
v_mfma_f32_16x16x32_bf16 a[12:15], v[20:23], v[76:79], a[12:15]
v_xor_b32 v4, 131072, v3
v_cvt_pk_bf16_f32 v86, v10, v11
s_waitcnt lgkmcnt(4)
v_mfma_f32_16x16x32_bf16 v[176:179], v[24:27], v[72:75], v[176:179]
ds_read_b64_tr_b16 v[20:21], v4
ds_read_b64_tr_b16 v[22:23], v4 offset:2048
v_mfma_f32_16x16x32_bf16 v[180:183], v[24:27], v[76:79], v[180:183]
v_exp_f32 v6, v6
v_mfma_f32_16x16x32_bf16 a[16:19], v[28:31], v[72:75], a[16:19]
ds_read_b64_tr_b16 v[24:25], v4 offset:4096
ds_read_b64_tr_b16 v[26:27], v4 offset:6144
v_mfma_f32_16x16x32_bf16 a[20:23], v[28:31], v[76:79], a[20:23]
v_exp_f32 v7, v7
s_waitcnt lgkmcnt(4)
v_mfma_f32_16x16x32_bf16 v[184:187], v[12:15], v[72:75], v[184:187]
ds_read_b64_tr_b16 v[28:29], v4 offset:8192
ds_read_b64_tr_b16 v[30:31], v4 offset:10240
v_mfma_f32_16x16x32_bf16 v[188:191], v[12:15], v[76:79], v[188:191]
s_movk_i32 s12, 388
v_lshlrev_b32 v10, 16, v87
v_mfma_f32_16x16x32_bf16 a[24:27], v[16:19], v[72:75], a[24:27]
ds_read_b64_tr_b16 v[12:13], v4 offset:12288
ds_read_b64_tr_b16 v[14:15], v4 offset:14336
v_mfma_f32_16x16x32_bf16 a[28:31], v[16:19], v[76:79], a[28:31]
v_xor_b32 v4, 131104, v3
s_waitcnt lgkmcnt(4)
v_mfma_f32_16x16x32_bf16 v[248:251], v[20:23], a[96:99], v[248:251]
ds_read_b64_tr_b16 v[16:17], v4
ds_read_b64_tr_b16 v[18:19], v4 offset:2048
v_mfma_f32_16x16x32_bf16 v[252:255], v[20:23], a[100:103], v[252:255]
buffer_load_dword off, s[8:11], s12 lds
v_mfma_f32_16x16x32_bf16 v[252:255], v[24:27], a[108:111], v[252:255]
ds_read_b64_tr_b16 v[20:21], v4 offset:4096
v_and_b32 v11, s50, v87
v_mfma_f32_16x16x32_bf16 v[248:251], v[24:27], a[104:107], v[248:251]
ds_read_b64_tr_b16 v[22:23], v4 offset:6144
s_waitcnt lgkmcnt(4)
v_mfma_f32_16x16x32_bf16 v[248:251], v[28:31], a[112:115], v[248:251]
ds_read_b64_tr_b16 v[24:25], v4 offset:8192
v_mov_b32 v8, 0
v_mfma_f32_16x16x32_bf16 v[252:255], v[28:31], a[116:119], v[252:255]
ds_read_b64_tr_b16 v[26:27], v4 offset:10240
v_cvt_pk_bf16_f32 v83, v6, v7
v_mfma_f32_16x16x32_bf16 v[252:255], v[12:15], a[124:127], v[252:255]
ds_read_b64_tr_b16 v[28:29], v4 offset:12288
ds_read_b64_tr_b16 v[30:31], v4 offset:14336
v_mfma_f32_16x16x32_bf16 v[248:251], v[12:15], a[120:123], v[248:251]
v_xor_b32 v4, 131136, v3
s_waitcnt lgkmcnt(4)
v_mfma_f32_16x16x32_bf16 v[32:35], v[16:19], a[96:99], v[32:35]
ds_read_b64_tr_b16 v[12:13], v4
v_fma_f32 v10, v10, s48, v2
v_mfma_f32_16x16x32_bf16 v[36:39], v[16:19], a[100:103], v[36:39]
ds_read_b64_tr_b16 v[14:15], v4 offset:2048
ds_read_b32 v8, v8 offset:14336
v_mfma_f32_16x16x32_bf16 v[36:39], v[20:23], a[108:111], v[36:39]
ds_read_b64_tr_b16 v[16:17], v4 offset:4096
v_fma_f32 v11, v11, s48, v2
v_mfma_f32_16x16x32_bf16 v[32:35], v[20:23], a[104:107], v[32:35]
ds_read_b64_tr_b16 v[18:19], v4 offset:6144
s_waitcnt lgkmcnt(5)
v_mfma_f32_16x16x32_bf16 v[32:35], v[24:27], a[112:115], v[32:35]
ds_read_b64_tr_b16 v[20:21], v4 offset:8192
v_exp_f32 v10, v10
v_mfma_f32_16x16x32_bf16 v[36:39], v[24:27], a[116:119], v[36:39]
ds_read_b64_tr_b16 v[22:23], v4 offset:10240
v_mfma_f32_16x16x32_bf16 v[36:39], v[28:31], a[124:127], v[36:39]
ds_read_b64_tr_b16 v[24:25], v4 offset:12288
ds_read_b64_tr_b16 v[26:27], v4 offset:14336
v_mfma_f32_16x16x32_bf16 v[32:35], v[28:31], a[120:123], v[32:35]
v_xor_b32 v4, 131168, v3
s_waitcnt lgkmcnt(4)
v_mfma_f32_16x16x32_bf16 v[40:43], v[12:15], a[96:99], v[40:43]
ds_read_b64_tr_b16 v[28:29], v4
v_cmp_le_u32 vcc, 106, v8
v_mfma_f32_16x16x32_bf16 v[44:47], v[12:15], a[100:103], v[44:47]
ds_read_b64_tr_b16 v[30:31], v4 offset:2048
v_exp_f32 v11, v11
v_mfma_f32_16x16x32_bf16 v[44:47], v[16:19], a[108:111], v[44:47]
ds_read_b64_tr_b16 v[12:13], v4 offset:4096
v_lshlrev_b32 v6, 16, v88
v_mfma_f32_16x16x32_bf16 v[40:43], v[16:19], a[104:107], v[40:43]
ds_read_b64_tr_b16 v[14:15], v4 offset:6144
s_waitcnt lgkmcnt(4)
v_mfma_f32_16x16x32_bf16 v[40:43], v[20:23], a[112:115], v[40:43]
ds_read_b64_tr_b16 v[16:17], v4 offset:8192
ds_read_b64_tr_b16 v[18:19], v4 offset:10240
v_mfma_f32_16x16x32_bf16 v[44:47], v[20:23], a[116:119], v[44:47]
s_cbranch_vccz L_sp98
L_ok98:
v_mfma_f32_16x16x32_bf16 v[44:47], v[24:27], a[124:127], v[44:47]
ds_read_b64_tr_b16 v[20:21], v4 offset:12288
v_and_b32 v7, s50, v88
v_mfma_f32_16x16x32_bf16 v[40:43], v[24:27], a[120:123], v[40:43]
ds_read_b64_tr_b16 v[22:23], v4 offset:14336
s_waitcnt lgkmcnt(4)
v_mfma_f32_16x16x32_bf16 v[48:51], v[28:31], a[96:99], v[48:51]
ds_read_b64_tr_b16 v[24:25], v240 offset:16384
v_cvt_pk_bf16_f32 v87, v10, v11
v_mfma_f32_16x16x32_bf16 v[52:55], v[28:31], a[100:103], v[52:55]
ds_read_b64_tr_b16 v[26:27], v240 offset:24576
v_fma_f32 v6, v6, s48, v0
v_mfma_f32_16x16x32_bf16 v[52:55], v[12:15], a[108:111], v[52:55]
ds_read_b64_tr_b16 v[28:29], v240 offset:16640
v_fma_f32 v7, v7, s48, v0
v_mfma_f32_16x16x32_bf16 v[48:51], v[12:15], a[104:107], v[48:51]
ds_read_b64_tr_b16 v[30:31], v240 offset:24832
s_waitcnt lgkmcnt(4)
v_mfma_f32_16x16x32_bf16 v[48:51], v[16:19], a[112:115], v[48:51]
ds_read_b64_tr_b16 v[12:13], v241 offset:16384
v_mfma_f32_16x16x32_bf16 v[52:55], v[16:19], a[116:119], v[52:55]
ds_read_b64_tr_b16 v[14:15], v241 offset:24576
v_mfma_f32_16x16x32_bf16 v[52:55], v[20:23], a[124:127], v[52:55]
ds_read_b64_tr_b16 v[16:17], v241 offset:16640
v_mfma_f32_16x16x32_bf16 v[48:51], v[20:23], a[120:123], v[48:51]
ds_read_b64_tr_b16 v[18:19], v241 offset:24832
s_waitcnt lgkmcnt(4)
v_mfma_f32_16x16x32_bf16 v[128:131], v[24:27], v[80:83], v[128:131]
ds_read_b64_tr_b16 v[20:21], v242 offset:16384
ds_read_b64_tr_b16 v[22:23], v242 offset:24576
v_mfma_f32_16x16x32_bf16 v[132:135], v[24:27], v[84:87], v[132:135]
v_exp_f32 v6, v6
v_exp_f32 v7, v7
v_lshlrev_b32 v10, 16, v92
v_and_b32 v11, s50, v92
v_pk_fma_f32 v[10:11], v[10:11], s[48:49], v[2:3] op_sel_hi:[1,0,0]
v_dot2c_f32_bf16 v5, s21, v86
v_dot2c_f32_bf16 v9, s21, v83
v_dot2c_f32_bf16 v5, s21, v87
v_mfma_f32_16x16x32_bf16 v[192:195], v[28:31], v[80:83], v[192:195]
ds_read_b64_tr_b16 v[24:25], v242 offset:16640
ds_read_b64_tr_b16 v[26:27], v242 offset:24832
v_mfma_f32_16x16x32_bf16 v[196:199], v[28:31], v[84:87], v[196:199]
s_branch L_pg19
L_sp99:
v_mov_b32 v8, 0
ds_read_b32 v8, v8 offset:14336
s_waitcnt lgkmcnt(0)
v_cmp_le_u32 vcc, 108, v8
s_cbranch_vccz L_sp99
s_branch L_ok99
L_sp101:
v_mov_b32 v8, 0
ds_read_b32 v8, v8 offset:14336
s_waitcnt lgkmcnt(0)
v_cmp_le_u32 vcc, 109, v8
s_cbranch_vccz L_sp101
s_branch L_ok101
L_sp102:
v_mov_b32 v8, 0
ds_read_b32 v8, v8 offset:14336
s_waitcnt lgkmcnt(0)
v_cmp_le_u32 vcc, 111, v8
s_cbranch_vccz L_sp102
s_branch L_ok102
.p2align 12
L_stub19:
s_setpc_b64 s[94:95]
L_pg19:
v_cvt_pk_bf16_f32 v88, v6, v7
s_waitcnt lgkmcnt(4)
v_mfma_f32_16x16x32_bf16 v[136:139], v[12:15], v[80:83], v[136:139]
ds_read_b64_tr_b16 v[28:29], v243 offset:16384
ds_read_b64_tr_b16 v[30:31], v243 offset:24576
v_mfma_f32_16x16x32_bf16 v[140:143], v[12:15], v[84:87], v[140:143]
v_mov_b32 v8, 0
v_exp_f32 v10, v10
v_exp_f32 v11, v11
v_lshlrev_b32 v6, 16, v89
v_and_b32 v7, s50, v89
v_pk_fma_f32 v[6:7], v[6:7], s[48:49], v[0:1] op_sel_hi:[1,0,0]
v_dot2c_f32_bf16 v9, s21, v88
v_mfma_f32_16x16x32_bf16 v[200:203], v[16:19], v[80:83], v[200:203]
ds_read_b64_tr_b16 v[12:13], v243 offset:16640
ds_read_b64_tr_b16 v[14:15], v243 offset:24832
v_mfma_f32_16x16x32_bf16 v[204:207], v[16:19], v[84:87], v[204:207]
v_cvt_pk_bf16_f32 v92, v10, v11
s_waitcnt lgkmcnt(4)
v_mfma_f32_16x16x32_bf16 v[144:147], v[20:23], v[80:83], v[144:147]
ds_read_b64_tr_b16 v[16:17], v244 offset:16384
ds_read_b64_tr_b16 v[18:19], v244 offset:24576
v_mfma_f32_16x16x32_bf16 v[148:151], v[20:23], v[84:87], v[148:151]
ds_read_b32 v8, v8 offset:14336
v_exp_f32 v6, v6
v_exp_f32 v7, v7
v_lshlrev_b32 v10, 16, v93
v_and_b32 v11, s50, v93
v_pk_fma_f32 v[10:11], v[10:11], s[48:49], v[2:3] op_sel_hi:[1,0,0]
v_dot2c_f32_bf16 v5, s21, v92
v_mfma_f32_16x16x32_bf16 v[208:211], v[24:27], v[80:83], v[208:211]
ds_read_b64_tr_b16 v[20:21], v244 offset:16640
ds_read_b64_tr_b16 v[22:23], v244 offset:24832
v_mfma_f32_16x16x32_bf16 v[212:215], v[24:27], v[84:87], v[212:215]
v_cvt_pk_bf16_f32 v89, v6, v7
s_waitcnt lgkmcnt(5)
v_mfma_f32_16x16x32_bf16 v[152:155], v[28:31], v[80:83], v[152:155]
ds_read_b64_tr_b16 v[24:25], v245 offset:16384
ds_read_b64_tr_b16 v[26:27], v245 offset:24576
v_mfma_f32_16x16x32_bf16 v[156:159], v[28:31], v[84:87], v[156:159]
v_exp_f32 v10, v10
v_exp_f32 v11, v11
v_lshlrev_b32 v6, 16, v90
v_and_b32 v7, s50, v90
v_pk_fma_f32 v[6:7], v[6:7], s[48:49], v[0:1] op_sel_hi:[1,0,0]
v_dot2c_f32_bf16 v9, s21, v89
v_mfma_f32_16x16x32_bf16 v[216:219], v[12:15], v[80:83], v[216:219]
ds_read_b64_tr_b16 v[28:29], v245 offset:16640
ds_read_b64_tr_b16 v[30:31], v245 offset:24832
v_mfma_f32_16x16x32_bf16 v[220:223], v[12:15], v[84:87], v[220:223]
v_cvt_pk_bf16_f32 v93, v10, v11
s_waitcnt lgkmcnt(4)
v_mfma_f32_16x16x32_bf16 v[160:163], v[16:19], v[80:83], v[160:163]
ds_read_b64_tr_b16 v[12:13], v246 offset:16384
ds_read_b64_tr_b16 v[14:15], v246 offset:24576
v_mfma_f32_16x16x32_bf16 v[164:167], v[16:19], v[84:87], v[164:167]
v_cmp_le_u32 vcc, 108, v8
v_exp_f32 v6, v6
v_exp_f32 v7, v7
v_lshlrev_b32 v10, 16, v94
v_and_b32 v11, s50, v94
v_pk_fma_f32 v[10:11], v[10:11], s[48:49], v[2:3] op_sel_hi:[1,0,0]
v_dot2c_f32_bf16 v5, s21, v93
v_mfma_f32_16x16x32_bf16 a[0:3], v[20:23], v[80:83], a[0:3]
ds_read_b64_tr_b16 v[16:17], v246 offset:16640
ds_read_b64_tr_b16 v[18:19], v246 offset:24832
v_mfma_f32_16x16x32_bf16 a[4:7], v[20:23], v[84:87], a[4:7]
v_cvt_pk_bf16_f32 v90, v6, v7
s_waitcnt lgkmcnt(4)
v_mfma_f32_16x16x32_bf16 v[168:171], v[24:27], v[80:83], v[168:171]
ds_read_b64_tr_b16 v[20:21], v247 offset:16384
ds_read_b64_tr_b16 v[22:23], v247 offset:24576
v_mfma_f32_16x16x32_bf16 v[172:175], v[24:27], v[84:87], v[172:175]
s_cbranch_vccz L_sp99
L_ok99:
v_exp_f32 v10, v10
v_exp_f32 v11, v11
v_lshlrev_b32 v6, 16, v91
v_and_b32 v7, s50, v91
v_pk_fma_f32 v[6:7], v[6:7], s[48:49], v[0:1] op_sel_hi:[1,0,0]
v_dot2c_f32_bf16 v9, s21, v90
v_mfma_f32_16x16x32_bf16 a[8:11], v[28:31], v[80:83], a[8:11]
ds_read_b64_tr_b16 v[24:25], v247 offset:16640
ds_read_b64_tr_b16 v[26:27], v247 offset:24832
v_mfma_f32_16x16x32_bf16 a[12:15], v[28:31], v[84:87], a[12:15]
v_cvt_pk_bf16_f32 v94, v10, v11
s_waitcnt lgkmcnt(4)
v_mfma_f32_16x16x32_bf16 v[176:179], v[12:15], v[80:83], v[176:179]
ds_read_b64_tr_b16 v[28:29], v232 offset:49152
ds_read_b64_tr_b16 v[30:31], v232 offset:57344
v_mfma_f32_16x16x32_bf16 v[180:183], v[12:15], v[84:87], v[180:183]
v_exp_f32 v6, v6
v_exp_f32 v7, v7
v_lshlrev_b32 v10, 16, v95
v_and_b32 v11, s50, v95
v_pk_fma_f32 v[10:11], v[10:11], s[48:49], v[2:3] op_sel_hi:[1,0,0]
v_dot2c_f32_bf16 v5, s21, v94
v_mfma_f32_16x16x32_bf16 a[16:19], v[16:19], v[80:83], a[16:19]
ds_read_b64_tr_b16 v[12:13], v232 offset:49408
ds_read_b64_tr_b16 v[14:15], v232 offset:57600
v_mfma_f32_16x16x32_bf16 a[20:23], v[16:19], v[84:87], a[20:23]
v_cvt_pk_bf16_f32 v91, v6, v7
s_waitcnt lgkmcnt(4)
v_mfma_f32_16x16x32_bf16 v[184:187], v[20:23], v[80:83], v[184:187]
ds_read_b64_tr_b16 v[16:17], v233 offset:49152
ds_read_b64_tr_b16 v[18:19], v233 offset:57344
v_mfma_f32_16x16x32_bf16 v[188:191], v[20:23], v[84:87], v[188:191]
s_movk_i32 s12, 396
v_exp_f32 v10, v10
v_exp_f32 v11, v11
v_lshlrev_b32 v6, 16, v96
v_and_b32 v7, s50, v96
v_pk_fma_f32 v[6:7], v[6:7], s[48:49], v[0:1] op_sel_hi:[1,0,0]
v_dot2c_f32_bf16 v9, s21, v91
v_mfma_f32_16x16x32_bf16 a[24:27], v[24:27], v[80:83], a[24:27]
ds_read_b64_tr_b16 v[20:21], v233 offset:49408
ds_read_b64_tr_b16 v[22:23], v233 offset:57600
v_mfma_f32_16x16x32_bf16 a[28:31], v[24:27], v[84:87], a[28:31]
v_cvt_pk_bf16_f32 v95, v10, v11
s_waitcnt lgkmcnt(4)
v_mfma_f32_16x16x32_bf16 v[128:131], v[28:31], v[88:91], v[128:131]
ds_read_b64_tr_b16 v[24:25], v234 offset:49152
ds_read_b64_tr_b16 v[26:27], v234 offset:57344
v_mfma_f32_16x16x32_bf16 v[132:135], v[28:31], v[92:95], v[132:135]
buffer_load_dword off, s[8:11], s12 lds
v_exp_f32 v6, v6
v_exp_f32 v7, v7
v_lshlrev_b32 v10, 16, v100
v_and_b32 v11, s50, v100
v_pk_fma_f32 v[10:11], v[10:11], s[48:49], v[2:3] op_sel_hi:[1,0,0]
v_dot2c_f32_bf16 v5, s21, v95
v_mfma_f32_16x16x32_bf16 v[192:195], v[12:15], v[88:91], v[192:195]
ds_read_b64_tr_b16 v[28:29], v234 offset:49408
ds_read_b64_tr_b16 v[30:31], v234 offset:57600
v_mfma_f32_16x16x32_bf16 v[196:199], v[12:15], v[92:95], v[196:199]
v_cvt_pk_bf16_f32 v96, v6, v7
s_waitcnt lgkmcnt(4)
v_mfma_f32_16x16x32_bf16 v[136:139], v[16:19], v[88:91], v[136:139]
ds_read_b64_tr_b16 v[12:13], v235 offset:49152
ds_read_b64_tr_b16 v[14:15], v235 offset:57344
v_mfma_f32_16x16x32_bf16 v[140:143], v[16:19], v[92:95], v[140:143]
v_exp_f32 v10, v10
v_exp_f32 v11, v11
v_lshlrev_b32 v6, 16, v97
v_and_b32 v7, s50, v97
v_pk_fma_f32 v[6:7], v[6:7], s[48:49], v[0:1] op_sel_hi:[1,0,0]
v_dot2c_f32_bf16 v9, s21, v96
v_mfma_f32_16x16x32_bf16 v[200:203], v[20:23], v[88:91], v[200:203]
ds_read_b64_tr_b16 v[16:17], v235 offset:49408
ds_read_b64_tr_b16 v[18:19], v235 offset:57600
v_mfma_f32_16x16x32_bf16 v[204:207], v[20:23], v[92:95], v[204:207]
v_cvt_pk_bf16_f32 v100, v10, v11
s_waitcnt lgkmcnt(4)
v_mfma_f32_16x16x32_bf16 v[144:147], v[24:27], v[88:91], v[144:147]
ds_read_b64_tr_b16 v[20:21], v236 offset:49152
ds_read_b64_tr_b16 v[22:23], v236 offset:57344
v_mfma_f32_16x16x32_bf16 v[148:151], v[24:27], v[92:95], v[148:151]
v_exp_f32 v6, v6
v_exp_f32 v7, v7
v_lshlrev_b32 v10, 16, v101
v_and_b32 v11, s50, v101
v_pk_fma_f32 v[10:11], v[10:11], s[48:49], v[2:3] op_sel_hi:[1,0,0]
v_dot2c_f32_bf16 v5, s21, v100
v_mfma_f32_16x16x32_bf16 v[208:211], v[28:31], v[88:91], v[208:211]
ds_read_b64_tr_b16 v[24:25], v236 offset:49408
ds_read_b64_tr_b16 v[26:27], v236 offset:57600
v_mfma_f32_16x16x32_bf16 v[212:215], v[28:31], v[92:95], v[212:215]
v_cvt_pk_bf16_f32 v97, v6, v7
s_waitcnt lgkmcnt(4)
v_mfma_f32_16x16x32_bf16 v[152:155], v[12:15], v[88:91], v[152:155]
ds_read_b64_tr_b16 v[28:29], v237 offset:49152
ds_read_b64_tr_b16 v[30:31], v237 offset:57344
v_mfma_f32_16x16x32_bf16 v[156:159], v[12:15], v[92:95], v[156:159]
v_exp_f32 v10, v10
v_exp_f32 v11, v11
v_lshlrev_b32 v6, 16, v98
v_and_b32 v7, s50, v98
v_pk_fma_f32 v[6:7], v[6:7], s[48:49], v[0:1] op_sel_hi:[1,0,0]
v_dot2c_f32_bf16 v9, s21, v97
v_mfma_f32_16x16x32_bf16 v[216:219], v[16:19], v[88:91], v[216:219]
ds_read_b64_tr_b16 v[12:13], v237 offset:49408
ds_read_b64_tr_b16 v[14:15], v237 offset:57600
v_mfma_f32_16x16x32_bf16 v[220:223], v[16:19], v[92:95], v[220:223]
v_cvt_pk_bf16_f32 v101, v10, v11
s_waitcnt lgkmcnt(4)
v_mfma_f32_16x16x32_bf16 v[160:163], v[20:23], v[88:91], v[160:163]
ds_read_b64_tr_b16 v[16:17], v238 offset:49152
ds_read_b64_tr_b16 v[18:19], v238 offset:57344
v_mfma_f32_16x16x32_bf16 v[164:167], v[20:23], v[92:95], v[164:167]
v_exp_f32 v6, v6
v_exp_f32 v7, v7
v_lshlrev_b32 v10, 16, v102
v_and_b32 v11, s50, v102
v_pk_fma_f32 v[10:11], v[10:11], s[48:49], v[2:3] op_sel_hi:[1,0,0]
v_dot2c_f32_bf16 v5, s21, v101
v_mfma_f32_16x16x32_bf16 a[0:3], v[24:27], v[88:91], a[0:3]
ds_read_b64_tr_b16 v[20:21], v238 offset:49408
ds_read_b64_tr_b16 v[22:23], v238 offset:57600
v_mfma_f32_16x16x32_bf16 a[4:7], v[24:27], v[92:95], a[4:7]
v_cvt_pk_bf16_f32 v98, v6, v7
s_waitcnt lgkmcnt(4)
v_mfma_f32_16x16x32_bf16 v[168:171], v[28:31], v[88:91], v[168:171]
ds_read_b64_tr_b16 v[24:25], v239 offset:49152
ds_read_b64_tr_b16 v[26:27], v239 offset:57344
v_mfma_f32_16x16x32_bf16 v[172:175], v[28:31], v[92:95], v[172:175]
v_exp_f32 v10, v10
v_exp_f32 v11, v11
v_lshlrev_b32 v6, 16, v99
v_and_b32 v7, s50, v99
v_pk_fma_f32 v[6:7], v[6:7], s[48:49], v[0:1] op_sel_hi:[1,0,0]
v_dot2c_f32_bf16 v9, s21, v98
v_mfma_f32_16x16x32_bf16 a[8:11], v[12:15], v[88:91], a[8:11]
ds_read_b64_tr_b16 v[28:29], v239 offset:49408
ds_read_b64_tr_b16 v[30:31], v239 offset:57600
v_mfma_f32_16x16x32_bf16 a[12:15], v[12:15], v[92:95], a[12:15]
v_xor_b32 v4, 81920, v3
v_cvt_pk_bf16_f32 v102, v10, v11
s_waitcnt lgkmcnt(4)
v_mfma_f32_16x16x32_bf16 v[176:179], v[16:19], v[88:91], v[176:179]
ds_read_b64_tr_b16 v[12:13], v4
ds_read_b64_tr_b16 v[14:15], v4 offset:2048
v_mfma_f32_16x16x32_bf16 v[180:183], v[16:19], v[92:95], v[180:183]
v_exp_f32 v6, v6
v_mfma_f32_16x16x32_bf16 a[16:19], v[20:23], v[88:91], a[16:19]
ds_read_b64_tr_b16 v[16:17], v4 offset:4096
ds_read_b64_tr_b16 v[18:19], v4 offset:6144
v_mfma_f32_16x16x32_bf16 a[20:23], v[20:23], v[92:95], a[20:23]
v_exp_f32 v7, v7
s_waitcnt lgkmcnt(4)
v_mfma_f32_16x16x32_bf16 v[184:187], v[24:27], v[88:91], v[184:187]
ds_read_b64_tr_b16 v[20:21], v4 offset:8192
ds_read_b64_tr_b16 v[22:23], v4 offset:10240
v_mfma_f32_16x16x32_bf16 v[188:191], v[24:27], v[92:95], v[188:191]
s_movk_i32 s12, 400
v_lshlrev_b32 v10, 16, v103
v_mfma_f32_16x16x32_bf16 a[24:27], v[28:31], v[88:91], a[24:27]
ds_read_b64_tr_b16 v[24:25], v4 offset:12288
ds_read_b64_tr_b16 v[26:27], v4 offset:14336
v_mfma_f32_16x16x32_bf16 a[28:31], v[28:31], v[92:95], a[28:31]
v_xor_b32 v4, 81952, v3
s_waitcnt lgkmcnt(4)
v_mfma_f32_16x16x32_bf16 v[56:59], v[12:15], a[64:67], 0
ds_read_b64_tr_b16 v[28:29], v4
ds_read_b64_tr_b16 v[30:31], v4 offset:2048
v_mfma_f32_16x16x32_bf16 v[60:63], v[12:15], a[68:71], 0
buffer_load_dword off, s[8:11], s12 lds
v_mfma_f32_16x16x32_bf16 v[60:63], v[16:19], a[76:79], v[60:63]
ds_read_b64_tr_b16 v[12:13], v4 offset:4096
v_and_b32 v11, s50, v103
v_mfma_f32_16x16x32_bf16 v[56:59], v[16:19], a[72:75], v[56:59]
ds_read_b64_tr_b16 v[14:15], v4 offset:6144
s_waitcnt lgkmcnt(4)
v_mfma_f32_16x16x32_bf16 v[56:59], v[20:23], a[80:83], v[56:59]
ds_read_b64_tr_b16 v[16:17], v4 offset:8192
v_mov_b32 v8, 0
v_mfma_f32_16x16x32_bf16 v[60:63], v[20:23], a[84:87], v[60:63]
ds_read_b64_tr_b16 v[18:19], v4 offset:10240
v_cvt_pk_bf16_f32 v99, v6, v7
v_mfma_f32_16x16x32_bf16 v[60:63], v[24:27], a[92:95], v[60:63]
ds_read_b64_tr_b16 v[20:21], v4 offset:12288
ds_read_b64_tr_b16 v[22:23], v4 offset:14336
v_mfma_f32_16x16x32_bf16 v[56:59], v[24:27], a[88:91], v[56:59]
v_xor_b32 v4, 81984, v3
s_waitcnt lgkmcnt(4)
v_mfma_f32_16x16x32_bf16 v[64:67], v[28:31], a[64:67], 0
ds_read_b64_tr_b16 v[24:25], v4
v_fma_f32 v10, v10, s48, v2
v_mfma_f32_16x16x32_bf16 v[68:71], v[28:31], a[68:71], 0
ds_read_b64_tr_b16 v[26:27], v4 offset:2048
ds_read_b32 v8, v8 offset:14336
v_mfma_f32_16x16x32_bf16 v[68:71], v[12:15], a[76:79], v[68:71]
ds_read_b64_tr_b16 v[28:29], v4 offset:4096
v_fma_f32 v11, v11, s48, v2
v_mfma_f32_16x16x32_bf16 v[64:67], v[12:15], a[72:75], v[64:67]
ds_read_b64_tr_b16 v[30:31], v4 offset:6144
s_waitcnt lgkmcnt(5)
v_mfma_f32_16x16x32_bf16 v[64:67], v[16:19], a[80:83], v[64:67]
ds_read_b64_tr_b16 v[12:13], v4 offset:8192
v_exp_f32 v10, v10
v_mfma_f32_16x16x32_bf16 v[68:71], v[16:19], a[84:87], v[68:71]
ds_read_b64_tr_b16 v[14:15], v4 offset:10240
v_mfma_f32_16x16x32_bf16 v[68:71], v[20:23], a[92:95], v[68:71]
ds_read_b64_tr_b16 v[16:17], v4 offset:12288
ds_read_b64_tr_b16 v[18:19], v4 offset:14336
v_mfma_f32_16x16x32_bf16 v[64:67], v[20:23], a[88:91], v[64:67]
v_xor_b32 v4, 82016, v3
s_waitcnt lgkmcnt(4)
v_mfma_f32_16x16x32_bf16 v[72:75], v[24:27], a[64:67], 0
ds_read_b64_tr_b16 v[20:21], v4
v_cmp_le_u32 vcc, 109, v8
v_mfma_f32_16x16x32_bf16 v[76:79], v[24:27], a[68:71], 0
ds_read_b64_tr_b16 v[22:23], v4 offset:2048
v_exp_f32 v11, v11
v_mfma_f32_16x16x32_bf16 v[76:79], v[28:31], a[76:79], v[76:79]
ds_read_b64_tr_b16 v[24:25], v4 offset:4096
v_lshlrev_b32 v6, 16, v104
v_mfma_f32_16x16x32_bf16 v[72:75], v[28:31], a[72:75], v[72:75]
ds_read_b64_tr_b16 v[26:27], v4 offset:6144
s_waitcnt lgkmcnt(4)
v_mfma_f32_16x16x32_bf16 v[72:75], v[12:15], a[80:83], v[72:75]
ds_read_b64_tr_b16 v[28:29], v4 offset:8192
ds_read_b64_tr_b16 v[30:31], v4 offset:10240
v_mfma_f32_16x16x32_bf16 v[76:79], v[12:15], a[84:87], v[76:79]
s_cbranch_vccz L_sp101
L_ok101:
v_mfma_f32_16x16x32_bf16 v[76:79], v[16:19], a[92:95], v[76:79]
ds_read_b64_tr_b16 v[12:13], v4 offset:12288
v_and_b32 v7, s50, v104
v_mfma_f32_16x16x32_bf16 v[72:75], v[16:19], a[88:91], v[72:75]
ds_read_b64_tr_b16 v[14:15], v4 offset:14336
s_waitcnt lgkmcnt(4)
v_mfma_f32_16x16x32_bf16 v[80:83], v[20:23], a[64:67], 0
ds_read_b64_tr_b16 v[16:17], v224 offset:32768
v_cvt_pk_bf16_f32 v103, v10, v11
v_mfma_f32_16x16x32_bf16 v[84:87], v[20:23], a[68:71], 0
ds_read_b64_tr_b16 v[18:19], v224 offset:40960
v_fma_f32 v6, v6, s48, v0
v_mfma_f32_16x16x32_bf16 v[84:87], v[24:27], a[76:79], v[84:87]
ds_read_b64_tr_b16 v[20:21], v224 offset:33024
v_fma_f32 v7, v7, s48, v0
v_mfma_f32_16x16x32_bf16 v[80:83], v[24:27], a[72:75], v[80:83]
ds_read_b64_tr_b16 v[22:23], v224 offset:41216
s_waitcnt lgkmcnt(4)
v_mfma_f32_16x16x32_bf16 v[80:83], v[28:31], a[80:83], v[80:83]
ds_read_b64_tr_b16 v[24:25], v225 offset:32768
v_mfma_f32_16x16x32_bf16 v[84:87], v[28:31], a[84:87], v[84:87]
ds_read_b64_tr_b16 v[26:27], v225 offset:40960
v_mfma_f32_16x16x32_bf16 v[84:87], v[12:15], a[92:95], v[84:87]
ds_read_b64_tr_b16 v[28:29], v225 offset:33024
v_mfma_f32_16x16x32_bf16 v[80:83], v[12:15], a[88:91], v[80:83]
ds_read_b64_tr_b16 v[30:31], v225 offset:41216
s_waitcnt lgkmcnt(4)
v_mfma_f32_16x16x32_bf16 v[128:131], v[16:19], v[96:99], v[128:131]
ds_read_b64_tr_b16 v[12:13], v226 offset:32768
ds_read_b64_tr_b16 v[14:15], v226 offset:40960
v_mfma_f32_16x16x32_bf16 v[132:135], v[16:19], v[100:103], v[132:135]
v_exp_f32 v6, v6
v_exp_f32 v7, v7
v_lshlrev_b32 v10, 16, v108
v_and_b32 v11, s50, v108
v_pk_fma_f32 v[10:11], v[10:11], s[48:49], v[2:3] op_sel_hi:[1,0,0]
v_dot2c_f32_bf16 v5, s21, v102
v_dot2c_f32_bf16 v9, s21, v99
v_dot2c_f32_bf16 v5, s21, v103
v_mfma_f32_16x16x32_bf16 v[192:195], v[20:23], v[96:99], v[192:195]
ds_read_b64_tr_b16 v[16:17], v226 offset:33024
ds_read_b64_tr_b16 v[18:19], v226 offset:41216
v_mfma_f32_16x16x32_bf16 v[196:199], v[20:23], v[100:103], v[196:199]
v_cvt_pk_bf16_f32 v104, v6, v7
s_waitcnt lgkmcnt(4)
v_mfma_f32_16x16x32_bf16 v[136:139], v[24:27], v[96:99], v[136:139]
ds_read_b64_tr_b16 v[20:21], v227 offset:32768
ds_read_b64_tr_b16 v[22:23], v227 offset:40960
v_mfma_f32_16x16x32_bf16 v[140:143], v[24:27], v[100:103], v[140:143]
v_mov_b32 v8, 0
v_exp_f32 v10, v10
v_exp_f32 v11, v11
v_lshlrev_b32 v6, 16, v105
v_and_b32 v7, s50, v105
v_pk_fma_f32 v[6:7], v[6:7], s[48:49], v[0:1] op_sel_hi:[1,0,0]
v_dot2c_f32_bf16 v9, s21, v104
buffer_load_dword v89, off, s[36:39], s4 sc1
v_mfma_f32_16x16x32_bf16 v[200:203], v[28:31], v[96:99], v[200:203]
ds_read_b64_tr_b16 v[24:25], v227 offset:33024
ds_read_b64_tr_b16 v[26:27], v227 offset:41216
v_mfma_f32_16x16x32_bf16 v[204:207], v[28:31], v[100:103], v[204:207]
v_cvt_pk_bf16_f32 v108, v10, v11
s_waitcnt lgkmcnt(4)
v_mfma_f32_16x16x32_bf16 v[144:147], v[12:15], v[96:99], v[144:147]
ds_read_b64_tr_b16 v[28:29], v228 offset:32768
ds_read_b64_tr_b16 v[30:31], v228 offset:40960
v_mfma_f32_16x16x32_bf16 v[148:151], v[12:15], v[100:103], v[148:151]
ds_read_b32 v8, v8 offset:14336
v_exp_f32 v6, v6
v_exp_f32 v7, v7
v_lshlrev_b32 v10, 16, v109
v_and_b32 v11, s50, v109
v_pk_fma_f32 v[10:11], v[10:11], s[48:49], v[2:3] op_sel_hi:[1,0,0]
v_dot2c_f32_bf16 v5, s21, v108
v_mfma_f32_16x16x32_bf16 v[208:211], v[16:19], v[96:99], v[208:211]
ds_read_b64_tr_b16 v[12:13], v228 offset:33024
ds_read_b64_tr_b16 v[14:15], v228 offset:41216
v_mfma_f32_16x16x32_bf16 v[212:215], v[16:19], v[100:103], v[212:215]
v_cvt_pk_bf16_f32 v105, v6, v7
s_waitcnt lgkmcnt(5)
v_mfma_f32_16x16x32_bf16 v[152:155], v[20:23], v[96:99], v[152:155]
ds_read_b64_tr_b16 v[16:17], v229 offset:32768
ds_read_b64_tr_b16 v[18:19], v229 offset:40960
v_mfma_f32_16x16x32_bf16 v[156:159], v[20:23], v[100:103], v[156:159]
v_exp_f32 v10, v10
v_exp_f32 v11, v11
v_lshlrev_b32 v6, 16, v106
v_and_b32 v7, s50, v106
v_pk_fma_f32 v[6:7], v[6:7], s[48:49], v[0:1] op_sel_hi:[1,0,0]
v_dot2c_f32_bf16 v9, s21, v105
v_mbcnt_lo_u32_b32 v90, -1, 0
v_mfma_f32_16x16x32_bf16 v[216:219], v[24:27], v[96:99], v[216:219]
ds_read_b64_tr_b16 v[20:21], v229 offset:33024
ds_read_b64_tr_b16 v[22:23], v229 offset:41216
v_mfma_f32_16x16x32_bf16 v[220:223], v[24:27], v[100:103], v[220:223]
v_cvt_pk_bf16_f32 v109, v10, v11
s_waitcnt lgkmcnt(4)
v_mfma_f32_16x16x32_bf16 v[160:163], v[28:31], v[96:99], v[160:163]
ds_read_b64_tr_b16 v[24:25], v230 offset:32768
ds_read_b64_tr_b16 v[26:27], v230 offset:40960
v_mfma_f32_16x16x32_bf16 v[164:167], v[28:31], v[100:103], v[164:167]
v_cmp_le_u32 vcc, 111, v8
v_exp_f32 v6, v6
v_exp_f32 v7, v7
v_lshlrev_b32 v10, 16, v110
v_and_b32 v11, s50, v110
v_pk_fma_f32 v[10:11], v[10:11], s[48:49], v[2:3] op_sel_hi:[1,0,0]
v_dot2c_f32_bf16 v5, s21, v109
v_mfma_f32_16x16x32_bf16 a[0:3], v[12:15], v[96:99], a[0:3]
ds_read_b64_tr_b16 v[28:29], v230 offset:33024
ds_read_b64_tr_b16 v[30:31], v230 offset:41216
v_mfma_f32_16x16x32_bf16 a[4:7], v[12:15], v[100:103], a[4:7]
v_cvt_pk_bf16_f32 v106, v6, v7
v_mbcnt_hi_u32_b32 v90, -1, v90
s_waitcnt lgkmcnt(4)
v_mfma_f32_16x16x32_bf16 v[168:171], v[16:19], v[96:99], v[168:171]
ds_read_b64_tr_b16 v[12:13], v231 offset:32768
ds_read_b64_tr_b16 v[14:15], v231 offset:40960
v_mfma_f32_16x16x32_bf16 v[172:175], v[16:19], v[100:103], v[172:175]
s_cbranch_vccz L_sp102
L_ok102:
v_exp_f32 v10, v10
v_exp_f32 v11, v11
v_lshlrev_b32 v6, 16, v107
v_and_b32 v7, s50, v107
v_pk_fma_f32 v[6:7], v[6:7], s[48:49], v[0:1] op_sel_hi:[1,0,0]
v_dot2c_f32_bf16 v9, s21, v106
v_mfma_f32_16x16x32_bf16 a[8:11], v[20:23], v[96:99], a[8:11]
ds_read_b64_tr_b16 v[16:17], v231 offset:33024
ds_read_b64_tr_b16 v[18:19], v231 offset:41216
v_mfma_f32_16x16x32_bf16 a[12:15], v[20:23], v[100:103], a[12:15]
v_cvt_pk_bf16_f32 v110, v10, v11
s_waitcnt lgkmcnt(4)
v_mfma_f32_16x16x32_bf16 v[176:179], v[24:27], v[96:99], v[176:179]
ds_read_b64_tr_b16 v[20:21], v224 offset:16384
ds_read_b64_tr_b16 v[22:23], v224 offset:24576
v_mfma_f32_16x16x32_bf16 v[180:183], v[24:27], v[100:103], v[180:183]
v_exp_f32 v6, v6
v_exp_f32 v7, v7
v_lshlrev_b32 v10, 16, v111
v_and_b32 v11, s50, v111
v_pk_fma_f32 v[10:11], v[10:11], s[48:49], v[2:3] op_sel_hi:[1,0,0]
v_dot2c_f32_bf16 v5, s21, v110
v_mfma_f32_16x16x32_bf16 a[16:19], v[28:31], v[96:99], a[16:19]
ds_read_b64_tr_b16 v[24:25], v224 offset:16640
ds_read_b64_tr_b16 v[26:27], v224 offset:24832
v_mfma_f32_16x16x32_bf16 a[20:23], v[28:31], v[100:103], a[20:23]
v_cvt_pk_bf16_f32 v107, v6, v7
v_lshlrev_b32 v88, 4, v90
s_waitcnt lgkmcnt(4)
v_mfma_f32_16x16x32_bf16 v[184:187], v[12:15], v[96:99], v[184:187]
ds_read_b64_tr_b16 v[28:29], v225 offset:16384
ds_read_b64_tr_b16 v[30:31], v225 offset:24576
v_mfma_f32_16x16x32_bf16 v[188:191], v[12:15], v[100:103], v[188:191]
s_movk_i32 s12, 408
v_exp_f32 v10, v10
v_exp_f32 v11, v11
v_lshlrev_b32 v6, 16, v112
v_and_b32 v7, s50, v112
v_pk_fma_f32 v[6:7], v[6:7], s[48:49], v[0:1] op_sel_hi:[1,0,0]
v_dot2c_f32_bf16 v9, s21, v107
v_mfma_f32_16x16x32_bf16 a[24:27], v[16:19], v[96:99], a[24:27]
ds_read_b64_tr_b16 v[12:13], v225 offset:16640
ds_read_b64_tr_b16 v[14:15], v225 offset:24832
v_mfma_f32_16x16x32_bf16 a[28:31], v[16:19], v[100:103], a[28:31]
v_cvt_pk_bf16_f32 v111, v10, v11
s_waitcnt lgkmcnt(4)
v_mfma_f32_16x16x32_bf16 v[128:131], v[20:23], v[104:107], v[128:131]
ds_read_b64_tr_b16 v[16:17], v226 offset:16384
ds_read_b64_tr_b16 v[18:19], v226 offset:24576
v_mfma_f32_16x16x32_bf16 v[132:135], v[20:23], v[108:111], v[132:135]
buffer_load_dword off, s[8:11], s12 lds
v_exp_f32 v6, v6
v_exp_f32 v7, v7
v_lshlrev_b32 v10, 16, v116
v_and_b32 v11, s50, v116
v_pk_fma_f32 v[10:11], v[10:11], s[48:49], v[2:3] op_sel_hi:[1,0,0]
v_dot2c_f32_bf16 v5, s21, v111
v_mfma_f32_16x16x32_bf16 v[192:195], v[24:27], v[104:107], v[192:195]
ds_read_b64_tr_b16 v[20:21], v226 offset:16640
ds_read_b64_tr_b16 v[22:23], v226 offset:24832
v_mfma_f32_16x16x32_bf16 v[196:199], v[24:27], v[108:111], v[196:199]
v_cvt_pk_bf16_f32 v112, v6, v7
s_waitcnt lgkmcnt(4)
v_mfma_f32_16x16x32_bf16 v[136:139], v[28:31], v[104:107], v[136:139]
ds_read_b64_tr_b16 v[24:25], v227 offset:16384
ds_read_b64_tr_b16 v[26:27], v227 offset:24576
v_mfma_f32_16x16x32_bf16 v[140:143], v[28:31], v[108:111], v[140:143]
v_exp_f32 v10, v10
v_exp_f32 v11, v11
v_lshlrev_b32 v6, 16, v113
v_and_b32 v7, s50, v113
v_pk_fma_f32 v[6:7], v[6:7], s[48:49], v[0:1] op_sel_hi:[1,0,0]
v_dot2c_f32_bf16 v9, s21, v112
v_mfma_f32_16x16x32_bf16 v[200:203], v[12:15], v[104:107], v[200:203]
ds_read_b64_tr_b16 v[28:29], v227 offset:16640
ds_read_b64_tr_b16 v[30:31], v227 offset:24832
v_mfma_f32_16x16x32_bf16 v[204:207], v[12:15], v[108:111], v[204:207]
v_cvt_pk_bf16_f32 v116, v10, v11
s_waitcnt lgkmcnt(4)
v_mfma_f32_16x16x32_bf16 v[144:147], v[16:19], v[104:107], v[144:147]
ds_read_b64_tr_b16 v[12:13], v228 offset:16384
ds_read_b64_tr_b16 v[14:15], v228 offset:24576
v_mfma_f32_16x16x32_bf16 v[148:151], v[16:19], v[108:111], v[148:151]
v_exp_f32 v6, v6
v_exp_f32 v7, v7
v_lshlrev_b32 v10, 16, v117
v_and_b32 v11, s50, v117
v_pk_fma_f32 v[10:11], v[10:11], s[48:49], v[2:3] op_sel_hi:[1,0,0]
v_dot2c_f32_bf16 v5, s21, v116
v_mfma_f32_16x16x32_bf16 v[208:211], v[20:23], v[104:107], v[208:211]
ds_read_b64_tr_b16 v[16:17], v228 offset:16640
ds_read_b64_tr_b16 v[18:19], v228 offset:24832
v_mfma_f32_16x16x32_bf16 v[212:215], v[20:23], v[108:111], v[212:215]
v_cvt_pk_bf16_f32 v113, v6, v7
s_waitcnt lgkmcnt(4)
v_mfma_f32_16x16x32_bf16 v[152:155], v[24:27], v[104:107], v[152:155]
ds_read_b64_tr_b16 v[20:21], v229 offset:16384
ds_read_b64_tr_b16 v[22:23], v229 offset:24576
v_mfma_f32_16x16x32_bf16 v[156:159], v[24:27], v[108:111], v[156:159]
v_exp_f32 v10, v10
v_exp_f32 v11, v11
v_lshlrev_b32 v6, 16, v114
v_and_b32 v7, s50, v114
v_pk_fma_f32 v[6:7], v[6:7], s[48:49], v[0:1] op_sel_hi:[1,0,0]
v_dot2c_f32_bf16 v9, s21, v113
v_mfma_f32_16x16x32_bf16 v[216:219], v[28:31], v[104:107], v[216:219]
ds_read_b64_tr_b16 v[24:25], v229 offset:16640
ds_read_b64_tr_b16 v[26:27], v229 offset:24832
v_mfma_f32_16x16x32_bf16 v[220:223], v[28:31], v[108:111], v[220:223]
v_cvt_pk_bf16_f32 v117, v10, v11
v_xor_b32 v92, 0, v3
s_waitcnt lgkmcnt(4)
v_mfma_f32_16x16x32_bf16 v[160:163], v[12:15], v[104:107], v[160:163]
ds_read_b64_tr_b16 v[28:29], v230 offset:16384
ds_read_b64_tr_b16 v[30:31], v230 offset:24576
v_mfma_f32_16x16x32_bf16 v[164:167], v[12:15], v[108:111], v[164:167]
v_exp_f32 v6, v6
v_exp_f32 v7, v7
v_lshlrev_b32 v10, 16, v118
v_and_b32 v11, s50, v118
v_pk_fma_f32 v[10:11], v[10:11], s[48:49], v[2:3] op_sel_hi:[1,0,0]
v_dot2c_f32_bf16 v5, s21, v117
v_mfma_f32_16x16x32_bf16 a[0:3], v[16:19], v[104:107], a[0:3]
ds_read_b64_tr_b16 v[12:13], v230 offset:16640
ds_read_b64_tr_b16 v[14:15], v230 offset:24832
v_mfma_f32_16x16x32_bf16 a[4:7], v[16:19], v[108:111], a[4:7]
v_cvt_pk_bf16_f32 v114, v6, v7
s_waitcnt lgkmcnt(4)
v_mfma_f32_16x16x32_bf16 v[168:171], v[20:23], v[104:107], v[168:171]
ds_read_b64_tr_b16 v[16:17], v231 offset:16384
ds_read_b64_tr_b16 v[18:19], v231 offset:24576
v_mfma_f32_16x16x32_bf16 v[172:175], v[20:23], v[108:111], v[172:175]
v_exp_f32 v10, v10
v_exp_f32 v11, v11
v_lshlrev_b32 v6, 16, v115
v_and_b32 v7, s50, v115
v_pk_fma_f32 v[6:7], v[6:7], s[48:49], v[0:1] op_sel_hi:[1,0,0]
v_dot2c_f32_bf16 v9, s21, v114
v_mfma_f32_16x16x32_bf16 a[8:11], v[24:27], v[104:107], a[8:11]
ds_read_b64_tr_b16 v[20:21], v231 offset:16640
ds_read_b64_tr_b16 v[22:23], v231 offset:24832
v_mfma_f32_16x16x32_bf16 a[12:15], v[24:27], v[108:111], a[12:15]
v_xor_b32 v4, 65536, v3
v_cvt_pk_bf16_f32 v118, v10, v11
s_waitcnt lgkmcnt(4)
v_mfma_f32_16x16x32_bf16 v[176:179], v[28:31], v[104:107], v[176:179]
ds_read_b64_tr_b16 v[24:25], v4
ds_read_b64_tr_b16 v[26:27], v4 offset:2048
v_mfma_f32_16x16x32_bf16 v[180:183], v[28:31], v[108:111], v[180:183]
s_branch L_pg20
L_sp104:
v_mov_b32 v8, 0
ds_read_b32 v8, v8 offset:14336
s_waitcnt lgkmcnt(0)
v_cmp_le_u32 vcc, 112, v8
s_cbranch_vccz L_sp104
s_branch L_ok104
L_sp105:
v_mov_b32 v8, 0
ds_read_b32 v8, v8 offset:14336
s_waitcnt lgkmcnt(0)
v_cmp_le_u32 vcc, 113, v8
s_cbranch_vccz L_sp105
s_branch L_ok105
L_sp106:
v_mov_b32 v8, 0
ds_read_b32 v8, v8 offset:14336
s_waitcnt lgkmcnt(0)
v_cmp_le_u32 vcc, 114, v8
s_cbranch_vccz L_sp106
s_branch L_ok106
L_sp107:
v_mov_b32 v8, 0
ds_read_b32 v8, v8 offset:14336
s_waitcnt lgkmcnt(0)
v_cmp_le_u32 vcc, 115, v8
s_cbranch_vccz L_sp107
s_branch L_ok107
.p2align 12
L_stub20:
s_setpc_b64 s[94:95]
L_pg20:
v_exp_f32 v6, v6
v_mfma_f32_16x16x32_bf16 a[16:19], v[12:15], v[104:107], a[16:19]
ds_read_b64_tr_b16 v[28:29], v4 offset:4096
ds_read_b64_tr_b16 v[30:31], v4 offset:6144
v_mfma_f32_16x16x32_bf16 a[20:23], v[12:15], v[108:111], a[20:23]
v_exp_f32 v7, v7
s_waitcnt lgkmcnt(4)
v_mfma_f32_16x16x32_bf16 v[184:187], v[16:19], v[104:107], v[184:187]
ds_read_b64_tr_b16 v[12:13], v4 offset:8192
ds_read_b64_tr_b16 v[14:15], v4 offset:10240
v_mfma_f32_16x16x32_bf16 v[188:191], v[16:19], v[108:111], v[188:191]
s_movk_i32 s12, 412
v_lshlrev_b32 v10, 16, v119
v_mfma_f32_16x16x32_bf16 a[24:27], v[20:23], v[104:107], a[24:27]
ds_read_b64_tr_b16 v[16:17], v4 offset:12288
ds_read_b64_tr_b16 v[18:19], v4 offset:14336
v_mfma_f32_16x16x32_bf16 a[28:31], v[20:23], v[108:111], a[28:31]
v_xor_b32 v4, 65568, v3
s_waitcnt lgkmcnt(4)
v_mfma_f32_16x16x32_bf16 v[56:59], v[24:27], a[96:99], v[56:59]
ds_read_b64_tr_b16 v[20:21], v4
ds_read_b64_tr_b16 v[22:23], v4 offset:2048
v_mfma_f32_16x16x32_bf16 v[60:63], v[24:27], a[100:103], v[60:63]
buffer_load_dword off, s[8:11], s12 lds
v_mfma_f32_16x16x32_bf16 v[60:63], v[28:31], a[108:111], v[60:63]
ds_read_b64_tr_b16 v[24:25], v4 offset:4096
v_and_b32 v11, s50, v119
v_mfma_f32_16x16x32_bf16 v[56:59], v[28:31], a[104:107], v[56:59]
ds_read_b64_tr_b16 v[26:27], v4 offset:6144
s_waitcnt lgkmcnt(4)
v_mfma_f32_16x16x32_bf16 v[56:59], v[12:15], a[112:115], v[56:59]
ds_read_b64_tr_b16 v[28:29], v4 offset:8192
v_cvt_pk_bf16_f32 v115, v6, v7
v_mfma_f32_16x16x32_bf16 v[60:63], v[12:15], a[116:119], v[60:63]
ds_read_b64_tr_b16 v[30:31], v4 offset:10240
v_fma_f32 v10, v10, s48, v2
v_mfma_f32_16x16x32_bf16 v[60:63], v[16:19], a[124:127], v[60:63]
ds_read_b64_tr_b16 v[12:13], v4 offset:12288
ds_read_b64_tr_b16 v[14:15], v4 offset:14336
v_mfma_f32_16x16x32_bf16 v[56:59], v[16:19], a[120:123], v[56:59]
v_xor_b32 v4, 65600, v3
s_waitcnt lgkmcnt(4)
v_mfma_f32_16x16x32_bf16 v[64:67], v[20:23], a[96:99], v[64:67]
ds_read_b64_tr_b16 v[16:17], v4
v_mov_b32 v8, 0
v_mfma_f32_16x16x32_bf16 v[68:71], v[20:23], a[100:103], v[68:71]
ds_read_b64_tr_b16 v[18:19], v4 offset:2048
v_fma_f32 v11, v11, s48, v2
v_mfma_f32_16x16x32_bf16 v[68:71], v[24:27], a[108:111], v[68:71]
ds_read_b64_tr_b16 v[20:21], v4 offset:4096
v_exp_f32 v10, v10
v_mfma_f32_16x16x32_bf16 v[64:67], v[24:27], a[104:107], v[64:67]
ds_read_b64_tr_b16 v[22:23], v4 offset:6144
v_xor_b32 v93, 32, v3
s_waitcnt lgkmcnt(4)
v_mfma_f32_16x16x32_bf16 v[64:67], v[28:31], a[112:115], v[64:67]
ds_read_b64_tr_b16 v[24:25], v4 offset:8192
v_exp_f32 v11, v11
v_mfma_f32_16x16x32_bf16 v[68:71], v[28:31], a[116:119], v[68:71]
ds_read_b64_tr_b16 v[26:27], v4 offset:10240
ds_read_b32 v8, v8 offset:14336
v_mfma_f32_16x16x32_bf16 v[68:71], v[12:15], a[124:127], v[68:71]
ds_read_b64_tr_b16 v[28:29], v4 offset:12288
ds_read_b64_tr_b16 v[30:31], v4 offset:14336
v_mfma_f32_16x16x32_bf16 v[64:67], v[12:15], a[120:123], v[64:67]
v_xor_b32 v4, 65632, v3
s_waitcnt lgkmcnt(5)
v_mfma_f32_16x16x32_bf16 v[72:75], v[16:19], a[96:99], v[72:75]
ds_read_b64_tr_b16 v[12:13], v4
v_lshlrev_b32 v6, 16, v120
v_mfma_f32_16x16x32_bf16 v[76:79], v[16:19], a[100:103], v[76:79]
ds_read_b64_tr_b16 v[14:15], v4 offset:2048
v_and_b32 v7, s50, v120
v_mfma_f32_16x16x32_bf16 v[76:79], v[20:23], a[108:111], v[76:79]
ds_read_b64_tr_b16 v[16:17], v4 offset:4096
v_cvt_pk_bf16_f32 v119, v10, v11
v_mfma_f32_16x16x32_bf16 v[72:75], v[20:23], a[104:107], v[72:75]
ds_read_b64_tr_b16 v[18:19], v4 offset:6144
s_waitcnt lgkmcnt(4)
v_mfma_f32_16x16x32_bf16 v[72:75], v[24:27], a[112:115], v[72:75]
ds_read_b64_tr_b16 v[20:21], v4 offset:8192
v_cmp_le_u32 vcc, 112, v8
v_mfma_f32_16x16x32_bf16 v[76:79], v[24:27], a[116:119], v[76:79]
ds_read_b64_tr_b16 v[22:23], v4 offset:10240
v_fma_f32 v6, v6, s48, v0
v_mfma_f32_16x16x32_bf16 v[76:79], v[28:31], a[124:127], v[76:79]
ds_read_b64_tr_b16 v[24:25], v4 offset:12288
v_fma_f32 v7, v7, s48, v0
v_mfma_f32_16x16x32_bf16 v[72:75], v[28:31], a[120:123], v[72:75]
ds_read_b64_tr_b16 v[26:27], v4 offset:14336
s_waitcnt lgkmcnt(4)
v_mfma_f32_16x16x32_bf16 v[80:83], v[12:15], a[96:99], v[80:83]
s_cbranch_vccz L_sp104
L_ok104:
ds_read_b64_tr_b16 v[28:29], v232 offset:32768
v_mfma_f32_16x16x32_bf16 v[84:87], v[12:15], a[100:103], v[84:87]
ds_read_b64_tr_b16 v[30:31], v232 offset:40960
v_xor_b32 v94, 64, v3
v_mfma_f32_16x16x32_bf16 v[84:87], v[16:19], a[108:111], v[84:87]
ds_read_b64_tr_b16 v[12:13], v232 offset:33024
v_xor_b32 v95, 96, v3
v_mfma_f32_16x16x32_bf16 v[80:83], v[16:19], a[104:107], v[80:83]
ds_read_b64_tr_b16 v[14:15], v232 offset:41216
s_waitcnt lgkmcnt(4)
v_mfma_f32_16x16x32_bf16 v[80:83], v[20:23], a[112:115], v[80:83]
ds_read_b64_tr_b16 v[16:17], v233 offset:32768
v_xor_b32 v96, 65536, v3
v_mfma_f32_16x16x32_bf16 v[84:87], v[20:23], a[116:119], v[84:87]
ds_read_b64_tr_b16 v[18:19], v233 offset:40960
v_xor_b32 v97, 65568, v3
v_mfma_f32_16x16x32_bf16 v[84:87], v[24:27], a[124:127], v[84:87]
ds_read_b64_tr_b16 v[20:21], v233 offset:33024
v_xor_b32 v98, 65600, v3
v_mfma_f32_16x16x32_bf16 v[80:83], v[24:27], a[120:123], v[80:83]
ds_read_b64_tr_b16 v[22:23], v233 offset:41216
s_waitcnt lgkmcnt(4)
v_mfma_f32_16x16x32_bf16 v[128:131], v[28:31], v[112:115], v[128:131]
ds_read_b64_tr_b16 v[24:25], v234 offset:32768
ds_read_b64_tr_b16 v[26:27], v234 offset:40960
v_mfma_f32_16x16x32_bf16 v[132:135], v[28:31], v[116:119], v[132:135]
v_exp_f32 v6, v6
v_exp_f32 v7, v7
v_lshlrev_b32 v10, 16, v124
v_and_b32 v11, s50, v124
v_pk_fma_f32 v[10:11], v[10:11], s[48:49], v[2:3] op_sel_hi:[1,0,0]
v_dot2c_f32_bf16 v5, s21, v118
v_dot2c_f32_bf16 v9, s21, v115
v_dot2c_f32_bf16 v5, s21, v119
v_mfma_f32_16x16x32_bf16 v[192:195], v[12:15], v[112:115], v[192:195]
ds_read_b64_tr_b16 v[28:29], v234 offset:33024
ds_read_b64_tr_b16 v[30:31], v234 offset:41216
v_mfma_f32_16x16x32_bf16 v[196:199], v[12:15], v[116:119], v[196:199]
v_cvt_pk_bf16_f32 v120, v6, v7
s_waitcnt lgkmcnt(4)
v_mfma_f32_16x16x32_bf16 v[136:139], v[16:19], v[112:115], v[136:139]
ds_read_b64_tr_b16 v[12:13], v235 offset:32768
ds_read_b64_tr_b16 v[14:15], v235 offset:40960
v_mfma_f32_16x16x32_bf16 v[140:143], v[16:19], v[116:119], v[140:143]
v_exp_f32 v10, v10
v_exp_f32 v11, v11
v_lshlrev_b32 v6, 16, v121
v_and_b32 v7, s50, v121
v_pk_fma_f32 v[6:7], v[6:7], s[48:49], v[0:1] op_sel_hi:[1,0,0]
v_dot2c_f32_bf16 v9, s21, v120
v_mfma_f32_16x16x32_bf16 v[200:203], v[20:23], v[112:115], v[200:203]
ds_read_b64_tr_b16 v[16:17], v235 offset:33024
ds_read_b64_tr_b16 v[18:19], v235 offset:41216
v_mfma_f32_16x16x32_bf16 v[204:207], v[20:23], v[116:119], v[204:207]
v_cvt_pk_bf16_f32 v124, v10, v11
v_xor_b32 v99, 65632, v3
s_waitcnt lgkmcnt(4)
v_mfma_f32_16x16x32_bf16 v[144:147], v[24:27], v[112:115], v[144:147]
ds_read_b64_tr_b16 v[20:21], v236 offset:32768
ds_read_b64_tr_b16 v[22:23], v236 offset:40960
v_mfma_f32_16x16x32_bf16 v[148:151], v[24:27], v[116:119], v[148:151]
v_mov_b32 v8, 0
v_exp_f32 v6, v6
v_exp_f32 v7, v7
v_lshlrev_b32 v10, 16, v125
v_and_b32 v11, s50, v125
v_pk_fma_f32 v[10:11], v[10:11], s[48:49], v[2:3] op_sel_hi:[1,0,0]
v_dot2c_f32_bf16 v5, s21, v124
v_mfma_f32_16x16x32_bf16 v[208:211], v[28:31], v[112:115], v[208:211]
ds_read_b64_tr_b16 v[24:25], v236 offset:33024
ds_read_b64_tr_b16 v[26:27], v236 offset:41216
v_mfma_f32_16x16x32_bf16 v[212:215], v[28:31], v[116:119], v[212:215]
v_cvt_pk_bf16_f32 v121, v6, v7
s_waitcnt lgkmcnt(4)
v_mfma_f32_16x16x32_bf16 v[152:155], v[12:15], v[112:115], v[152:155]
ds_read_b64_tr_b16 v[28:29], v237 offset:32768
ds_read_b64_tr_b16 v[30:31], v237 offset:40960
v_mfma_f32_16x16x32_bf16 v[156:159], v[12:15], v[116:119], v[156:159]
ds_read_b32 v8, v8 offset:14336
v_exp_f32 v10, v10
v_exp_f32 v11, v11
v_lshlrev_b32 v6, 16, v122
v_and_b32 v7, s50, v122
v_pk_fma_f32 v[6:7], v[6:7], s[48:49], v[0:1] op_sel_hi:[1,0,0]
v_dot2c_f32_bf16 v9, s21, v121
v_mfma_f32_16x16x32_bf16 v[216:219], v[16:19], v[112:115], v[216:219]
ds_read_b64_tr_b16 v[12:13], v237 offset:33024
ds_read_b64_tr_b16 v[14:15], v237 offset:41216
v_mfma_f32_16x16x32_bf16 v[220:223], v[16:19], v[116:119], v[220:223]
v_cvt_pk_bf16_f32 v125, v10, v11
s_waitcnt lgkmcnt(5)
v_mfma_f32_16x16x32_bf16 v[160:163], v[20:23], v[112:115], v[160:163]
ds_read_b64_tr_b16 v[16:17], v238 offset:32768
ds_read_b64_tr_b16 v[18:19], v238 offset:40960
v_mfma_f32_16x16x32_bf16 v[164:167], v[20:23], v[116:119], v[164:167]
v_exp_f32 v6, v6
v_exp_f32 v7, v7
v_lshlrev_b32 v10, 16, v126
v_and_b32 v11, s50, v126
v_pk_fma_f32 v[10:11], v[10:11], s[48:49], v[2:3] op_sel_hi:[1,0,0]
v_dot2c_f32_bf16 v5, s21, v125
s_waitcnt vmcnt(2)
v_readfirstlane_b32 s5, v89
s_mov_b32 s6, 0
s_nop 2
s_cmp_ge_u32 s5, 1
s_cbranch_scc1 L_rdy
L_chk:
buffer_load_dword v89, off, s[36:39], s4 sc1
s_add_u32 s6, s6, 1
s_waitcnt vmcnt(0)
v_readfirstlane_b32 s5, v89
s_cmp_ge_u32 s6, 0x400000
s_cbranch_scc1 L_rdy
s_nop 2
s_cmp_lt_u32 s5, 1
s_cbranch_scc1 L_chk
L_rdy:
v_mfma_f32_16x16x32_bf16 a[0:3], v[24:27], v[112:115], a[0:3]
ds_read_b64_tr_b16 v[20:21], v238 offset:33024
ds_read_b64_tr_b16 v[22:23], v238 offset:41216
v_mfma_f32_16x16x32_bf16 a[4:7], v[24:27], v[116:119], a[4:7]
v_cvt_pk_bf16_f32 v122, v6, v7
s_waitcnt lgkmcnt(4)
v_mfma_f32_16x16x32_bf16 v[168:171], v[28:31], v[112:115], v[168:171]
ds_read_b64_tr_b16 v[24:25], v239 offset:32768
ds_read_b64_tr_b16 v[26:27], v239 offset:40960
v_mfma_f32_16x16x32_bf16 v[172:175], v[28:31], v[116:119], v[172:175]
v_cmp_le_u32 vcc, 113, v8
v_exp_f32 v10, v10
v_exp_f32 v11, v11
v_lshlrev_b32 v6, 16, v123
v_and_b32 v7, s50, v123
v_pk_fma_f32 v[6:7], v[6:7], s[48:49], v[0:1] op_sel_hi:[1,0,0]
v_dot2c_f32_bf16 v9, s21, v122
v_mfma_f32_16x16x32_bf16 a[8:11], v[12:15], v[112:115], a[8:11]
ds_read_b64_tr_b16 v[28:29], v239 offset:33024
ds_read_b64_tr_b16 v[30:31], v239 offset:41216
v_mfma_f32_16x16x32_bf16 a[12:15], v[12:15], v[116:119], a[12:15]
v_cvt_pk_bf16_f32 v126, v10, v11
s_waitcnt lgkmcnt(4)
v_mfma_f32_16x16x32_bf16 v[176:179], v[16:19], v[112:115], v[176:179]
s_cbranch_vccz L_sp105
L_ok105:
ds_read_b64_tr_b16 v[12:13], v224 offset:49152
v_mfma_f32_16x16x32_bf16 v[180:183], v[16:19], v[116:119], v[180:183]
ds_read_b64_tr_b16 v[14:15], v224 offset:57344
v_exp_f32 v6, v6
v_exp_f32 v7, v7
v_lshlrev_b32 v10, 16, v127
v_and_b32 v11, s50, v127
v_pk_fma_f32 v[10:11], v[10:11], s[48:49], v[2:3] op_sel_hi:[1,0,0]
v_dot2c_f32_bf16 v5, s21, v126
v_mfma_f32_16x16x32_bf16 a[16:19], v[20:23], v[112:115], a[16:19]
ds_read_b64_tr_b16 v[16:17], v224 offset:49408
ds_read_b64_tr_b16 v[18:19], v224 offset:57600
v_mfma_f32_16x16x32_bf16 a[20:23], v[20:23], v[116:119], a[20:23]
v_cvt_pk_bf16_f32 v123, v6, v7
s_waitcnt lgkmcnt(4)
v_mfma_f32_16x16x32_bf16 v[184:187], v[24:27], v[112:115], v[184:187]
ds_read_b64_tr_b16 v[20:21], v225 offset:49152
ds_read_b64_tr_b16 v[22:23], v225 offset:57344
v_mfma_f32_16x16x32_bf16 v[188:191], v[24:27], v[116:119], v[188:191]
s_movk_i32 s12, 420
v_exp_f32 v10, v10
v_exp_f32 v11, v11
v_dot2c_f32_bf16 v9, s21, v123
v_mfma_f32_16x16x32_bf16 a[24:27], v[28:31], v[112:115], a[24:27]
ds_read_b64_tr_b16 v[24:25], v225 offset:49408
ds_read_b64_tr_b16 v[26:27], v225 offset:57600
v_mfma_f32_16x16x32_bf16 a[28:31], v[28:31], v[116:119], a[28:31]
v_cvt_pk_bf16_f32 v127, v10, v11
s_waitcnt lgkmcnt(4)
v_mfma_f32_16x16x32_bf16 v[128:131], v[12:15], v[120:123], v[128:131]
ds_read_b64_tr_b16 v[28:29], v226 offset:49152
ds_read_b64_tr_b16 v[30:31], v226 offset:57344
v_mfma_f32_16x16x32_bf16 v[132:135], v[12:15], v[124:127], v[132:135]
buffer_load_dword off, s[8:11], s12 lds
v_dot2c_f32_bf16 v5, s21, v127
v_mfma_f32_16x16x32_bf16 v[192:195], v[16:19], v[120:123], v[192:195]
ds_read_b64_tr_b16 v[12:13], v226 offset:49408
ds_read_b64_tr_b16 v[14:15], v226 offset:57600
v_mfma_f32_16x16x32_bf16 v[196:199], v[16:19], v[124:127], v[196:199]
v_xor_b32 v100, 131072, v3
v_xor_b32 v101, 131104, v3
s_waitcnt lgkmcnt(4)
v_mfma_f32_16x16x32_bf16 v[136:139], v[20:23], v[120:123], v[136:139]
ds_read_b64_tr_b16 v[16:17], v227 offset:49152
ds_read_b64_tr_b16 v[18:19], v227 offset:57344
v_mfma_f32_16x16x32_bf16 v[140:143], v[20:23], v[124:127], v[140:143]
v_permlane32_swap_b32 v9, v5
v_mfma_f32_16x16x32_bf16 v[200:203], v[24:27], v[120:123], v[200:203]
ds_read_b64_tr_b16 v[20:21], v227 offset:49408
ds_read_b64_tr_b16 v[22:23], v227 offset:57600
v_mfma_f32_16x16x32_bf16 v[204:207], v[24:27], v[124:127], v[204:207]
v_add_f32 v9, v9, v5
v_mov_b32 v5, v9
s_waitcnt lgkmcnt(4)
v_mfma_f32_16x16x32_bf16 v[144:147], v[28:31], v[120:123], v[144:147]
ds_read_b64_tr_b16 v[24:25], v228 offset:49152
ds_read_b64_tr_b16 v[26:27], v228 offset:57344
v_mfma_f32_16x16x32_bf16 v[148:151], v[28:31], v[124:127], v[148:151]
v_mov_b32 v8, 0
v_xor_b32 v102, 131136, v3
v_mfma_f32_16x16x32_bf16 v[208:211], v[12:15], v[120:123], v[208:211]
ds_read_b64_tr_b16 v[28:29], v228 offset:49408
ds_read_b64_tr_b16 v[30:31], v228 offset:57600
v_mfma_f32_16x16x32_bf16 v[212:215], v[12:15], v[124:127], v[212:215]
v_permlane16_swap_b32 v9, v5
s_waitcnt lgkmcnt(4)
v_mfma_f32_16x16x32_bf16 v[152:155], v[16:19], v[120:123], v[152:155]
ds_read_b64_tr_b16 v[12:13], v229 offset:49152
ds_read_b64_tr_b16 v[14:15], v229 offset:57344
v_mfma_f32_16x16x32_bf16 v[156:159], v[16:19], v[124:127], v[156:159]
ds_read_b32 v8, v8 offset:14336
v_xor_b32 v103, 131168, v3
v_mfma_f32_16x16x32_bf16 v[216:219], v[20:23], v[120:123], v[216:219]
ds_read_b64_tr_b16 v[16:17], v229 offset:49408
ds_read_b64_tr_b16 v[18:19], v229 offset:57600
v_mfma_f32_16x16x32_bf16 v[220:223], v[20:23], v[124:127], v[220:223]
v_add_f32 v9, v9, v5
s_waitcnt lgkmcnt(5)
v_mfma_f32_16x16x32_bf16 v[160:163], v[24:27], v[120:123], v[160:163]
ds_read_b64_tr_b16 v[20:21], v230 offset:49152
ds_read_b64_tr_b16 v[22:23], v230 offset:57344
v_mfma_f32_16x16x32_bf16 v[164:167], v[24:27], v[124:127], v[164:167]
v_rcp_f32 v9, v9
v_mfma_f32_16x16x32_bf16 a[0:3], v[28:31], v[120:123], a[0:3]
ds_read_b64_tr_b16 v[24:25], v230 offset:49408
ds_read_b64_tr_b16 v[26:27], v230 offset:57600
v_mfma_f32_16x16x32_bf16 a[4:7], v[28:31], v[124:127], a[4:7]
v_mov_b32 v5, v9
s_waitcnt lgkmcnt(4)
v_mfma_f32_16x16x32_bf16 v[168:171], v[12:15], v[120:123], v[168:171]
ds_read_b64_tr_b16 v[28:29], v231 offset:49152
ds_read_b64_tr_b16 v[30:31], v231 offset:57344
v_mfma_f32_16x16x32_bf16 v[172:175], v[12:15], v[124:127], v[172:175]
v_cmp_le_u32 vcc, 114, v8
v_permlane32_swap_b32 v9, v5
v_mfma_f32_16x16x32_bf16 a[8:11], v[16:19], v[120:123], a[8:11]
ds_read_b64_tr_b16 v[12:13], v231 offset:49408
ds_read_b64_tr_b16 v[14:15], v231 offset:57600
v_mfma_f32_16x16x32_bf16 a[12:15], v[16:19], v[124:127], a[12:15]
s_waitcnt lgkmcnt(4)
v_mfma_f32_16x16x32_bf16 v[176:179], v[20:23], v[120:123], v[176:179]
s_cbranch_vccz L_sp106
L_ok106:
ds_read_b64_tr_b16 v[16:17], v100
v_mfma_f32_16x16x32_bf16 v[180:183], v[20:23], v[124:127], v[180:183]
ds_read_b64_tr_b16 v[18:19], v100 offset:2048
v_mfma_f32_16x16x32_bf16 a[16:19], v[24:27], v[120:123], a[16:19]
ds_read_b64_tr_b16 v[20:21], v101
ds_read_b64_tr_b16 v[22:23], v101 offset:2048
v_mfma_f32_16x16x32_bf16 a[20:23], v[24:27], v[124:127], a[20:23]
s_waitcnt lgkmcnt(4)
v_mfma_f32_16x16x32_bf16 v[184:187], v[28:31], v[120:123], v[184:187]
ds_read_b64_tr_b16 v[24:25], v102
ds_read_b64_tr_b16 v[26:27], v102 offset:2048
v_mfma_f32_16x16x32_bf16 v[188:191], v[28:31], v[124:127], v[188:191]
s_movk_i32 s12, 424
v_mfma_f32_16x16x32_bf16 a[24:27], v[12:15], v[120:123], a[24:27]
ds_read_b64_tr_b16 v[28:29], v103
ds_read_b64_tr_b16 v[30:31], v103 offset:2048
v_mfma_f32_16x16x32_bf16 a[28:31], v[12:15], v[124:127], a[28:31]
v_mul_f32 v128, v9, v128
v_mul_f32 v129, v9, v129
v_cvt_pk_bf16_f32 v128, v128, v129
v_mul_f32 v130, v9, v130
v_mul_f32 v131, v9, v131
v_cvt_pk_bf16_f32 v129, v130, v131
v_mul_f32 v136, v9, v136
v_mul_f32 v137, v9, v137
v_cvt_pk_bf16_f32 v130, v136, v137
v_mul_f32 v138, v9, v138
v_mul_f32 v139, v9, v139
v_cvt_pk_bf16_f32 v131, v138, v139
v_mul_f32 v132, v5, v132
v_mul_f32 v133, v5, v133
v_cvt_pk_bf16_f32 v132, v132, v133
v_mul_f32 v134, v5, v134
v_mul_f32 v135, v5, v135
v_cvt_pk_bf16_f32 v133, v134, v135
v_mul_f32 v140, v5, v140
v_mul_f32 v141, v5, v141
v_cvt_pk_bf16_f32 v134, v140, v141
v_mul_f32 v142, v5, v142
v_mul_f32 v143, v5, v143
v_cvt_pk_bf16_f32 v135, v142, v143
s_waitcnt lgkmcnt(4)
v_mfma_f32_16x16x32_bf16 a[128:131], v[16:19], v[128:131], a[128:131]
ds_read_b64_tr_b16 v[12:13], v100 offset:4096
v_mul_f32 v144, v9, v144
v_mfma_f32_16x16x32_bf16 a[132:135], v[16:19], v[132:135], a[132:135]
ds_read_b64_tr_b16 v[14:15], v100 offset:6144
buffer_load_dword off, s[8:11], s12 lds
v_mul_f32 v145, v9, v145
v_cvt_pk_bf16_f32 v144, v144, v145
v_mul_f32 v146, v9, v146
v_mul_f32 v147, v9, v147
v_mfma_f32_16x16x32_bf16 a[136:139], v[20:23], v[128:131], a[136:139]
ds_read_b64_tr_b16 v[16:17], v101 offset:4096
v_cvt_pk_bf16_f32 v145, v146, v147
v_mfma_f32_16x16x32_bf16 a[140:143], v[20:23], v[132:135], a[140:143]
ds_read_b64_tr_b16 v[18:19], v101 offset:6144
v_mul_f32 v152, v9, v152
v_mul_f32 v153, v9, v153
v_cvt_pk_bf16_f32 v146, v152, v153
v_mul_f32 v154, v9, v154
v_mul_f32 v155, v9, v155
s_waitcnt lgkmcnt(4)
v_mfma_f32_16x16x32_bf16 a[144:147], v[24:27], v[128:131], a[144:147]
ds_read_b64_tr_b16 v[20:21], v102 offset:4096
v_cvt_pk_bf16_f32 v147, v154, v155
v_mfma_f32_16x16x32_bf16 a[148:151], v[24:27], v[132:135], a[148:151]
ds_read_b64_tr_b16 v[22:23], v102 offset:6144
v_mul_f32 v148, v5, v148
v_mul_f32 v149, v5, v149
v_cvt_pk_bf16_f32 v148, v148, v149
v_mul_f32 v150, v5, v150
v_mul_f32 v151, v5, v151
v_cvt_pk_bf16_f32 v149, v150, v151
v_mfma_f32_16x16x32_bf16 a[152:155], v[28:31], v[128:131], a[152:155]
ds_read_b64_tr_b16 v[24:25], v103 offset:4096
v_mul_f32 v156, v5, v156
v_mfma_f32_16x16x32_bf16 a[156:159], v[28:31], v[132:135], a[156:159]
ds_read_b64_tr_b16 v[26:27], v103 offset:6144
v_mul_f32 v157, v5, v157
v_cvt_pk_bf16_f32 v150, v156, v157
v_mul_f32 v158, v5, v158
v_mul_f32 v159, v5, v159
v_cvt_pk_bf16_f32 v151, v158, v159
s_waitcnt lgkmcnt(4)
v_mfma_f32_16x16x32_bf16 a[128:131], v[12:15], v[144:147], a[128:131]
ds_read_b64_tr_b16 v[28:29], v100 offset:8192
v_mov_b32 v8, 0
v_mfma_f32_16x16x32_bf16 a[132:135], v[12:15], v[148:151], a[132:135]
ds_read_b64_tr_b16 v[30:31], v100 offset:10240
v_mul_f32 v160, v9, v160
v_mul_f32 v161, v9, v161
v_cvt_pk_bf16_f32 v160, v160, v161
v_mul_f32 v162, v9, v162
v_mul_f32 v163, v9, v163
v_cvt_pk_bf16_f32 v161, v162, v163
v_mfma_f32_16x16x32_bf16 a[136:139], v[16:19], v[144:147], a[136:139]
ds_read_b64_tr_b16 v[12:13], v101 offset:8192
v_mul_f32 v168, v9, v168
v_mfma_f32_16x16x32_bf16 a[140:143], v[16:19], v[148:151], a[140:143]
ds_read_b64_tr_b16 v[14:15], v101 offset:10240
v_mul_f32 v169, v9, v169
v_cvt_pk_bf16_f32 v162, v168, v169
v_mul_f32 v170, v9, v170
v_mul_f32 v171, v9, v171
v_cvt_pk_bf16_f32 v163, v170, v171
s_waitcnt lgkmcnt(4)
v_mfma_f32_16x16x32_bf16 a[144:147], v[20:23], v[144:147], a[144:147]
ds_read_b64_tr_b16 v[16:17], v102 offset:8192
v_mul_f32 v164, v5, v164
v_mfma_f32_16x16x32_bf16 a[148:151], v[20:23], v[148:151], a[148:151]
ds_read_b64_tr_b16 v[18:19], v102 offset:10240
v_mul_f32 v165, v5, v165
ds_read_b32 v8, v8 offset:14336
v_cvt_pk_bf16_f32 v164, v164, v165
v_mul_f32 v166, v5, v166
v_mul_f32 v167, v5, v167
v_cvt_pk_bf16_f32 v165, v166, v167
v_mfma_f32_16x16x32_bf16 a[152:155], v[24:27], v[144:147], a[152:155]
ds_read_b64_tr_b16 v[20:21], v103 offset:8192
v_mul_f32 v172, v5, v172
v_mfma_f32_16x16x32_bf16 a[156:159], v[24:27], v[148:151], a[156:159]
ds_read_b64_tr_b16 v[22:23], v103 offset:10240
v_mul_f32 v173, v5, v173
v_cvt_pk_bf16_f32 v166, v172, v173
v_mul_f32 v174, v5, v174
v_mul_f32 v175, v5, v175
v_cvt_pk_bf16_f32 v167, v174, v175
s_waitcnt lgkmcnt(5)
v_mfma_f32_16x16x32_bf16 a[128:131], v[28:31], v[160:163], a[128:131]
ds_read_b64_tr_b16 v[24:25], v100 offset:12288
v_mul_f32 v176, v9, v176
v_mfma_f32_16x16x32_bf16 a[132:135], v[28:31], v[164:167], a[132:135]
ds_read_b64_tr_b16 v[26:27], v100 offset:14336
v_mul_f32 v177, v9, v177
v_cvt_pk_bf16_f32 v176, v176, v177
v_mul_f32 v178, v9, v178
v_mul_f32 v179, v9, v179
v_cvt_pk_bf16_f32 v177, v178, v179
v_mul_f32 v184, v9, v184
v_mfma_f32_16x16x32_bf16 a[136:139], v[12:15], v[160:163], a[136:139]
ds_read_b64_tr_b16 v[28:29], v101 offset:12288
v_mul_f32 v185, v9, v185
v_mfma_f32_16x16x32_bf16 a[140:143], v[12:15], v[164:167], a[140:143]
ds_read_b64_tr_b16 v[30:31], v101 offset:14336
v_cvt_pk_bf16_f32 v178, v184, v185
v_mul_f32 v186, v9, v186
v_mul_f32 v187, v9, v187
v_cvt_pk_bf16_f32 v179, v186, v187
v_mul_f32 v180, v5, v180
s_waitcnt lgkmcnt(4)
v_mfma_f32_16x16x32_bf16 a[144:147], v[16:19], v[160:163], a[144:147]
ds_read_b64_tr_b16 v[12:13], v102 offset:12288
v_cmp_le_u32 vcc, 115, v8
v_mfma_f32_16x16x32_bf16 a[148:151], v[16:19], v[164:167], a[148:151]
ds_read_b64_tr_b16 v[14:15], v102 offset:14336
v_mul_f32 v181, v5, v181
v_cvt_pk_bf16_f32 v180, v180, v181
v_mul_f32 v182, v5, v182
v_mul_f32 v183, v5, v183
v_cvt_pk_bf16_f32 v181, v182, v183
v_mfma_f32_16x16x32_bf16 a[152:155], v[20:23], v[160:163], a[152:155]
ds_read_b64_tr_b16 v[16:17], v103 offset:12288
v_mul_f32 v188, v5, v188
v_mfma_f32_16x16x32_bf16 a[156:159], v[20:23], v[164:167], a[156:159]
ds_read_b64_tr_b16 v[18:19], v103 offset:14336
v_mul_f32 v189, v5, v189
v_cvt_pk_bf16_f32 v182, v188, v189
v_mul_f32 v190, v5, v190
v_mul_f32 v191, v5, v191
v_cvt_pk_bf16_f32 v183, v190, v191
s_waitcnt lgkmcnt(4)
v_mfma_f32_16x16x32_bf16 a[128:131], v[24:27], v[176:179], a[128:131]
s_cbranch_vccz L_sp107
L_ok107:
ds_read_b64_tr_b16 v[20:21], v100 offset:16384
v_mfma_f32_16x16x32_bf16 a[132:135], v[24:27], v[180:183], a[132:135]
ds_read_b64_tr_b16 v[22:23], v100 offset:18432
v_mul_f32 v192, v9, v192
v_mul_f32 v193, v9, v193
v_cvt_pk_bf16_f32 v192, v192, v193
v_mul_f32 v194, v9, v194
v_mul_f32 v195, v9, v195
v_cvt_pk_bf16_f32 v193, v194, v195
v_mfma_f32_16x16x32_bf16 a[136:139], v[28:31], v[176:179], a[136:139]
ds_read_b64_tr_b16 v[24:25], v101 offset:16384
v_mul_f32 v200, v9, v200
v_mfma_f32_16x16x32_bf16 a[140:143], v[28:31], v[180:183], a[140:143]
ds_read_b64_tr_b16 v[26:27], v101 offset:18432
v_mul_f32 v201, v9, v201
v_cvt_pk_bf16_f32 v194, v200, v201
v_mul_f32 v202, v9, v202
v_mul_f32 v203, v9, v203
v_cvt_pk_bf16_f32 v195, v202, v203
s_waitcnt lgkmcnt(4)
v_mfma_f32_16x16x32_bf16 a[144:147], v[12:15], v[176:179], a[144:147]
ds_read_b64_tr_b16 v[28:29], v102 offset:16384
s_movk_i32 s12, 428
v_mfma_f32_16x16x32_bf16 a[148:151], v[12:15], v[180:183], a[148:151]
ds_read_b64_tr_b16 v[30:31], v102 offset:18432
v_mul_f32 v196, v5, v196
v_mul_f32 v197, v5, v197
v_cvt_pk_bf16_f32 v196, v196, v197
v_mul_f32 v198, v5, v198
v_mul_f32 v199, v5, v199
v_cvt_pk_bf16_f32 v197, v198, v199
v_mfma_f32_16x16x32_bf16 a[152:155], v[16:19], v[176:179], a[152:155]
ds_read_b64_tr_b16 v[12:13], v103 offset:16384
v_mul_f32 v204, v5, v204
v_mfma_f32_16x16x32_bf16 a[156:159], v[16:19], v[180:183], a[156:159]
ds_read_b64_tr_b16 v[14:15], v103 offset:18432
v_mul_f32 v205, v5, v205
v_cvt_pk_bf16_f32 v198, v204, v205
v_mul_f32 v206, v5, v206
v_mul_f32 v207, v5, v207
v_cvt_pk_bf16_f32 v199, v206, v207
s_waitcnt lgkmcnt(4)
v_mfma_f32_16x16x32_bf16 a[128:131], v[20:23], v[192:195], a[128:131]
ds_read_b64_tr_b16 v[16:17], v100 offset:20480
v_mul_f32 v208, v9, v208
v_mfma_f32_16x16x32_bf16 a[132:135], v[20:23], v[196:199], a[132:135]
ds_read_b64_tr_b16 v[18:19], v100 offset:22528
buffer_load_dword off, s[8:11], s12 lds
v_mul_f32 v209, v9, v209
v_cvt_pk_bf16_f32 v208, v208, v209
v_mul_f32 v210, v9, v210
v_mul_f32 v211, v9, v211
v_mfma_f32_16x16x32_bf16 a[136:139], v[24:27], v[192:195], a[136:139]
ds_read_b64_tr_b16 v[20:21], v101 offset:20480
v_cvt_pk_bf16_f32 v209, v210, v211
v_mfma_f32_16x16x32_bf16 a[140:143], v[24:27], v[196:199], a[140:143]
ds_read_b64_tr_b16 v[22:23], v101 offset:22528
v_mul_f32 v216, v9, v216
v_mul_f32 v217, v9, v217
v_cvt_pk_bf16_f32 v210, v216, v217
v_mul_f32 v218, v9, v218
v_mul_f32 v219, v9, v219
s_waitcnt lgkmcnt(4)
v_mfma_f32_16x16x32_bf16 a[144:147], v[28:31], v[192:195], a[144:147]
ds_read_b64_tr_b16 v[24:25], v102 offset:20480
v_cvt_pk_bf16_f32 v211, v218, v219
v_mfma_f32_16x16x32_bf16 a[148:151], v[28:31], v[196:199], a[148:151]
ds_read_b64_tr_b16 v[26:27], v102 offset:22528
v_mul_f32 v212, v5, v212
v_mul_f32 v213, v5, v213
v_cvt_pk_bf16_f32 v212, v212, v213
v_mul_f32 v214, v5, v214
v_mul_f32 v215, v5, v215
v_cvt_pk_bf16_f32 v213, v214, v215
v_mfma_f32_16x16x32_bf16 a[152:155], v[12:15], v[192:195], a[152:155]
s_branch L_pg21
L_sp108:
v_mov_b32 v8, 0
ds_read_b32 v8, v8 offset:14336
s_waitcnt lgkmcnt(0)
v_cmp_le_u32 vcc, 117, v8
s_cbranch_vccz L_sp108
s_branch L_ok108
L_sp110:
v_mov_b32 v8, 0
ds_read_b32 v8, v8 offset:14336
s_waitcnt lgkmcnt(0)
v_cmp_le_u32 vcc, 119, v8
s_cbranch_vccz L_sp110
s_branch L_ok110
.p2align 12
L_stub21:
s_setpc_b64 s[94:95]
L_pg21:
ds_read_b64_tr_b16 v[28:29], v103 offset:20480
v_mul_f32 v220, v5, v220
v_mfma_f32_16x16x32_bf16 a[156:159], v[12:15], v[196:199], a[156:159]
ds_read_b64_tr_b16 v[30:31], v103 offset:22528
v_mul_f32 v221, v5, v221
v_cvt_pk_bf16_f32 v214, v220, v221
v_mul_f32 v222, v5, v222
v_mul_f32 v223, v5, v223
v_cvt_pk_bf16_f32 v215, v222, v223
s_waitcnt lgkmcnt(4)
v_mfma_f32_16x16x32_bf16 a[128:131], v[16:19], v[208:211], a[128:131]
ds_read_b64_tr_b16 v[12:13], v100 offset:24576
v_mov_b32 v8, 0
v_mfma_f32_16x16x32_bf16 a[132:135], v[16:19], v[212:215], a[132:135]
ds_read_b64_tr_b16 v[14:15], v100 offset:26624
v_accvgpr_read_b32 v108, a0
v_accvgpr_read_b32 v109, a1
v_mul_f32 v108, v9, v108
v_mul_f32 v109, v9, v109
v_cvt_pk_bf16_f32 v112, v108, v109
v_accvgpr_read_b32 v110, a2
v_accvgpr_read_b32 v111, a3
v_mul_f32 v110, v9, v110
v_mul_f32 v111, v9, v111
v_cvt_pk_bf16_f32 v113, v110, v111
v_mfma_f32_16x16x32_bf16 a[136:139], v[20:23], v[208:211], a[136:139]
ds_read_b64_tr_b16 v[16:17], v101 offset:24576
v_accvgpr_read_b32 v108, a8
v_mfma_f32_16x16x32_bf16 a[140:143], v[20:23], v[212:215], a[140:143]
ds_read_b64_tr_b16 v[18:19], v101 offset:26624
v_accvgpr_read_b32 v109, a9
v_mul_f32 v108, v9, v108
v_mul_f32 v109, v9, v109
v_cvt_pk_bf16_f32 v114, v108, v109
v_accvgpr_read_b32 v110, a10
v_accvgpr_read_b32 v111, a11
v_mul_f32 v110, v9, v110
v_mul_f32 v111, v9, v111
v_cvt_pk_bf16_f32 v115, v110, v111
s_waitcnt lgkmcnt(4)
v_mfma_f32_16x16x32_bf16 a[144:147], v[24:27], v[208:211], a[144:147]
ds_read_b64_tr_b16 v[20:21], v102 offset:24576
v_accvgpr_read_b32 v108, a4
v_mfma_f32_16x16x32_bf16 a[148:151], v[24:27], v[212:215], a[148:151]
ds_read_b64_tr_b16 v[22:23], v102 offset:26624
v_accvgpr_read_b32 v109, a5
ds_read_b32 v8, v8 offset:14336
v_mul_f32 v108, v5, v108
v_mul_f32 v109, v5, v109
v_cvt_pk_bf16_f32 v116, v108, v109
v_accvgpr_read_b32 v110, a6
v_accvgpr_read_b32 v111, a7
v_mul_f32 v110, v5, v110
v_mul_f32 v111, v5, v111
v_cvt_pk_bf16_f32 v117, v110, v111
v_mfma_f32_16x16x32_bf16 a[152:155], v[28:31], v[208:211], a[152:155]
ds_read_b64_tr_b16 v[24:25], v103 offset:24576
v_accvgpr_read_b32 v108, a12
v_mfma_f32_16x16x32_bf16 a[156:159], v[28:31], v[212:215], a[156:159]
ds_read_b64_tr_b16 v[26:27], v103 offset:26624
v_accvgpr_read_b32 v109, a13
v_mul_f32 v108, v5, v108
v_mul_f32 v109, v5, v109
v_cvt_pk_bf16_f32 v118, v108, v109
v_accvgpr_read_b32 v110, a14
v_accvgpr_read_b32 v111, a15
v_mul_f32 v110, v5, v110
v_mul_f32 v111, v5, v111
v_cvt_pk_bf16_f32 v119, v110, v111
s_waitcnt lgkmcnt(5)
v_mfma_f32_16x16x32_bf16 a[128:131], v[12:15], v[112:115], a[128:131]
ds_read_b64_tr_b16 v[28:29], v100 offset:28672
v_accvgpr_read_b32 v108, a16
v_mfma_f32_16x16x32_bf16 a[132:135], v[12:15], v[116:119], a[132:135]
ds_read_b64_tr_b16 v[30:31], v100 offset:30720
v_accvgpr_read_b32 v109, a17
v_mul_f32 v108, v9, v108
v_mul_f32 v109, v9, v109
v_cvt_pk_bf16_f32 v120, v108, v109
v_accvgpr_read_b32 v110, a18
v_accvgpr_read_b32 v111, a19
v_mul_f32 v110, v9, v110
v_mul_f32 v111, v9, v111
v_cvt_pk_bf16_f32 v121, v110, v111
v_accvgpr_read_b32 v108, a24
v_mfma_f32_16x16x32_bf16 a[136:139], v[16:19], v[112:115], a[136:139]
ds_read_b64_tr_b16 v[12:13], v101 offset:28672
v_accvgpr_read_b32 v109, a25
v_mfma_f32_16x16x32_bf16 a[140:143], v[16:19], v[116:119], a[140:143]
ds_read_b64_tr_b16 v[14:15], v101 offset:30720
v_mul_f32 v108, v9, v108
v_mul_f32 v109, v9, v109
v_cvt_pk_bf16_f32 v122, v108, v109
v_accvgpr_read_b32 v110, a26
v_accvgpr_read_b32 v111, a27
v_mul_f32 v110, v9, v110
v_mul_f32 v111, v9, v111
v_cvt_pk_bf16_f32 v123, v110, v111
v_accvgpr_read_b32 v108, a20
s_waitcnt lgkmcnt(4)
v_mfma_f32_16x16x32_bf16 a[144:147], v[20:23], v[112:115], a[144:147]
ds_read_b64_tr_b16 v[16:17], v102 offset:28672
v_cmp_le_u32 vcc, 117, v8
v_mfma_f32_16x16x32_bf16 a[148:151], v[20:23], v[116:119], a[148:151]
ds_read_b64_tr_b16 v[18:19], v102 offset:30720
v_accvgpr_read_b32 v109, a21
v_mul_f32 v108, v5, v108
v_mul_f32 v109, v5, v109
v_cvt_pk_bf16_f32 v124, v108, v109
v_accvgpr_read_b32 v110, a22
v_accvgpr_read_b32 v111, a23
v_mul_f32 v110, v5, v110
v_mul_f32 v111, v5, v111
v_cvt_pk_bf16_f32 v125, v110, v111
v_mfma_f32_16x16x32_bf16 a[152:155], v[24:27], v[112:115], a[152:155]
ds_read_b64_tr_b16 v[20:21], v103 offset:28672
v_accvgpr_read_b32 v108, a28
v_mfma_f32_16x16x32_bf16 a[156:159], v[24:27], v[116:119], a[156:159]
ds_read_b64_tr_b16 v[22:23], v103 offset:30720
v_accvgpr_read_b32 v109, a29
v_mul_f32 v108, v5, v108
v_mul_f32 v109, v5, v109
v_cvt_pk_bf16_f32 v126, v108, v109
v_accvgpr_read_b32 v110, a30
v_accvgpr_read_b32 v111, a31
v_mul_f32 v110, v5, v110
v_mul_f32 v111, v5, v111
v_cvt_pk_bf16_f32 v127, v110, v111
s_waitcnt lgkmcnt(4)
v_mfma_f32_16x16x32_bf16 a[128:131], v[28:31], v[120:123], a[128:131]
s_cbranch_vccz L_sp108
L_ok108:
ds_read_b64_tr_b16 v[24:25], v96 offset:49152
v_mfma_f32_16x16x32_bf16 a[132:135], v[28:31], v[124:127], a[132:135]
ds_read_b64_tr_b16 v[26:27], v96 offset:51200
v_mfma_f32_16x16x32_bf16 a[136:139], v[12:15], v[120:123], a[136:139]
ds_read_b64_tr_b16 v[28:29], v96 offset:53248
v_mfma_f32_16x16x32_bf16 a[140:143], v[12:15], v[124:127], a[140:143]
ds_read_b64_tr_b16 v[30:31], v96 offset:55296
s_waitcnt lgkmcnt(4)
v_mfma_f32_16x16x32_bf16 a[144:147], v[16:19], v[120:123], a[144:147]
ds_read_b64_tr_b16 v[12:13], v96 offset:57344
s_movk_i32 s12, 432
v_mfma_f32_16x16x32_bf16 a[148:151], v[16:19], v[124:127], a[148:151]
ds_read_b64_tr_b16 v[14:15], v96 offset:59392
v_mfma_f32_16x16x32_bf16 a[152:155], v[20:23], v[120:123], a[152:155]
ds_read_b64_tr_b16 v[16:17], v96 offset:61440
v_mfma_f32_16x16x32_bf16 a[156:159], v[20:23], v[124:127], a[156:159]
ds_read_b64_tr_b16 v[18:19], v96 offset:63488
s_waitcnt lgkmcnt(4)
v_mfma_f32_16x16x32_bf16 a[160:163], v[24:27], v[128:131], a[160:163]
ds_read_b64_tr_b16 v[20:21], v97 offset:49152
ds_read_b64_tr_b16 v[22:23], v97 offset:51200
v_mfma_f32_16x16x32_bf16 a[164:167], v[24:27], v[132:135], a[164:167]
buffer_load_dword off, s[8:11], s12 lds
v_mfma_f32_16x16x32_bf16 a[164:167], v[28:31], v[148:151], a[164:167]
ds_read_b64_tr_b16 v[24:25], v97 offset:53248
v_accvgpr_read_b32 v168, a128
v_mfma_f32_16x16x32_bf16 a[160:163], v[28:31], v[144:147], a[160:163]
ds_read_b64_tr_b16 v[26:27], v97 offset:55296
v_accvgpr_read_b32 v169, a129
s_waitcnt lgkmcnt(4)
v_mfma_f32_16x16x32_bf16 a[160:163], v[12:15], v[160:163], a[160:163]
ds_read_b64_tr_b16 v[28:29], v97 offset:57344
v_cvt_pk_bf16_f32 v136, v168, v169
v_mfma_f32_16x16x32_bf16 a[164:167], v[12:15], v[164:167], a[164:167]
ds_read_b64_tr_b16 v[30:31], v97 offset:59392
v_accvgpr_read_b32 v170, a130
v_mfma_f32_16x16x32_bf16 a[164:167], v[16:19], v[180:183], a[164:167]
ds_read_b64_tr_b16 v[12:13], v97 offset:61440
v_accvgpr_read_b32 v171, a131
v_mfma_f32_16x16x32_bf16 a[160:163], v[16:19], v[176:179], a[160:163]
ds_read_b64_tr_b16 v[14:15], v97 offset:63488
v_cvt_pk_bf16_f32 v137, v170, v171
s_waitcnt lgkmcnt(4)
v_mfma_f32_16x16x32_bf16 a[168:171], v[20:23], v[128:131], a[168:171]
ds_read_b64_tr_b16 v[16:17], v98 offset:49152
v_accvgpr_read_b32 v168, a136
v_mfma_f32_16x16x32_bf16 a[172:175], v[20:23], v[132:135], a[172:175]
ds_read_b64_tr_b16 v[18:19], v98 offset:51200
v_accvgpr_read_b32 v169, a137
v_cvt_pk_bf16_f32 v138, v168, v169
v_mfma_f32_16x16x32_bf16 a[172:175], v[24:27], v[148:151], a[172:175]
ds_read_b64_tr_b16 v[20:21], v98 offset:53248
v_accvgpr_read_b32 v170, a138
v_mfma_f32_16x16x32_bf16 a[168:171], v[24:27], v[144:147], a[168:171]
ds_read_b64_tr_b16 v[22:23], v98 offset:55296
s_waitcnt lgkmcnt(4)
v_mfma_f32_16x16x32_bf16 a[168:171], v[28:31], v[160:163], a[168:171]
ds_read_b64_tr_b16 v[24:25], v98 offset:57344
v_accvgpr_read_b32 v171, a139
v_mfma_f32_16x16x32_bf16 a[172:175], v[28:31], v[164:167], a[172:175]
ds_read_b64_tr_b16 v[26:27], v98 offset:59392
v_cvt_pk_bf16_f32 v139, v170, v171
v_mfma_f32_16x16x32_bf16 a[172:175], v[12:15], v[180:183], a[172:175]
ds_read_b64_tr_b16 v[28:29], v98 offset:61440
buffer_store_dwordx4 v[136:139], v88, s[28:31], s49 offen sc1
v_mfma_f32_16x16x32_bf16 a[168:171], v[12:15], v[176:179], a[168:171]
ds_read_b64_tr_b16 v[30:31], v98 offset:63488
v_accvgpr_read_b32 v168, a132
s_waitcnt lgkmcnt(4)
v_mfma_f32_16x16x32_bf16 a[176:179], v[16:19], v[128:131], a[176:179]
ds_read_b64_tr_b16 v[12:13], v99 offset:49152
v_accvgpr_read_b32 v169, a133
v_mfma_f32_16x16x32_bf16 a[180:183], v[16:19], v[132:135], a[180:183]
ds_read_b64_tr_b16 v[14:15], v99 offset:51200
v_cvt_pk_bf16_f32 v140, v168, v169
v_mfma_f32_16x16x32_bf16 a[180:183], v[20:23], v[148:151], a[180:183]
ds_read_b64_tr_b16 v[16:17], v99 offset:53248
v_accvgpr_read_b32 v170, a134
v_mfma_f32_16x16x32_bf16 a[176:179], v[20:23], v[144:147], a[176:179]
ds_read_b64_tr_b16 v[18:19], v99 offset:55296
v_accvgpr_read_b32 v171, a135
s_waitcnt lgkmcnt(4)
v_mfma_f32_16x16x32_bf16 a[176:179], v[24:27], v[160:163], a[176:179]
ds_read_b64_tr_b16 v[20:21], v99 offset:57344
v_cvt_pk_bf16_f32 v141, v170, v171
v_mfma_f32_16x16x32_bf16 a[180:183], v[24:27], v[164:167], a[180:183]
ds_read_b64_tr_b16 v[22:23], v99 offset:59392
v_accvgpr_read_b32 v168, a140
v_accvgpr_read_b32 v169, a141
v_mfma_f32_16x16x32_bf16 a[180:183], v[28:31], v[180:183], a[180:183]
ds_read_b64_tr_b16 v[24:25], v99 offset:61440
v_cvt_pk_bf16_f32 v142, v168, v169
v_mfma_f32_16x16x32_bf16 a[176:179], v[28:31], v[176:179], a[176:179]
ds_read_b64_tr_b16 v[26:27], v99 offset:63488
s_waitcnt lgkmcnt(4)
v_mfma_f32_16x16x32_bf16 a[184:187], v[12:15], v[128:131], a[184:187]
ds_read_b64_tr_b16 v[28:29], v96 offset:16384
v_accvgpr_read_b32 v170, a142
v_mfma_f32_16x16x32_bf16 a[188:191], v[12:15], v[132:135], a[188:191]
ds_read_b64_tr_b16 v[30:31], v96 offset:18432
v_accvgpr_read_b32 v171, a143
v_cvt_pk_bf16_f32 v143, v170, v171
v_mfma_f32_16x16x32_bf16 a[188:191], v[16:19], v[148:151], a[188:191]
ds_read_b64_tr_b16 v[12:13], v96 offset:20480
buffer_store_dwordx4 v[140:143], v88, s[28:31], s49 offen offset:1024 sc1
v_mfma_f32_16x16x32_bf16 a[184:187], v[16:19], v[144:147], a[184:187]
ds_read_b64_tr_b16 v[14:15], v96 offset:22528
s_waitcnt lgkmcnt(4)
v_mfma_f32_16x16x32_bf16 a[184:187], v[20:23], v[160:163], a[184:187]
ds_read_b64_tr_b16 v[16:17], v96 offset:24576
s_movk_i32 s12, 436
v_mfma_f32_16x16x32_bf16 a[188:191], v[20:23], v[164:167], a[188:191]
ds_read_b64_tr_b16 v[18:19], v96 offset:26624
v_accvgpr_read_b32 v168, a144
v_mfma_f32_16x16x32_bf16 a[188:191], v[24:27], v[180:183], a[188:191]
ds_read_b64_tr_b16 v[20:21], v96 offset:28672
v_accvgpr_read_b32 v169, a145
v_mfma_f32_16x16x32_bf16 a[184:187], v[24:27], v[176:179], a[184:187]
ds_read_b64_tr_b16 v[22:23], v96 offset:30720
v_cvt_pk_bf16_f32 v152, v168, v169
s_waitcnt lgkmcnt(4)
v_mfma_f32_16x16x32_bf16 a[160:163], v[28:31], v[192:195], a[160:163]
ds_read_b64_tr_b16 v[24:25], v97 offset:16384
v_accvgpr_read_b32 v170, a146
v_mfma_f32_16x16x32_bf16 a[164:167], v[28:31], v[196:199], a[164:167]
ds_read_b64_tr_b16 v[26:27], v97 offset:18432
buffer_load_dword off, s[8:11], s12 lds
v_mfma_f32_16x16x32_bf16 a[164:167], v[12:15], v[212:215], a[164:167]
ds_read_b64_tr_b16 v[28:29], v97 offset:20480
v_accvgpr_read_b32 v171, a147
v_mfma_f32_16x16x32_bf16 a[160:163], v[12:15], v[208:211], a[160:163]
ds_read_b64_tr_b16 v[30:31], v97 offset:22528
s_waitcnt lgkmcnt(4)
v_mfma_f32_16x16x32_bf16 a[160:163], v[16:19], v[112:115], a[160:163]
ds_read_b64_tr_b16 v[12:13], v97 offset:24576
v_cvt_pk_bf16_f32 v153, v170, v171
v_mfma_f32_16x16x32_bf16 a[164:167], v[16:19], v[116:119], a[164:167]
ds_read_b64_tr_b16 v[14:15], v97 offset:26624
v_accvgpr_read_b32 v168, a152
v_accvgpr_read_b32 v169, a153
v_mfma_f32_16x16x32_bf16 a[164:167], v[20:23], v[124:127], a[164:167]
ds_read_b64_tr_b16 v[16:17], v97 offset:28672
v_cvt_pk_bf16_f32 v154, v168, v169
v_mfma_f32_16x16x32_bf16 a[160:163], v[20:23], v[120:123], a[160:163]
ds_read_b64_tr_b16 v[18:19], v97 offset:30720
v_accvgpr_read_b32 v170, a154
s_waitcnt lgkmcnt(4)
v_mfma_f32_16x16x32_bf16 a[168:171], v[24:27], v[192:195], a[168:171]
ds_read_b64_tr_b16 v[20:21], v98 offset:16384
v_mov_b32 v8, 0
v_mfma_f32_16x16x32_bf16 a[172:175], v[24:27], v[196:199], a[172:175]
ds_read_b64_tr_b16 v[22:23], v98 offset:18432
v_accvgpr_read_b32 v171, a155
v_mfma_f32_16x16x32_bf16 a[172:175], v[28:31], v[212:215], a[172:175]
ds_read_b64_tr_b16 v[24:25], v98 offset:20480
v_cvt_pk_bf16_f32 v155, v170, v171
v_mfma_f32_16x16x32_bf16 a[168:171], v[28:31], v[208:211], a[168:171]
ds_read_b64_tr_b16 v[26:27], v98 offset:22528
buffer_store_dwordx4 v[152:155], v88, s[28:31], s49 offen offset:2048 sc1
s_waitcnt lgkmcnt(4)
v_mfma_f32_16x16x32_bf16 a[168:171], v[12:15], v[112:115], a[168:171]
ds_read_b64_tr_b16 v[28:29], v98 offset:24576
v_accvgpr_read_b32 v168, a148
v_mfma_f32_16x16x32_bf16 a[172:175], v[12:15], v[116:119], a[172:175]
ds_read_b64_tr_b16 v[30:31], v98 offset:26624
ds_read_b32 v8, v8 offset:14336
v_mfma_f32_16x16x32_bf16 a[172:175], v[16:19], v[124:127], a[172:175]
ds_read_b64_tr_b16 v[12:13], v98 offset:28672
v_accvgpr_read_b32 v169, a149
v_mfma_f32_16x16x32_bf16 a[168:171], v[16:19], v[120:123], a[168:171]
ds_read_b64_tr_b16 v[14:15], v98 offset:30720
s_waitcnt lgkmcnt(5)
v_mfma_f32_16x16x32_bf16 a[176:179], v[20:23], v[192:195], a[176:179]
ds_read_b64_tr_b16 v[16:17], v99 offset:16384
v_cvt_pk_bf16_f32 v156, v168, v169
v_mfma_f32_16x16x32_bf16 a[180:183], v[20:23], v[196:199], a[180:183]
ds_read_b64_tr_b16 v[18:19], v99 offset:18432
v_accvgpr_read_b32 v170, a150
v_accvgpr_read_b32 v171, a151
v_mfma_f32_16x16x32_bf16 a[180:183], v[24:27], v[212:215], a[180:183]
ds_read_b64_tr_b16 v[20:21], v99 offset:20480
v_cvt_pk_bf16_f32 v157, v170, v171
v_mfma_f32_16x16x32_bf16 a[176:179], v[24:27], v[208:211], a[176:179]
ds_read_b64_tr_b16 v[22:23], v99 offset:22528
v_accvgpr_read_b32 v168, a156
s_waitcnt lgkmcnt(4)
v_mfma_f32_16x16x32_bf16 a[176:179], v[28:31], v[112:115], a[176:179]
ds_read_b64_tr_b16 v[24:25], v99 offset:24576
v_cmp_le_u32 vcc, 119, v8
v_mfma_f32_16x16x32_bf16 a[180:183], v[28:31], v[116:119], a[180:183]
ds_read_b64_tr_b16 v[26:27], v99 offset:26624
v_accvgpr_read_b32 v169, a157
v_mfma_f32_16x16x32_bf16 a[180:183], v[12:15], v[124:127], a[180:183]
ds_read_b64_tr_b16 v[28:29], v99 offset:28672
v_cvt_pk_bf16_f32 v158, v168, v169
v_mfma_f32_16x16x32_bf16 a[176:179], v[12:15], v[120:123], a[176:179]
ds_read_b64_tr_b16 v[30:31], v99 offset:30720
v_accvgpr_read_b32 v170, a158
s_waitcnt lgkmcnt(4)
v_mfma_f32_16x16x32_bf16 a[184:187], v[16:19], v[192:195], a[184:187]
s_cbranch_vccz L_sp110
L_ok110:
ds_read_b64_tr_b16 v[12:13], v92 offset:32768
v_mfma_f32_16x16x32_bf16 a[188:191], v[16:19], v[196:199], a[188:191]
ds_read_b64_tr_b16 v[14:15], v92 offset:34816
v_accvgpr_read_b32 v171, a159
v_cvt_pk_bf16_f32 v159, v170, v171
v_mfma_f32_16x16x32_bf16 a[188:191], v[20:23], v[212:215], a[188:191]
ds_read_b64_tr_b16 v[16:17], v92 offset:36864
buffer_store_dwordx4 v[156:159], v88, s[28:31], s49 offen offset:3072 sc1
v_mfma_f32_16x16x32_bf16 a[184:187], v[20:23], v[208:211], a[184:187]
ds_read_b64_tr_b16 v[18:19], v92 offset:38912
s_waitcnt lgkmcnt(4)
v_mfma_f32_16x16x32_bf16 a[184:187], v[24:27], v[112:115], a[184:187]
ds_read_b64_tr_b16 v[20:21], v92 offset:40960
s_movk_i32 s12, 440
v_mfma_f32_16x16x32_bf16 a[188:191], v[24:27], v[116:119], a[188:191]
ds_read_b64_tr_b16 v[22:23], v92 offset:43008
s_add_u32 s49, s49, 12288
v_mfma_f32_16x16x32_bf16 a[188:191], v[28:31], v[124:127], a[188:191]
ds_read_b64_tr_b16 v[24:25], v92 offset:45056
v_mfma_f32_16x16x32_bf16 a[184:187], v[28:31], v[120:123], a[184:187]
ds_read_b64_tr_b16 v[26:27], v92 offset:47104
s_waitcnt lgkmcnt(4)
v_mfma_f32_16x16x32_bf16 a[192:195], v[12:15], v[128:131], a[192:195]
ds_read_b64_tr_b16 v[28:29], v93 offset:32768
ds_read_b64_tr_b16 v[30:31], v93 offset:34816
v_mfma_f32_16x16x32_bf16 a[196:199], v[12:15], v[132:135], a[196:199]
buffer_load_dword off, s[8:11], s12 lds
v_mfma_f32_16x16x32_bf16 a[196:199], v[16:19], v[148:151], a[196:199]
ds_read_b64_tr_b16 v[12:13], v93 offset:36864
v_accvgpr_read_b32 v168, a160
v_mfma_f32_16x16x32_bf16 a[192:195], v[16:19], v[144:147], a[192:195]
ds_read_b64_tr_b16 v[14:15], v93 offset:38912
v_accvgpr_read_b32 v169, a161
s_waitcnt lgkmcnt(4)
v_mfma_f32_16x16x32_bf16 a[192:195], v[20:23], v[160:163], a[192:195]
ds_read_b64_tr_b16 v[16:17], v93 offset:40960
v_cvt_pk_bf16_f32 v136, v168, v169
v_mfma_f32_16x16x32_bf16 a[196:199], v[20:23], v[164:167], a[196:199]
ds_read_b64_tr_b16 v[18:19], v93 offset:43008
v_accvgpr_read_b32 v170, a162
v_mfma_f32_16x16x32_bf16 a[196:199], v[24:27], v[180:183], a[196:199]
ds_read_b64_tr_b16 v[20:21], v93 offset:45056
v_accvgpr_read_b32 v171, a163
v_mfma_f32_16x16x32_bf16 a[192:195], v[24:27], v[176:179], a[192:195]
ds_read_b64_tr_b16 v[22:23], v93 offset:47104
v_cvt_pk_bf16_f32 v137, v170, v171
s_waitcnt lgkmcnt(4)
v_mfma_f32_16x16x32_bf16 a[200:203], v[28:31], v[128:131], a[200:203]
ds_read_b64_tr_b16 v[24:25], v94 offset:32768
v_accvgpr_read_b32 v168, a168
v_mfma_f32_16x16x32_bf16 a[204:207], v[28:31], v[132:135], a[204:207]
ds_read_b64_tr_b16 v[26:27], v94 offset:34816
v_accvgpr_read_b32 v169, a169
v_cvt_pk_bf16_f32 v138, v168, v169
v_mfma_f32_16x16x32_bf16 a[204:207], v[12:15], v[148:151], a[204:207]
ds_read_b64_tr_b16 v[28:29], v94 offset:36864
v_accvgpr_read_b32 v170, a170
v_mfma_f32_16x16x32_bf16 a[200:203], v[12:15], v[144:147], a[200:203]
ds_read_b64_tr_b16 v[30:31], v94 offset:38912
s_waitcnt lgkmcnt(4)
v_mfma_f32_16x16x32_bf16 a[200:203], v[16:19], v[160:163], a[200:203]
ds_read_b64_tr_b16 v[12:13], v94 offset:40960
v_accvgpr_read_b32 v171, a171
v_mfma_f32_16x16x32_bf16 a[204:207], v[16:19], v[164:167], a[204:207]
ds_read_b64_tr_b16 v[14:15], v94 offset:43008
v_cvt_pk_bf16_f32 v139, v170, v171
v_mfma_f32_16x16x32_bf16 a[204:207], v[20:23], v[180:183], a[204:207]
ds_read_b64_tr_b16 v[16:17], v94 offset:45056
buffer_store_dwordx4 v[136:139], v88, s[28:31], s49 offen sc1
v_mfma_f32_16x16x32_bf16 a[200:203], v[20:23], v[176:179], a[200:203]
ds_read_b64_tr_b16 v[18:19], v94 offset:47104
s_waitcnt lgkmcnt(4)
v_mfma_f32_16x16x32_bf16 a[208:211], v[24:27], v[128:131], a[208:211]
ds_read_b64_tr_b16 v[20:21], v95 offset:32768
v_accvgpr_read_b32 v168, a164
v_mfma_f32_16x16x32_bf16 a[212:215], v[24:27], v[132:135], a[212:215]
ds_read_b64_tr_b16 v[22:23], v95 offset:34816
v_accvgpr_read_b32 v169, a165
v_cvt_pk_bf16_f32 v140, v168, v169
v_mfma_f32_16x16x32_bf16 a[212:215], v[28:31], v[148:151], a[212:215]
ds_read_b64_tr_b16 v[24:25], v95 offset:36864
v_accvgpr_read_b32 v170, a166
v_mfma_f32_16x16x32_bf16 a[208:211], v[28:31], v[144:147], a[208:211]
ds_read_b64_tr_b16 v[26:27], v95 offset:38912
v_accvgpr_read_b32 v171, a167
s_waitcnt lgkmcnt(4)
v_mfma_f32_16x16x32_bf16 a[208:211], v[12:15], v[160:163], a[208:211]
ds_read_b64_tr_b16 v[28:29], v95 offset:40960
v_cvt_pk_bf16_f32 v141, v170, v171
v_mfma_f32_16x16x32_bf16 a[212:215], v[12:15], v[164:167], a[212:215]
ds_read_b64_tr_b16 v[30:31], v95 offset:43008
v_accvgpr_read_b32 v168, a172
v_mfma_f32_16x16x32_bf16 a[212:215], v[16:19], v[180:183], a[212:215]
ds_read_b64_tr_b16 v[12:13], v95 offset:45056
v_accvgpr_read_b32 v169, a173
v_mfma_f32_16x16x32_bf16 a[208:211], v[16:19], v[176:179], a[208:211]
ds_read_b64_tr_b16 v[14:15], v95 offset:47104
v_cvt_pk_bf16_f32 v142, v168, v169
s_waitcnt lgkmcnt(4)
v_mfma_f32_16x16x32_bf16 a[216:219], v[20:23], v[128:131], a[216:219]
ds_read_b64_tr_b16 v[16:17], v92 offset:16384
v_accvgpr_read_b32 v170, a174
v_mfma_f32_16x16x32_bf16 a[220:223], v[20:23], v[132:135], a[220:223]
ds_read_b64_tr_b16 v[18:19], v92 offset:18432
v_accvgpr_read_b32 v171, a175
v_cvt_pk_bf16_f32 v143, v170, v171
v_mfma_f32_16x16x32_bf16 a[220:223], v[24:27], v[148:151], a[220:223]
ds_read_b64_tr_b16 v[20:21], v92 offset:20480
buffer_store_dwordx4 v[140:143], v88, s[28:31], s49 offen offset:1024 sc1
v_mfma_f32_16x16x32_bf16 a[216:219], v[24:27], v[144:147], a[216:219]
ds_read_b64_tr_b16 v[22:23], v92 offset:22528
s_waitcnt lgkmcnt(4)
v_mfma_f32_16x16x32_bf16 a[216:219], v[28:31], v[160:163], a[216:219]
ds_read_b64_tr_b16 v[24:25], v92 offset:24576
s_movk_i32 s12, 444
v_mfma_f32_16x16x32_bf16 a[220:223], v[28:31], v[164:167], a[220:223]
ds_read_b64_tr_b16 v[26:27], v92 offset:26624
v_accvgpr_read_b32 v168, a176
v_mfma_f32_16x16x32_bf16 a[220:223], v[12:15], v[180:183], a[220:223]
ds_read_b64_tr_b16 v[28:29], v92 offset:28672
v_accvgpr_read_b32 v169, a177
v_mfma_f32_16x16x32_bf16 a[216:219], v[12:15], v[176:179], a[216:219]
ds_read_b64_tr_b16 v[30:31], v92 offset:30720
s_waitcnt lgkmcnt(4)
v_mfma_f32_16x16x32_bf16 a[192:195], v[16:19], v[192:195], a[192:195]
ds_read_b64_tr_b16 v[12:13], v93 offset:16384
v_cvt_pk_bf16_f32 v152, v168, v169
v_mfma_f32_16x16x32_bf16 a[196:199], v[16:19], v[196:199], a[196:199]
ds_read_b64_tr_b16 v[14:15], v93 offset:18432
buffer_load_dword off, s[8:11], s12 lds
v_mfma_f32_16x16x32_bf16 a[196:199], v[20:23], v[212:215], a[196:199]
ds_read_b64_tr_b16 v[16:17], v93 offset:20480
v_accvgpr_read_b32 v170, a178
v_mfma_f32_16x16x32_bf16 a[192:195], v[20:23], v[208:211], a[192:195]
ds_read_b64_tr_b16 v[18:19], v93 offset:22528
v_accvgpr_read_b32 v171, a179
s_waitcnt lgkmcnt(4)
v_mfma_f32_16x16x32_bf16 a[192:195], v[24:27], v[112:115], a[192:195]
ds_read_b64_tr_b16 v[20:21], v93 offset:24576
v_cvt_pk_bf16_f32 v153, v170, v171
v_mfma_f32_16x16x32_bf16 a[196:199], v[24:27], v[116:119], a[196:199]
ds_read_b64_tr_b16 v[22:23], v93 offset:26624
v_accvgpr_read_b32 v168, a184
v_mfma_f32_16x16x32_bf16 a[196:199], v[28:31], v[124:127], a[196:199]
ds_read_b64_tr_b16 v[24:25], v93 offset:28672
v_accvgpr_read_b32 v169, a185
v_mfma_f32_16x16x32_bf16 a[192:195], v[28:31], v[120:123], a[192:195]
ds_read_b64_tr_b16 v[26:27], v93 offset:30720
v_cvt_pk_bf16_f32 v154, v168, v169
s_waitcnt lgkmcnt(4)
v_mfma_f32_16x16x32_bf16 a[200:203], v[12:15], v[192:195], a[200:203]
ds_read_b64_tr_b16 v[28:29], v94 offset:16384
v_mov_b32 v8, 0
v_mfma_f32_16x16x32_bf16 a[204:207], v[12:15], v[196:199], a[204:207]
ds_read_b64_tr_b16 v[30:31], v94 offset:18432
v_accvgpr_read_b32 v170, a186
v_accvgpr_read_b32 v171, a187
v_mfma_f32_16x16x32_bf16 a[204:207], v[16:19], v[212:215], a[204:207]
ds_read_b64_tr_b16 v[12:13], v94 offset:20480
v_cvt_pk_bf16_f32 v155, v170, v171
v_mfma_f32_16x16x32_bf16 a[200:203], v[16:19], v[208:211], a[200:203]
ds_read_b64_tr_b16 v[14:15], v94 offset:22528
s_waitcnt lgkmcnt(4)
v_mfma_f32_16x16x32_bf16 a[200:203], v[20:23], v[112:115], a[200:203]
ds_read_b64_tr_b16 v[16:17], v94 offset:24576
buffer_store_dwordx4 v[152:155], v88, s[28:31], s49 offen offset:2048 sc1
v_mfma_f32_16x16x32_bf16 a[204:207], v[20:23], v[116:119], a[204:207]
ds_read_b64_tr_b16 v[18:19], v94 offset:26624
ds_read_b32 v8, v8 offset:14336
v_mfma_f32_16x16x32_bf16 a[204:207], v[24:27], v[124:127], a[204:207]
ds_read_b64_tr_b16 v[20:21], v94 offset:28672
v_accvgpr_read_b32 v168, a180
v_mfma_f32_16x16x32_bf16 a[200:203], v[24:27], v[120:123], a[200:203]
ds_read_b64_tr_b16 v[22:23], v94 offset:30720
v_accvgpr_read_b32 v169, a181
s_waitcnt lgkmcnt(5)
v_mfma_f32_16x16x32_bf16 a[208:211], v[28:31], v[192:195], a[208:211]
ds_read_b64_tr_b16 v[24:25], v95 offset:16384
v_cvt_pk_bf16_f32 v156, v168, v169
v_mfma_f32_16x16x32_bf16 a[212:215], v[28:31], v[196:199], a[212:215]
ds_read_b64_tr_b16 v[26:27], v95 offset:18432
v_accvgpr_read_b32 v170, a182
v_mfma_f32_16x16x32_bf16 a[212:215], v[12:15], v[212:215], a[212:215]
s_branch L_pg22
L_sp112:
v_mov_b32 v8, 0
ds_read_b32 v8, v8 offset:14336
s_waitcnt lgkmcnt(0)
v_cmp_le_u32 vcc, 122, v8
s_cbranch_vccz L_sp112
s_branch L_ok112
L_sp115:
v_mov_b32 v8, 0
ds_read_b32 v8, v8 offset:14336
s_waitcnt lgkmcnt(0)
v_cmp_le_u32 vcc, 124, v8
s_cbranch_vccz L_sp115
s_branch L_ok115
.p2align 12
L_stub22:
s_setpc_b64 s[94:95]
L_pg22:
ds_read_b64_tr_b16 v[28:29], v95 offset:20480
v_accvgpr_read_b32 v171, a183
v_mfma_f32_16x16x32_bf16 a[208:211], v[12:15], v[208:211], a[208:211]
ds_read_b64_tr_b16 v[30:31], v95 offset:22528
v_cvt_pk_bf16_f32 v157, v170, v171
s_waitcnt lgkmcnt(4)
v_mfma_f32_16x16x32_bf16 a[208:211], v[16:19], v[112:115], a[208:211]
ds_read_b64_tr_b16 v[12:13], v95 offset:24576
v_cmp_le_u32 vcc, 122, v8
v_mfma_f32_16x16x32_bf16 a[212:215], v[16:19], v[116:119], a[212:215]
ds_read_b64_tr_b16 v[14:15], v95 offset:26624
v_accvgpr_read_b32 v168, a188
v_mfma_f32_16x16x32_bf16 a[212:215], v[20:23], v[124:127], a[212:215]
ds_read_b64_tr_b16 v[16:17], v95 offset:28672
v_accvgpr_read_b32 v169, a189
v_mfma_f32_16x16x32_bf16 a[208:211], v[20:23], v[120:123], a[208:211]
ds_read_b64_tr_b16 v[18:19], v95 offset:30720
v_cvt_pk_bf16_f32 v158, v168, v169
s_waitcnt lgkmcnt(4)
v_mfma_f32_16x16x32_bf16 a[216:219], v[24:27], v[192:195], a[216:219]
s_cbranch_vccz L_sp112
L_ok112:
ds_read_b64_tr_b16 v[20:21], v96
v_mfma_f32_16x16x32_bf16 a[220:223], v[24:27], v[196:199], a[220:223]
ds_read_b64_tr_b16 v[22:23], v96 offset:2048
v_accvgpr_read_b32 v170, a190
v_accvgpr_read_b32 v171, a191
v_mfma_f32_16x16x32_bf16 a[220:223], v[28:31], v[212:215], a[220:223]
ds_read_b64_tr_b16 v[24:25], v96 offset:4096
v_cvt_pk_bf16_f32 v159, v170, v171
v_mfma_f32_16x16x32_bf16 a[216:219], v[28:31], v[208:211], a[216:219]
ds_read_b64_tr_b16 v[26:27], v96 offset:6144
s_waitcnt lgkmcnt(4)
v_mfma_f32_16x16x32_bf16 a[216:219], v[12:15], v[112:115], a[216:219]
ds_read_b64_tr_b16 v[28:29], v96 offset:8192
buffer_store_dwordx4 v[156:159], v88, s[28:31], s49 offen offset:3072 sc1
v_mfma_f32_16x16x32_bf16 a[220:223], v[12:15], v[116:119], a[220:223]
ds_read_b64_tr_b16 v[30:31], v96 offset:10240
s_add_u32 s49, s49, 12288
v_mfma_f32_16x16x32_bf16 a[220:223], v[16:19], v[124:127], a[220:223]
ds_read_b64_tr_b16 v[12:13], v96 offset:12288
v_mfma_f32_16x16x32_bf16 a[216:219], v[16:19], v[120:123], a[216:219]
ds_read_b64_tr_b16 v[14:15], v96 offset:14336
s_waitcnt lgkmcnt(4)
v_mfma_f32_16x16x32_bf16 a[224:227], v[20:23], v[128:131], a[224:227]
ds_read_b64_tr_b16 v[16:17], v97
v_mfma_f32_16x16x32_bf16 a[228:231], v[20:23], v[132:135], a[228:231]
ds_read_b64_tr_b16 v[18:19], v97 offset:2048
v_mfma_f32_16x16x32_bf16 a[228:231], v[24:27], v[148:151], a[228:231]
ds_read_b64_tr_b16 v[20:21], v97 offset:4096
v_accvgpr_read_b32 v168, a192
v_mfma_f32_16x16x32_bf16 a[224:227], v[24:27], v[144:147], a[224:227]
ds_read_b64_tr_b16 v[22:23], v97 offset:6144
s_waitcnt lgkmcnt(4)
v_mfma_f32_16x16x32_bf16 a[224:227], v[28:31], v[160:163], a[224:227]
ds_read_b64_tr_b16 v[24:25], v97 offset:8192
v_accvgpr_read_b32 v169, a193
v_mfma_f32_16x16x32_bf16 a[228:231], v[28:31], v[164:167], a[228:231]
ds_read_b64_tr_b16 v[26:27], v97 offset:10240
v_cvt_pk_bf16_f32 v136, v168, v169
v_accvgpr_read_b32 v170, a194
v_mfma_f32_16x16x32_bf16 a[228:231], v[12:15], v[180:183], a[228:231]
ds_read_b64_tr_b16 v[28:29], v97 offset:12288
v_accvgpr_read_b32 v171, a195
v_mfma_f32_16x16x32_bf16 a[224:227], v[12:15], v[176:179], a[224:227]
ds_read_b64_tr_b16 v[30:31], v97 offset:14336
s_waitcnt lgkmcnt(4)
v_mfma_f32_16x16x32_bf16 a[232:235], v[16:19], v[128:131], a[232:235]
ds_read_b64_tr_b16 v[12:13], v98
v_cvt_pk_bf16_f32 v137, v170, v171
v_mfma_f32_16x16x32_bf16 a[236:239], v[16:19], v[132:135], a[236:239]
ds_read_b64_tr_b16 v[14:15], v98 offset:2048
v_accvgpr_read_b32 v168, a200
v_accvgpr_read_b32 v169, a201
v_mfma_f32_16x16x32_bf16 a[236:239], v[20:23], v[148:151], a[236:239]
ds_read_b64_tr_b16 v[16:17], v98 offset:4096
v_cvt_pk_bf16_f32 v138, v168, v169
v_mfma_f32_16x16x32_bf16 a[232:235], v[20:23], v[144:147], a[232:235]
ds_read_b64_tr_b16 v[18:19], v98 offset:6144
s_waitcnt lgkmcnt(4)
v_mfma_f32_16x16x32_bf16 a[232:235], v[24:27], v[160:163], a[232:235]
ds_read_b64_tr_b16 v[20:21], v98 offset:8192
v_accvgpr_read_b32 v170, a202
v_mfma_f32_16x16x32_bf16 a[236:239], v[24:27], v[164:167], a[236:239]
ds_read_b64_tr_b16 v[22:23], v98 offset:10240
v_accvgpr_read_b32 v171, a203
v_cvt_pk_bf16_f32 v139, v170, v171
v_mfma_f32_16x16x32_bf16 a[236:239], v[28:31], v[180:183], a[236:239]
ds_read_b64_tr_b16 v[24:25], v98 offset:12288
buffer_store_dwordx4 v[136:139], v88, s[28:31], s49 offen sc1
v_mfma_f32_16x16x32_bf16 a[232:235], v[28:31], v[176:179], a[232:235]
ds_read_b64_tr_b16 v[26:27], v98 offset:14336
s_waitcnt lgkmcnt(4)
v_mfma_f32_16x16x32_bf16 a[240:243], v[12:15], v[128:131], a[240:243]
ds_read_b64_tr_b16 v[28:29], v99
v_accvgpr_read_b32 v168, a196
v_mfma_f32_16x16x32_bf16 a[244:247], v[12:15], v[132:135], a[244:247]
ds_read_b64_tr_b16 v[30:31], v99 offset:2048
v_mfma_f32_16x16x32_bf16 a[244:247], v[16:19], v[148:151], a[244:247]
ds_read_b64_tr_b16 v[12:13], v99 offset:4096
v_accvgpr_read_b32 v169, a197
v_mfma_f32_16x16x32_bf16 a[240:243], v[16:19], v[144:147], a[240:243]
ds_read_b64_tr_b16 v[14:15], v99 offset:6144
v_cvt_pk_bf16_f32 v140, v168, v169
s_waitcnt lgkmcnt(4)
v_mfma_f32_16x16x32_bf16 a[240:243], v[20:23], v[160:163], a[240:243]
ds_read_b64_tr_b16 v[16:17], v99 offset:8192
v_accvgpr_read_b32 v170, a198
v_mfma_f32_16x16x32_bf16 a[244:247], v[20:23], v[164:167], a[244:247]
ds_read_b64_tr_b16 v[18:19], v99 offset:10240
v_accvgpr_read_b32 v171, a199
v_mfma_f32_16x16x32_bf16 a[244:247], v[24:27], v[180:183], a[244:247]
ds_read_b64_tr_b16 v[20:21], v99 offset:12288
v_cvt_pk_bf16_f32 v141, v170, v171
v_mfma_f32_16x16x32_bf16 a[240:243], v[24:27], v[176:179], a[240:243]
ds_read_b64_tr_b16 v[22:23], v99 offset:14336
v_accvgpr_read_b32 v168, a204
s_waitcnt lgkmcnt(4)
v_mfma_f32_16x16x32_bf16 a[248:251], v[28:31], v[128:131], a[248:251]
ds_read_b64_tr_b16 v[24:25], v96 offset:32768
v_accvgpr_read_b32 v169, a205
v_mfma_f32_16x16x32_bf16 a[252:255], v[28:31], v[132:135], a[252:255]
ds_read_b64_tr_b16 v[26:27], v96 offset:34816
v_cvt_pk_bf16_f32 v142, v168, v169
v_mfma_f32_16x16x32_bf16 a[252:255], v[12:15], v[148:151], a[252:255]
ds_read_b64_tr_b16 v[28:29], v96 offset:36864
v_accvgpr_read_b32 v170, a206
v_mfma_f32_16x16x32_bf16 a[248:251], v[12:15], v[144:147], a[248:251]
ds_read_b64_tr_b16 v[30:31], v96 offset:38912
v_accvgpr_read_b32 v171, a207
s_waitcnt lgkmcnt(4)
v_mfma_f32_16x16x32_bf16 a[248:251], v[16:19], v[160:163], a[248:251]
ds_read_b64_tr_b16 v[12:13], v96 offset:40960
v_cvt_pk_bf16_f32 v143, v170, v171
v_mfma_f32_16x16x32_bf16 a[252:255], v[16:19], v[164:167], a[252:255]
ds_read_b64_tr_b16 v[14:15], v96 offset:43008
buffer_store_dwordx4 v[140:143], v88, s[28:31], s49 offen offset:1024 sc1
v_mfma_f32_16x16x32_bf16 a[252:255], v[20:23], v[180:183], a[252:255]
ds_read_b64_tr_b16 v[16:17], v96 offset:45056
v_accvgpr_read_b32 v168, a208
v_mfma_f32_16x16x32_bf16 a[248:251], v[20:23], v[176:179], a[248:251]
ds_read_b64_tr_b16 v[18:19], v96 offset:47104
s_waitcnt lgkmcnt(4)
v_mfma_f32_16x16x32_bf16 a[224:227], v[24:27], v[192:195], a[224:227]
ds_read_b64_tr_b16 v[20:21], v97 offset:32768
v_accvgpr_read_b32 v169, a209
v_mfma_f32_16x16x32_bf16 a[228:231], v[24:27], v[196:199], a[228:231]
ds_read_b64_tr_b16 v[22:23], v97 offset:34816
v_cvt_pk_bf16_f32 v152, v168, v169
v_mfma_f32_16x16x32_bf16 a[228:231], v[28:31], v[212:215], a[228:231]
ds_read_b64_tr_b16 v[24:25], v97 offset:36864
v_accvgpr_read_b32 v170, a210
v_mfma_f32_16x16x32_bf16 a[224:227], v[28:31], v[208:211], a[224:227]
ds_read_b64_tr_b16 v[26:27], v97 offset:38912
s_waitcnt lgkmcnt(4)
v_mfma_f32_16x16x32_bf16 a[224:227], v[12:15], v[112:115], a[224:227]
ds_read_b64_tr_b16 v[28:29], v97 offset:40960
v_accvgpr_read_b32 v171, a211
v_mfma_f32_16x16x32_bf16 a[228:231], v[12:15], v[116:119], a[228:231]
ds_read_b64_tr_b16 v[30:31], v97 offset:43008
v_cvt_pk_bf16_f32 v153, v170, v171
v_accvgpr_read_b32 v168, a216
v_mfma_f32_16x16x32_bf16 a[228:231], v[16:19], v[124:127], a[228:231]
ds_read_b64_tr_b16 v[12:13], v97 offset:45056
v_accvgpr_read_b32 v169, a217
v_mfma_f32_16x16x32_bf16 a[224:227], v[16:19], v[120:123], a[224:227]
ds_read_b64_tr_b16 v[14:15], v97 offset:47104
s_waitcnt lgkmcnt(4)
v_mfma_f32_16x16x32_bf16 a[232:235], v[20:23], v[192:195], a[232:235]
ds_read_b64_tr_b16 v[16:17], v98 offset:32768
v_cvt_pk_bf16_f32 v154, v168, v169
v_mfma_f32_16x16x32_bf16 a[236:239], v[20:23], v[196:199], a[236:239]
ds_read_b64_tr_b16 v[18:19], v98 offset:34816
v_accvgpr_read_b32 v170, a218
v_accvgpr_read_b32 v171, a219
v_mfma_f32_16x16x32_bf16 a[236:239], v[24:27], v[212:215], a[236:239]
ds_read_b64_tr_b16 v[20:21], v98 offset:36864
s_waitcnt vmcnt(2)
v_mfma_f32_16x16x32_bf16 a[232:235], v[24:27], v[208:211], a[232:235]
ds_read_b64_tr_b16 v[22:23], v98 offset:38912
s_atomic_add s20, s[16:17], 0
s_waitcnt lgkmcnt(4)
v_mfma_f32_16x16x32_bf16 a[232:235], v[28:31], v[112:115], a[232:235]
ds_read_b64_tr_b16 v[24:25], v98 offset:40960
v_cvt_pk_bf16_f32 v155, v170, v171
v_mfma_f32_16x16x32_bf16 a[236:239], v[28:31], v[116:119], a[236:239]
ds_read_b64_tr_b16 v[26:27], v98 offset:43008
buffer_store_dwordx4 v[152:155], v88, s[28:31], s49 offen offset:2048 sc1
v_mfma_f32_16x16x32_bf16 a[236:239], v[12:15], v[124:127], a[236:239]
ds_read_b64_tr_b16 v[28:29], v98 offset:45056
v_accvgpr_read_b32 v168, a212
v_mfma_f32_16x16x32_bf16 a[232:235], v[12:15], v[120:123], a[232:235]
ds_read_b64_tr_b16 v[30:31], v98 offset:47104
s_waitcnt lgkmcnt(4)
v_mfma_f32_16x16x32_bf16 a[240:243], v[16:19], v[192:195], a[240:243]
ds_read_b64_tr_b16 v[12:13], v99 offset:32768
v_accvgpr_read_b32 v169, a213
v_mfma_f32_16x16x32_bf16 a[244:247], v[16:19], v[196:199], a[244:247]
ds_read_b64_tr_b16 v[14:15], v99 offset:34816
v_cvt_pk_bf16_f32 v156, v168, v169
v_mfma_f32_16x16x32_bf16 a[244:247], v[20:23], v[212:215], a[244:247]
ds_read_b64_tr_b16 v[16:17], v99 offset:36864
v_accvgpr_read_b32 v170, a214
v_mfma_f32_16x16x32_bf16 a[240:243], v[20:23], v[208:211], a[240:243]
ds_read_b64_tr_b16 v[18:19], v99 offset:38912
v_accvgpr_read_b32 v171, a215
s_waitcnt lgkmcnt(4)
v_mfma_f32_16x16x32_bf16 a[240:243], v[24:27], v[112:115], a[240:243]
ds_read_b64_tr_b16 v[20:21], v99 offset:40960
v_cvt_pk_bf16_f32 v157, v170, v171
v_mfma_f32_16x16x32_bf16 a[244:247], v[24:27], v[116:119], a[244:247]
ds_read_b64_tr_b16 v[22:23], v99 offset:43008
v_accvgpr_read_b32 v168, a220
v_mfma_f32_16x16x32_bf16 a[244:247], v[28:31], v[124:127], a[244:247]
ds_read_b64_tr_b16 v[24:25], v99 offset:45056
v_accvgpr_read_b32 v169, a221
v_mfma_f32_16x16x32_bf16 a[240:243], v[28:31], v[120:123], a[240:243]
ds_read_b64_tr_b16 v[26:27], v99 offset:47104
v_cvt_pk_bf16_f32 v158, v168, v169
s_waitcnt lgkmcnt(4)
v_mfma_f32_16x16x32_bf16 a[248:251], v[12:15], v[192:195], a[248:251]
ds_read_b64_tr_b16 v[28:29], v92 offset:49152
v_accvgpr_read_b32 v170, a222
v_mfma_f32_16x16x32_bf16 a[252:255], v[12:15], v[196:199], a[252:255]
ds_read_b64_tr_b16 v[30:31], v92 offset:51200
v_accvgpr_read_b32 v171, a223
v_mfma_f32_16x16x32_bf16 a[252:255], v[16:19], v[212:215], a[252:255]
ds_read_b64_tr_b16 v[12:13], v92 offset:53248
v_cvt_pk_bf16_f32 v159, v170, v171
v_mfma_f32_16x16x32_bf16 a[248:251], v[16:19], v[208:211], a[248:251]
ds_read_b64_tr_b16 v[14:15], v92 offset:55296
s_waitcnt lgkmcnt(4)
v_mfma_f32_16x16x32_bf16 a[248:251], v[20:23], v[112:115], a[248:251]
ds_read_b64_tr_b16 v[16:17], v92 offset:57344
buffer_store_dwordx4 v[156:159], v88, s[28:31], s49 offen offset:3072 sc1
v_mfma_f32_16x16x32_bf16 a[252:255], v[20:23], v[116:119], a[252:255]
ds_read_b64_tr_b16 v[18:19], v92 offset:59392
s_add_u32 s49, s49, 12288
v_mfma_f32_16x16x32_bf16 a[252:255], v[24:27], v[124:127], a[252:255]
ds_read_b64_tr_b16 v[20:21], v92 offset:61440
v_mfma_f32_16x16x32_bf16 a[248:251], v[24:27], v[120:123], a[248:251]
ds_read_b64_tr_b16 v[22:23], v92 offset:63488
s_waitcnt lgkmcnt(4)
v_mfma_f32_16x16x32_bf16 a[32:35], v[28:31], v[128:131], a[32:35]
ds_read_b64_tr_b16 v[24:25], v93 offset:49152
v_mfma_f32_16x16x32_bf16 a[36:39], v[28:31], v[132:135], a[36:39]
ds_read_b64_tr_b16 v[26:27], v93 offset:51200
v_mfma_f32_16x16x32_bf16 a[36:39], v[12:15], v[148:151], a[36:39]
ds_read_b64_tr_b16 v[28:29], v93 offset:53248
v_accvgpr_read_b32 v168, a224
v_mfma_f32_16x16x32_bf16 a[32:35], v[12:15], v[144:147], a[32:35]
ds_read_b64_tr_b16 v[30:31], v93 offset:55296
v_accvgpr_read_b32 v169, a225
s_waitcnt lgkmcnt(4)
v_mfma_f32_16x16x32_bf16 a[32:35], v[16:19], v[160:163], a[32:35]
ds_read_b64_tr_b16 v[12:13], v93 offset:57344
v_cvt_pk_bf16_f32 v136, v168, v169
v_mfma_f32_16x16x32_bf16 a[36:39], v[16:19], v[164:167], a[36:39]
ds_read_b64_tr_b16 v[14:15], v93 offset:59392
v_accvgpr_read_b32 v170, a226
v_mfma_f32_16x16x32_bf16 a[36:39], v[20:23], v[180:183], a[36:39]
ds_read_b64_tr_b16 v[16:17], v93 offset:61440
v_accvgpr_read_b32 v171, a227
v_mfma_f32_16x16x32_bf16 a[32:35], v[20:23], v[176:179], a[32:35]
ds_read_b64_tr_b16 v[18:19], v93 offset:63488
v_cvt_pk_bf16_f32 v137, v170, v171
s_waitcnt lgkmcnt(4)
v_mfma_f32_16x16x32_bf16 a[40:43], v[24:27], v[128:131], a[40:43]
ds_read_b64_tr_b16 v[20:21], v94 offset:49152
v_mov_b32 v8, 0
v_mfma_f32_16x16x32_bf16 a[44:47], v[24:27], v[132:135], a[44:47]
ds_read_b64_tr_b16 v[22:23], v94 offset:51200
v_accvgpr_read_b32 v168, a232
v_mfma_f32_16x16x32_bf16 a[44:47], v[28:31], v[148:151], a[44:47]
ds_read_b64_tr_b16 v[24:25], v94 offset:53248
v_accvgpr_read_b32 v169, a233
v_mfma_f32_16x16x32_bf16 a[40:43], v[28:31], v[144:147], a[40:43]
ds_read_b64_tr_b16 v[26:27], v94 offset:55296
v_cvt_pk_bf16_f32 v138, v168, v169
s_waitcnt lgkmcnt(4)
v_mfma_f32_16x16x32_bf16 a[40:43], v[12:15], v[160:163], a[40:43]
ds_read_b64_tr_b16 v[28:29], v94 offset:57344
v_accvgpr_read_b32 v170, a234
v_mfma_f32_16x16x32_bf16 a[44:47], v[12:15], v[164:167], a[44:47]
ds_read_b64_tr_b16 v[30:31], v94 offset:59392
ds_read_b32 v8, v8 offset:14336
v_mfma_f32_16x16x32_bf16 a[44:47], v[16:19], v[180:183], a[44:47]
ds_read_b64_tr_b16 v[12:13], v94 offset:61440
v_accvgpr_read_b32 v171, a235
v_mfma_f32_16x16x32_bf16 a[40:43], v[16:19], v[176:179], a[40:43]
ds_read_b64_tr_b16 v[14:15], v94 offset:63488
v_cvt_pk_bf16_f32 v139, v170, v171
s_waitcnt lgkmcnt(5)
v_mfma_f32_16x16x32_bf16 a[48:51], v[20:23], v[128:131], a[48:51]
ds_read_b64_tr_b16 v[16:17], v95 offset:49152
buffer_store_dwordx4 v[136:139], v88, s[28:31], s49 offen sc1
v_mfma_f32_16x16x32_bf16 a[52:55], v[20:23], v[132:135], a[52:55]
ds_read_b64_tr_b16 v[18:19], v95 offset:51200
v_accvgpr_read_b32 v168, a228
v_mfma_f32_16x16x32_bf16 a[52:55], v[24:27], v[148:151], a[52:55]
ds_read_b64_tr_b16 v[20:21], v95 offset:53248
v_accvgpr_read_b32 v169, a229
v_mfma_f32_16x16x32_bf16 a[48:51], v[24:27], v[144:147], a[48:51]
ds_read_b64_tr_b16 v[22:23], v95 offset:55296
s_waitcnt lgkmcnt(4)
v_mfma_f32_16x16x32_bf16 a[48:51], v[28:31], v[160:163], a[48:51]
ds_read_b64_tr_b16 v[24:25], v95 offset:57344
v_cmp_le_u32 vcc, 124, v8
v_mfma_f32_16x16x32_bf16 a[52:55], v[28:31], v[164:167], a[52:55]
ds_read_b64_tr_b16 v[26:27], v95 offset:59392
v_cvt_pk_bf16_f32 v140, v168, v169
v_accvgpr_read_b32 v170, a230
v_mfma_f32_16x16x32_bf16 a[52:55], v[12:15], v[180:183], a[52:55]
ds_read_b64_tr_b16 v[28:29], v95 offset:61440
v_accvgpr_read_b32 v171, a231
v_mfma_f32_16x16x32_bf16 a[48:51], v[12:15], v[176:179], a[48:51]
ds_read_b64_tr_b16 v[30:31], v95 offset:63488
s_waitcnt lgkmcnt(4)
v_mfma_f32_16x16x32_bf16 a[56:59], v[16:19], v[128:131], a[56:59]
s_cbranch_vccz L_sp115
L_ok115:
ds_read_b64_tr_b16 v[12:13], v100
v_mfma_f32_16x16x32_bf16 a[60:63], v[16:19], v[132:135], a[60:63]
ds_read_b64_tr_b16 v[14:15], v100 offset:2048
v_cvt_pk_bf16_f32 v141, v170, v171
v_accvgpr_read_b32 v168, a236
v_mfma_f32_16x16x32_bf16 a[60:63], v[20:23], v[148:151], a[60:63]
ds_read_b64_tr_b16 v[16:17], v100 offset:4096
v_accvgpr_read_b32 v169, a237
v_mfma_f32_16x16x32_bf16 a[56:59], v[20:23], v[144:147], a[56:59]
ds_read_b64_tr_b16 v[18:19], v100 offset:6144
s_waitcnt lgkmcnt(4)
v_mfma_f32_16x16x32_bf16 a[56:59], v[24:27], v[160:163], a[56:59]
ds_read_b64_tr_b16 v[20:21], v100 offset:8192
v_cvt_pk_bf16_f32 v142, v168, v169
v_mfma_f32_16x16x32_bf16 a[60:63], v[24:27], v[164:167], a[60:63]
ds_read_b64_tr_b16 v[22:23], v100 offset:10240
v_accvgpr_read_b32 v170, a238
v_accvgpr_read_b32 v171, a239
v_mfma_f32_16x16x32_bf16 a[60:63], v[28:31], v[180:183], a[60:63]
ds_read_b64_tr_b16 v[24:25], v100 offset:12288
v_cvt_pk_bf16_f32 v143, v170, v171
v_mfma_f32_16x16x32_bf16 a[56:59], v[28:31], v[176:179], a[56:59]
ds_read_b64_tr_b16 v[26:27], v100 offset:14336
s_waitcnt lgkmcnt(4)
v_mfma_f32_16x16x32_bf16 a[32:35], v[12:15], v[192:195], a[32:35]
ds_read_b64_tr_b16 v[28:29], v101
buffer_store_dwordx4 v[140:143], v88, s[28:31], s49 offen offset:1024 sc1
v_mfma_f32_16x16x32_bf16 a[36:39], v[12:15], v[196:199], a[36:39]
ds_read_b64_tr_b16 v[30:31], v101 offset:2048
v_accvgpr_read_b32 v168, a240
v_mfma_f32_16x16x32_bf16 a[36:39], v[16:19], v[212:215], a[36:39]
ds_read_b64_tr_b16 v[12:13], v101 offset:4096
v_accvgpr_read_b32 v169, a241
v_mfma_f32_16x16x32_bf16 a[32:35], v[16:19], v[208:211], a[32:35]
ds_read_b64_tr_b16 v[14:15], v101 offset:6144
v_cvt_pk_bf16_f32 v152, v168, v169
s_waitcnt lgkmcnt(4)
v_mfma_f32_16x16x32_bf16 a[32:35], v[20:23], v[112:115], a[32:35]
ds_read_b64_tr_b16 v[16:17], v101 offset:8192
v_accvgpr_read_b32 v170, a242
v_mfma_f32_16x16x32_bf16 a[36:39], v[20:23], v[116:119], a[36:39]
ds_read_b64_tr_b16 v[18:19], v101 offset:10240
v_accvgpr_read_b32 v171, a243
v_mfma_f32_16x16x32_bf16 a[36:39], v[24:27], v[124:127], a[36:39]
ds_read_b64_tr_b16 v[20:21], v101 offset:12288
v_cvt_pk_bf16_f32 v153, v170, v171
v_mfma_f32_16x16x32_bf16 a[32:35], v[24:27], v[120:123], a[32:35]
ds_read_b64_tr_b16 v[22:23], v101 offset:14336
v_accvgpr_read_b32 v168, a248
s_waitcnt lgkmcnt(4)
v_mfma_f32_16x16x32_bf16 a[40:43], v[28:31], v[192:195], a[40:43]
ds_read_b64_tr_b16 v[24:25], v102
v_accvgpr_read_b32 v169, a249
v_mfma_f32_16x16x32_bf16 a[44:47], v[28:31], v[196:199], a[44:47]
ds_read_b64_tr_b16 v[26:27], v102 offset:2048
v_cvt_pk_bf16_f32 v154, v168, v169
v_mfma_f32_16x16x32_bf16 a[44:47], v[12:15], v[212:215], a[44:47]
ds_read_b64_tr_b16 v[28:29], v102 offset:4096
s_waitcnt vmcnt(2)
v_mfma_f32_16x16x32_bf16 a[40:43], v[12:15], v[208:211], a[40:43]
ds_read_b64_tr_b16 v[30:31], v102 offset:6144
s_atomic_add s20, s[16:17], 128
v_accvgpr_read_b32 v170, a250
s_waitcnt lgkmcnt(4)
v_mfma_f32_16x16x32_bf16 a[40:43], v[16:19], v[112:115], a[40:43]
ds_read_b64_tr_b16 v[12:13], v102 offset:8192
v_accvgpr_read_b32 v171, a251
v_mfma_f32_16x16x32_bf16 a[44:47], v[16:19], v[116:119], a[44:47]
ds_read_b64_tr_b16 v[14:15], v102 offset:10240
v_cvt_pk_bf16_f32 v155, v170, v171
v_mfma_f32_16x16x32_bf16 a[44:47], v[20:23], v[124:127], a[44:47]
ds_read_b64_tr_b16 v[16:17], v102 offset:12288
buffer_store_dwordx4 v[152:155], v88, s[28:31], s49 offen offset:2048 sc1
v_mfma_f32_16x16x32_bf16 a[40:43], v[20:23], v[120:123], a[40:43]
ds_read_b64_tr_b16 v[18:19], v102 offset:14336
s_waitcnt lgkmcnt(4)
v_mfma_f32_16x16x32_bf16 a[48:51], v[24:27], v[192:195], a[48:51]
ds_read_b64_tr_b16 v[20:21], v103
v_accvgpr_read_b32 v168, a244
v_mfma_f32_16x16x32_bf16 a[52:55], v[24:27], v[196:199], a[52:55]
ds_read_b64_tr_b16 v[22:23], v103 offset:2048
v_accvgpr_read_b32 v169, a245
v_cvt_pk_bf16_f32 v156, v168, v169
v_mfma_f32_16x16x32_bf16 a[52:55], v[28:31], v[212:215], a[52:55]
ds_read_b64_tr_b16 v[24:25], v103 offset:4096
v_accvgpr_read_b32 v170, a246
v_mfma_f32_16x16x32_bf16 a[48:51], v[28:31], v[208:211], a[48:51]
ds_read_b64_tr_b16 v[26:27], v103 offset:6144
s_waitcnt lgkmcnt(4)
v_mfma_f32_16x16x32_bf16 a[48:51], v[12:15], v[112:115], a[48:51]
ds_read_b64_tr_b16 v[28:29], v103 offset:8192
v_accvgpr_read_b32 v171, a247
v_mfma_f32_16x16x32_bf16 a[52:55], v[12:15], v[116:119], a[52:55]
ds_read_b64_tr_b16 v[30:31], v103 offset:10240
v_cvt_pk_bf16_f32 v157, v170, v171
v_accvgpr_read_b32 v168, a252
v_mfma_f32_16x16x32_bf16 a[52:55], v[16:19], v[124:127], a[52:55]
ds_read_b64_tr_b16 v[12:13], v103 offset:12288
v_accvgpr_read_b32 v169, a253
v_mfma_f32_16x16x32_bf16 a[48:51], v[16:19], v[120:123], a[48:51]
ds_read_b64_tr_b16 v[14:15], v103 offset:14336
s_waitcnt lgkmcnt(4)
v_mfma_f32_16x16x32_bf16 a[56:59], v[20:23], v[192:195], a[56:59]
ds_read_b64_tr_b16 v[16:17], v100 offset:16384
v_cvt_pk_bf16_f32 v158, v168, v169
v_mfma_f32_16x16x32_bf16 a[60:63], v[20:23], v[196:199], a[60:63]
ds_read_b64_tr_b16 v[18:19], v100 offset:18432
v_accvgpr_read_b32 v170, a254
v_accvgpr_read_b32 v171, a255
v_mfma_f32_16x16x32_bf16 a[60:63], v[24:27], v[212:215], a[60:63]
ds_read_b64_tr_b16 v[20:21], v100 offset:20480
v_cvt_pk_bf16_f32 v159, v170, v171
v_mfma_f32_16x16x32_bf16 a[56:59], v[24:27], v[208:211], a[56:59]
ds_read_b64_tr_b16 v[22:23], v100 offset:22528
s_waitcnt lgkmcnt(4)
v_mfma_f32_16x16x32_bf16 a[56:59], v[28:31], v[112:115], a[56:59]
ds_read_b64_tr_b16 v[24:25], v100 offset:24576
buffer_store_dwordx4 v[156:159], v88, s[28:31], s49 offen offset:3072 sc1
v_mfma_f32_16x16x32_bf16 a[60:63], v[28:31], v[116:119], a[60:63]
ds_read_b64_tr_b16 v[26:27], v100 offset:26624
s_add_u32 s49, s49, 12288
v_mfma_f32_16x16x32_bf16 a[60:63], v[12:15], v[124:127], a[60:63]
ds_read_b64_tr_b16 v[28:29], v100 offset:28672
v_mfma_f32_16x16x32_bf16 a[56:59], v[12:15], v[120:123], a[56:59]
ds_read_b64_tr_b16 v[30:31], v100 offset:30720
s_waitcnt lgkmcnt(4)
v_mfma_f32_16x16x32_bf16 v[248:251], v[16:19], v[128:131], v[248:251]
ds_read_b64_tr_b16 v[12:13], v101 offset:16384
v_mfma_f32_16x16x32_bf16 v[252:255], v[16:19], v[132:135], v[252:255]
ds_read_b64_tr_b16 v[14:15], v101 offset:18432
v_mfma_f32_16x16x32_bf16 v[252:255], v[20:23], v[148:151], v[252:255]
ds_read_b64_tr_b16 v[16:17], v101 offset:20480
v_accvgpr_read_b32 v168, a32
v_mfma_f32_16x16x32_bf16 v[248:251], v[20:23], v[144:147], v[248:251]
ds_read_b64_tr_b16 v[18:19], v101 offset:22528
v_accvgpr_read_b32 v169, a33
s_waitcnt lgkmcnt(4)
v_mfma_f32_16x16x32_bf16 v[248:251], v[24:27], v[160:163], v[248:251]
ds_read_b64_tr_b16 v[20:21], v101 offset:24576
v_cvt_pk_bf16_f32 v136, v168, v169
v_mfma_f32_16x16x32_bf16 v[252:255], v[24:27], v[164:167], v[252:255]
ds_read_b64_tr_b16 v[22:23], v101 offset:26624
v_accvgpr_read_b32 v170, a34
v_mfma_f32_16x16x32_bf16 v[252:255], v[28:31], v[180:183], v[252:255]
ds_read_b64_tr_b16 v[24:25], v101 offset:28672
v_accvgpr_read_b32 v171, a35
v_mfma_f32_16x16x32_bf16 v[248:251], v[28:31], v[176:179], v[248:251]
ds_read_b64_tr_b16 v[26:27], v101 offset:30720
v_cvt_pk_bf16_f32 v137, v170, v171
s_waitcnt lgkmcnt(4)
v_mfma_f32_16x16x32_bf16 v[32:35], v[12:15], v[128:131], v[32:35]
ds_read_b64_tr_b16 v[28:29], v102 offset:16384
v_mov_b32 v8, 0
v_mfma_f32_16x16x32_bf16 v[36:39], v[12:15], v[132:135], v[36:39]
ds_read_b64_tr_b16 v[30:31], v102 offset:18432
v_accvgpr_read_b32 v168, a40
v_mfma_f32_16x16x32_bf16 v[36:39], v[16:19], v[148:151], v[36:39]
ds_read_b64_tr_b16 v[12:13], v102 offset:20480
v_accvgpr_read_b32 v169, a41
v_mfma_f32_16x16x32_bf16 v[32:35], v[16:19], v[144:147], v[32:35]
ds_read_b64_tr_b16 v[14:15], v102 offset:22528
v_cvt_pk_bf16_f32 v138, v168, v169
s_waitcnt lgkmcnt(4)
v_mfma_f32_16x16x32_bf16 v[32:35], v[20:23], v[160:163], v[32:35]
ds_read_b64_tr_b16 v[16:17], v102 offset:24576
v_accvgpr_read_b32 v170, a42
v_mfma_f32_16x16x32_bf16 v[36:39], v[20:23], v[164:167], v[36:39]
ds_read_b64_tr_b16 v[18:19], v102 offset:26624
ds_read_b32 v8, v8 offset:14336
v_mfma_f32_16x16x32_bf16 v[36:39], v[24:27], v[180:183], v[36:39]
ds_read_b64_tr_b16 v[20:21], v102 offset:28672
v_accvgpr_read_b32 v171, a43
v_mfma_f32_16x16x32_bf16 v[32:35], v[24:27], v[176:179], v[32:35]
ds_read_b64_tr_b16 v[22:23], v102 offset:30720
v_cvt_pk_bf16_f32 v139, v170, v171
s_waitcnt lgkmcnt(5)
v_mfma_f32_16x16x32_bf16 v[40:43], v[28:31], v[128:131], v[40:43]
ds_read_b64_tr_b16 v[24:25], v103 offset:16384
buffer_store_dwordx4 v[136:139], v88, s[28:31], s49 offen sc1
v_mfma_f32_16x16x32_bf16 v[44:47], v[28:31], v[132:135], v[44:47]
s_branch L_pg23
L_sp117:
v_mov_b32 v8, 0
ds_read_b32 v8, v8 offset:14336
s_waitcnt lgkmcnt(0)
v_cmp_le_u32 vcc, 127, v8
s_cbranch_vccz L_sp117
s_branch L_ok117
.p2align 12
L_stub23:
s_setpc_b64 s[94:95]
L_pg23:
ds_read_b64_tr_b16 v[26:27], v103 offset:18432
v_mfma_f32_16x16x32_bf16 v[44:47], v[12:15], v[148:151], v[44:47]
ds_read_b64_tr_b16 v[28:29], v103 offset:20480
v_accvgpr_read_b32 v168, a36
v_mfma_f32_16x16x32_bf16 v[40:43], v[12:15], v[144:147], v[40:43]
ds_read_b64_tr_b16 v[30:31], v103 offset:22528
v_accvgpr_read_b32 v169, a37
s_waitcnt lgkmcnt(4)
v_mfma_f32_16x16x32_bf16 v[40:43], v[16:19], v[160:163], v[40:43]
ds_read_b64_tr_b16 v[12:13], v103 offset:24576
v_cmp_le_u32 vcc, 127, v8
v_mfma_f32_16x16x32_bf16 v[44:47], v[16:19], v[164:167], v[44:47]
ds_read_b64_tr_b16 v[14:15], v103 offset:26624
v_cvt_pk_bf16_f32 v140, v168, v169
v_mfma_f32_16x16x32_bf16 v[44:47], v[20:23], v[180:183], v[44:47]
ds_read_b64_tr_b16 v[16:17], v103 offset:28672
v_accvgpr_read_b32 v170, a38
v_mfma_f32_16x16x32_bf16 v[40:43], v[20:23], v[176:179], v[40:43]
ds_read_b64_tr_b16 v[18:19], v103 offset:30720
v_accvgpr_read_b32 v171, a39
s_waitcnt lgkmcnt(4)
v_mfma_f32_16x16x32_bf16 v[48:51], v[24:27], v[128:131], v[48:51]
s_cbranch_vccz L_sp117
L_ok117:
ds_read_b64_tr_b16 v[20:21], v96 offset:49152
v_mfma_f32_16x16x32_bf16 v[52:55], v[24:27], v[132:135], v[52:55]
ds_read_b64_tr_b16 v[22:23], v96 offset:51200
v_cvt_pk_bf16_f32 v141, v170, v171
v_mfma_f32_16x16x32_bf16 v[52:55], v[28:31], v[148:151], v[52:55]
ds_read_b64_tr_b16 v[24:25], v96 offset:53248
v_accvgpr_read_b32 v168, a44
v_mfma_f32_16x16x32_bf16 v[48:51], v[28:31], v[144:147], v[48:51]
ds_read_b64_tr_b16 v[26:27], v96 offset:55296
v_accvgpr_read_b32 v169, a45
s_waitcnt lgkmcnt(4)
v_mfma_f32_16x16x32_bf16 v[48:51], v[12:15], v[160:163], v[48:51]
ds_read_b64_tr_b16 v[28:29], v96 offset:57344
v_cvt_pk_bf16_f32 v142, v168, v169
v_mfma_f32_16x16x32_bf16 v[52:55], v[12:15], v[164:167], v[52:55]
ds_read_b64_tr_b16 v[30:31], v96 offset:59392
v_accvgpr_read_b32 v170, a46
v_mfma_f32_16x16x32_bf16 v[52:55], v[16:19], v[180:183], v[52:55]
ds_read_b64_tr_b16 v[12:13], v96 offset:61440
v_accvgpr_read_b32 v171, a47
v_mfma_f32_16x16x32_bf16 v[48:51], v[16:19], v[176:179], v[48:51]
ds_read_b64_tr_b16 v[14:15], v96 offset:63488
v_cvt_pk_bf16_f32 v143, v170, v171
s_waitcnt lgkmcnt(4)
v_mfma_f32_16x16x32_bf16 v[248:251], v[20:23], v[192:195], v[248:251]
ds_read_b64_tr_b16 v[16:17], v97 offset:49152
buffer_store_dwordx4 v[140:143], v88, s[28:31], s49 offen offset:1024 sc1
v_mfma_f32_16x16x32_bf16 v[252:255], v[20:23], v[196:199], v[252:255]
ds_read_b64_tr_b16 v[18:19], v97 offset:51200
v_accvgpr_read_b32 v168, a48
v_mfma_f32_16x16x32_bf16 v[252:255], v[24:27], v[212:215], v[252:255]
ds_read_b64_tr_b16 v[20:21], v97 offset:53248
v_accvgpr_read_b32 v169, a49
v_mfma_f32_16x16x32_bf16 v[248:251], v[24:27], v[208:211], v[248:251]
ds_read_b64_tr_b16 v[22:23], v97 offset:55296
s_waitcnt lgkmcnt(4)
v_mfma_f32_16x16x32_bf16 v[248:251], v[28:31], v[112:115], v[248:251]
ds_read_b64_tr_b16 v[24:25], v97 offset:57344
v_cvt_pk_bf16_f32 v152, v168, v169
v_mfma_f32_16x16x32_bf16 v[252:255], v[28:31], v[116:119], v[252:255]
ds_read_b64_tr_b16 v[26:27], v97 offset:59392
v_accvgpr_read_b32 v170, a50
v_accvgpr_read_b32 v171, a51
v_mfma_f32_16x16x32_bf16 v[252:255], v[12:15], v[124:127], v[252:255]
ds_read_b64_tr_b16 v[28:29], v97 offset:61440
v_cvt_pk_bf16_f32 v153, v170, v171
v_mfma_f32_16x16x32_bf16 v[248:251], v[12:15], v[120:123], v[248:251]
ds_read_b64_tr_b16 v[30:31], v97 offset:63488
s_waitcnt lgkmcnt(4)
v_mfma_f32_16x16x32_bf16 v[32:35], v[16:19], v[192:195], v[32:35]
ds_read_b64_tr_b16 v[12:13], v98 offset:49152
v_accvgpr_read_b32 v168, a56
v_mfma_f32_16x16x32_bf16 v[36:39], v[16:19], v[196:199], v[36:39]
ds_read_b64_tr_b16 v[14:15], v98 offset:51200
v_accvgpr_read_b32 v169, a57
v_cvt_pk_bf16_f32 v154, v168, v169
v_mfma_f32_16x16x32_bf16 v[36:39], v[20:23], v[212:215], v[36:39]
ds_read_b64_tr_b16 v[16:17], v98 offset:53248
v_accvgpr_read_b32 v170, a58
v_mfma_f32_16x16x32_bf16 v[32:35], v[20:23], v[208:211], v[32:35]
ds_read_b64_tr_b16 v[18:19], v98 offset:55296
s_waitcnt lgkmcnt(4)
v_mfma_f32_16x16x32_bf16 v[32:35], v[24:27], v[112:115], v[32:35]
ds_read_b64_tr_b16 v[20:21], v98 offset:57344
v_accvgpr_read_b32 v171, a59
v_mfma_f32_16x16x32_bf16 v[36:39], v[24:27], v[116:119], v[36:39]
ds_read_b64_tr_b16 v[22:23], v98 offset:59392
v_cvt_pk_bf16_f32 v155, v170, v171
v_mfma_f32_16x16x32_bf16 v[36:39], v[28:31], v[124:127], v[36:39]
ds_read_b64_tr_b16 v[24:25], v98 offset:61440
buffer_store_dwordx4 v[152:155], v88, s[28:31], s49 offen offset:2048 sc1
v_mfma_f32_16x16x32_bf16 v[32:35], v[28:31], v[120:123], v[32:35]
ds_read_b64_tr_b16 v[26:27], v98 offset:63488
s_waitcnt lgkmcnt(4)
v_mfma_f32_16x16x32_bf16 v[40:43], v[12:15], v[192:195], v[40:43]
ds_read_b64_tr_b16 v[28:29], v99 offset:49152
v_accvgpr_read_b32 v168, a52
v_mfma_f32_16x16x32_bf16 v[44:47], v[12:15], v[196:199], v[44:47]
ds_read_b64_tr_b16 v[30:31], v99 offset:51200
v_accvgpr_read_b32 v169, a53
v_cvt_pk_bf16_f32 v156, v168, v169
v_mfma_f32_16x16x32_bf16 v[44:47], v[16:19], v[212:215], v[44:47]
ds_read_b64_tr_b16 v[12:13], v99 offset:53248
v_accvgpr_read_b32 v170, a54
v_mfma_f32_16x16x32_bf16 v[40:43], v[16:19], v[208:211], v[40:43]
ds_read_b64_tr_b16 v[14:15], v99 offset:55296
s_waitcnt lgkmcnt(4)
v_mfma_f32_16x16x32_bf16 v[40:43], v[20:23], v[112:115], v[40:43]
ds_read_b64_tr_b16 v[16:17], v99 offset:57344
v_accvgpr_read_b32 v171, a55
v_mfma_f32_16x16x32_bf16 v[44:47], v[20:23], v[116:119], v[44:47]
ds_read_b64_tr_b16 v[18:19], v99 offset:59392
v_cvt_pk_bf16_f32 v157, v170, v171
v_accvgpr_read_b32 v168, a60
v_mfma_f32_16x16x32_bf16 v[44:47], v[24:27], v[124:127], v[44:47]
ds_read_b64_tr_b16 v[20:21], v99 offset:61440
v_accvgpr_read_b32 v169, a61
v_mfma_f32_16x16x32_bf16 v[40:43], v[24:27], v[120:123], v[40:43]
ds_read_b64_tr_b16 v[22:23], v99 offset:63488
s_waitcnt lgkmcnt(4)
v_mfma_f32_16x16x32_bf16 v[48:51], v[28:31], v[192:195], v[48:51]
ds_read_b64_tr_b16 v[24:25], v96 offset:16384
v_cvt_pk_bf16_f32 v158, v168, v169
v_mfma_f32_16x16x32_bf16 v[52:55], v[28:31], v[196:199], v[52:55]
ds_read_b64_tr_b16 v[26:27], v96 offset:18432
v_accvgpr_read_b32 v170, a62
v_accvgpr_read_b32 v171, a63
v_mfma_f32_16x16x32_bf16 v[52:55], v[12:15], v[212:215], v[52:55]
ds_read_b64_tr_b16 v[28:29], v96 offset:20480
v_cvt_pk_bf16_f32 v159, v170, v171
v_mfma_f32_16x16x32_bf16 v[48:51], v[12:15], v[208:211], v[48:51]
ds_read_b64_tr_b16 v[30:31], v96 offset:22528
s_waitcnt lgkmcnt(4)
v_mfma_f32_16x16x32_bf16 v[48:51], v[16:19], v[112:115], v[48:51]
ds_read_b64_tr_b16 v[12:13], v96 offset:24576
buffer_store_dwordx4 v[156:159], v88, s[28:31], s49 offen offset:3072 sc1
v_mfma_f32_16x16x32_bf16 v[52:55], v[16:19], v[116:119], v[52:55]
ds_read_b64_tr_b16 v[14:15], v96 offset:26624
s_add_u32 s49, s49, 12288
v_mfma_f32_16x16x32_bf16 v[52:55], v[20:23], v[124:127], v[52:55]
ds_read_b64_tr_b16 v[16:17], v96 offset:28672
v_mfma_f32_16x16x32_bf16 v[48:51], v[20:23], v[120:123], v[48:51]
ds_read_b64_tr_b16 v[18:19], v96 offset:30720
s_waitcnt lgkmcnt(4)
v_mfma_f32_16x16x32_bf16 v[56:59], v[24:27], v[128:131], v[56:59]
ds_read_b64_tr_b16 v[20:21], v97 offset:16384
v_mfma_f32_16x16x32_bf16 v[60:63], v[24:27], v[132:135], v[60:63]
ds_read_b64_tr_b16 v[22:23], v97 offset:18432
v_mfma_f32_16x16x32_bf16 v[60:63], v[28:31], v[148:151], v[60:63]
ds_read_b64_tr_b16 v[24:25], v97 offset:20480
v_cvt_pk_bf16_f32 v136, v248, v249
v_mfma_f32_16x16x32_bf16 v[56:59], v[28:31], v[144:147], v[56:59]
ds_read_b64_tr_b16 v[26:27], v97 offset:22528
s_waitcnt lgkmcnt(4)
v_mfma_f32_16x16x32_bf16 v[56:59], v[12:15], v[160:163], v[56:59]
ds_read_b64_tr_b16 v[28:29], v97 offset:24576
v_cvt_pk_bf16_f32 v137, v250, v251
v_mfma_f32_16x16x32_bf16 v[60:63], v[12:15], v[164:167], v[60:63]
ds_read_b64_tr_b16 v[30:31], v97 offset:26624
v_cvt_pk_bf16_f32 v138, v32, v33
v_mfma_f32_16x16x32_bf16 v[60:63], v[16:19], v[180:183], v[60:63]
ds_read_b64_tr_b16 v[12:13], v97 offset:28672
v_cvt_pk_bf16_f32 v139, v34, v35
v_mfma_f32_16x16x32_bf16 v[56:59], v[16:19], v[176:179], v[56:59]
ds_read_b64_tr_b16 v[14:15], v97 offset:30720
s_waitcnt lgkmcnt(4)
v_mfma_f32_16x16x32_bf16 v[64:67], v[20:23], v[128:131], v[64:67]
ds_read_b64_tr_b16 v[16:17], v98 offset:16384
buffer_store_dwordx4 v[136:139], v88, s[28:31], s49 offen sc1
v_mfma_f32_16x16x32_bf16 v[68:71], v[20:23], v[132:135], v[68:71]
ds_read_b64_tr_b16 v[18:19], v98 offset:18432
v_mfma_f32_16x16x32_bf16 v[68:71], v[24:27], v[148:151], v[68:71]
ds_read_b64_tr_b16 v[20:21], v98 offset:20480
v_cvt_pk_bf16_f32 v140, v252, v253
v_mfma_f32_16x16x32_bf16 v[64:67], v[24:27], v[144:147], v[64:67]
ds_read_b64_tr_b16 v[22:23], v98 offset:22528
s_waitcnt lgkmcnt(4)
v_mfma_f32_16x16x32_bf16 v[64:67], v[28:31], v[160:163], v[64:67]
ds_read_b64_tr_b16 v[24:25], v98 offset:24576
v_cvt_pk_bf16_f32 v141, v254, v255
v_mfma_f32_16x16x32_bf16 v[68:71], v[28:31], v[164:167], v[68:71]
ds_read_b64_tr_b16 v[26:27], v98 offset:26624
v_cvt_pk_bf16_f32 v142, v36, v37
v_mfma_f32_16x16x32_bf16 v[68:71], v[12:15], v[180:183], v[68:71]
ds_read_b64_tr_b16 v[28:29], v98 offset:28672
v_cvt_pk_bf16_f32 v143, v38, v39
v_mfma_f32_16x16x32_bf16 v[64:67], v[12:15], v[176:179], v[64:67]
ds_read_b64_tr_b16 v[30:31], v98 offset:30720
s_waitcnt lgkmcnt(4)
v_mfma_f32_16x16x32_bf16 v[72:75], v[16:19], v[128:131], v[72:75]
ds_read_b64_tr_b16 v[12:13], v99 offset:16384
buffer_store_dwordx4 v[140:143], v88, s[28:31], s49 offen offset:1024 sc1
v_mfma_f32_16x16x32_bf16 v[76:79], v[16:19], v[132:135], v[76:79]
ds_read_b64_tr_b16 v[14:15], v99 offset:18432
v_mfma_f32_16x16x32_bf16 v[76:79], v[20:23], v[148:151], v[76:79]
ds_read_b64_tr_b16 v[16:17], v99 offset:20480
v_cvt_pk_bf16_f32 v152, v40, v41
v_mfma_f32_16x16x32_bf16 v[72:75], v[20:23], v[144:147], v[72:75]
ds_read_b64_tr_b16 v[18:19], v99 offset:22528
s_waitcnt lgkmcnt(4)
v_mfma_f32_16x16x32_bf16 v[72:75], v[24:27], v[160:163], v[72:75]
ds_read_b64_tr_b16 v[20:21], v99 offset:24576
v_cvt_pk_bf16_f32 v153, v42, v43
v_mfma_f32_16x16x32_bf16 v[76:79], v[24:27], v[164:167], v[76:79]
ds_read_b64_tr_b16 v[22:23], v99 offset:26624
v_cvt_pk_bf16_f32 v154, v48, v49
v_mfma_f32_16x16x32_bf16 v[76:79], v[28:31], v[180:183], v[76:79]
ds_read_b64_tr_b16 v[24:25], v99 offset:28672
v_cvt_pk_bf16_f32 v155, v50, v51
v_mfma_f32_16x16x32_bf16 v[72:75], v[28:31], v[176:179], v[72:75]
ds_read_b64_tr_b16 v[26:27], v99 offset:30720
s_waitcnt lgkmcnt(4)
v_mfma_f32_16x16x32_bf16 v[80:83], v[12:15], v[128:131], v[80:83]
ds_read_b64_tr_b16 v[28:29], v92 offset:32768
buffer_store_dwordx4 v[152:155], v88, s[28:31], s49 offen offset:2048 sc1
v_mfma_f32_16x16x32_bf16 v[84:87], v[12:15], v[132:135], v[84:87]
ds_read_b64_tr_b16 v[30:31], v92 offset:34816
v_mfma_f32_16x16x32_bf16 v[84:87], v[16:19], v[148:151], v[84:87]
ds_read_b64_tr_b16 v[12:13], v92 offset:36864
v_cvt_pk_bf16_f32 v156, v44, v45
v_mfma_f32_16x16x32_bf16 v[80:83], v[16:19], v[144:147], v[80:83]
ds_read_b64_tr_b16 v[14:15], v92 offset:38912
s_waitcnt lgkmcnt(4)
v_mfma_f32_16x16x32_bf16 v[80:83], v[20:23], v[160:163], v[80:83]
ds_read_b64_tr_b16 v[16:17], v92 offset:40960
v_cvt_pk_bf16_f32 v157, v46, v47
v_mfma_f32_16x16x32_bf16 v[84:87], v[20:23], v[164:167], v[84:87]
ds_read_b64_tr_b16 v[18:19], v92 offset:43008
v_cvt_pk_bf16_f32 v158, v52, v53
v_mfma_f32_16x16x32_bf16 v[84:87], v[24:27], v[180:183], v[84:87]
ds_read_b64_tr_b16 v[20:21], v92 offset:45056
v_cvt_pk_bf16_f32 v159, v54, v55
v_mfma_f32_16x16x32_bf16 v[80:83], v[24:27], v[176:179], v[80:83]
ds_read_b64_tr_b16 v[22:23], v92 offset:47104
s_waitcnt lgkmcnt(4)
v_mfma_f32_16x16x32_bf16 v[56:59], v[28:31], v[192:195], v[56:59]
ds_read_b64_tr_b16 v[24:25], v93 offset:32768
buffer_store_dwordx4 v[156:159], v88, s[28:31], s49 offen offset:3072 sc1
v_mfma_f32_16x16x32_bf16 v[60:63], v[28:31], v[196:199], v[60:63]
ds_read_b64_tr_b16 v[26:27], v93 offset:34816
v_mfma_f32_16x16x32_bf16 v[60:63], v[12:15], v[212:215], v[60:63]
ds_read_b64_tr_b16 v[28:29], v93 offset:36864
s_add_u32 s49, s49, 12288
v_mfma_f32_16x16x32_bf16 v[56:59], v[12:15], v[208:211], v[56:59]
ds_read_b64_tr_b16 v[30:31], v93 offset:38912
s_waitcnt lgkmcnt(4)
v_mfma_f32_16x16x32_bf16 v[56:59], v[16:19], v[112:115], v[56:59]
ds_read_b64_tr_b16 v[12:13], v93 offset:40960
v_mfma_f32_16x16x32_bf16 v[60:63], v[16:19], v[116:119], v[60:63]
ds_read_b64_tr_b16 v[14:15], v93 offset:43008
v_mfma_f32_16x16x32_bf16 v[60:63], v[20:23], v[124:127], v[60:63]
ds_read_b64_tr_b16 v[16:17], v93 offset:45056
v_mfma_f32_16x16x32_bf16 v[56:59], v[20:23], v[120:123], v[56:59]
ds_read_b64_tr_b16 v[18:19], v93 offset:47104
s_waitcnt lgkmcnt(4)
v_mfma_f32_16x16x32_bf16 v[64:67], v[24:27], v[192:195], v[64:67]
ds_read_b64_tr_b16 v[20:21], v94 offset:32768
v_mfma_f32_16x16x32_bf16 v[68:71], v[24:27], v[196:199], v[68:71]
ds_read_b64_tr_b16 v[22:23], v94 offset:34816
v_mfma_f32_16x16x32_bf16 v[68:71], v[28:31], v[212:215], v[68:71]
ds_read_b64_tr_b16 v[24:25], v94 offset:36864
v_mfma_f32_16x16x32_bf16 v[64:67], v[28:31], v[208:211], v[64:67]
ds_read_b64_tr_b16 v[26:27], v94 offset:38912
s_waitcnt lgkmcnt(4)
v_mfma_f32_16x16x32_bf16 v[64:67], v[12:15], v[112:115], v[64:67]
ds_read_b64_tr_b16 v[28:29], v94 offset:40960
v_mfma_f32_16x16x32_bf16 v[68:71], v[12:15], v[116:119], v[68:71]
ds_read_b64_tr_b16 v[30:31], v94 offset:43008
v_mfma_f32_16x16x32_bf16 v[68:71], v[16:19], v[124:127], v[68:71]
ds_read_b64_tr_b16 v[12:13], v94 offset:45056
v_mfma_f32_16x16x32_bf16 v[64:67], v[16:19], v[120:123], v[64:67]
ds_read_b64_tr_b16 v[14:15], v94 offset:47104
s_waitcnt lgkmcnt(4)
v_mfma_f32_16x16x32_bf16 v[72:75], v[20:23], v[192:195], v[72:75]
ds_read_b64_tr_b16 v[16:17], v95 offset:32768
v_mfma_f32_16x16x32_bf16 v[76:79], v[20:23], v[196:199], v[76:79]
ds_read_b64_tr_b16 v[18:19], v95 offset:34816
v_mfma_f32_16x16x32_bf16 v[76:79], v[24:27], v[212:215], v[76:79]
ds_read_b64_tr_b16 v[20:21], v95 offset:36864
v_cvt_pk_bf16_f32 v136, v56, v57
v_mfma_f32_16x16x32_bf16 v[72:75], v[24:27], v[208:211], v[72:75]
ds_read_b64_tr_b16 v[22:23], v95 offset:38912
s_waitcnt lgkmcnt(4)
v_mfma_f32_16x16x32_bf16 v[72:75], v[28:31], v[112:115], v[72:75]
ds_read_b64_tr_b16 v[24:25], v95 offset:40960
v_cvt_pk_bf16_f32 v137, v58, v59
v_mfma_f32_16x16x32_bf16 v[76:79], v[28:31], v[116:119], v[76:79]
ds_read_b64_tr_b16 v[26:27], v95 offset:43008
v_cvt_pk_bf16_f32 v138, v64, v65
v_mfma_f32_16x16x32_bf16 v[76:79], v[12:15], v[124:127], v[76:79]
ds_read_b64_tr_b16 v[28:29], v95 offset:45056
v_cvt_pk_bf16_f32 v139, v66, v67
v_mfma_f32_16x16x32_bf16 v[72:75], v[12:15], v[120:123], v[72:75]
ds_read_b64_tr_b16 v[30:31], v95 offset:47104
s_waitcnt lgkmcnt(4)
v_mfma_f32_16x16x32_bf16 v[80:83], v[16:19], v[192:195], v[80:83]
buffer_store_dwordx4 v[136:139], v88, s[28:31], s49 offen sc1
v_mfma_f32_16x16x32_bf16 v[84:87], v[16:19], v[196:199], v[84:87]
v_cvt_pk_bf16_f32 v140, v60, v61
v_cvt_pk_bf16_f32 v141, v62, v63
v_mfma_f32_16x16x32_bf16 v[84:87], v[20:23], v[212:215], v[84:87]
v_cvt_pk_bf16_f32 v142, v68, v69
v_cvt_pk_bf16_f32 v143, v70, v71
v_mfma_f32_16x16x32_bf16 v[80:83], v[20:23], v[208:211], v[80:83]
buffer_store_dwordx4 v[140:143], v88, s[28:31], s49 offen offset:1024 sc1
s_waitcnt lgkmcnt(0)
v_mfma_f32_16x16x32_bf16 v[80:83], v[24:27], v[112:115], v[80:83]
s_waitcnt vmcnt(6)
s_atomic_add s90, s[18:19], 256 glc
v_mfma_f32_16x16x32_bf16 v[84:87], v[24:27], v[116:119], v[84:87]
v_mfma_f32_16x16x32_bf16 v[84:87], v[28:31], v[124:127], v[84:87]
v_mfma_f32_16x16x32_bf16 v[80:83], v[28:31], v[120:123], v[80:83]
v_cvt_pk_bf16_f32 v152, v72, v73
v_cvt_pk_bf16_f32 v153, v74, v75
s_nop 5
v_cvt_pk_bf16_f32 v154, v80, v81
v_cvt_pk_bf16_f32 v155, v82, v83
buffer_store_dwordx4 v[152:155], v88, s[28:31], s49 offen offset:2048 sc1
v_cvt_pk_bf16_f32 v156, v76, v77
v_cvt_pk_bf16_f32 v157, v78, v79
v_cvt_pk_bf16_f32 v158, v84, v85
v_cvt_pk_bf16_f32 v159, v86, v87
buffer_store_dwordx4 v[156:159], v88, s[28:31], s49 offen offset:3072 sc1
s_add_u32 s49, s49, 12288
v_mbcnt_lo_u32_b32 v1, -1, 0
v_mbcnt_hi_u32_b32 v1, -1, v1
s_mul_i32 s7, s42, 37
s_lshr_b32 s7, s7, 8
s_mul_i32 s7, s7, 7
s_sub_u32 s13, s42, s7
s_mul_i32 s5, s47, 5248
s_add_u32 s5, s5, 22020096
s_lshl_b32 s6, s40, 7
s_lshl_b32 s7, s42, 1
s_add_u32 s6, s6, s7
s_mul_i32 s6, s6, 86016
s_mul_i32 s7, s42, 172032
s_mul_i32 s91, s40, 896
s_add_u32 s7, s7, s91
s_mov_b32 s91, 0xffff0000
s_lshl_b32 s93, s3, 7
s_add_u32 s5, s5, s93
s_lshr_b32 s93, s45, 2
s_mul_i32 s93, s93, 3
s_add_u32 s93, s93, s3
s_lshl_b32 s93, s93, 2
s_and_b32 s94, s45, 3
s_add_u32 s93, s93, s94
s_lshl_b32 s93, s93, 6
s_add_u32 s94, s93, 2304
v_add_u32 v8, s94, v1
v_lshrrev_b32 v13, 8, v8
v_mul_u32_u24 v6, 43, v13
v_lshrrev_b32 v6, 7, v6
v_mul_u32_u24 v7, 3, v6
v_sub_u32 v13, v13, v7
v_bfe_u32 v7, v8, 6, 1
v_lshl_add_u32 v13, v13, 1, v7
v_and_b32 v7, 15, v8
v_lshl_add_u32 v13, v13, 4, v7
v_mul_u32_u24 v13, 1792, v13
v_add_u32 v6, s13, v6
v_subrev_u32 v7, 7, v6
v_min_u32 v6, v6, v7
v_lshl_add_u32 v13, v6, 7, v13
v_bfe_u32 v7, v8, 7, 1
v_lshl_add_u32 v13, v7, 6, v13
v_bfe_u32 v7, v8, 4, 1
v_lshl_add_u32 v13, v7, 5, v13
v_bfe_u32 v7, v8, 5, 1
v_lshl_add_u32 v13, v7, 4, v13
v_lshlrev_b32 v10, 4, v8
s_add_u32 s94, s93, 3840
v_add_u32 v8, s94, v1
v_lshrrev_b32 v14, 8, v8
v_mul_u32_u24 v6, 43, v14
v_lshrrev_b32 v6, 7, v6
v_mul_u32_u24 v7, 3, v6
v_sub_u32 v14, v14, v7
v_bfe_u32 v7, v8, 6, 1
v_lshl_add_u32 v14, v14, 1, v7
v_and_b32 v7, 15, v8
v_lshl_add_u32 v14, v14, 4, v7
v_mul_u32_u24 v14, 1792, v14
v_add_u32 v6, s13, v6
v_subrev_u32 v7, 7, v6
v_min_u32 v6, v6, v7
v_lshl_add_u32 v14, v6, 7, v14
v_bfe_u32 v7, v8, 7, 1
v_lshl_add_u32 v14, v7, 6, v14
v_bfe_u32 v7, v8, 4, 1
v_lshl_add_u32 v14, v7, 5, v14
v_bfe_u32 v7, v8, 5, 1
v_lshl_add_u32 v14, v7, 4, v14
v_lshlrev_b32 v11, 4, v8
s_waitcnt lgkmcnt(0)
s_cmp_lt_u32 s90, 7
s_cbranch_scc1 L_tb
s_add_u32 s93, s6, 0
buffer_load_dwordx4 v[96:99], v10, s[28:31], s93 offen sc1
s_add_u32 s93, s6, 86016
buffer_load_dwordx4 v[100:103], v10, s[28:31], s93 offen sc1
s_add_u32 s93, s6, 2752512
buffer_load_dwordx4 v[104:107], v10, s[28:31], s93 offen sc1
s_add_u32 s93, s6, 2838528
buffer_load_dwordx4 v[108:111], v10, s[28:31], s93 offen sc1
s_add_u32 s93, s6, 5505024
buffer_load_dwordx4 v[112:115], v10, s[28:31], s93 offen sc1
s_add_u32 s93, s6, 5591040
buffer_load_dwordx4 v[116:119], v10, s[28:31], s93 offen sc1
s_add_u32 s93, s6, 8257536
buffer_load_dwordx4 v[120:123], v10, s[28:31], s93 offen sc1
s_add_u32 s93, s6, 8343552
buffer_load_dwordx4 v[124:127], v10, s[28:31], s93 offen sc1
s_waitcnt vmcnt(8)
s_mov_b32 s95, 1
s_atomic_add s95, s[18:19], 640 glc
s_mov_b32 s94, 7
s_branch L_tm
L_tb:
s_waitcnt vmcnt(0)
s_atomic_add s20, s[18:19], 640
s_mov_b32 s92, 0
L_sqa:
s_mov_b32 s90, 0
s_atomic_add s90, s[18:19], 256 glc
s_add_u32 s92, s92, 1
L_swa:
s_waitcnt lgkmcnt(0)
s_bitcmp1_b32 s92, 22
s_cbranch_scc1 L_sxa
s_cmp_lt_u32 s90, 8
s_cbranch_scc1 L_sqa
L_sxa:
s_add_u32 s93, s6, 0
buffer_load_dwordx4 v[96:99], v10, s[28:31], s93 offen sc1
s_add_u32 s93, s6, 86016
buffer_load_dwordx4 v[100:103], v10, s[28:31], s93 offen sc1
s_add_u32 s93, s6, 2752512
buffer_load_dwordx4 v[104:107], v10, s[28:31], s93 offen sc1
s_add_u32 s93, s6, 2838528
buffer_load_dwordx4 v[108:111], v10, s[28:31], s93 offen sc1
s_add_u32 s93, s6, 5505024
buffer_load_dwordx4 v[112:115], v10, s[28:31], s93 offen sc1
s_add_u32 s93, s6, 5591040
buffer_load_dwordx4 v[116:119], v10, s[28:31], s93 offen sc1
s_add_u32 s93, s6, 8257536
buffer_load_dwordx4 v[120:123], v10, s[28:31], s93 offen sc1
s_add_u32 s93, s6, 8343552
buffer_load_dwordx4 v[124:127], v10, s[28:31], s93 offen sc1
s_mov_b32 s95, 0
s_atomic_add s95, s[18:19], 640 glc
s_mov_b32 s94, 8
L_tm:
s_waitcnt vmcnt(0) lgkmcnt(0)
s_cmp_lt_u32 s95, s94
s_cselect_b32 s94, 1, 0
s_cbranch_scc1 L_tn
s_add_u32 s93, s6, 0
buffer_load_dwordx4 v[208:211], v11, s[28:31], s93 offen sc1
s_add_u32 s93, s6, 86016
buffer_load_dwordx4 v[212:215], v11, s[28:31], s93 offen sc1
s_add_u32 s93, s6, 2752512
buffer_load_dwordx4 v[216:219], v11, s[28:31], s93 offen sc1
s_add_u32 s93, s6, 2838528
buffer_load_dwordx4 v[220:223], v11, s[28:31], s93 offen sc1
s_add_u32 s93, s6, 5505024
buffer_load_dwordx4 v[224:227], v11, s[28:31], s93 offen sc1
s_add_u32 s93, s6, 5591040
buffer_load_dwordx4 v[228:231], v11, s[28:31], s93 offen sc1
s_add_u32 s93, s6, 8257536
buffer_load_dwordx4 v[232:235], v11, s[28:31], s93 offen sc1
s_add_u32 s93, s6, 8343552
buffer_load_dwordx4 v[236:239], v11, s[28:31], s93 offen sc1
s_branch L_ts
L_tn:
s_mov_b32 s95, 0
s_atomic_add s95, s[18:19], 640 glc
L_ts:
v_lshlrev_b32 v16, 16, v96
v_and_b32 v17, s91, v96
v_lshlrev_b32 v18, 16, v97
v_and_b32 v19, s91, v97
v_lshlrev_b32 v20, 16, v98
v_and_b32 v21, s91, v98
v_lshlrev_b32 v22, 16, v99
v_and_b32 v23, s91, v99
v_lshlrev_b32 v2, 16, v100
v_and_b32 v3, s91, v100
v_pk_add_f32 v[16:17], v[16:17], v[2:3]
v_lshlrev_b32 v6, 16, v101
v_and_b32 v7, s91, v101
v_pk_add_f32 v[18:19], v[18:19], v[6:7]
v_lshlrev_b32 v2, 16, v102
v_and_b32 v3, s91, v102
v_pk_add_f32 v[20:21], v[20:21], v[2:3]
v_lshlrev_b32 v6, 16, v103
v_and_b32 v7, s91, v103
v_pk_add_f32 v[22:23], v[22:23], v[6:7]
v_lshlrev_b32 v2, 16, v104
v_and_b32 v3, s91, v104
v_pk_add_f32 v[16:17], v[16:17], v[2:3]
v_lshlrev_b32 v6, 16, v105
v_and_b32 v7, s91, v105
v_pk_add_f32 v[18:19], v[18:19], v[6:7]
v_lshlrev_b32 v2, 16, v106
v_and_b32 v3, s91, v106
v_pk_add_f32 v[20:21], v[20:21], v[2:3]
v_lshlrev_b32 v6, 16, v107
v_and_b32 v7, s91, v107
v_pk_add_f32 v[22:23], v[22:23], v[6:7]
v_lshlrev_b32 v2, 16, v108
v_and_b32 v3, s91, v108
v_pk_add_f32 v[16:17], v[16:17], v[2:3]
v_lshlrev_b32 v6, 16, v109
v_and_b32 v7, s91, v109
v_pk_add_f32 v[18:19], v[18:19], v[6:7]
v_lshlrev_b32 v2, 16, v110
v_and_b32 v3, s91, v110
v_pk_add_f32 v[20:21], v[20:21], v[2:3]
v_lshlrev_b32 v6, 16, v111
v_and_b32 v7, s91, v111
v_pk_add_f32 v[22:23], v[22:23], v[6:7]
v_lshlrev_b32 v2, 16, v112
v_and_b32 v3, s91, v112
v_pk_add_f32 v[16:17], v[16:17], v[2:3]
v_lshlrev_b32 v6, 16, v113
v_and_b32 v7, s91, v113
v_pk_add_f32 v[18:19], v[18:19], v[6:7]
v_lshlrev_b32 v2, 16, v114
v_and_b32 v3, s91, v114
v_pk_add_f32 v[20:21], v[20:21], v[2:3]
v_lshlrev_b32 v6, 16, v115
v_and_b32 v7, s91, v115
v_pk_add_f32 v[22:23], v[22:23], v[6:7]
v_lshlrev_b32 v2, 16, v116
v_and_b32 v3, s91, v116
v_pk_add_f32 v[16:17], v[16:17], v[2:3]
v_lshlrev_b32 v6, 16, v117
v_and_b32 v7, s91, v117
v_pk_add_f32 v[18:19], v[18:19], v[6:7]
v_lshlrev_b32 v2, 16, v118
v_and_b32 v3, s91, v118
v_pk_add_f32 v[20:21], v[20:21], v[2:3]
v_lshlrev_b32 v6, 16, v119
v_and_b32 v7, s91, v119
v_pk_add_f32 v[22:23], v[22:23], v[6:7]
v_lshlrev_b32 v2, 16, v120
v_and_b32 v3, s91, v120
v_pk_add_f32 v[16:17], v[16:17], v[2:3]
v_lshlrev_b32 v6, 16, v121
v_and_b32 v7, s91, v121
v_pk_add_f32 v[18:19], v[18:19], v[6:7]
v_lshlrev_b32 v2, 16, v122
v_and_b32 v3, s91, v122
v_pk_add_f32 v[20:21], v[20:21], v[2:3]
v_lshlrev_b32 v6, 16, v123
v_and_b32 v7, s91, v123
v_pk_add_f32 v[22:23], v[22:23], v[6:7]
v_lshlrev_b32 v2, 16, v124
v_and_b32 v3, s91, v124
v_pk_add_f32 v[16:17], v[16:17], v[2:3]
v_lshlrev_b32 v6, 16, v125
v_and_b32 v7, s91, v125
v_pk_add_f32 v[18:19], v[18:19], v[6:7]
s_branch L_pg24
.p2align 12
L_stub24:
s_setpc_b64 s[94:95]
L_pg24:
v_lshlrev_b32 v2, 16, v126
v_and_b32 v3, s91, v126
v_pk_add_f32 v[20:21], v[20:21], v[2:3]
v_lshlrev_b32 v6, 16, v127
v_and_b32 v7, s91, v127
v_pk_add_f32 v[22:23], v[22:23], v[6:7]
s_nop 0
v_cvt_pk_bf16_f32 v24, v16, v17
v_cvt_pk_bf16_f32 v25, v18, v19
v_cvt_pk_bf16_f32 v26, v20, v21
v_cvt_pk_bf16_f32 v27, v22, v23
s_nop 1
v_permlane16_swap_b32 v24, v26
v_permlane16_swap_b32 v25, v27
s_cmp_eq_u32 s94, 0
s_cbranch_scc1 L_tl
s_mov_b32 s92, 0
s_branch L_swb
L_sqb:
s_mov_b32 s95, 0
s_atomic_add s95, s[18:19], 640 glc
s_add_u32 s92, s92, 1
L_swb:
s_waitcnt lgkmcnt(0)
s_bitcmp1_b32 s92, 22
s_cbranch_scc1 L_sxb
s_cmp_lt_u32 s95, 8
s_cbranch_scc1 L_sqb
L_sxb:
s_add_u32 s93, s6, 0
buffer_load_dwordx4 v[208:211], v11, s[28:31], s93 offen sc1
s_add_u32 s93, s6, 86016
buffer_load_dwordx4 v[212:215], v11, s[28:31], s93 offen sc1
s_add_u32 s93, s6, 2752512
buffer_load_dwordx4 v[216:219], v11, s[28:31], s93 offen sc1
s_add_u32 s93, s6, 2838528
buffer_load_dwordx4 v[220:223], v11, s[28:31], s93 offen sc1
s_add_u32 s93, s6, 5505024
buffer_load_dwordx4 v[224:227], v11, s[28:31], s93 offen sc1
s_add_u32 s93, s6, 5591040
buffer_load_dwordx4 v[228:231], v11, s[28:31], s93 offen sc1
s_add_u32 s93, s6, 8257536
buffer_load_dwordx4 v[232:235], v11, s[28:31], s93 offen sc1
s_add_u32 s93, s6, 8343552
buffer_load_dwordx4 v[236:239], v11, s[28:31], s93 offen sc1
L_tl:
buffer_store_dwordx4 v[24:27], v13, s[32:35], s7 offen
s_waitcnt vmcnt(8)
v_lshlrev_b32 v32, 16, v208
v_and_b32 v33, s91, v208
v_lshlrev_b32 v34, 16, v209
v_and_b32 v35, s91, v209
v_lshlrev_b32 v36, 16, v210
v_and_b32 v37, s91, v210
v_lshlrev_b32 v38, 16, v211
v_and_b32 v39, s91, v211
s_waitcnt vmcnt(7)
v_lshlrev_b32 v2, 16, v212
v_and_b32 v3, s91, v212
v_pk_add_f32 v[32:33], v[32:33], v[2:3]
v_lshlrev_b32 v6, 16, v213
v_and_b32 v7, s91, v213
v_pk_add_f32 v[34:35], v[34:35], v[6:7]
v_lshlrev_b32 v2, 16, v214
v_and_b32 v3, s91, v214
v_pk_add_f32 v[36:37], v[36:37], v[2:3]
v_lshlrev_b32 v6, 16, v215
v_and_b32 v7, s91, v215
v_pk_add_f32 v[38:39], v[38:39], v[6:7]
s_waitcnt vmcnt(6)
v_lshlrev_b32 v2, 16, v216
v_and_b32 v3, s91, v216
v_pk_add_f32 v[32:33], v[32:33], v[2:3]
v_lshlrev_b32 v6, 16, v217
v_and_b32 v7, s91, v217
v_pk_add_f32 v[34:35], v[34:35], v[6:7]
v_lshlrev_b32 v2, 16, v218
v_and_b32 v3, s91, v218
v_pk_add_f32 v[36:37], v[36:37], v[2:3]
v_lshlrev_b32 v6, 16, v219
v_and_b32 v7, s91, v219
v_pk_add_f32 v[38:39], v[38:39], v[6:7]
s_waitcnt vmcnt(5)
v_lshlrev_b32 v2, 16, v220
v_and_b32 v3, s91, v220
v_pk_add_f32 v[32:33], v[32:33], v[2:3]
v_lshlrev_b32 v6, 16, v221
v_and_b32 v7, s91, v221
v_pk_add_f32 v[34:35], v[34:35], v[6:7]
v_lshlrev_b32 v2, 16, v222
v_and_b32 v3, s91, v222
v_pk_add_f32 v[36:37], v[36:37], v[2:3]
v_lshlrev_b32 v6, 16, v223
v_and_b32 v7, s91, v223
v_pk_add_f32 v[38:39], v[38:39], v[6:7]
s_waitcnt vmcnt(4)
v_lshlrev_b32 v2, 16, v224
v_and_b32 v3, s91, v224
v_pk_add_f32 v[32:33], v[32:33], v[2:3]
v_lshlrev_b32 v6, 16, v225
v_and_b32 v7, s91, v225
v_pk_add_f32 v[34:35], v[34:35], v[6:7]
v_lshlrev_b32 v2, 16, v226
v_and_b32 v3, s91, v226
v_pk_add_f32 v[36:37], v[36:37], v[2:3]
v_lshlrev_b32 v6, 16, v227
v_and_b32 v7, s91, v227
v_pk_add_f32 v[38:39], v[38:39], v[6:7]
s_waitcnt vmcnt(3)
v_lshlrev_b32 v2, 16, v228
v_and_b32 v3, s91, v228
v_pk_add_f32 v[32:33], v[32:33], v[2:3]
v_lshlrev_b32 v6, 16, v229
v_and_b32 v7, s91, v229
v_pk_add_f32 v[34:35], v[34:35], v[6:7]
v_lshlrev_b32 v2, 16, v230
v_and_b32 v3, s91, v230
v_pk_add_f32 v[36:37], v[36:37], v[2:3]
v_lshlrev_b32 v6, 16, v231
v_and_b32 v7, s91, v231
v_pk_add_f32 v[38:39], v[38:39], v[6:7]
s_waitcnt vmcnt(2)
v_lshlrev_b32 v2, 16, v232
v_and_b32 v3, s91, v232
v_pk_add_f32 v[32:33], v[32:33], v[2:3]
v_lshlrev_b32 v6, 16, v233
v_and_b32 v7, s91, v233
v_pk_add_f32 v[34:35], v[34:35], v[6:7]
v_lshlrev_b32 v2, 16, v234
v_and_b32 v3, s91, v234
v_pk_add_f32 v[36:37], v[36:37], v[2:3]
v_lshlrev_b32 v6, 16, v235
v_and_b32 v7, s91, v235
v_pk_add_f32 v[38:39], v[38:39], v[6:7]
s_waitcnt vmcnt(1)
v_lshlrev_b32 v2, 16, v236
v_and_b32 v3, s91, v236
v_pk_add_f32 v[32:33], v[32:33], v[2:3]
v_lshlrev_b32 v6, 16, v237
v_and_b32 v7, s91, v237
v_pk_add_f32 v[34:35], v[34:35], v[6:7]
v_lshlrev_b32 v2, 16, v238
v_and_b32 v3, s91, v238
v_pk_add_f32 v[36:37], v[36:37], v[2:3]
v_lshlrev_b32 v6, 16, v239
v_and_b32 v7, s91, v239
v_pk_add_f32 v[38:39], v[38:39], v[6:7]
s_nop 0
v_cvt_pk_bf16_f32 v28, v32, v33
v_cvt_pk_bf16_f32 v29, v34, v35
v_cvt_pk_bf16_f32 v30, v36, v37
v_cvt_pk_bf16_f32 v31, v38, v39
s_nop 1
v_permlane16_swap_b32 v28, v30
v_permlane16_swap_b32 v29, v31
buffer_store_dwordx4 v[28:31], v14, s[32:35], s7 offen
s_endpgm
.p2align 7
.type L_tab,@object
L_tab:
.long 0, 1, 2, 3, 4, 5, 6, 7, 8, 9, 10, 11, 12, 13, 14, 15
.long 16, 17, 18, 19, 20, 21, 22, 23, 24, 25, 26, 27, 28, 29, 30, 31
.long 32, 33, 34, 35, 36, 37, 38, 39, 40, 41, 42, 43, 44, 45, 46, 47
.long 48, 49, 50, 51, 52, 53, 54, 55, 56, 57, 58, 59, 60, 61, 62, 63
.long 64, 65, 66, 67, 68, 69, 70, 71, 72, 73, 74, 75, 76, 77, 78, 79
.long 80, 81, 82, 83, 84, 85, 86, 87, 88, 89, 90, 91, 92, 93, 94, 95
.long 96, 97, 98, 99, 100, 101, 102, 103, 104, 105, 106, 107, 108, 109, 110, 111
.long 112, 113, 114, 115, 116, 117, 118, 119, 120, 121, 122, 123, 124, 125, 126, 127
.long 128, 129, 130, 131, 132, 133, 134, 135, 136, 137, 138, 139, 140, 141, 142, 143
.long 144, 145, 146, 147, 148, 149, 150, 151, 152, 153, 154, 155, 156, 157, 158, 159
.long 160, 161, 162, 163, 164, 165, 166, 167, 168, 169, 170, 171, 172, 173, 174, 175
.long 176, 177, 178, 179, 180, 181, 182, 183, 184, 185, 186, 187, 188, 189, 190, 191
.long 192, 193, 194, 195, 196, 197, 198, 199, 200, 201, 202, 203, 204, 205, 206, 207
.long 208, 209, 210, 211, 212, 213, 214, 215, 216, 217, 218, 219, 220, 221, 222, 223
.long 224, 225, 226, 227, 228, 229, 230, 231, 232, 233, 234, 235, 236, 237, 238, 239
.long 240, 241, 242, 243, 244, 245, 246, 247, 248, 249, 250, 251, 252, 253, 254, 255
L_code_end:
.section .rodata,"a"
.p2align 6
.amdhsa_kernel concat_heads__mha_block_cached__gqa_block_cached__near_ridge_kernel
  .amdhsa_next_free_vgpr 512
  .amdhsa_next_free_sgpr 102
  .amdhsa_accum_offset 256
  .amdhsa_group_segment_fixed_size 0
  .amdhsa_kernarg_size 104
  .amdhsa_user_sgpr_count 2
  .amdhsa_user_sgpr_kernarg_segment_ptr 1
  .amdhsa_system_sgpr_workgroup_id_x 1
  .amdhsa_float_denorm_mode_32 3
.end_amdhsa_kernel
```
